```python
import torch

def _softmax(x, axis=-1):
    return torch.softmax(x, dim=axis)
def _gelu(x):
    return torch.nn.functional.gelu(x, approximate="tanh")
def _silu(x):
    return torch.nn.functional.silu(x)
def _sigmoid(x):
    return torch.sigmoid(x)
def _layernorm(x, axis=-1, eps=1e-5):
    m = x.mean(dim=axis, keepdim=True)
    v = x.var(dim=axis, keepdim=True, unbiased=False)
    return (x - m) / torch.sqrt(v + eps)
def _scatter_add(tgt, idx, src, axis=0):
    return tgt.clone().index_add_(axis, idx, src)
def _segment_sum(src, seg, n):
    out = torch.zeros((n,) + src.shape[1:], dtype=src.dtype)
    return out.index_add_(0, seg, src)
def _pad(x, pw):
    flat = tuple(v for pair in reversed(pw) for v in pair)
    return torch.nn.functional.pad(x, flat)

kernel_name = 'gated_mix__compressed_kv_cla__glu_gated_glu__prompt'

def setup_inputs():

    _w = (lambda a: (lambda t: t.to(torch.bfloat16) if t.is_floating_point() else t)(torch.as_tensor(a)))
    def _A_setup():
        B, H, Sq, Sk, D, M = 1, 32, 2048, 2048, 128, 512
        Dc = 4 * D
        return {
            "x": _w((lambda *s: torch.randn(*s, dtype=torch.bfloat16) * 0.05)(B, Sq, M)),
            "c_kv": _w((lambda *s: torch.randn(*s, dtype=torch.bfloat16) * 0.8)(B, Sk, Dc)),
            "w_q": _w((lambda *s: torch.randn(*s, dtype=torch.bfloat16) * 6.4)(M, H, D) * (M ** -0.5)),
            "w_uk": _w((lambda *s: torch.randn(*s, dtype=torch.bfloat16) * 6.4)(Dc, H, D) * (Dc ** -0.5)),
            "w_uv": _w((lambda *s: torch.randn(*s, dtype=torch.bfloat16) * 0.8)(Dc, H, D) * (Dc ** -0.5)),
            "w_o": _w((lambda *s: torch.randn(*s, dtype=torch.bfloat16) * 0.8)(H, D, M) * ((H * D) ** -0.5)),
        }
    _A_in = _A_setup()

    def _B_setup():
        B, S, D, F = 1, 2048, 512, 1792
        return {
            "x": _w((lambda *s: torch.randn(*s, dtype=torch.bfloat16) * 0.05)(B, S, D)),
            "w_gate": _w((lambda *s: torch.randn(*s, dtype=torch.bfloat16) * 1.6)(D, F)),
            "w_up": _w((lambda *s: torch.randn(*s, dtype=torch.bfloat16) * 0.05)(D, F)),
            "w_down": _w((lambda *s: torch.randn(*s, dtype=torch.bfloat16) * 0.05)(F, D)),
        }
    _B_in = _B_setup()

    return {
        "A_x": _A_in["x"],
        "A_c_kv": _A_in["c_kv"],
        "A_w_q": _A_in["w_q"],
        "A_w_uk": _A_in["w_uk"],
        "A_w_uv": _A_in["w_uv"],
        "A_w_o": _A_in["w_o"],
        "B_x": _B_in["x"],
        "B_w_gate": _B_in["w_gate"],
        "B_w_up": _B_in["w_up"],
        "B_w_down": _B_in["w_down"],
        "gate_w": _w((lambda *s: torch.randn(*s, dtype=torch.bfloat16) * 0.05)(512) * 16.0),
    }

def reference(A_x, A_c_kv, A_w_q, A_w_uk, A_w_uv, A_w_o, B_x, B_w_gate, B_w_up, B_w_down, gate_w):
    def _A_ref(x, c_kv, w_q, w_uk, w_uv, w_o):
        B, Sq, M = x.shape[0], x.shape[1], x.shape[2]
        Sk = c_kv.shape[1]
        H, D = w_q.shape[1], w_q.shape[2]
        q = torch.einsum("bqm,mhd->bhqd", x, w_q)
        k = torch.einsum("bkc,chd->bhkd", c_kv, w_uk)
        v = torch.einsum("bkc,chd->bhkd", c_kv, w_uv)
        scores = torch.einsum("bhqd,bhkd->bhqk", q, k) * (D ** -0.5)
        off = Sk - Sq
        qi = torch.arange(Sq)[:, None]
        kj = torch.arange(Sk)[None, :]
        cmask = kj <= (qi + off)
        scores = torch.where(cmask[None, None], scores, -1e9)
        p = _softmax(scores, axis=-1)
        ctx = torch.einsum("bhqk,bhkd->bhqd", p, v)
        return torch.einsum("bhqd,hdm->bqm", ctx, w_o)

    def _B_ref(x, w_gate, w_up, w_down):
        g = torch.einsum("bsd,df->bsf", x, w_gate)
        u = torch.einsum("bsd,df->bsf", x, w_up)
        h = _sigmoid(g) * u
        return torch.einsum("bsf,fd->bsd", h, w_down)

    x = A_x
    g = _sigmoid((x * gate_w).sum(-1, keepdims=True))
    a = _A_ref(x, A_c_kv, A_w_q, A_w_uk, A_w_uv, A_w_o)
    b = _B_ref(x, B_w_gate, B_w_up, B_w_down)
    return g * a + (1 - g) * b
```

```asm
; @launch grid=(256,1,1) block=(256,1,1) lds=163840
.amdgcn_target "amdgcn-amd-amdhsa--gfx950"
.text
.globl gated_mix__compressed_kv_cla__glu_gated_glu__prompt_kernel
.p2align 8
.type gated_mix__compressed_kv_cla__glu_gated_glu__prompt_kernel,@function
gated_mix__compressed_kv_cla__glu_gated_glu__prompt_kernel:
  s_cmp_ge_u32 s2, 256
  s_cbranch_scc1 L_end
  s_load_dwordx16 s[4:19], s[0:1], 0
  s_load_dwordx8 s[20:27], s[0:1], 64
  s_load_dwordx4 s[28:31], s[0:1], 96
  v_lshrrev_b32 v148, 6, v0
  v_and_b32 v144, 63, v0
  v_readfirstlane_b32 s34, v148
  s_getpc_b64 s[88:89]
  s_lshr_b32 s35, s2, 3
  s_mul_i32 s35, s35, 3072
  v_min_u32 v158, 5, v144
  v_mad_u32_u24 v158, v148, 6, v158
  v_lshl_add_u32 v158, v158, 7, s35
  global_load_dword a0, v158, s[88:89]
  s_and_b32 s35, s2, 6
  s_lshl_b32 s35, s35, 2
  s_bfe_u32 s32, s2, 0x30003
  s_add_u32 s32, s32, s35
  s_lshr_b32 s33, s2, 6
  s_lshl_b32 s33, s33, 1
  s_and_b32 s35, s2, 1
  s_add_u32 s33, s33, s35
  s_and_b32 s34, s34, 3
  s_and_b32 s76, s34, 1
  s_lshr_b32 s77, s34, 1
  s_lshl_b32 s69, s34, 12
  v_lshrrev_b32 v145, 4, v144
  v_and_b32 v146, 15, v144
  v_lshlrev_b32 v148, 13, v145
  v_lshlrev_b32 v149, 1, v145
  v_xor_b32 v149, v149, v146
  v_xor_b32 v150, 8, v149
  v_lshl_add_u32 v22, v149, 4, v148
  v_lshl_add_u32 v150, v150, 4, v148
  v_add_u32 v23, 31744, v22
  v_add_u32 v24, 63488, v150
  v_add_u32 v25, 95232, v150
  v_lshrrev_b32 v148, 3, v144
  v_lshlrev_b32 v148, 10, v148
  v_and_b32 v149, 7, v144
  v_xor_b32 v149, v149, v145
  v_xor_b32 v150, 4, v149
  v_lshl_add_u32 v18, v149, 4, v148
  v_lshl_add_u32 v150, v150, 4, v148
  v_add_u32 v19, 7168, v150
  v_add_u32 v20, 14336, v18
  v_add_u32 v21, 21504, v150
  s_lshl_b32 s64, s33, 18
  s_lshl_b32 s35, s77, 17
  s_add_u32 s64, s64, s35
  s_lshl_b32 s35, s76, 15
  s_add_u32 s64, s64, s35
  s_add_u32 s65, s64, 65536
  s_lshl_b32 s66, s34, 17
  s_lshl_b32 s35, s32, 8
  s_add_u32 s66, s66, s35
  s_mov_b32 s67, s66
  s_mov_b32 s42, 4194304
  s_mov_b32 s43, 0x20000
  s_mov_b32 s38, 2097152
  s_mov_b32 s39, 0x20000
  s_mov_b32 s46, 4194304
  s_mov_b32 s47, 0x20000
  s_waitcnt lgkmcnt(0)
  s_mov_b32 s40, s10
  s_mov_b32 s41, s11
  s_mov_b32 s36, s6
  s_mov_b32 s37, s7
  s_mov_b32 s44, s12
  s_mov_b32 s45, s13
  s_add_u32 m0, s69, 0
  s_nop 0
  buffer_load_dwordx4 v22, s[40:43], s66 offen offset:0 sc1 lds
  buffer_load_dwordx4 v23, s[40:43], s66 offen offset:1024 sc1 lds
  buffer_load_dwordx4 v24, s[40:43], s66 offen offset:2048 sc1 lds
  buffer_load_dwordx4 v25, s[40:43], s66 offen offset:3072 sc1 lds
  s_add_u32 s66, s66, 524288
  s_add_u32 m0, s69, 16384
  s_nop 0
  buffer_load_dwordx4 v18, s[36:39], s64 offen offset:0 sc1 lds
  buffer_load_dwordx4 v19, s[36:39], s64 offen offset:1024 sc1 lds
  buffer_load_dwordx4 v20, s[36:39], s64 offen offset:2048 sc1 lds
  buffer_load_dwordx4 v21, s[36:39], s64 offen offset:3072 sc1 lds
  s_add_u32 s64, s64, 128
  s_add_u32 m0, s69, 32768
  s_nop 0
  buffer_load_dwordx4 v18, s[36:39], s65 offen offset:0 sc1 lds
  buffer_load_dwordx4 v19, s[36:39], s65 offen offset:1024 sc1 lds
  buffer_load_dwordx4 v20, s[36:39], s65 offen offset:2048 sc1 lds
  buffer_load_dwordx4 v21, s[36:39], s65 offen offset:3072 sc1 lds
  s_add_u32 s65, s65, 128
  v_lshrrev_b32 v148, 1, v146
  v_xor_b32 v148, v148, v145
  v_lshlrev_b32 v148, 4, v148
  v_lshl_add_u32 v148, v146, 7, v148
  s_lshl_b32 s35, s76, 13
  v_add_u32 v2, s35, v148
  v_xor_b32 v3, 64, v2
  v_add_u32 v4, 0x10000, v2
  v_add_u32 v5, 0x10000, v3
  v_lshrrev_b32 v148, 2, v146
  v_and_b32 v149, 3, v146
  v_lshl_add_u32 v150, v145, 3, v148
  v_and_b32 v151, 1, v145
  v_lshl_add_u32 v152, v151, 2, v148
  v_lshlrev_b32 v153, 8, v150
  v_lshl_add_u32 v153, v149, 3, v153
  s_lshl_b32 s35, s77, 2
  v_xor_b32 v152, s35, v152
  v_xor_b32 v154, 0, v152
  v_lshl_add_u32 v6, v154, 5, v153
  v_add_u32 v10, 0x10000, v6
  v_xor_b32 v154, 1, v152
  v_lshl_add_u32 v7, v154, 5, v153
  v_add_u32 v11, 0x10000, v7
  v_xor_b32 v154, 2, v152
  v_lshl_add_u32 v8, v154, 5, v153
  v_add_u32 v12, 0x10000, v8
  v_xor_b32 v154, 3, v152
  v_lshl_add_u32 v9, v154, 5, v153
  v_add_u32 v13, 0x10000, v9
  v_lshrrev_b32 v152, 1, v148
  v_lshl_add_u32 v152, v151, 1, v152
  v_lshlrev_b32 v153, 7, v150
  v_lshl_add_u32 v153, v149, 3, v153
  s_lshl_b32 s35, s77, 1
  v_xor_b32 v152, s35, v152
  v_xor_b32 v154, 0, v152
  v_lshl_add_u32 v14, v154, 5, v153
  v_add_u32 v16, 0x10000, v14
  v_xor_b32 v154, 1, v152
  v_lshl_add_u32 v15, v154, 5, v153
  v_add_u32 v17, 0x10000, v15
  v_lshrrev_b32 v148, 3, v144
  v_mul_u32_u24 v148, 3584, v148
  v_and_b32 v149, 7, v144
  v_lshlrev_b32 v150, 1, v151
  v_xor_b32 v149, v149, v150
  v_xor_b32 v150, 0, v149
  v_lshl_add_u32 v26, v150, 4, v148
  v_xor_b32 v150, 4, v149
  v_lshl_add_u32 v27, v150, 4, v148
  v_add_u32 v27, 27648, v27
  v_xor_b32 v150, 0, v149
  v_lshl_add_u32 v28, v150, 4, v148
  v_add_u32 v28, 55296, v28
  v_xor_b32 v150, 4, v149
  v_lshl_add_u32 v29, v150, 4, v148
  v_add_u32 v29, 82944, v29
  v_lshlrev_b32 v30, 4, v144
  s_mov_b32 s48, s30
  s_mov_b32 s49, s31
  s_mov_b32 s50, 75497472
  s_mov_b32 s51, 0x20000
  s_mov_b32 s52, s28
  s_mov_b32 s53, s29
  s_mov_b32 s54, 256
  s_mov_b32 s55, 0x20000
  s_mov_b64 exec, 0
  s_cmp_eq_u32 s34, 0
  s_cbranch_scc1 L_pg0
  s_cmp_eq_u32 s34, 1
  s_cbranch_scc1 L_pg1
  s_cmp_eq_u32 s34, 2
  s_cbranch_scc1 L_pg2
  s_branch L_pg3
L_walk1:
  s_mov_b64 exec, -1
  s_add_u32 m0, s69, 49152
  s_nop 0
  buffer_load_dwordx4 v22, s[44:47], s67 offen offset:0 sc1 lds
  buffer_load_dwordx4 v23, s[44:47], s67 offen offset:1024 sc1 lds
  buffer_load_dwordx4 v24, s[44:47], s67 offen offset:2048 sc1 lds
  buffer_load_dwordx4 v25, s[44:47], s67 offen offset:3072 sc1 lds
  s_add_u32 s67, s67, 524288
  s_waitcnt vmcnt(8) lgkmcnt(0)
  s_barrier
  ds_read_b64_tr_b16 v[32:33], v6 offset:0
  ds_read_b64_tr_b16 v[34:35], v6 offset:1024
  ds_read_b64_tr_b16 v[36:37], v6 offset:8192
  ds_read_b64_tr_b16 v[38:39], v6 offset:9216
  ds_read_b128 v[64:67], v2 offset:16384
  ds_read_b128 v[68:71], v3 offset:16384
  ds_read_b64_tr_b16 v[40:41], v7 offset:0
  ds_read_b64_tr_b16 v[42:43], v7 offset:1024
  ds_read_b64_tr_b16 v[44:45], v7 offset:8192
  ds_read_b64_tr_b16 v[46:47], v7 offset:9216
  ds_read_b128 v[72:75], v2 offset:18432
  ds_read_b128 v[76:79], v3 offset:18432
  ds_read_b128 v[80:83], v2 offset:20480
  ds_read_b128 v[84:87], v3 offset:20480
  s_waitcnt lgkmcnt(9)
  v_mfma_f32_16x16x32_bf16 v[128:131], v[32:35], v[64:67], 0
  ds_read_b128 v[88:91], v2 offset:22528
  ds_read_b128 v[92:95], v3 offset:22528
  s_waitcnt lgkmcnt(10)
  v_mfma_f32_16x16x32_bf16 v[128:131], v[36:39], v[68:71], v[128:131]
  ds_read_b64_tr_b16 v[48:49], v8 offset:0
  ds_read_b64_tr_b16 v[50:51], v8 offset:1024
  s_waitcnt lgkmcnt(10)
  v_mfma_f32_16x16x32_bf16 v[132:135], v[40:43], v[64:67], 0
  ds_read_b64_tr_b16 v[52:53], v8 offset:8192
  ds_read_b64_tr_b16 v[54:55], v8 offset:9216
  s_waitcnt lgkmcnt(10)
  v_mfma_f32_16x16x32_bf16 v[132:135], v[44:47], v[68:71], v[132:135]
  ds_read_b64_tr_b16 v[56:57], v9 offset:0
  ds_read_b64_tr_b16 v[58:59], v9 offset:1024
  s_waitcnt lgkmcnt(11)
  v_mfma_f32_16x16x32_bf16 v[140:143], v[40:43], v[72:75], 0
  ds_read_b64_tr_b16 v[60:61], v9 offset:8192
  ds_read_b64_tr_b16 v[62:63], v9 offset:9216
  s_waitcnt lgkmcnt(12)
  v_mfma_f32_16x16x32_bf16 v[140:143], v[44:47], v[76:79], v[140:143]
  v_mfma_f32_16x16x32_bf16 v[136:139], v[32:35], v[72:75], 0
  s_add_u32 m0, s69, 81920
  v_mfma_f32_16x16x32_bf16 v[136:139], v[36:39], v[76:79], v[136:139]
  buffer_load_dwordx4 v18, s[36:39], s64 offen offset:0 sc1 lds
  s_waitcnt lgkmcnt(11)
  v_mfma_f32_16x16x32_bf16 v[144:147], v[32:35], v[80:83], 0
  s_waitcnt lgkmcnt(10)
  v_mfma_f32_16x16x32_bf16 v[144:147], v[36:39], v[84:87], v[144:147]
  buffer_load_dwordx4 v19, s[36:39], s64 offen offset:1024 sc1 lds
  v_mfma_f32_16x16x32_bf16 v[148:151], v[40:43], v[80:83], 0
  v_mfma_f32_16x16x32_bf16 v[148:151], v[44:47], v[84:87], v[148:151]
  buffer_load_dwordx4 v20, s[36:39], s64 offen offset:2048 sc1 lds
  s_waitcnt lgkmcnt(9)
  v_mfma_f32_16x16x32_bf16 v[156:159], v[40:43], v[88:91], 0
  s_waitcnt lgkmcnt(8)
  v_mfma_f32_16x16x32_bf16 v[156:159], v[44:47], v[92:95], v[156:159]
  buffer_load_dwordx4 v21, s[36:39], s64 offen offset:3072 sc1 lds
  v_mfma_f32_16x16x32_bf16 v[152:155], v[32:35], v[88:91], 0
  s_waitcnt lgkmcnt(0)
  v_mfma_f32_16x16x32_bf16 v[152:155], v[36:39], v[92:95], v[152:155]
  v_mfma_f32_16x16x32_bf16 v[192:195], v[48:51], v[64:67], 0
  s_add_u32 s64, s64, 128
  v_mfma_f32_16x16x32_bf16 v[192:195], v[52:55], v[68:71], v[192:195]
  s_waitcnt vmcnt(8)
  s_barrier
  v_mfma_f32_16x16x32_bf16 v[196:199], v[56:59], v[64:67], 0
  ds_read_b128 v[96:99], v2 offset:32768
  v_mfma_f32_16x16x32_bf16 v[196:199], v[60:63], v[68:71], v[196:199]
  s_add_u32 m0, s69, 98304
  ds_read_b128 v[100:103], v3 offset:32768
  v_mfma_f32_16x16x32_bf16 v[204:207], v[56:59], v[72:75], 0
  ds_read_b128 v[104:107], v2 offset:34816
  v_mfma_f32_16x16x32_bf16 v[204:207], v[60:63], v[76:79], v[204:207]
  ds_read_b128 v[108:111], v3 offset:34816
  v_mfma_f32_16x16x32_bf16 v[200:203], v[48:51], v[72:75], 0
  ds_read_b128 v[112:115], v2 offset:36864
  v_mfma_f32_16x16x32_bf16 v[200:203], v[52:55], v[76:79], v[200:203]
  ds_read_b128 v[116:119], v3 offset:36864
  v_mfma_f32_16x16x32_bf16 v[208:211], v[48:51], v[80:83], 0
  ds_read_b128 v[120:123], v2 offset:38912
  v_mfma_f32_16x16x32_bf16 v[208:211], v[52:55], v[84:87], v[208:211]
  ds_read_b128 v[124:127], v3 offset:38912
  v_mfma_f32_16x16x32_bf16 v[212:215], v[56:59], v[80:83], 0
  buffer_load_dwordx4 v18, s[36:39], s65 offen offset:0 sc1 lds
  v_mfma_f32_16x16x32_bf16 v[212:215], v[60:63], v[84:87], v[212:215]
  buffer_load_dwordx4 v19, s[36:39], s65 offen offset:1024 sc1 lds
  v_mfma_f32_16x16x32_bf16 v[220:223], v[56:59], v[88:91], 0
  buffer_load_dwordx4 v20, s[36:39], s65 offen offset:2048 sc1 lds
  v_mfma_f32_16x16x32_bf16 v[220:223], v[60:63], v[92:95], v[220:223]
  buffer_load_dwordx4 v21, s[36:39], s65 offen offset:3072 sc1 lds
  v_mfma_f32_16x16x32_bf16 v[216:219], v[48:51], v[88:91], 0
  s_add_u32 s65, s65, 128
  v_mfma_f32_16x16x32_bf16 v[216:219], v[52:55], v[92:95], v[216:219]
  s_waitcnt lgkmcnt(2)
  v_mfma_f32_16x16x32_bf16 v[160:163], v[32:35], v[96:99], 0
  v_mfma_f32_16x16x32_bf16 v[160:163], v[36:39], v[100:103], v[160:163]
  s_add_u32 m0, s69, 65536
  v_mfma_f32_16x16x32_bf16 v[164:167], v[40:43], v[96:99], 0
  v_mfma_f32_16x16x32_bf16 v[164:167], v[44:47], v[100:103], v[164:167]
  buffer_load_dwordx4 v22, s[40:43], s66 offen offset:0 sc1 lds
  v_mfma_f32_16x16x32_bf16 v[172:175], v[40:43], v[104:107], 0
  v_mfma_f32_16x16x32_bf16 v[172:175], v[44:47], v[108:111], v[172:175]
  v_mfma_f32_16x16x32_bf16 v[168:171], v[32:35], v[104:107], 0
  buffer_load_dwordx4 v23, s[40:43], s66 offen offset:1024 sc1 lds
  v_mfma_f32_16x16x32_bf16 v[168:171], v[36:39], v[108:111], v[168:171]
  v_mfma_f32_16x16x32_bf16 v[176:179], v[32:35], v[112:115], 0
  buffer_load_dwordx4 v24, s[40:43], s66 offen offset:2048 sc1 lds
  v_mfma_f32_16x16x32_bf16 v[176:179], v[36:39], v[116:119], v[176:179]
  v_mfma_f32_16x16x32_bf16 v[180:183], v[40:43], v[112:115], 0
  v_mfma_f32_16x16x32_bf16 v[180:183], v[44:47], v[116:119], v[180:183]
  buffer_load_dwordx4 v25, s[40:43], s66 offen offset:3072 sc1 lds
  s_waitcnt lgkmcnt(1)
  v_mfma_f32_16x16x32_bf16 v[188:191], v[40:43], v[120:123], 0
  s_waitcnt lgkmcnt(0)
  v_mfma_f32_16x16x32_bf16 v[188:191], v[44:47], v[124:127], v[188:191]
  s_add_u32 s66, s66, 524288
  v_mfma_f32_16x16x32_bf16 v[184:187], v[32:35], v[120:123], 0
  v_mfma_f32_16x16x32_bf16 v[184:187], v[36:39], v[124:127], v[184:187]
  s_waitcnt vmcnt(12) lgkmcnt(0)
  s_barrier
  s_lshl_b32 s35, s2, 2
  s_add_u32 s35, s35, s34
  s_cmp_eq_u32 s35, 224
  s_cbranch_scc1 L_tagl
L_tagl_r:
  v_mfma_f32_16x16x32_bf16 v[224:227], v[48:51], v[96:99], 0
  ds_read_b64_tr_b16 v[32:33], v6 offset:49152
  ds_read_b64_tr_b16 v[34:35], v6 offset:50176
  v_mfma_f32_16x16x32_bf16 v[224:227], v[52:55], v[100:103], v[224:227]
  ds_read_b64_tr_b16 v[36:37], v6 offset:57344
  ds_read_b64_tr_b16 v[38:39], v6 offset:58368
  v_mfma_f32_16x16x32_bf16 v[228:231], v[56:59], v[96:99], 0
  ds_read_b64_tr_b16 v[40:41], v7 offset:49152
  ds_read_b64_tr_b16 v[42:43], v7 offset:50176
  v_mfma_f32_16x16x32_bf16 v[228:231], v[60:63], v[100:103], v[228:231]
  ds_read_b64_tr_b16 v[44:45], v7 offset:57344
  ds_read_b64_tr_b16 v[46:47], v7 offset:58368
  v_mfma_f32_16x16x32_bf16 v[236:239], v[56:59], v[104:107], 0
  v_mfma_f32_16x16x32_bf16 v[236:239], v[60:63], v[108:111], v[236:239]
  s_add_u32 m0, s69, 114688
  v_mfma_f32_16x16x32_bf16 v[232:235], v[48:51], v[104:107], 0
  buffer_load_dwordx4 v22, s[44:47], s67 offen offset:0 sc1 lds
  v_mfma_f32_16x16x32_bf16 v[232:235], v[52:55], v[108:111], v[232:235]
  v_mfma_f32_16x16x32_bf16 v[240:243], v[48:51], v[112:115], 0
  buffer_load_dwordx4 v23, s[44:47], s67 offen offset:1024 sc1 lds
  v_mfma_f32_16x16x32_bf16 v[240:243], v[52:55], v[116:119], v[240:243]
  v_mfma_f32_16x16x32_bf16 v[244:247], v[56:59], v[112:115], 0
  buffer_load_dwordx4 v24, s[44:47], s67 offen offset:2048 sc1 lds
  v_mfma_f32_16x16x32_bf16 v[244:247], v[60:63], v[116:119], v[244:247]
  v_mfma_f32_16x16x32_bf16 v[252:255], v[56:59], v[120:123], 0
  v_mfma_f32_16x16x32_bf16 v[252:255], v[60:63], v[124:127], v[252:255]
  buffer_load_dwordx4 v25, s[44:47], s67 offen offset:3072 sc1 lds
  v_mfma_f32_16x16x32_bf16 v[248:251], v[48:51], v[120:123], 0
  s_waitcnt lgkmcnt(0)
  v_mfma_f32_16x16x32_bf16 v[248:251], v[52:55], v[124:127], v[248:251]
  s_add_u32 s67, s67, 524288
  v_mfma_f32_16x16x32_bf16 a[128:131], v[64:67], v[32:35], 0
  s_add_u32 m0, s69, 16384
  ds_read_b64_tr_b16 v[48:49], v8 offset:49152
  s_lshl_b32 s35, s32, 19
  v_mfma_f32_16x16x32_bf16 a[128:131], v[68:71], v[36:39], a[128:131]
  buffer_load_dwordx4 v18, s[36:39], s64 offen offset:0 sc1 lds
  v_mfma_f32_16x16x32_bf16 a[160:163], v[64:67], v[40:43], 0
  s_lshl_b32 s72, s33, 16
  ds_read_b64_tr_b16 v[50:51], v8 offset:50176
  v_mfma_f32_16x16x32_bf16 a[160:163], v[68:71], v[44:47], a[160:163]
  s_add_u32 s35, s35, s72
  v_mfma_f32_16x16x32_bf16 a[164:167], v[72:75], v[40:43], 0
  s_lshl_b32 s72, s76, 15
  ds_read_b64_tr_b16 v[52:53], v8 offset:57344
  v_mfma_f32_16x16x32_bf16 a[164:167], v[76:79], v[44:47], a[164:167]
  buffer_load_dwordx4 v19, s[36:39], s64 offen offset:1024 sc1 lds
  v_mfma_f32_16x16x32_bf16 a[132:135], v[72:75], v[32:35], 0
  s_add_u32 s35, s35, s72
  ds_read_b64_tr_b16 v[54:55], v8 offset:58368
  v_mfma_f32_16x16x32_bf16 a[132:135], v[76:79], v[36:39], a[132:135]
  s_lshl_b32 s72, s77, 12
  v_mfma_f32_16x16x32_bf16 a[136:139], v[80:83], v[32:35], 0
  s_add_u32 s68, s35, s72
  ds_read_b64_tr_b16 v[56:57], v9 offset:49152
  v_mfma_f32_16x16x32_bf16 a[136:139], v[84:87], v[36:39], a[136:139]
  buffer_load_dwordx4 v20, s[36:39], s64 offen offset:2048 sc1 lds
  v_mfma_f32_16x16x32_bf16 a[168:171], v[80:83], v[40:43], 0
  s_add_u32 s99, s68, 16777216
  ds_read_b64_tr_b16 v[58:59], v9 offset:50176
  v_mfma_f32_16x16x32_bf16 a[168:171], v[84:87], v[44:47], a[168:171]
  s_lshr_b32 s35, s32, 3
  v_mfma_f32_16x16x32_bf16 a[172:175], v[88:91], v[40:43], 0
  s_mul_i32 s71, s35, 7
  ds_read_b64_tr_b16 v[60:61], v9 offset:57344
  v_mfma_f32_16x16x32_bf16 a[172:175], v[92:95], v[44:47], a[172:175]
  buffer_load_dwordx4 v21, s[36:39], s64 offen offset:3072 sc1 lds
  v_mfma_f32_16x16x32_bf16 a[140:143], v[88:91], v[32:35], 0
  s_and_b32 s72, s32, 7
  ds_read_b64_tr_b16 v[62:63], v9 offset:58368
  v_mfma_f32_16x16x32_bf16 a[140:143], v[92:95], v[36:39], a[140:143]
  s_add_u32 s64, s64, 128
  s_add_u32 s73, s72, 1
  v_mfma_f32_16x16x32_bf16 a[144:147], v[96:99], v[32:35], 0
  s_add_u32 m0, s69, 32768
  s_lshr_b32 s73, s73, 3
  v_mfma_f32_16x16x32_bf16 a[144:147], v[100:103], v[36:39], a[144:147]
  buffer_load_dwordx4 v18, s[36:39], s65 offen offset:0 sc1 lds
  v_mfma_f32_16x16x32_bf16 a[176:179], v[96:99], v[40:43], 0
  s_xor_b32 s98, s73, 1
  v_mfma_f32_16x16x32_bf16 a[176:179], v[100:103], v[44:47], a[176:179]
  s_min_u32 s72, s72, 6
  v_mfma_f32_16x16x32_bf16 a[180:183], v[104:107], v[40:43], 0
  s_add_u32 s71, s71, s72
  v_mfma_f32_16x16x32_bf16 a[180:183], v[108:111], v[44:47], a[180:183]
  buffer_load_dwordx4 v19, s[36:39], s65 offen offset:1024 sc1 lds
  v_mfma_f32_16x16x32_bf16 a[148:151], v[104:107], v[32:35], 0
  s_and_b32 s35, s32, 7
  v_mfma_f32_16x16x32_bf16 a[148:151], v[108:111], v[36:39], a[148:151]
  s_lshl_b32 s72, s33, 3
  v_mfma_f32_16x16x32_bf16 a[152:155], v[112:115], v[32:35], 0
  s_add_u32 s35, s35, s72
  v_mfma_f32_16x16x32_bf16 a[152:155], v[116:119], v[36:39], a[152:155]
  buffer_load_dwordx4 v20, s[36:39], s65 offen offset:2048 sc1 lds
  v_mfma_f32_16x16x32_bf16 a[184:187], v[112:115], v[40:43], 0
  s_lshl_b32 s35, s35, 17
  v_mfma_f32_16x16x32_bf16 a[184:187], v[116:119], v[44:47], a[184:187]
  s_lshl_b32 s72, s34, 11
  v_mfma_f32_16x16x32_bf16 a[188:191], v[120:123], v[40:43], 0
  s_add_u32 s35, s35, s72
  v_mfma_f32_16x16x32_bf16 a[188:191], v[124:127], v[44:47], a[188:191]
  buffer_load_dwordx4 v21, s[36:39], s65 offen offset:3072 sc1 lds
  v_mfma_f32_16x16x32_bf16 a[156:159], v[120:123], v[32:35], 0
  s_add_u32 s65, s65, 128
  s_add_u32 s3, s35, 58720256
  v_mfma_f32_16x16x32_bf16 a[156:159], v[124:127], v[36:39], a[156:159]
  s_waitcnt vmcnt(12) lgkmcnt(0)
  s_barrier
  s_branch L_main
.p2align 12
L_pg0:
  s_cbranch_execz L_pg4
L_main:
  v_mfma_f32_16x16x32_bf16 a[192:195], v[64:67], v[48:51], 0
  ds_read_b64_tr_b16 v[32:33], v10 offset:0
  ds_read_b64_tr_b16 v[34:35], v10 offset:1024
  v_mfma_f32_16x16x32_bf16 a[192:195], v[68:71], v[52:55], a[192:195]
  ds_read_b64_tr_b16 v[36:37], v10 offset:8192
  ds_read_b64_tr_b16 v[38:39], v10 offset:9216
  v_mfma_f32_16x16x32_bf16 a[224:227], v[64:67], v[56:59], 0
  ds_read_b64_tr_b16 v[40:41], v11 offset:0
  ds_read_b64_tr_b16 v[42:43], v11 offset:1024
  v_mfma_f32_16x16x32_bf16 a[224:227], v[68:71], v[60:63], a[224:227]
  ds_read_b128 v[64:67], v4 offset:16384
  v_mfma_f32_16x16x32_bf16 a[228:231], v[72:75], v[56:59], 0
  s_add_u32 m0, s69, 0
  ds_read_b128 v[68:71], v5 offset:16384
  v_mfma_f32_16x16x32_bf16 a[228:231], v[76:79], v[60:63], a[228:231]
  ds_read_b64_tr_b16 v[44:45], v11 offset:8192
  ds_read_b64_tr_b16 v[46:47], v11 offset:9216
  v_mfma_f32_16x16x32_bf16 a[196:199], v[72:75], v[48:51], 0
  buffer_load_dwordx4 v22, s[40:43], s66 offen offset:0 sc1 lds
  v_mfma_f32_16x16x32_bf16 a[196:199], v[76:79], v[52:55], a[196:199]
  ds_read_b128 v[72:75], v4 offset:18432
  v_mfma_f32_16x16x32_bf16 a[200:203], v[80:83], v[48:51], 0
  ds_read_b128 v[76:79], v5 offset:18432
  v_mfma_f32_16x16x32_bf16 a[200:203], v[84:87], v[52:55], a[200:203]
  v_mfma_f32_16x16x32_bf16 a[232:235], v[80:83], v[56:59], 0
  v_mfma_f32_16x16x32_bf16 a[232:235], v[84:87], v[60:63], a[232:235]
  ds_read_b128 v[80:83], v4 offset:20480
  v_mfma_f32_16x16x32_bf16 a[236:239], v[88:91], v[56:59], 0
  ds_read_b128 v[84:87], v5 offset:20480
  v_mfma_f32_16x16x32_bf16 a[236:239], v[92:95], v[60:63], a[236:239]
  buffer_load_dwordx4 v23, s[40:43], s66 offen offset:1024 sc1 lds
  v_mfma_f32_16x16x32_bf16 a[204:207], v[88:91], v[48:51], 0
  v_mfma_f32_16x16x32_bf16 a[204:207], v[92:95], v[52:55], a[204:207]
  ds_read_b128 v[88:91], v4 offset:22528
  v_mfma_f32_16x16x32_bf16 a[208:211], v[96:99], v[48:51], 0
  ds_read_b128 v[92:95], v5 offset:22528
  v_mfma_f32_16x16x32_bf16 a[208:211], v[100:103], v[52:55], a[208:211]
  v_mfma_f32_16x16x32_bf16 a[240:243], v[96:99], v[56:59], 0
  v_mfma_f32_16x16x32_bf16 a[240:243], v[100:103], v[60:63], a[240:243]
  ds_read_b128 v[96:99], v4 offset:32768
  v_mfma_f32_16x16x32_bf16 a[244:247], v[104:107], v[56:59], 0
  ds_read_b128 v[100:103], v5 offset:32768
  v_mfma_f32_16x16x32_bf16 a[244:247], v[108:111], v[60:63], a[244:247]
  buffer_load_dwordx4 v24, s[40:43], s66 offen offset:2048 sc1 lds
  v_mfma_f32_16x16x32_bf16 a[212:215], v[104:107], v[48:51], 0
  v_mfma_f32_16x16x32_bf16 a[212:215], v[108:111], v[52:55], a[212:215]
  ds_read_b128 v[104:107], v4 offset:34816
  v_mfma_f32_16x16x32_bf16 a[216:219], v[112:115], v[48:51], 0
  ds_read_b128 v[108:111], v5 offset:34816
  v_mfma_f32_16x16x32_bf16 a[216:219], v[116:119], v[52:55], a[216:219]
  v_mfma_f32_16x16x32_bf16 a[248:251], v[112:115], v[56:59], 0
  v_mfma_f32_16x16x32_bf16 a[248:251], v[116:119], v[60:63], a[248:251]
  ds_read_b128 v[112:115], v4 offset:36864
  v_mfma_f32_16x16x32_bf16 a[252:255], v[120:123], v[56:59], 0
  ds_read_b128 v[116:119], v5 offset:36864
  v_mfma_f32_16x16x32_bf16 a[252:255], v[124:127], v[60:63], a[252:255]
  buffer_load_dwordx4 v25, s[40:43], s66 offen offset:3072 sc1 lds
  v_mfma_f32_16x16x32_bf16 a[220:223], v[120:123], v[48:51], 0
  s_add_u32 s66, s66, 524288
  v_mfma_f32_16x16x32_bf16 a[220:223], v[124:127], v[52:55], a[220:223]
  s_waitcnt lgkmcnt(6)
  ds_read_b128 v[120:123], v4 offset:38912
  ds_read_b128 v[124:127], v5 offset:38912
  v_mfma_f32_16x16x32_bf16 v[128:131], v[32:35], v[64:67], v[128:131]
  ds_read_b64_tr_b16 v[48:49], v12 offset:0
  v_mfma_f32_16x16x32_bf16 v[128:131], v[36:39], v[68:71], v[128:131]
  v_mfma_f32_16x16x32_bf16 v[132:135], v[40:43], v[64:67], v[132:135]
  s_add_u32 m0, s69, 49152
  ds_read_b64_tr_b16 v[50:51], v12 offset:1024
  v_mfma_f32_16x16x32_bf16 v[132:135], v[44:47], v[68:71], v[132:135]
  buffer_load_dwordx4 v22, s[44:47], s67 offen offset:0 sc1 lds
  v_mfma_f32_16x16x32_bf16 v[140:143], v[40:43], v[72:75], v[140:143]
  ds_read_b64_tr_b16 v[52:53], v12 offset:8192
  v_mfma_f32_16x16x32_bf16 v[140:143], v[44:47], v[76:79], v[140:143]
  v_mfma_f32_16x16x32_bf16 v[136:139], v[32:35], v[72:75], v[136:139]
  ds_read_b64_tr_b16 v[54:55], v12 offset:9216
  v_mfma_f32_16x16x32_bf16 v[136:139], v[36:39], v[76:79], v[136:139]
  v_mfma_f32_16x16x32_bf16 v[144:147], v[32:35], v[80:83], v[144:147]
  ds_read_b64_tr_b16 v[56:57], v13 offset:0
  v_mfma_f32_16x16x32_bf16 v[144:147], v[36:39], v[84:87], v[144:147]
  v_mfma_f32_16x16x32_bf16 v[148:151], v[40:43], v[80:83], v[148:151]
  ds_read_b64_tr_b16 v[58:59], v13 offset:1024
  v_mfma_f32_16x16x32_bf16 v[148:151], v[44:47], v[84:87], v[148:151]
  buffer_load_dwordx4 v23, s[44:47], s67 offen offset:1024 sc1 lds
  v_mfma_f32_16x16x32_bf16 v[156:159], v[40:43], v[88:91], v[156:159]
  ds_read_b64_tr_b16 v[60:61], v13 offset:8192
  v_mfma_f32_16x16x32_bf16 v[156:159], v[44:47], v[92:95], v[156:159]
  v_mfma_f32_16x16x32_bf16 v[152:155], v[32:35], v[88:91], v[152:155]
  ds_read_b64_tr_b16 v[62:63], v13 offset:9216
  v_mfma_f32_16x16x32_bf16 v[152:155], v[36:39], v[92:95], v[152:155]
  s_waitcnt lgkmcnt(8)
  v_mfma_f32_16x16x32_bf16 v[160:163], v[32:35], v[96:99], v[160:163]
  v_mfma_f32_16x16x32_bf16 v[160:163], v[36:39], v[100:103], v[160:163]
  v_mfma_f32_16x16x32_bf16 v[164:167], v[40:43], v[96:99], v[164:167]
  v_mfma_f32_16x16x32_bf16 v[164:167], v[44:47], v[100:103], v[164:167]
  buffer_load_dwordx4 v24, s[44:47], s67 offen offset:2048 sc1 lds
  v_mfma_f32_16x16x32_bf16 v[172:175], v[40:43], v[104:107], v[172:175]
  v_mfma_f32_16x16x32_bf16 v[172:175], v[44:47], v[108:111], v[172:175]
  v_mfma_f32_16x16x32_bf16 v[168:171], v[32:35], v[104:107], v[168:171]
  v_mfma_f32_16x16x32_bf16 v[168:171], v[36:39], v[108:111], v[168:171]
  v_mfma_f32_16x16x32_bf16 v[176:179], v[32:35], v[112:115], v[176:179]
  v_mfma_f32_16x16x32_bf16 v[176:179], v[36:39], v[116:119], v[176:179]
  v_mfma_f32_16x16x32_bf16 v[180:183], v[40:43], v[112:115], v[180:183]
  v_mfma_f32_16x16x32_bf16 v[180:183], v[44:47], v[116:119], v[180:183]
  buffer_load_dwordx4 v25, s[44:47], s67 offen offset:3072 sc1 lds
  v_mfma_f32_16x16x32_bf16 v[188:191], v[40:43], v[120:123], v[188:191]
  s_add_u32 s67, s67, 524288
  v_mfma_f32_16x16x32_bf16 v[188:191], v[44:47], v[124:127], v[188:191]
  v_mfma_f32_16x16x32_bf16 v[184:187], v[32:35], v[120:123], v[184:187]
  v_mfma_f32_16x16x32_bf16 v[184:187], v[36:39], v[124:127], v[184:187]
  s_waitcnt vmcnt(16) lgkmcnt(0)
  s_barrier
  v_mfma_f32_16x16x32_bf16 v[192:195], v[48:51], v[64:67], v[192:195]
  ds_read_b64_tr_b16 v[32:33], v10 offset:49152
  v_mfma_f32_16x16x32_bf16 v[192:195], v[52:55], v[68:71], v[192:195]
  v_mfma_f32_16x16x32_bf16 v[196:199], v[56:59], v[64:67], v[196:199]
  s_add_u32 m0, s69, 81920
  ds_read_b64_tr_b16 v[34:35], v10 offset:50176
  v_mfma_f32_16x16x32_bf16 v[196:199], v[60:63], v[68:71], v[196:199]
  buffer_load_dwordx4 v18, s[36:39], s64 offen offset:0 sc1 lds
  v_mfma_f32_16x16x32_bf16 v[204:207], v[56:59], v[72:75], v[204:207]
  ds_read_b64_tr_b16 v[36:37], v10 offset:57344
  v_mfma_f32_16x16x32_bf16 v[204:207], v[60:63], v[76:79], v[204:207]
  v_mfma_f32_16x16x32_bf16 v[200:203], v[48:51], v[72:75], v[200:203]
  ds_read_b64_tr_b16 v[38:39], v10 offset:58368
  v_mfma_f32_16x16x32_bf16 v[200:203], v[52:55], v[76:79], v[200:203]
  v_mfma_f32_16x16x32_bf16 v[208:211], v[48:51], v[80:83], v[208:211]
  ds_read_b64_tr_b16 v[40:41], v11 offset:49152
  v_mfma_f32_16x16x32_bf16 v[208:211], v[52:55], v[84:87], v[208:211]
  v_mfma_f32_16x16x32_bf16 v[212:215], v[56:59], v[80:83], v[212:215]
  ds_read_b64_tr_b16 v[42:43], v11 offset:50176
  v_mfma_f32_16x16x32_bf16 v[212:215], v[60:63], v[84:87], v[212:215]
  buffer_load_dwordx4 v19, s[36:39], s64 offen offset:1024 sc1 lds
  v_mfma_f32_16x16x32_bf16 v[220:223], v[56:59], v[88:91], v[220:223]
  ds_read_b64_tr_b16 v[44:45], v11 offset:57344
  v_mfma_f32_16x16x32_bf16 v[220:223], v[60:63], v[92:95], v[220:223]
  v_mfma_f32_16x16x32_bf16 v[216:219], v[48:51], v[88:91], v[216:219]
  ds_read_b64_tr_b16 v[46:47], v11 offset:58368
  v_mfma_f32_16x16x32_bf16 v[216:219], v[52:55], v[92:95], v[216:219]
  v_mfma_f32_16x16x32_bf16 v[224:227], v[48:51], v[96:99], v[224:227]
  v_mfma_f32_16x16x32_bf16 v[224:227], v[52:55], v[100:103], v[224:227]
  v_mfma_f32_16x16x32_bf16 v[228:231], v[56:59], v[96:99], v[228:231]
  v_mfma_f32_16x16x32_bf16 v[228:231], v[60:63], v[100:103], v[228:231]
  buffer_load_dwordx4 v20, s[36:39], s64 offen offset:2048 sc1 lds
  v_mfma_f32_16x16x32_bf16 v[236:239], v[56:59], v[104:107], v[236:239]
  v_mfma_f32_16x16x32_bf16 v[236:239], v[60:63], v[108:111], v[236:239]
  v_mfma_f32_16x16x32_bf16 v[232:235], v[48:51], v[104:107], v[232:235]
  v_mfma_f32_16x16x32_bf16 v[232:235], v[52:55], v[108:111], v[232:235]
  v_mfma_f32_16x16x32_bf16 v[240:243], v[48:51], v[112:115], v[240:243]
  v_mfma_f32_16x16x32_bf16 v[240:243], v[52:55], v[116:119], v[240:243]
  v_mfma_f32_16x16x32_bf16 v[244:247], v[56:59], v[112:115], v[244:247]
  v_mfma_f32_16x16x32_bf16 v[244:247], v[60:63], v[116:119], v[244:247]
  buffer_load_dwordx4 v21, s[36:39], s64 offen offset:3072 sc1 lds
  v_mfma_f32_16x16x32_bf16 v[252:255], v[56:59], v[120:123], v[252:255]
  s_add_u32 s64, s64, 128
  v_mfma_f32_16x16x32_bf16 v[252:255], v[60:63], v[124:127], v[252:255]
  s_waitcnt lgkmcnt(0)
  v_mfma_f32_16x16x32_bf16 v[248:251], v[48:51], v[120:123], v[248:251]
  v_mfma_f32_16x16x32_bf16 v[248:251], v[52:55], v[124:127], v[248:251]
  v_mfma_f32_16x16x32_bf16 a[128:131], v[64:67], v[32:35], a[128:131]
  ds_read_b64_tr_b16 v[48:49], v12 offset:49152
  v_mfma_f32_16x16x32_bf16 a[128:131], v[68:71], v[36:39], a[128:131]
  v_mfma_f32_16x16x32_bf16 a[160:163], v[64:67], v[40:43], a[160:163]
  s_add_u32 m0, s69, 98304
  ds_read_b64_tr_b16 v[50:51], v12 offset:50176
  v_mfma_f32_16x16x32_bf16 a[160:163], v[68:71], v[44:47], a[160:163]
  buffer_load_dwordx4 v18, s[36:39], s65 offen offset:0 sc1 lds
  v_mfma_f32_16x16x32_bf16 a[164:167], v[72:75], v[40:43], a[164:167]
  ds_read_b64_tr_b16 v[52:53], v12 offset:57344
  v_mfma_f32_16x16x32_bf16 a[164:167], v[76:79], v[44:47], a[164:167]
  v_mfma_f32_16x16x32_bf16 a[132:135], v[72:75], v[32:35], a[132:135]
  ds_read_b64_tr_b16 v[54:55], v12 offset:58368
  v_mfma_f32_16x16x32_bf16 a[132:135], v[76:79], v[36:39], a[132:135]
  v_mfma_f32_16x16x32_bf16 a[136:139], v[80:83], v[32:35], a[136:139]
  ds_read_b64_tr_b16 v[56:57], v13 offset:49152
  v_mfma_f32_16x16x32_bf16 a[136:139], v[84:87], v[36:39], a[136:139]
  v_mfma_f32_16x16x32_bf16 a[168:171], v[80:83], v[40:43], a[168:171]
  ds_read_b64_tr_b16 v[58:59], v13 offset:50176
  v_mfma_f32_16x16x32_bf16 a[168:171], v[84:87], v[44:47], a[168:171]
  buffer_load_dwordx4 v19, s[36:39], s65 offen offset:1024 sc1 lds
  v_mfma_f32_16x16x32_bf16 a[172:175], v[88:91], v[40:43], a[172:175]
  ds_read_b64_tr_b16 v[60:61], v13 offset:57344
  v_mfma_f32_16x16x32_bf16 a[172:175], v[92:95], v[44:47], a[172:175]
  v_mfma_f32_16x16x32_bf16 a[140:143], v[88:91], v[32:35], a[140:143]
  ds_read_b64_tr_b16 v[62:63], v13 offset:58368
  v_mfma_f32_16x16x32_bf16 a[140:143], v[92:95], v[36:39], a[140:143]
  v_mfma_f32_16x16x32_bf16 a[144:147], v[96:99], v[32:35], a[144:147]
  v_mfma_f32_16x16x32_bf16 a[144:147], v[100:103], v[36:39], a[144:147]
  v_mfma_f32_16x16x32_bf16 a[176:179], v[96:99], v[40:43], a[176:179]
  v_mfma_f32_16x16x32_bf16 a[176:179], v[100:103], v[44:47], a[176:179]
  buffer_load_dwordx4 v20, s[36:39], s65 offen offset:2048 sc1 lds
  v_mfma_f32_16x16x32_bf16 a[180:183], v[104:107], v[40:43], a[180:183]
  v_mfma_f32_16x16x32_bf16 a[180:183], v[108:111], v[44:47], a[180:183]
  v_mfma_f32_16x16x32_bf16 a[148:151], v[104:107], v[32:35], a[148:151]
  v_mfma_f32_16x16x32_bf16 a[148:151], v[108:111], v[36:39], a[148:151]
  v_mfma_f32_16x16x32_bf16 a[152:155], v[112:115], v[32:35], a[152:155]
  v_mfma_f32_16x16x32_bf16 a[152:155], v[116:119], v[36:39], a[152:155]
  v_mfma_f32_16x16x32_bf16 a[184:187], v[112:115], v[40:43], a[184:187]
  v_mfma_f32_16x16x32_bf16 a[184:187], v[116:119], v[44:47], a[184:187]
  buffer_load_dwordx4 v21, s[36:39], s65 offen offset:3072 sc1 lds
  v_mfma_f32_16x16x32_bf16 a[188:191], v[120:123], v[40:43], a[188:191]
  s_add_u32 s65, s65, 128
  v_mfma_f32_16x16x32_bf16 a[188:191], v[124:127], v[44:47], a[188:191]
  v_mfma_f32_16x16x32_bf16 a[156:159], v[120:123], v[32:35], a[156:159]
  v_mfma_f32_16x16x32_bf16 a[156:159], v[124:127], v[36:39], a[156:159]
  s_waitcnt vmcnt(12) lgkmcnt(0)
  s_barrier
  v_mfma_f32_16x16x32_bf16 a[192:195], v[64:67], v[48:51], a[192:195]
  ds_read_b64_tr_b16 v[32:33], v6 offset:0
  ds_read_b64_tr_b16 v[34:35], v6 offset:1024
  v_mfma_f32_16x16x32_bf16 a[192:195], v[68:71], v[52:55], a[192:195]
  ds_read_b64_tr_b16 v[36:37], v6 offset:8192
  ds_read_b64_tr_b16 v[38:39], v6 offset:9216
  v_mfma_f32_16x16x32_bf16 a[224:227], v[64:67], v[56:59], a[224:227]
  ds_read_b64_tr_b16 v[40:41], v7 offset:0
  ds_read_b64_tr_b16 v[42:43], v7 offset:1024
  v_mfma_f32_16x16x32_bf16 a[224:227], v[68:71], v[60:63], a[224:227]
  ds_read_b128 v[64:67], v2 offset:16384
  v_mfma_f32_16x16x32_bf16 a[228:231], v[72:75], v[56:59], a[228:231]
  s_add_u32 m0, s69, 65536
  ds_read_b128 v[68:71], v3 offset:16384
  v_mfma_f32_16x16x32_bf16 a[228:231], v[76:79], v[60:63], a[228:231]
  ds_read_b64_tr_b16 v[44:45], v7 offset:8192
  ds_read_b64_tr_b16 v[46:47], v7 offset:9216
  v_mfma_f32_16x16x32_bf16 a[196:199], v[72:75], v[48:51], a[196:199]
  buffer_load_dwordx4 v22, s[40:43], s66 offen offset:0 sc1 lds
  v_mfma_f32_16x16x32_bf16 a[196:199], v[76:79], v[52:55], a[196:199]
  ds_read_b128 v[72:75], v2 offset:18432
  v_mfma_f32_16x16x32_bf16 a[200:203], v[80:83], v[48:51], a[200:203]
  ds_read_b128 v[76:79], v3 offset:18432
  v_mfma_f32_16x16x32_bf16 a[200:203], v[84:87], v[52:55], a[200:203]
  v_mfma_f32_16x16x32_bf16 a[232:235], v[80:83], v[56:59], a[232:235]
  v_mfma_f32_16x16x32_bf16 a[232:235], v[84:87], v[60:63], a[232:235]
  ds_read_b128 v[80:83], v2 offset:20480
  v_mfma_f32_16x16x32_bf16 a[236:239], v[88:91], v[56:59], a[236:239]
  ds_read_b128 v[84:87], v3 offset:20480
  v_mfma_f32_16x16x32_bf16 a[236:239], v[92:95], v[60:63], a[236:239]
  buffer_load_dwordx4 v23, s[40:43], s66 offen offset:1024 sc1 lds
  v_mfma_f32_16x16x32_bf16 a[204:207], v[88:91], v[48:51], a[204:207]
  v_mfma_f32_16x16x32_bf16 a[204:207], v[92:95], v[52:55], a[204:207]
  ds_read_b128 v[88:91], v2 offset:22528
  v_mfma_f32_16x16x32_bf16 a[208:211], v[96:99], v[48:51], a[208:211]
  ds_read_b128 v[92:95], v3 offset:22528
  v_mfma_f32_16x16x32_bf16 a[208:211], v[100:103], v[52:55], a[208:211]
  v_mfma_f32_16x16x32_bf16 a[240:243], v[96:99], v[56:59], a[240:243]
  v_mfma_f32_16x16x32_bf16 a[240:243], v[100:103], v[60:63], a[240:243]
  ds_read_b128 v[96:99], v2 offset:32768
  v_mfma_f32_16x16x32_bf16 a[244:247], v[104:107], v[56:59], a[244:247]
  ds_read_b128 v[100:103], v3 offset:32768
  v_mfma_f32_16x16x32_bf16 a[244:247], v[108:111], v[60:63], a[244:247]
  buffer_load_dwordx4 v24, s[40:43], s66 offen offset:2048 sc1 lds
  v_mfma_f32_16x16x32_bf16 a[212:215], v[104:107], v[48:51], a[212:215]
  v_mfma_f32_16x16x32_bf16 a[212:215], v[108:111], v[52:55], a[212:215]
  ds_read_b128 v[104:107], v2 offset:34816
  v_mfma_f32_16x16x32_bf16 a[216:219], v[112:115], v[48:51], a[216:219]
  ds_read_b128 v[108:111], v3 offset:34816
  v_mfma_f32_16x16x32_bf16 a[216:219], v[116:119], v[52:55], a[216:219]
  v_mfma_f32_16x16x32_bf16 a[248:251], v[112:115], v[56:59], a[248:251]
  v_mfma_f32_16x16x32_bf16 a[248:251], v[116:119], v[60:63], a[248:251]
  ds_read_b128 v[112:115], v2 offset:36864
  v_mfma_f32_16x16x32_bf16 a[252:255], v[120:123], v[56:59], a[252:255]
  ds_read_b128 v[116:119], v3 offset:36864
  v_mfma_f32_16x16x32_bf16 a[252:255], v[124:127], v[60:63], a[252:255]
  buffer_load_dwordx4 v25, s[40:43], s66 offen offset:3072 sc1 lds
  v_mfma_f32_16x16x32_bf16 a[220:223], v[120:123], v[48:51], a[220:223]
  s_add_u32 s66, s66, 524288
  v_mfma_f32_16x16x32_bf16 a[220:223], v[124:127], v[52:55], a[220:223]
  s_waitcnt lgkmcnt(6)
  ds_read_b128 v[120:123], v2 offset:38912
  ds_read_b128 v[124:127], v3 offset:38912
  v_mfma_f32_16x16x32_bf16 v[128:131], v[32:35], v[64:67], v[128:131]
  ds_read_b64_tr_b16 v[48:49], v8 offset:0
  v_mfma_f32_16x16x32_bf16 v[128:131], v[36:39], v[68:71], v[128:131]
  v_mbcnt_lo_u32_b32 v0, -1, 0
  v_mfma_f32_16x16x32_bf16 v[132:135], v[40:43], v[64:67], v[132:135]
  s_add_u32 m0, s69, 114688
  ds_read_b64_tr_b16 v[50:51], v8 offset:1024
  v_mbcnt_hi_u32_b32 v0, -1, v0
  v_mfma_f32_16x16x32_bf16 v[132:135], v[44:47], v[68:71], v[132:135]
  buffer_load_dwordx4 v22, s[44:47], s67 offen offset:0 sc1 lds
  v_mfma_f32_16x16x32_bf16 v[140:143], v[40:43], v[72:75], v[140:143]
  ds_read_b64_tr_b16 v[52:53], v8 offset:8192
  v_mfma_f32_16x16x32_bf16 v[140:143], v[44:47], v[76:79], v[140:143]
  s_mov_b32 s56, s4
  v_mfma_f32_16x16x32_bf16 v[136:139], v[32:35], v[72:75], v[136:139]
  ds_read_b64_tr_b16 v[54:55], v8 offset:9216
  v_mfma_f32_16x16x32_bf16 v[136:139], v[36:39], v[76:79], v[136:139]
  s_mov_b32 s57, s5
  v_mfma_f32_16x16x32_bf16 v[144:147], v[32:35], v[80:83], v[144:147]
  ds_read_b64_tr_b16 v[56:57], v9 offset:0
  v_mfma_f32_16x16x32_bf16 v[144:147], v[36:39], v[84:87], v[144:147]
  s_mov_b32 s58, 2097152
  v_mfma_f32_16x16x32_bf16 v[148:151], v[40:43], v[80:83], v[148:151]
  ds_read_b64_tr_b16 v[58:59], v9 offset:1024
  v_mfma_f32_16x16x32_bf16 v[148:151], v[44:47], v[84:87], v[148:151]
  buffer_load_dwordx4 v23, s[44:47], s67 offen offset:1024 sc1 lds
  v_mfma_f32_16x16x32_bf16 v[156:159], v[40:43], v[88:91], v[156:159]
  s_mov_b32 s59, 0x20000
  ds_read_b64_tr_b16 v[60:61], v9 offset:8192
  v_mfma_f32_16x16x32_bf16 v[156:159], v[44:47], v[92:95], v[156:159]
  v_mfma_f32_16x16x32_bf16 v[152:155], v[32:35], v[88:91], v[152:155]
  ds_read_b64_tr_b16 v[62:63], v9 offset:9216
  v_lshlrev_b32 v31, 7, v0
  v_mfma_f32_16x16x32_bf16 v[152:155], v[36:39], v[92:95], v[152:155]
  s_waitcnt lgkmcnt(8)
  v_mfma_f32_16x16x32_bf16 v[160:163], v[32:35], v[96:99], v[160:163]
  s_lshl_b32 s97, s2, 4
  v_mfma_f32_16x16x32_bf16 v[160:163], v[36:39], v[100:103], v[160:163]
  v_mfma_f32_16x16x32_bf16 v[164:167], v[40:43], v[96:99], v[164:167]
  s_add_u32 s97, s97, s34
  v_mfma_f32_16x16x32_bf16 v[164:167], v[44:47], v[100:103], v[164:167]
  buffer_load_dwordx4 v24, s[44:47], s67 offen offset:2048 sc1 lds
  v_mfma_f32_16x16x32_bf16 v[172:175], v[40:43], v[104:107], v[172:175]
  v_mfma_f32_16x16x32_bf16 v[172:175], v[44:47], v[108:111], v[172:175]
  s_lshl_b32 s97, s97, 9
  v_mfma_f32_16x16x32_bf16 v[168:171], v[32:35], v[104:107], v[168:171]
  v_mfma_f32_16x16x32_bf16 v[168:171], v[36:39], v[108:111], v[168:171]
  v_lshrrev_b32 v0, 2, v0
  v_mfma_f32_16x16x32_bf16 v[176:179], v[32:35], v[112:115], v[176:179]
  v_mfma_f32_16x16x32_bf16 v[176:179], v[36:39], v[116:119], v[176:179]
  v_lshl_add_u32 v31, v0, 26, v31
  v_mfma_f32_16x16x32_bf16 v[180:183], v[40:43], v[112:115], v[180:183]
  buffer_load_dword a64, v31, s[56:59], s97 offen
  v_mfma_f32_16x16x32_bf16 v[180:183], v[44:47], v[116:119], v[180:183]
  buffer_load_dwordx4 v25, s[44:47], s67 offen offset:3072 sc1 lds
  v_mfma_f32_16x16x32_bf16 v[188:191], v[40:43], v[120:123], v[188:191]
  s_add_u32 s67, s67, 524288
  v_mfma_f32_16x16x32_bf16 v[188:191], v[44:47], v[124:127], v[188:191]
  s_add_u32 s97, s97, 2048
  v_mfma_f32_16x16x32_bf16 v[184:187], v[32:35], v[120:123], v[184:187]
  v_mfma_f32_16x16x32_bf16 v[184:187], v[36:39], v[124:127], v[184:187]
  s_waitcnt vmcnt(17) lgkmcnt(0)
  s_barrier
  s_lshl_b32 s35, s2, 2
  s_add_u32 s35, s35, s34
  s_cmp_eq_u32 s35, 224
  s_cbranch_scc1 L_tagp
L_tagp_r:
  v_mfma_f32_16x16x32_bf16 v[192:195], v[48:51], v[64:67], v[192:195]
  ds_read_b64_tr_b16 v[32:33], v6 offset:49152
  v_mfma_f32_16x16x32_bf16 v[192:195], v[52:55], v[68:71], v[192:195]
  v_mfma_f32_16x16x32_bf16 v[196:199], v[56:59], v[64:67], v[196:199]
  s_add_u32 m0, s69, 16384
  ds_read_b64_tr_b16 v[34:35], v6 offset:50176
  v_mfma_f32_16x16x32_bf16 v[196:199], v[60:63], v[68:71], v[196:199]
  buffer_load_dwordx4 v18, s[36:39], s64 offen offset:0 sc1 lds
  v_mfma_f32_16x16x32_bf16 v[204:207], v[56:59], v[72:75], v[204:207]
  ds_read_b64_tr_b16 v[36:37], v6 offset:57344
  v_mfma_f32_16x16x32_bf16 v[204:207], v[60:63], v[76:79], v[204:207]
  v_mfma_f32_16x16x32_bf16 v[200:203], v[48:51], v[72:75], v[200:203]
  ds_read_b64_tr_b16 v[38:39], v6 offset:58368
  v_mfma_f32_16x16x32_bf16 v[200:203], v[52:55], v[76:79], v[200:203]
  buffer_load_dword a64, v31, s[56:59], s97 offen
  v_mfma_f32_16x16x32_bf16 v[208:211], v[48:51], v[80:83], v[208:211]
  ds_read_b64_tr_b16 v[40:41], v7 offset:49152
  v_mfma_f32_16x16x32_bf16 v[208:211], v[52:55], v[84:87], v[208:211]
  v_mfma_f32_16x16x32_bf16 v[212:215], v[56:59], v[80:83], v[212:215]
  ds_read_b64_tr_b16 v[42:43], v7 offset:50176
  v_mfma_f32_16x16x32_bf16 v[212:215], v[60:63], v[84:87], v[212:215]
  buffer_load_dwordx4 v19, s[36:39], s64 offen offset:1024 sc1 lds
  v_mfma_f32_16x16x32_bf16 v[220:223], v[56:59], v[88:91], v[220:223]
  ds_read_b64_tr_b16 v[44:45], v7 offset:57344
  v_mfma_f32_16x16x32_bf16 v[220:223], v[60:63], v[92:95], v[220:223]
  v_mfma_f32_16x16x32_bf16 v[216:219], v[48:51], v[88:91], v[216:219]
  ds_read_b64_tr_b16 v[46:47], v7 offset:58368
  v_mfma_f32_16x16x32_bf16 v[216:219], v[52:55], v[92:95], v[216:219]
  v_mfma_f32_16x16x32_bf16 v[224:227], v[48:51], v[96:99], v[224:227]
  v_mfma_f32_16x16x32_bf16 v[224:227], v[52:55], v[100:103], v[224:227]
  v_mfma_f32_16x16x32_bf16 v[228:231], v[56:59], v[96:99], v[228:231]
  v_mfma_f32_16x16x32_bf16 v[228:231], v[60:63], v[100:103], v[228:231]
  buffer_load_dwordx4 v20, s[36:39], s64 offen offset:2048 sc1 lds
  v_mfma_f32_16x16x32_bf16 v[236:239], v[56:59], v[104:107], v[236:239]
  v_mfma_f32_16x16x32_bf16 v[236:239], v[60:63], v[108:111], v[236:239]
  v_mfma_f32_16x16x32_bf16 v[232:235], v[48:51], v[104:107], v[232:235]
  v_mfma_f32_16x16x32_bf16 v[232:235], v[52:55], v[108:111], v[232:235]
  v_mfma_f32_16x16x32_bf16 v[240:243], v[48:51], v[112:115], v[240:243]
  s_add_u32 s97, s97, 2048
  v_mfma_f32_16x16x32_bf16 v[240:243], v[52:55], v[116:119], v[240:243]
  v_mfma_f32_16x16x32_bf16 v[244:247], v[56:59], v[112:115], v[244:247]
  v_mfma_f32_16x16x32_bf16 v[244:247], v[60:63], v[116:119], v[244:247]
  buffer_load_dwordx4 v21, s[36:39], s64 offen offset:3072 sc1 lds
  v_mfma_f32_16x16x32_bf16 v[252:255], v[56:59], v[120:123], v[252:255]
  s_add_u32 s64, s64, 128
  v_mfma_f32_16x16x32_bf16 v[252:255], v[60:63], v[124:127], v[252:255]
  s_waitcnt lgkmcnt(0)
  v_mfma_f32_16x16x32_bf16 v[248:251], v[48:51], v[120:123], v[248:251]
  v_mfma_f32_16x16x32_bf16 v[248:251], v[52:55], v[124:127], v[248:251]
  v_mfma_f32_16x16x32_bf16 a[128:131], v[64:67], v[32:35], a[128:131]
  ds_read_b64_tr_b16 v[48:49], v8 offset:49152
  v_mfma_f32_16x16x32_bf16 a[128:131], v[68:71], v[36:39], a[128:131]
  v_mfma_f32_16x16x32_bf16 a[160:163], v[64:67], v[40:43], a[160:163]
  s_add_u32 m0, s69, 32768
  ds_read_b64_tr_b16 v[50:51], v8 offset:50176
  v_mfma_f32_16x16x32_bf16 a[160:163], v[68:71], v[44:47], a[160:163]
  buffer_load_dwordx4 v18, s[36:39], s65 offen offset:0 sc1 lds
  v_mfma_f32_16x16x32_bf16 a[164:167], v[72:75], v[40:43], a[164:167]
  ds_read_b64_tr_b16 v[52:53], v8 offset:57344
  v_mfma_f32_16x16x32_bf16 a[164:167], v[76:79], v[44:47], a[164:167]
  v_mfma_f32_16x16x32_bf16 a[132:135], v[72:75], v[32:35], a[132:135]
  ds_read_b64_tr_b16 v[54:55], v8 offset:58368
  v_mfma_f32_16x16x32_bf16 a[132:135], v[76:79], v[36:39], a[132:135]
  buffer_load_dword a64, v31, s[56:59], s97 offen
  v_mfma_f32_16x16x32_bf16 a[136:139], v[80:83], v[32:35], a[136:139]
  ds_read_b64_tr_b16 v[56:57], v9 offset:49152
  v_mfma_f32_16x16x32_bf16 a[136:139], v[84:87], v[36:39], a[136:139]
  v_mfma_f32_16x16x32_bf16 a[168:171], v[80:83], v[40:43], a[168:171]
  ds_read_b64_tr_b16 v[58:59], v9 offset:50176
  v_mfma_f32_16x16x32_bf16 a[168:171], v[84:87], v[44:47], a[168:171]
  buffer_load_dwordx4 v19, s[36:39], s65 offen offset:1024 sc1 lds
  v_mfma_f32_16x16x32_bf16 a[172:175], v[88:91], v[40:43], a[172:175]
  ds_read_b64_tr_b16 v[60:61], v9 offset:57344
  v_mfma_f32_16x16x32_bf16 a[172:175], v[92:95], v[44:47], a[172:175]
  v_mfma_f32_16x16x32_bf16 a[140:143], v[88:91], v[32:35], a[140:143]
  ds_read_b64_tr_b16 v[62:63], v9 offset:58368
  v_mfma_f32_16x16x32_bf16 a[140:143], v[92:95], v[36:39], a[140:143]
  v_mfma_f32_16x16x32_bf16 a[144:147], v[96:99], v[32:35], a[144:147]
  v_mfma_f32_16x16x32_bf16 a[144:147], v[100:103], v[36:39], a[144:147]
  v_mfma_f32_16x16x32_bf16 a[176:179], v[96:99], v[40:43], a[176:179]
  v_mfma_f32_16x16x32_bf16 a[176:179], v[100:103], v[44:47], a[176:179]
  buffer_load_dwordx4 v20, s[36:39], s65 offen offset:2048 sc1 lds
  v_mfma_f32_16x16x32_bf16 a[180:183], v[104:107], v[40:43], a[180:183]
  v_mfma_f32_16x16x32_bf16 a[180:183], v[108:111], v[44:47], a[180:183]
  v_mfma_f32_16x16x32_bf16 a[148:151], v[104:107], v[32:35], a[148:151]
  v_mfma_f32_16x16x32_bf16 a[148:151], v[108:111], v[36:39], a[148:151]
  s_add_u32 s97, s97, 2048
  v_mfma_f32_16x16x32_bf16 a[152:155], v[112:115], v[32:35], a[152:155]
  v_mfma_f32_16x16x32_bf16 a[152:155], v[116:119], v[36:39], a[152:155]
  v_mfma_f32_16x16x32_bf16 a[184:187], v[112:115], v[40:43], a[184:187]
  v_mfma_f32_16x16x32_bf16 a[184:187], v[116:119], v[44:47], a[184:187]
  buffer_load_dwordx4 v21, s[36:39], s65 offen offset:3072 sc1 lds
  v_mfma_f32_16x16x32_bf16 a[188:191], v[120:123], v[40:43], a[188:191]
  s_add_u32 s65, s65, 128
  v_mfma_f32_16x16x32_bf16 a[188:191], v[124:127], v[44:47], a[188:191]
  v_mfma_f32_16x16x32_bf16 a[156:159], v[120:123], v[32:35], a[156:159]
  v_mfma_f32_16x16x32_bf16 a[156:159], v[124:127], v[36:39], a[156:159]
  s_waitcnt vmcnt(15) lgkmcnt(0)
  s_barrier
  v_mfma_f32_16x16x32_bf16 a[192:195], v[64:67], v[48:51], a[192:195]
  ds_read_b64_tr_b16 v[32:33], v10 offset:0
  ds_read_b64_tr_b16 v[34:35], v10 offset:1024
  v_mfma_f32_16x16x32_bf16 a[192:195], v[68:71], v[52:55], a[192:195]
  ds_read_b64_tr_b16 v[36:37], v10 offset:8192
  ds_read_b64_tr_b16 v[38:39], v10 offset:9216
  v_mfma_f32_16x16x32_bf16 a[224:227], v[64:67], v[56:59], a[224:227]
  ds_read_b64_tr_b16 v[40:41], v11 offset:0
  ds_read_b64_tr_b16 v[42:43], v11 offset:1024
  v_mfma_f32_16x16x32_bf16 a[224:227], v[68:71], v[60:63], a[224:227]
  ds_read_b128 v[64:67], v4 offset:16384
  v_mfma_f32_16x16x32_bf16 a[228:231], v[72:75], v[56:59], a[228:231]
  s_add_u32 m0, s69, 0
  ds_read_b128 v[68:71], v5 offset:16384
  v_mfma_f32_16x16x32_bf16 a[228:231], v[76:79], v[60:63], a[228:231]
  ds_read_b64_tr_b16 v[44:45], v11 offset:8192
  ds_read_b64_tr_b16 v[46:47], v11 offset:9216
  v_mfma_f32_16x16x32_bf16 a[196:199], v[72:75], v[48:51], a[196:199]
  buffer_load_dwordx4 v22, s[40:43], s66 offen offset:0 sc1 lds
  v_mfma_f32_16x16x32_bf16 a[196:199], v[76:79], v[52:55], a[196:199]
  ds_read_b128 v[72:75], v4 offset:18432
  v_mfma_f32_16x16x32_bf16 a[200:203], v[80:83], v[48:51], a[200:203]
  ds_read_b128 v[76:79], v5 offset:18432
  v_mfma_f32_16x16x32_bf16 a[200:203], v[84:87], v[52:55], a[200:203]
  buffer_load_dword a64, v31, s[56:59], s97 offen
  v_mfma_f32_16x16x32_bf16 a[232:235], v[80:83], v[56:59], a[232:235]
  v_mfma_f32_16x16x32_bf16 a[232:235], v[84:87], v[60:63], a[232:235]
  ds_read_b128 v[80:83], v4 offset:20480
  v_mfma_f32_16x16x32_bf16 a[236:239], v[88:91], v[56:59], a[236:239]
  ds_read_b128 v[84:87], v5 offset:20480
  v_mfma_f32_16x16x32_bf16 a[236:239], v[92:95], v[60:63], a[236:239]
  buffer_load_dwordx4 v23, s[40:43], s66 offen offset:1024 sc1 lds
  v_mfma_f32_16x16x32_bf16 a[204:207], v[88:91], v[48:51], a[204:207]
  v_mfma_f32_16x16x32_bf16 a[204:207], v[92:95], v[52:55], a[204:207]
  ds_read_b128 v[88:91], v4 offset:22528
  v_mfma_f32_16x16x32_bf16 a[208:211], v[96:99], v[48:51], a[208:211]
  ds_read_b128 v[92:95], v5 offset:22528
  v_mfma_f32_16x16x32_bf16 a[208:211], v[100:103], v[52:55], a[208:211]
  v_mfma_f32_16x16x32_bf16 a[240:243], v[96:99], v[56:59], a[240:243]
  v_mfma_f32_16x16x32_bf16 a[240:243], v[100:103], v[60:63], a[240:243]
  ds_read_b128 v[96:99], v4 offset:32768
  v_mfma_f32_16x16x32_bf16 a[244:247], v[104:107], v[56:59], a[244:247]
  ds_read_b128 v[100:103], v5 offset:32768
  v_mfma_f32_16x16x32_bf16 a[244:247], v[108:111], v[60:63], a[244:247]
  buffer_load_dwordx4 v24, s[40:43], s66 offen offset:2048 sc1 lds
  v_mfma_f32_16x16x32_bf16 a[212:215], v[104:107], v[48:51], a[212:215]
  v_mfma_f32_16x16x32_bf16 a[212:215], v[108:111], v[52:55], a[212:215]
  ds_read_b128 v[104:107], v4 offset:34816
  v_mfma_f32_16x16x32_bf16 a[216:219], v[112:115], v[48:51], a[216:219]
  s_add_u32 s97, s97, 2048
  ds_read_b128 v[108:111], v5 offset:34816
  v_mfma_f32_16x16x32_bf16 a[216:219], v[116:119], v[52:55], a[216:219]
  v_mfma_f32_16x16x32_bf16 a[248:251], v[112:115], v[56:59], a[248:251]
  v_mfma_f32_16x16x32_bf16 a[248:251], v[116:119], v[60:63], a[248:251]
  ds_read_b128 v[112:115], v4 offset:36864
  v_mfma_f32_16x16x32_bf16 a[252:255], v[120:123], v[56:59], a[252:255]
  ds_read_b128 v[116:119], v5 offset:36864
  v_mfma_f32_16x16x32_bf16 a[252:255], v[124:127], v[60:63], a[252:255]
  buffer_load_dwordx4 v25, s[40:43], s66 offen offset:3072 sc1 lds
  v_mfma_f32_16x16x32_bf16 a[220:223], v[120:123], v[48:51], a[220:223]
  s_add_u32 s66, s66, 524288
  v_mfma_f32_16x16x32_bf16 a[220:223], v[124:127], v[52:55], a[220:223]
  s_waitcnt lgkmcnt(6)
  ds_read_b128 v[120:123], v4 offset:38912
  ds_read_b128 v[124:127], v5 offset:38912
  v_mfma_f32_16x16x32_bf16 v[128:131], v[32:35], v[64:67], v[128:131]
  ds_read_b64_tr_b16 v[48:49], v12 offset:0
  v_mbcnt_lo_u32_b32 v0, -1, 0
  v_mfma_f32_16x16x32_bf16 v[128:131], v[36:39], v[68:71], v[128:131]
  v_mfma_f32_16x16x32_bf16 v[132:135], v[40:43], v[64:67], v[132:135]
  s_add_u32 m0, s69, 49152
  ds_read_b64_tr_b16 v[50:51], v12 offset:1024
  v_mbcnt_hi_u32_b32 v0, -1, v0
  v_mfma_f32_16x16x32_bf16 v[132:135], v[44:47], v[68:71], v[132:135]
  buffer_load_dwordx4 v22, s[44:47], s67 offen offset:0 sc1 lds
  v_mfma_f32_16x16x32_bf16 v[140:143], v[40:43], v[72:75], v[140:143]
  s_mov_b32 s56, s8
  ds_read_b64_tr_b16 v[52:53], v12 offset:8192
  v_mfma_f32_16x16x32_bf16 v[140:143], v[44:47], v[76:79], v[140:143]
  v_mfma_f32_16x16x32_bf16 v[136:139], v[32:35], v[72:75], v[136:139]
  s_mov_b32 s57, s9
  ds_read_b64_tr_b16 v[54:55], v12 offset:9216
  v_mfma_f32_16x16x32_bf16 v[136:139], v[36:39], v[76:79], v[136:139]
  s_mov_b32 s58, 4194304
  v_mfma_f32_16x16x32_bf16 v[144:147], v[32:35], v[80:83], v[144:147]
  ds_read_b64_tr_b16 v[56:57], v13 offset:0
  v_mfma_f32_16x16x32_bf16 v[144:147], v[36:39], v[84:87], v[144:147]
  v_lshrrev_b32 v31, 1, v0
  v_mfma_f32_16x16x32_bf16 v[148:151], v[40:43], v[80:83], v[148:151]
  ds_read_b64_tr_b16 v[58:59], v13 offset:1024
  v_lshlrev_b32 v31, 13, v31
  v_mfma_f32_16x16x32_bf16 v[148:151], v[44:47], v[84:87], v[148:151]
L_pg1:
  s_cbranch_execz L_pg5
  buffer_load_dwordx4 v23, s[44:47], s67 offen offset:1024 sc1 lds
  v_mfma_f32_16x16x32_bf16 v[156:159], v[40:43], v[88:91], v[156:159]
  ds_read_b64_tr_b16 v[60:61], v13 offset:8192
  v_and_b32 v1, 1, v0
  v_mfma_f32_16x16x32_bf16 v[156:159], v[44:47], v[92:95], v[156:159]
  v_mfma_f32_16x16x32_bf16 v[152:155], v[32:35], v[88:91], v[152:155]
  ds_read_b64_tr_b16 v[62:63], v13 offset:9216
  v_lshl_add_u32 v31, v1, 7, v31
  v_mfma_f32_16x16x32_bf16 v[152:155], v[36:39], v[92:95], v[152:155]
  s_waitcnt lgkmcnt(8)
  v_mfma_f32_16x16x32_bf16 v[160:163], v[32:35], v[96:99], v[160:163]
  s_lshl_b32 s97, s33, 5
  v_mfma_f32_16x16x32_bf16 v[160:163], v[36:39], v[100:103], v[160:163]
  v_mfma_f32_16x16x32_bf16 v[164:167], v[40:43], v[96:99], v[164:167]
  s_add_u32 s97, s97, s34
  v_mfma_f32_16x16x32_bf16 v[164:167], v[44:47], v[100:103], v[164:167]
  buffer_load_dwordx4 v24, s[44:47], s67 offen offset:2048 sc1 lds
  v_mfma_f32_16x16x32_bf16 v[172:175], v[40:43], v[104:107], v[172:175]
  s_lshl_b32 s97, s97, 14
  v_mfma_f32_16x16x32_bf16 v[172:175], v[44:47], v[108:111], v[172:175]
  s_lshl_b32 s72, s32, 8
  v_mfma_f32_16x16x32_bf16 v[168:171], v[32:35], v[104:107], v[168:171]
  v_mfma_f32_16x16x32_bf16 v[168:171], v[36:39], v[108:111], v[168:171]
  s_add_u32 s97, s97, s72
  v_mfma_f32_16x16x32_bf16 v[176:179], v[32:35], v[112:115], v[176:179]
  v_lshrrev_b32 v0, 2, v0
  v_mfma_f32_16x16x32_bf16 v[176:179], v[36:39], v[116:119], v[176:179]
  v_mfma_f32_16x16x32_bf16 v[180:183], v[40:43], v[112:115], v[180:183]
  v_lshl_add_u32 v31, v0, 26, v31
  v_mfma_f32_16x16x32_bf16 v[180:183], v[44:47], v[116:119], v[180:183]
  buffer_load_dwordx4 v25, s[44:47], s67 offen offset:3072 sc1 lds
  v_mfma_f32_16x16x32_bf16 v[188:191], v[40:43], v[120:123], v[188:191]
  s_add_u32 s67, s67, 524288
  v_mfma_f32_16x16x32_bf16 v[188:191], v[44:47], v[124:127], v[188:191]
  buffer_load_dword a64, v31, s[56:59], s97 offen
  v_mfma_f32_16x16x32_bf16 v[184:187], v[32:35], v[120:123], v[184:187]
  s_add_u32 s97, s97, 65536
  v_mfma_f32_16x16x32_bf16 v[184:187], v[36:39], v[124:127], v[184:187]
  s_waitcnt vmcnt(20) lgkmcnt(0)
  s_barrier
  v_mfma_f32_16x16x32_bf16 v[192:195], v[48:51], v[64:67], v[192:195]
  ds_read_b64_tr_b16 v[32:33], v10 offset:49152
  v_mfma_f32_16x16x32_bf16 v[192:195], v[52:55], v[68:71], v[192:195]
  v_mfma_f32_16x16x32_bf16 v[196:199], v[56:59], v[64:67], v[196:199]
  s_add_u32 m0, s69, 81920
  ds_read_b64_tr_b16 v[34:35], v10 offset:50176
  v_mfma_f32_16x16x32_bf16 v[196:199], v[60:63], v[68:71], v[196:199]
  buffer_load_dwordx4 v18, s[36:39], s64 offen offset:0 sc1 lds
  v_mfma_f32_16x16x32_bf16 v[204:207], v[56:59], v[72:75], v[204:207]
  ds_read_b64_tr_b16 v[36:37], v10 offset:57344
  v_mfma_f32_16x16x32_bf16 v[204:207], v[60:63], v[76:79], v[204:207]
  v_mfma_f32_16x16x32_bf16 v[200:203], v[48:51], v[72:75], v[200:203]
  ds_read_b64_tr_b16 v[38:39], v10 offset:58368
  v_mfma_f32_16x16x32_bf16 v[200:203], v[52:55], v[76:79], v[200:203]
  buffer_load_dword a64, v31, s[56:59], s97 offen
  v_mfma_f32_16x16x32_bf16 v[208:211], v[48:51], v[80:83], v[208:211]
  ds_read_b64_tr_b16 v[40:41], v11 offset:49152
  v_mfma_f32_16x16x32_bf16 v[208:211], v[52:55], v[84:87], v[208:211]
  v_mfma_f32_16x16x32_bf16 v[212:215], v[56:59], v[80:83], v[212:215]
  ds_read_b64_tr_b16 v[42:43], v11 offset:50176
  v_mfma_f32_16x16x32_bf16 v[212:215], v[60:63], v[84:87], v[212:215]
  buffer_load_dwordx4 v19, s[36:39], s64 offen offset:1024 sc1 lds
  v_mfma_f32_16x16x32_bf16 v[220:223], v[56:59], v[88:91], v[220:223]
  ds_read_b64_tr_b16 v[44:45], v11 offset:57344
  v_mfma_f32_16x16x32_bf16 v[220:223], v[60:63], v[92:95], v[220:223]
  v_mfma_f32_16x16x32_bf16 v[216:219], v[48:51], v[88:91], v[216:219]
  ds_read_b64_tr_b16 v[46:47], v11 offset:58368
  v_mfma_f32_16x16x32_bf16 v[216:219], v[52:55], v[92:95], v[216:219]
  v_mfma_f32_16x16x32_bf16 v[224:227], v[48:51], v[96:99], v[224:227]
  v_mfma_f32_16x16x32_bf16 v[224:227], v[52:55], v[100:103], v[224:227]
  v_mfma_f32_16x16x32_bf16 v[228:231], v[56:59], v[96:99], v[228:231]
  v_mfma_f32_16x16x32_bf16 v[228:231], v[60:63], v[100:103], v[228:231]
  buffer_load_dwordx4 v20, s[36:39], s64 offen offset:2048 sc1 lds
  v_mfma_f32_16x16x32_bf16 v[236:239], v[56:59], v[104:107], v[236:239]
  v_mfma_f32_16x16x32_bf16 v[236:239], v[60:63], v[108:111], v[236:239]
  v_mfma_f32_16x16x32_bf16 v[232:235], v[48:51], v[104:107], v[232:235]
  v_mfma_f32_16x16x32_bf16 v[232:235], v[52:55], v[108:111], v[232:235]
  v_mfma_f32_16x16x32_bf16 v[240:243], v[48:51], v[112:115], v[240:243]
  s_add_u32 s97, s97, 65536
  v_mfma_f32_16x16x32_bf16 v[240:243], v[52:55], v[116:119], v[240:243]
  v_mfma_f32_16x16x32_bf16 v[244:247], v[56:59], v[112:115], v[244:247]
  v_mfma_f32_16x16x32_bf16 v[244:247], v[60:63], v[116:119], v[244:247]
  buffer_load_dwordx4 v21, s[36:39], s64 offen offset:3072 sc1 lds
  v_mfma_f32_16x16x32_bf16 v[252:255], v[56:59], v[120:123], v[252:255]
  s_add_u32 s64, s64, 128
  v_mfma_f32_16x16x32_bf16 v[252:255], v[60:63], v[124:127], v[252:255]
  s_waitcnt lgkmcnt(0)
  v_mfma_f32_16x16x32_bf16 v[248:251], v[48:51], v[120:123], v[248:251]
  v_mfma_f32_16x16x32_bf16 v[248:251], v[52:55], v[124:127], v[248:251]
  v_mfma_f32_16x16x32_bf16 a[128:131], v[64:67], v[32:35], a[128:131]
  ds_read_b64_tr_b16 v[48:49], v12 offset:49152
  v_mfma_f32_16x16x32_bf16 a[128:131], v[68:71], v[36:39], a[128:131]
  v_mfma_f32_16x16x32_bf16 a[160:163], v[64:67], v[40:43], a[160:163]
  s_add_u32 m0, s69, 98304
  ds_read_b64_tr_b16 v[50:51], v12 offset:50176
  v_mfma_f32_16x16x32_bf16 a[160:163], v[68:71], v[44:47], a[160:163]
  buffer_load_dwordx4 v18, s[36:39], s65 offen offset:0 sc1 lds
  v_mfma_f32_16x16x32_bf16 a[164:167], v[72:75], v[40:43], a[164:167]
  ds_read_b64_tr_b16 v[52:53], v12 offset:57344
  v_mfma_f32_16x16x32_bf16 a[164:167], v[76:79], v[44:47], a[164:167]
  v_mfma_f32_16x16x32_bf16 a[132:135], v[72:75], v[32:35], a[132:135]
  ds_read_b64_tr_b16 v[54:55], v12 offset:58368
  v_mfma_f32_16x16x32_bf16 a[132:135], v[76:79], v[36:39], a[132:135]
  buffer_load_dword a64, v31, s[56:59], s97 offen
  v_mfma_f32_16x16x32_bf16 a[136:139], v[80:83], v[32:35], a[136:139]
  ds_read_b64_tr_b16 v[56:57], v13 offset:49152
  v_mfma_f32_16x16x32_bf16 a[136:139], v[84:87], v[36:39], a[136:139]
  v_mfma_f32_16x16x32_bf16 a[168:171], v[80:83], v[40:43], a[168:171]
  ds_read_b64_tr_b16 v[58:59], v13 offset:50176
  v_mfma_f32_16x16x32_bf16 a[168:171], v[84:87], v[44:47], a[168:171]
  buffer_load_dwordx4 v19, s[36:39], s65 offen offset:1024 sc1 lds
  v_mfma_f32_16x16x32_bf16 a[172:175], v[88:91], v[40:43], a[172:175]
  ds_read_b64_tr_b16 v[60:61], v13 offset:57344
  v_mfma_f32_16x16x32_bf16 a[172:175], v[92:95], v[44:47], a[172:175]
  v_mfma_f32_16x16x32_bf16 a[140:143], v[88:91], v[32:35], a[140:143]
  ds_read_b64_tr_b16 v[62:63], v13 offset:58368
  v_mfma_f32_16x16x32_bf16 a[140:143], v[92:95], v[36:39], a[140:143]
  v_mfma_f32_16x16x32_bf16 a[144:147], v[96:99], v[32:35], a[144:147]
  v_mfma_f32_16x16x32_bf16 a[144:147], v[100:103], v[36:39], a[144:147]
  v_mfma_f32_16x16x32_bf16 a[176:179], v[96:99], v[40:43], a[176:179]
  v_mfma_f32_16x16x32_bf16 a[176:179], v[100:103], v[44:47], a[176:179]
  buffer_load_dwordx4 v20, s[36:39], s65 offen offset:2048 sc1 lds
  v_mfma_f32_16x16x32_bf16 a[180:183], v[104:107], v[40:43], a[180:183]
  v_mfma_f32_16x16x32_bf16 a[180:183], v[108:111], v[44:47], a[180:183]
  v_mfma_f32_16x16x32_bf16 a[148:151], v[104:107], v[32:35], a[148:151]
  v_mfma_f32_16x16x32_bf16 a[148:151], v[108:111], v[36:39], a[148:151]
  s_add_u32 s97, s97, 65536
  v_mfma_f32_16x16x32_bf16 a[152:155], v[112:115], v[32:35], a[152:155]
  v_mfma_f32_16x16x32_bf16 a[152:155], v[116:119], v[36:39], a[152:155]
  v_mfma_f32_16x16x32_bf16 a[184:187], v[112:115], v[40:43], a[184:187]
  v_mfma_f32_16x16x32_bf16 a[184:187], v[116:119], v[44:47], a[184:187]
  buffer_load_dwordx4 v21, s[36:39], s65 offen offset:3072 sc1 lds
  v_mfma_f32_16x16x32_bf16 a[188:191], v[120:123], v[40:43], a[188:191]
  s_add_u32 s65, s65, 128
  v_mfma_f32_16x16x32_bf16 a[188:191], v[124:127], v[44:47], a[188:191]
  v_mfma_f32_16x16x32_bf16 a[156:159], v[120:123], v[32:35], a[156:159]
  v_mfma_f32_16x16x32_bf16 a[156:159], v[124:127], v[36:39], a[156:159]
  s_waitcnt vmcnt(15) lgkmcnt(0)
  s_barrier
  v_mfma_f32_16x16x32_bf16 a[192:195], v[64:67], v[48:51], a[192:195]
  ds_read_b64_tr_b16 v[32:33], v6 offset:0
  ds_read_b64_tr_b16 v[34:35], v6 offset:1024
  v_mfma_f32_16x16x32_bf16 a[192:195], v[68:71], v[52:55], a[192:195]
  ds_read_b64_tr_b16 v[36:37], v6 offset:8192
  ds_read_b64_tr_b16 v[38:39], v6 offset:9216
  v_mfma_f32_16x16x32_bf16 a[224:227], v[64:67], v[56:59], a[224:227]
  ds_read_b64_tr_b16 v[40:41], v7 offset:0
  ds_read_b64_tr_b16 v[42:43], v7 offset:1024
  v_mfma_f32_16x16x32_bf16 a[224:227], v[68:71], v[60:63], a[224:227]
  ds_read_b128 v[64:67], v2 offset:16384
  v_mfma_f32_16x16x32_bf16 a[228:231], v[72:75], v[56:59], a[228:231]
  s_add_u32 m0, s69, 65536
  ds_read_b128 v[68:71], v3 offset:16384
  v_mfma_f32_16x16x32_bf16 a[228:231], v[76:79], v[60:63], a[228:231]
  ds_read_b64_tr_b16 v[44:45], v7 offset:8192
  ds_read_b64_tr_b16 v[46:47], v7 offset:9216
  v_mfma_f32_16x16x32_bf16 a[196:199], v[72:75], v[48:51], a[196:199]
  buffer_load_dwordx4 v22, s[40:43], s66 offen offset:0 sc1 lds
  v_mfma_f32_16x16x32_bf16 a[196:199], v[76:79], v[52:55], a[196:199]
  ds_read_b128 v[72:75], v2 offset:18432
  v_mfma_f32_16x16x32_bf16 a[200:203], v[80:83], v[48:51], a[200:203]
  ds_read_b128 v[76:79], v3 offset:18432
  v_mfma_f32_16x16x32_bf16 a[200:203], v[84:87], v[52:55], a[200:203]
  buffer_load_dword a64, v31, s[56:59], s97 offen
  v_mfma_f32_16x16x32_bf16 a[232:235], v[80:83], v[56:59], a[232:235]
  v_mfma_f32_16x16x32_bf16 a[232:235], v[84:87], v[60:63], a[232:235]
  ds_read_b128 v[80:83], v2 offset:20480
  v_mfma_f32_16x16x32_bf16 a[236:239], v[88:91], v[56:59], a[236:239]
  ds_read_b128 v[84:87], v3 offset:20480
  v_mfma_f32_16x16x32_bf16 a[236:239], v[92:95], v[60:63], a[236:239]
  buffer_load_dwordx4 v23, s[40:43], s66 offen offset:1024 sc1 lds
  v_mfma_f32_16x16x32_bf16 a[204:207], v[88:91], v[48:51], a[204:207]
  v_mfma_f32_16x16x32_bf16 a[204:207], v[92:95], v[52:55], a[204:207]
  ds_read_b128 v[88:91], v2 offset:22528
  v_mfma_f32_16x16x32_bf16 a[208:211], v[96:99], v[48:51], a[208:211]
  ds_read_b128 v[92:95], v3 offset:22528
  v_mfma_f32_16x16x32_bf16 a[208:211], v[100:103], v[52:55], a[208:211]
  v_mfma_f32_16x16x32_bf16 a[240:243], v[96:99], v[56:59], a[240:243]
  v_mfma_f32_16x16x32_bf16 a[240:243], v[100:103], v[60:63], a[240:243]
  ds_read_b128 v[96:99], v2 offset:32768
  v_mfma_f32_16x16x32_bf16 a[244:247], v[104:107], v[56:59], a[244:247]
  ds_read_b128 v[100:103], v3 offset:32768
  v_mfma_f32_16x16x32_bf16 a[244:247], v[108:111], v[60:63], a[244:247]
  buffer_load_dwordx4 v24, s[40:43], s66 offen offset:2048 sc1 lds
  v_mfma_f32_16x16x32_bf16 a[212:215], v[104:107], v[48:51], a[212:215]
  v_mfma_f32_16x16x32_bf16 a[212:215], v[108:111], v[52:55], a[212:215]
  ds_read_b128 v[104:107], v2 offset:34816
  v_mfma_f32_16x16x32_bf16 a[216:219], v[112:115], v[48:51], a[216:219]
  s_add_u32 s97, s97, 65536
  ds_read_b128 v[108:111], v3 offset:34816
  v_mfma_f32_16x16x32_bf16 a[216:219], v[116:119], v[52:55], a[216:219]
  v_mfma_f32_16x16x32_bf16 a[248:251], v[112:115], v[56:59], a[248:251]
  v_mfma_f32_16x16x32_bf16 a[248:251], v[116:119], v[60:63], a[248:251]
  ds_read_b128 v[112:115], v2 offset:36864
  v_mfma_f32_16x16x32_bf16 a[252:255], v[120:123], v[56:59], a[252:255]
  ds_read_b128 v[116:119], v3 offset:36864
  v_mfma_f32_16x16x32_bf16 a[252:255], v[124:127], v[60:63], a[252:255]
  buffer_load_dwordx4 v25, s[40:43], s66 offen offset:3072 sc1 lds
  v_mfma_f32_16x16x32_bf16 a[220:223], v[120:123], v[48:51], a[220:223]
  s_add_u32 s66, s66, 524288
  v_mfma_f32_16x16x32_bf16 a[220:223], v[124:127], v[52:55], a[220:223]
  s_waitcnt lgkmcnt(6)
  ds_read_b128 v[120:123], v2 offset:38912
  ds_read_b128 v[124:127], v3 offset:38912
  v_mfma_f32_16x16x32_bf16 v[128:131], v[32:35], v[64:67], v[128:131]
  ds_read_b64_tr_b16 v[48:49], v8 offset:0
  v_mfma_f32_16x16x32_bf16 v[128:131], v[36:39], v[68:71], v[128:131]
  v_mfma_f32_16x16x32_bf16 v[132:135], v[40:43], v[64:67], v[132:135]
  s_add_u32 m0, s69, 114688
  ds_read_b64_tr_b16 v[50:51], v8 offset:1024
  v_mfma_f32_16x16x32_bf16 v[132:135], v[44:47], v[68:71], v[132:135]
  buffer_load_dwordx4 v22, s[44:47], s67 offen offset:0 sc1 lds
  v_mfma_f32_16x16x32_bf16 v[140:143], v[40:43], v[72:75], v[140:143]
  ds_read_b64_tr_b16 v[52:53], v8 offset:8192
  v_mfma_f32_16x16x32_bf16 v[140:143], v[44:47], v[76:79], v[140:143]
  buffer_load_dword a64, v31, s[56:59], s97 offen
  v_mfma_f32_16x16x32_bf16 v[136:139], v[32:35], v[72:75], v[136:139]
  ds_read_b64_tr_b16 v[54:55], v8 offset:9216
  v_mfma_f32_16x16x32_bf16 v[136:139], v[36:39], v[76:79], v[136:139]
  v_mfma_f32_16x16x32_bf16 v[144:147], v[32:35], v[80:83], v[144:147]
  ds_read_b64_tr_b16 v[56:57], v9 offset:0
  v_mfma_f32_16x16x32_bf16 v[144:147], v[36:39], v[84:87], v[144:147]
  v_mfma_f32_16x16x32_bf16 v[148:151], v[40:43], v[80:83], v[148:151]
  ds_read_b64_tr_b16 v[58:59], v9 offset:1024
  v_mfma_f32_16x16x32_bf16 v[148:151], v[44:47], v[84:87], v[148:151]
  buffer_load_dwordx4 v23, s[44:47], s67 offen offset:1024 sc1 lds
  v_mfma_f32_16x16x32_bf16 v[156:159], v[40:43], v[88:91], v[156:159]
  ds_read_b64_tr_b16 v[60:61], v9 offset:8192
  v_mfma_f32_16x16x32_bf16 v[156:159], v[44:47], v[92:95], v[156:159]
  v_mfma_f32_16x16x32_bf16 v[152:155], v[32:35], v[88:91], v[152:155]
  ds_read_b64_tr_b16 v[62:63], v9 offset:9216
  v_mfma_f32_16x16x32_bf16 v[152:155], v[36:39], v[92:95], v[152:155]
  s_waitcnt lgkmcnt(8)
  s_add_u32 s97, s97, 65536
  v_mfma_f32_16x16x32_bf16 v[160:163], v[32:35], v[96:99], v[160:163]
  v_mfma_f32_16x16x32_bf16 v[160:163], v[36:39], v[100:103], v[160:163]
  v_mfma_f32_16x16x32_bf16 v[164:167], v[40:43], v[96:99], v[164:167]
  v_mfma_f32_16x16x32_bf16 v[164:167], v[44:47], v[100:103], v[164:167]
  buffer_load_dwordx4 v24, s[44:47], s67 offen offset:2048 sc1 lds
  v_mfma_f32_16x16x32_bf16 v[172:175], v[40:43], v[104:107], v[172:175]
  v_mfma_f32_16x16x32_bf16 v[172:175], v[44:47], v[108:111], v[172:175]
  v_mfma_f32_16x16x32_bf16 v[168:171], v[32:35], v[104:107], v[168:171]
  v_mfma_f32_16x16x32_bf16 v[168:171], v[36:39], v[108:111], v[168:171]
  v_mfma_f32_16x16x32_bf16 v[176:179], v[32:35], v[112:115], v[176:179]
  v_mfma_f32_16x16x32_bf16 v[176:179], v[36:39], v[116:119], v[176:179]
  buffer_load_dword a2, off, s[52:55], 0 sc1
  v_mfma_f32_16x16x32_bf16 v[180:183], v[40:43], v[112:115], v[180:183]
  v_mfma_f32_16x16x32_bf16 v[180:183], v[44:47], v[116:119], v[180:183]
  buffer_load_dwordx4 v25, s[44:47], s67 offen offset:3072 sc1 lds
  v_mfma_f32_16x16x32_bf16 v[188:191], v[40:43], v[120:123], v[188:191]
  s_add_u32 s67, s67, 524288
  v_mfma_f32_16x16x32_bf16 v[188:191], v[44:47], v[124:127], v[188:191]
  v_mfma_f32_16x16x32_bf16 v[184:187], v[32:35], v[120:123], v[184:187]
  v_mfma_f32_16x16x32_bf16 v[184:187], v[36:39], v[124:127], v[184:187]
  s_waitcnt vmcnt(22) lgkmcnt(0)
  s_barrier
  v_mfma_f32_16x16x32_bf16 v[192:195], v[48:51], v[64:67], v[192:195]
  ds_read_b64_tr_b16 v[32:33], v6 offset:49152
  v_mfma_f32_16x16x32_bf16 v[192:195], v[52:55], v[68:71], v[192:195]
  v_mfma_f32_16x16x32_bf16 v[196:199], v[56:59], v[64:67], v[196:199]
  s_add_u32 m0, s69, 16384
  ds_read_b64_tr_b16 v[34:35], v6 offset:50176
  v_mfma_f32_16x16x32_bf16 v[196:199], v[60:63], v[68:71], v[196:199]
  buffer_load_dwordx4 v18, s[36:39], s64 offen offset:0 sc1 lds
  v_mfma_f32_16x16x32_bf16 v[204:207], v[56:59], v[72:75], v[204:207]
  ds_read_b64_tr_b16 v[36:37], v6 offset:57344
  v_mfma_f32_16x16x32_bf16 v[204:207], v[60:63], v[76:79], v[204:207]
  v_mfma_f32_16x16x32_bf16 v[200:203], v[48:51], v[72:75], v[200:203]
  ds_read_b64_tr_b16 v[38:39], v6 offset:58368
  v_mfma_f32_16x16x32_bf16 v[200:203], v[52:55], v[76:79], v[200:203]
  buffer_load_dword a64, v31, s[56:59], s97 offen
  v_mfma_f32_16x16x32_bf16 v[208:211], v[48:51], v[80:83], v[208:211]
  ds_read_b64_tr_b16 v[40:41], v7 offset:49152
  v_mfma_f32_16x16x32_bf16 v[208:211], v[52:55], v[84:87], v[208:211]
  v_mfma_f32_16x16x32_bf16 v[212:215], v[56:59], v[80:83], v[212:215]
  ds_read_b64_tr_b16 v[42:43], v7 offset:50176
  v_mfma_f32_16x16x32_bf16 v[212:215], v[60:63], v[84:87], v[212:215]
  buffer_load_dwordx4 v19, s[36:39], s64 offen offset:1024 sc1 lds
  v_mfma_f32_16x16x32_bf16 v[220:223], v[56:59], v[88:91], v[220:223]
  ds_read_b64_tr_b16 v[44:45], v7 offset:57344
  v_mfma_f32_16x16x32_bf16 v[220:223], v[60:63], v[92:95], v[220:223]
  v_mfma_f32_16x16x32_bf16 v[216:219], v[48:51], v[88:91], v[216:219]
  ds_read_b64_tr_b16 v[46:47], v7 offset:58368
  v_mfma_f32_16x16x32_bf16 v[216:219], v[52:55], v[92:95], v[216:219]
  v_mfma_f32_16x16x32_bf16 v[224:227], v[48:51], v[96:99], v[224:227]
  v_mfma_f32_16x16x32_bf16 v[224:227], v[52:55], v[100:103], v[224:227]
  v_mfma_f32_16x16x32_bf16 v[228:231], v[56:59], v[96:99], v[228:231]
  v_mfma_f32_16x16x32_bf16 v[228:231], v[60:63], v[100:103], v[228:231]
  buffer_load_dwordx4 v20, s[36:39], s64 offen offset:2048 sc1 lds
  v_mfma_f32_16x16x32_bf16 v[236:239], v[56:59], v[104:107], v[236:239]
  v_mfma_f32_16x16x32_bf16 v[236:239], v[60:63], v[108:111], v[236:239]
  v_mfma_f32_16x16x32_bf16 v[232:235], v[48:51], v[104:107], v[232:235]
  v_mfma_f32_16x16x32_bf16 v[232:235], v[52:55], v[108:111], v[232:235]
  v_mfma_f32_16x16x32_bf16 v[240:243], v[48:51], v[112:115], v[240:243]
  s_add_u32 s97, s97, 65536
  v_mfma_f32_16x16x32_bf16 v[240:243], v[52:55], v[116:119], v[240:243]
  v_mfma_f32_16x16x32_bf16 v[244:247], v[56:59], v[112:115], v[244:247]
  v_mfma_f32_16x16x32_bf16 v[244:247], v[60:63], v[116:119], v[244:247]
  buffer_load_dwordx4 v21, s[36:39], s64 offen offset:3072 sc1 lds
  v_mfma_f32_16x16x32_bf16 v[252:255], v[56:59], v[120:123], v[252:255]
  s_add_u32 s64, s64, 128
  v_mfma_f32_16x16x32_bf16 v[252:255], v[60:63], v[124:127], v[252:255]
  s_waitcnt lgkmcnt(0)
  v_mfma_f32_16x16x32_bf16 v[248:251], v[48:51], v[120:123], v[248:251]
  v_mfma_f32_16x16x32_bf16 v[248:251], v[52:55], v[124:127], v[248:251]
  v_mfma_f32_16x16x32_bf16 a[128:131], v[64:67], v[32:35], a[128:131]
  ds_read_b64_tr_b16 v[48:49], v8 offset:49152
  v_mfma_f32_16x16x32_bf16 a[128:131], v[68:71], v[36:39], a[128:131]
  v_mfma_f32_16x16x32_bf16 a[160:163], v[64:67], v[40:43], a[160:163]
  s_add_u32 m0, s69, 32768
  ds_read_b64_tr_b16 v[50:51], v8 offset:50176
  v_mfma_f32_16x16x32_bf16 a[160:163], v[68:71], v[44:47], a[160:163]
  buffer_load_dwordx4 v18, s[36:39], s65 offen offset:0 sc1 lds
  v_mfma_f32_16x16x32_bf16 a[164:167], v[72:75], v[40:43], a[164:167]
  ds_read_b64_tr_b16 v[52:53], v8 offset:57344
  v_mfma_f32_16x16x32_bf16 a[164:167], v[76:79], v[44:47], a[164:167]
  v_mfma_f32_16x16x32_bf16 a[132:135], v[72:75], v[32:35], a[132:135]
  ds_read_b64_tr_b16 v[54:55], v8 offset:58368
  v_mfma_f32_16x16x32_bf16 a[132:135], v[76:79], v[36:39], a[132:135]
  buffer_load_dword a64, v31, s[56:59], s97 offen
  v_mfma_f32_16x16x32_bf16 a[136:139], v[80:83], v[32:35], a[136:139]
  ds_read_b64_tr_b16 v[56:57], v9 offset:49152
  v_mfma_f32_16x16x32_bf16 a[136:139], v[84:87], v[36:39], a[136:139]
  v_mfma_f32_16x16x32_bf16 a[168:171], v[80:83], v[40:43], a[168:171]
  ds_read_b64_tr_b16 v[58:59], v9 offset:50176
  v_mfma_f32_16x16x32_bf16 a[168:171], v[84:87], v[44:47], a[168:171]
  buffer_load_dwordx4 v19, s[36:39], s65 offen offset:1024 sc1 lds
  v_mfma_f32_16x16x32_bf16 a[172:175], v[88:91], v[40:43], a[172:175]
  ds_read_b64_tr_b16 v[60:61], v9 offset:57344
  v_mfma_f32_16x16x32_bf16 a[172:175], v[92:95], v[44:47], a[172:175]
  v_mfma_f32_16x16x32_bf16 a[140:143], v[88:91], v[32:35], a[140:143]
  ds_read_b64_tr_b16 v[62:63], v9 offset:58368
  v_mfma_f32_16x16x32_bf16 a[140:143], v[92:95], v[36:39], a[140:143]
  v_mfma_f32_16x16x32_bf16 a[144:147], v[96:99], v[32:35], a[144:147]
  v_mfma_f32_16x16x32_bf16 a[144:147], v[100:103], v[36:39], a[144:147]
  v_mfma_f32_16x16x32_bf16 a[176:179], v[96:99], v[40:43], a[176:179]
  v_mfma_f32_16x16x32_bf16 a[176:179], v[100:103], v[44:47], a[176:179]
  buffer_load_dwordx4 v20, s[36:39], s65 offen offset:2048 sc1 lds
  v_mfma_f32_16x16x32_bf16 a[180:183], v[104:107], v[40:43], a[180:183]
  v_mfma_f32_16x16x32_bf16 a[180:183], v[108:111], v[44:47], a[180:183]
  v_mfma_f32_16x16x32_bf16 a[148:151], v[104:107], v[32:35], a[148:151]
  v_mfma_f32_16x16x32_bf16 a[148:151], v[108:111], v[36:39], a[148:151]
  s_add_u32 s97, s97, 65536
  v_mfma_f32_16x16x32_bf16 a[152:155], v[112:115], v[32:35], a[152:155]
  v_mfma_f32_16x16x32_bf16 a[152:155], v[116:119], v[36:39], a[152:155]
  v_mfma_f32_16x16x32_bf16 a[184:187], v[112:115], v[40:43], a[184:187]
  v_mfma_f32_16x16x32_bf16 a[184:187], v[116:119], v[44:47], a[184:187]
  buffer_load_dwordx4 v21, s[36:39], s65 offen offset:3072 sc1 lds
  v_mfma_f32_16x16x32_bf16 a[188:191], v[120:123], v[40:43], a[188:191]
  s_add_u32 s65, s65, 128
  v_mfma_f32_16x16x32_bf16 a[188:191], v[124:127], v[44:47], a[188:191]
  v_mfma_f32_16x16x32_bf16 a[156:159], v[120:123], v[32:35], a[156:159]
  v_mfma_f32_16x16x32_bf16 a[156:159], v[124:127], v[36:39], a[156:159]
  s_waitcnt vmcnt(16) lgkmcnt(0)
  s_barrier
  v_mfma_f32_16x16x32_bf16 a[192:195], v[64:67], v[48:51], a[192:195]
  ds_read_b64_tr_b16 v[32:33], v10 offset:0
  ds_read_b64_tr_b16 v[34:35], v10 offset:1024
  v_mfma_f32_16x16x32_bf16 a[192:195], v[68:71], v[52:55], a[192:195]
  ds_read_b64_tr_b16 v[36:37], v10 offset:8192
  ds_read_b64_tr_b16 v[38:39], v10 offset:9216
  v_mfma_f32_16x16x32_bf16 a[224:227], v[64:67], v[56:59], a[224:227]
  ds_read_b64_tr_b16 v[40:41], v11 offset:0
  ds_read_b64_tr_b16 v[42:43], v11 offset:1024
  v_mfma_f32_16x16x32_bf16 a[224:227], v[68:71], v[60:63], a[224:227]
  ds_read_b128 v[64:67], v4 offset:16384
  v_mfma_f32_16x16x32_bf16 a[228:231], v[72:75], v[56:59], a[228:231]
  s_add_u32 m0, s69, 0
  ds_read_b128 v[68:71], v5 offset:16384
  v_mfma_f32_16x16x32_bf16 a[228:231], v[76:79], v[60:63], a[228:231]
  ds_read_b64_tr_b16 v[44:45], v11 offset:8192
  ds_read_b64_tr_b16 v[46:47], v11 offset:9216
  v_mfma_f32_16x16x32_bf16 a[196:199], v[72:75], v[48:51], a[196:199]
  buffer_load_dwordx4 v22, s[40:43], s66 offen offset:0 sc1 lds
  v_mfma_f32_16x16x32_bf16 a[196:199], v[76:79], v[52:55], a[196:199]
  ds_read_b128 v[72:75], v4 offset:18432
  v_mfma_f32_16x16x32_bf16 a[200:203], v[80:83], v[48:51], a[200:203]
  ds_read_b128 v[76:79], v5 offset:18432
  v_mfma_f32_16x16x32_bf16 a[200:203], v[84:87], v[52:55], a[200:203]
  buffer_load_dword a64, v31, s[56:59], s97 offen
  v_mfma_f32_16x16x32_bf16 a[232:235], v[80:83], v[56:59], a[232:235]
  v_mfma_f32_16x16x32_bf16 a[232:235], v[84:87], v[60:63], a[232:235]
  ds_read_b128 v[80:83], v4 offset:20480
  v_mfma_f32_16x16x32_bf16 a[236:239], v[88:91], v[56:59], a[236:239]
  ds_read_b128 v[84:87], v5 offset:20480
  v_mfma_f32_16x16x32_bf16 a[236:239], v[92:95], v[60:63], a[236:239]
  buffer_load_dwordx4 v23, s[40:43], s66 offen offset:1024 sc1 lds
  v_mfma_f32_16x16x32_bf16 a[204:207], v[88:91], v[48:51], a[204:207]
  v_mfma_f32_16x16x32_bf16 a[204:207], v[92:95], v[52:55], a[204:207]
  ds_read_b128 v[88:91], v4 offset:22528
  v_mfma_f32_16x16x32_bf16 a[208:211], v[96:99], v[48:51], a[208:211]
  ds_read_b128 v[92:95], v5 offset:22528
  v_mfma_f32_16x16x32_bf16 a[208:211], v[100:103], v[52:55], a[208:211]
  v_mfma_f32_16x16x32_bf16 a[240:243], v[96:99], v[56:59], a[240:243]
  v_mfma_f32_16x16x32_bf16 a[240:243], v[100:103], v[60:63], a[240:243]
  ds_read_b128 v[96:99], v4 offset:32768
  v_mfma_f32_16x16x32_bf16 a[244:247], v[104:107], v[56:59], a[244:247]
  ds_read_b128 v[100:103], v5 offset:32768
  v_mfma_f32_16x16x32_bf16 a[244:247], v[108:111], v[60:63], a[244:247]
  buffer_load_dwordx4 v24, s[40:43], s66 offen offset:2048 sc1 lds
  v_mfma_f32_16x16x32_bf16 a[212:215], v[104:107], v[48:51], a[212:215]
  v_mfma_f32_16x16x32_bf16 a[212:215], v[108:111], v[52:55], a[212:215]
  ds_read_b128 v[104:107], v4 offset:34816
  v_mfma_f32_16x16x32_bf16 a[216:219], v[112:115], v[48:51], a[216:219]
  s_add_u32 s97, s97, 65536
  ds_read_b128 v[108:111], v5 offset:34816
  v_mfma_f32_16x16x32_bf16 a[216:219], v[116:119], v[52:55], a[216:219]
  v_mfma_f32_16x16x32_bf16 a[248:251], v[112:115], v[56:59], a[248:251]
  v_mfma_f32_16x16x32_bf16 a[248:251], v[116:119], v[60:63], a[248:251]
  ds_read_b128 v[112:115], v4 offset:36864
  v_mfma_f32_16x16x32_bf16 a[252:255], v[120:123], v[56:59], a[252:255]
  ds_read_b128 v[116:119], v5 offset:36864
  v_mfma_f32_16x16x32_bf16 a[252:255], v[124:127], v[60:63], a[252:255]
  buffer_load_dwordx4 v25, s[40:43], s66 offen offset:3072 sc1 lds
  v_mfma_f32_16x16x32_bf16 a[220:223], v[120:123], v[48:51], a[220:223]
  s_add_u32 s66, s66, 524288
  v_mfma_f32_16x16x32_bf16 a[220:223], v[124:127], v[52:55], a[220:223]
  s_waitcnt lgkmcnt(6)
  ds_read_b128 v[120:123], v4 offset:38912
  ds_read_b128 v[124:127], v5 offset:38912
  s_cmp_eq_u32 s77, 0
  s_cselect_b32 s56, s18, s20
  s_cselect_b32 s57, s19, s21
  v_mfma_f32_16x16x32_bf16 v[128:131], v[32:35], v[64:67], v[128:131]
  ds_read_b64_tr_b16 v[48:49], v12 offset:0
  v_mfma_f32_16x16x32_bf16 v[128:131], v[36:39], v[68:71], v[128:131]
  v_mbcnt_lo_u32_b32 v0, -1, 0
  v_mfma_f32_16x16x32_bf16 v[132:135], v[40:43], v[64:67], v[132:135]
  s_add_u32 m0, s69, 49152
  ds_read_b64_tr_b16 v[50:51], v12 offset:1024
  v_mfma_f32_16x16x32_bf16 v[132:135], v[44:47], v[68:71], v[132:135]
  buffer_load_dwordx4 v22, s[44:47], s67 offen offset:0 sc1 lds
  v_mfma_f32_16x16x32_bf16 v[140:143], v[40:43], v[72:75], v[140:143]
  ds_read_b64_tr_b16 v[52:53], v12 offset:8192
  v_mbcnt_hi_u32_b32 v0, -1, v0
  v_mfma_f32_16x16x32_bf16 v[140:143], v[44:47], v[76:79], v[140:143]
  s_mov_b32 s58, 1835008
  v_mfma_f32_16x16x32_bf16 v[136:139], v[32:35], v[72:75], v[136:139]
  ds_read_b64_tr_b16 v[54:55], v12 offset:9216
  v_mfma_f32_16x16x32_bf16 v[136:139], v[36:39], v[76:79], v[136:139]
  v_mfma_f32_16x16x32_bf16 v[144:147], v[32:35], v[80:83], v[144:147]
  ds_read_b64_tr_b16 v[56:57], v13 offset:0
  v_mul_u32_u24 v31, 3584, v0
  v_mfma_f32_16x16x32_bf16 v[144:147], v[36:39], v[84:87], v[144:147]
  v_mfma_f32_16x16x32_bf16 v[148:151], v[40:43], v[80:83], v[148:151]
  s_lshl_b32 s97, s33, 4
  ds_read_b64_tr_b16 v[58:59], v13 offset:1024
  v_mfma_f32_16x16x32_bf16 v[148:151], v[44:47], v[84:87], v[148:151]
  buffer_load_dwordx4 v23, s[44:47], s67 offen offset:1024 sc1 lds
  v_mfma_f32_16x16x32_bf16 v[156:159], v[40:43], v[88:91], v[156:159]
  ds_read_b64_tr_b16 v[60:61], v13 offset:8192
  v_mfma_f32_16x16x32_bf16 v[156:159], v[44:47], v[92:95], v[156:159]
  s_add_u32 s97, s97, s76
  v_mfma_f32_16x16x32_bf16 v[152:155], v[32:35], v[88:91], v[152:155]
  ds_read_b64_tr_b16 v[62:63], v13 offset:9216
  v_mfma_f32_16x16x32_bf16 v[152:155], v[36:39], v[92:95], v[152:155]
  s_waitcnt lgkmcnt(8)
  s_mul_i32 s97, s97, 14336
  v_mfma_f32_16x16x32_bf16 v[160:163], v[32:35], v[96:99], v[160:163]
  v_mfma_f32_16x16x32_bf16 v[160:163], v[36:39], v[100:103], v[160:163]
  s_lshl_b32 s72, s71, 7
  v_mfma_f32_16x16x32_bf16 v[164:167], v[40:43], v[96:99], v[164:167]
  v_mfma_f32_16x16x32_bf16 v[164:167], v[44:47], v[100:103], v[164:167]
  buffer_load_dwordx4 v24, s[44:47], s67 offen offset:2048 sc1 lds
  v_mfma_f32_16x16x32_bf16 v[172:175], v[40:43], v[104:107], v[172:175]
  s_add_u32 s97, s97, s72
  v_mfma_f32_16x16x32_bf16 v[172:175], v[44:47], v[108:111], v[172:175]
  v_mfma_f32_16x16x32_bf16 v[168:171], v[32:35], v[104:107], v[168:171]
  v_lshrrev_b32 v0, 2, v0
  v_mfma_f32_16x16x32_bf16 v[168:171], v[36:39], v[108:111], v[168:171]
  v_mfma_f32_16x16x32_bf16 v[176:179], v[32:35], v[112:115], v[176:179]
  v_mfma_f32_16x16x32_bf16 v[176:179], v[36:39], v[116:119], v[176:179]
  v_lshl_add_u32 v31, v0, 26, v31
  v_mfma_f32_16x16x32_bf16 v[180:183], v[40:43], v[112:115], v[180:183]
  buffer_load_dword a64, v31, s[56:59], s97 offen
  v_mfma_f32_16x16x32_bf16 v[180:183], v[44:47], v[116:119], v[180:183]
  buffer_load_dwordx4 v25, s[44:47], s67 offen offset:3072 sc1 lds
  v_mfma_f32_16x16x32_bf16 v[188:191], v[40:43], v[120:123], v[188:191]
  s_add_u32 s67, s67, 524288
  v_mfma_f32_16x16x32_bf16 v[188:191], v[44:47], v[124:127], v[188:191]
  s_add_u32 s97, s97, 28672
  v_mfma_f32_16x16x32_bf16 v[184:187], v[32:35], v[120:123], v[184:187]
  v_mfma_f32_16x16x32_bf16 v[184:187], v[36:39], v[124:127], v[184:187]
  s_waitcnt vmcnt(20) lgkmcnt(0)
  s_barrier
  v_accvgpr_read_b32 v1, a2
  v_mov_b32 v0, 0
  v_cmp_eq_u32 vcc, 0, v1
  s_cbranch_vccnz L_spin_tag
L_spin_tag_r:
  v_readfirstlane_b32 s101, v1
  v_mfma_f32_16x16x32_bf16 v[192:195], v[48:51], v[64:67], v[192:195]
  ds_read_b64_tr_b16 v[32:33], v10 offset:49152
  v_mfma_f32_16x16x32_bf16 v[192:195], v[52:55], v[68:71], v[192:195]
  v_mfma_f32_16x16x32_bf16 v[196:199], v[56:59], v[64:67], v[196:199]
  s_add_u32 m0, s69, 81920
  ds_read_b64_tr_b16 v[34:35], v10 offset:50176
  v_mfma_f32_16x16x32_bf16 v[196:199], v[60:63], v[68:71], v[196:199]
  buffer_load_dwordx4 v18, s[36:39], s64 offen offset:0 sc1 lds
  v_mfma_f32_16x16x32_bf16 v[204:207], v[56:59], v[72:75], v[204:207]
  ds_read_b64_tr_b16 v[36:37], v10 offset:57344
  v_mfma_f32_16x16x32_bf16 v[204:207], v[60:63], v[76:79], v[204:207]
  v_mfma_f32_16x16x32_bf16 v[200:203], v[48:51], v[72:75], v[200:203]
  ds_read_b64_tr_b16 v[38:39], v10 offset:58368
  v_mfma_f32_16x16x32_bf16 v[200:203], v[52:55], v[76:79], v[200:203]
  buffer_load_dword a64, v31, s[56:59], s97 offen
  v_mfma_f32_16x16x32_bf16 v[208:211], v[48:51], v[80:83], v[208:211]
  ds_read_b64_tr_b16 v[40:41], v11 offset:49152
  v_mfma_f32_16x16x32_bf16 v[208:211], v[52:55], v[84:87], v[208:211]
  v_mfma_f32_16x16x32_bf16 v[212:215], v[56:59], v[80:83], v[212:215]
  ds_read_b64_tr_b16 v[42:43], v11 offset:50176
  v_mfma_f32_16x16x32_bf16 v[212:215], v[60:63], v[84:87], v[212:215]
  buffer_load_dwordx4 v19, s[36:39], s64 offen offset:1024 sc1 lds
  v_mfma_f32_16x16x32_bf16 v[220:223], v[56:59], v[88:91], v[220:223]
  ds_read_b64_tr_b16 v[44:45], v11 offset:57344
  v_mfma_f32_16x16x32_bf16 v[220:223], v[60:63], v[92:95], v[220:223]
  v_mfma_f32_16x16x32_bf16 v[216:219], v[48:51], v[88:91], v[216:219]
  ds_read_b64_tr_b16 v[46:47], v11 offset:58368
  v_mfma_f32_16x16x32_bf16 v[216:219], v[52:55], v[92:95], v[216:219]
  v_mfma_f32_16x16x32_bf16 v[224:227], v[48:51], v[96:99], v[224:227]
  v_mfma_f32_16x16x32_bf16 v[224:227], v[52:55], v[100:103], v[224:227]
  v_mfma_f32_16x16x32_bf16 v[228:231], v[56:59], v[96:99], v[228:231]
  v_mfma_f32_16x16x32_bf16 v[228:231], v[60:63], v[100:103], v[228:231]
  buffer_load_dwordx4 v20, s[36:39], s64 offen offset:2048 sc1 lds
  v_mfma_f32_16x16x32_bf16 v[236:239], v[56:59], v[104:107], v[236:239]
  v_mfma_f32_16x16x32_bf16 v[236:239], v[60:63], v[108:111], v[236:239]
  v_mfma_f32_16x16x32_bf16 v[232:235], v[48:51], v[104:107], v[232:235]
  v_mfma_f32_16x16x32_bf16 v[232:235], v[52:55], v[108:111], v[232:235]
  v_mfma_f32_16x16x32_bf16 v[240:243], v[48:51], v[112:115], v[240:243]
  s_add_u32 s97, s97, 28672
  v_mfma_f32_16x16x32_bf16 v[240:243], v[52:55], v[116:119], v[240:243]
L_pg2:
  s_cbranch_execz L_pg6
  v_mfma_f32_16x16x32_bf16 v[244:247], v[56:59], v[112:115], v[244:247]
  v_mfma_f32_16x16x32_bf16 v[244:247], v[60:63], v[116:119], v[244:247]
  buffer_load_dwordx4 v21, s[36:39], s64 offen offset:3072 sc1 lds
  v_mfma_f32_16x16x32_bf16 v[252:255], v[56:59], v[120:123], v[252:255]
  s_add_u32 s64, s64, 128
  v_mfma_f32_16x16x32_bf16 v[252:255], v[60:63], v[124:127], v[252:255]
  s_waitcnt lgkmcnt(0)
  v_mfma_f32_16x16x32_bf16 v[248:251], v[48:51], v[120:123], v[248:251]
  v_mfma_f32_16x16x32_bf16 v[248:251], v[52:55], v[124:127], v[248:251]
  v_mfma_f32_16x16x32_bf16 a[128:131], v[64:67], v[32:35], a[128:131]
  ds_read_b64_tr_b16 v[48:49], v12 offset:49152
  v_mfma_f32_16x16x32_bf16 a[128:131], v[68:71], v[36:39], a[128:131]
  buffer_load_dword a64, v31, s[56:59], s97 offen
  v_mfma_f32_16x16x32_bf16 a[160:163], v[64:67], v[40:43], a[160:163]
  s_add_u32 m0, s69, 98304
  ds_read_b64_tr_b16 v[50:51], v12 offset:50176
  v_mfma_f32_16x16x32_bf16 a[160:163], v[68:71], v[44:47], a[160:163]
  buffer_load_dwordx4 v18, s[36:39], s65 offen offset:0 sc1 lds
  v_mfma_f32_16x16x32_bf16 a[164:167], v[72:75], v[40:43], a[164:167]
  s_add_u32 s97, s97, 28672
  ds_read_b64_tr_b16 v[52:53], v12 offset:57344
  v_mfma_f32_16x16x32_bf16 a[164:167], v[76:79], v[44:47], a[164:167]
  v_mfma_f32_16x16x32_bf16 a[132:135], v[72:75], v[32:35], a[132:135]
  ds_read_b64_tr_b16 v[54:55], v12 offset:58368
  v_mfma_f32_16x16x32_bf16 a[132:135], v[76:79], v[36:39], a[132:135]
  s_lshr_b32 s35, s101, 31
  v_mfma_f32_16x16x32_bf16 a[136:139], v[80:83], v[32:35], a[136:139]
  ds_read_b64_tr_b16 v[56:57], v13 offset:49152
  v_mfma_f32_16x16x32_bf16 a[136:139], v[84:87], v[36:39], a[136:139]
  v_mfma_f32_16x16x32_bf16 a[168:171], v[80:83], v[40:43], a[168:171]
  s_bitset0_b32 s101, 31
  ds_read_b64_tr_b16 v[58:59], v13 offset:50176
  v_mfma_f32_16x16x32_bf16 a[168:171], v[84:87], v[44:47], a[168:171]
  buffer_load_dwordx4 v19, s[36:39], s65 offen offset:1024 sc1 lds
  v_mfma_f32_16x16x32_bf16 a[172:175], v[88:91], v[40:43], a[172:175]
  ds_read_b64_tr_b16 v[60:61], v13 offset:57344
  v_mfma_f32_16x16x32_bf16 a[172:175], v[92:95], v[44:47], a[172:175]
  s_xor_b32 s35, s35, s33
  v_mfma_f32_16x16x32_bf16 a[140:143], v[88:91], v[32:35], a[140:143]
  ds_read_b64_tr_b16 v[62:63], v13 offset:58368
  v_mfma_f32_16x16x32_bf16 a[140:143], v[92:95], v[36:39], a[140:143]
  v_mfma_f32_16x16x32_bf16 a[144:147], v[96:99], v[32:35], a[144:147]
  v_mfma_f32_16x16x32_bf16 a[144:147], v[100:103], v[36:39], a[144:147]
  s_and_b32 s35, s35, 1
  v_mfma_f32_16x16x32_bf16 a[176:179], v[96:99], v[40:43], a[176:179]
  v_mfma_f32_16x16x32_bf16 a[176:179], v[100:103], v[44:47], a[176:179]
  buffer_load_dwordx4 v20, s[36:39], s65 offen offset:2048 sc1 lds
  v_mfma_f32_16x16x32_bf16 a[180:183], v[104:107], v[40:43], a[180:183]
  s_or_b32 s16, s33, 1
  v_mfma_f32_16x16x32_bf16 a[180:183], v[108:111], v[44:47], a[180:183]
  v_mfma_f32_16x16x32_bf16 a[148:151], v[104:107], v[32:35], a[148:151]
  v_mfma_f32_16x16x32_bf16 a[148:151], v[108:111], v[36:39], a[148:151]
  s_sub_u32 s17, 16, s16
  v_mfma_f32_16x16x32_bf16 a[152:155], v[112:115], v[32:35], a[152:155]
  v_mfma_f32_16x16x32_bf16 a[152:155], v[116:119], v[36:39], a[152:155]
  v_mfma_f32_16x16x32_bf16 a[184:187], v[112:115], v[40:43], a[184:187]
  s_sub_u32 s16, s16, s35
  v_mfma_f32_16x16x32_bf16 a[184:187], v[116:119], v[44:47], a[184:187]
  buffer_load_dwordx4 v21, s[36:39], s65 offen offset:3072 sc1 lds
  v_mfma_f32_16x16x32_bf16 a[188:191], v[120:123], v[40:43], a[188:191]
  s_add_u32 s65, s65, 128
  v_mfma_f32_16x16x32_bf16 a[188:191], v[124:127], v[44:47], a[188:191]
  s_sub_u32 s17, s17, s35
  v_mfma_f32_16x16x32_bf16 a[156:159], v[120:123], v[32:35], a[156:159]
  v_mfma_f32_16x16x32_bf16 a[156:159], v[124:127], v[36:39], a[156:159]
  s_waitcnt vmcnt(15) lgkmcnt(0)
  s_barrier
  v_mfma_f32_16x16x32_bf16 a[192:195], v[64:67], v[48:51], a[192:195]
  ds_read_b64_tr_b16 v[32:33], v6 offset:0
  ds_read_b64_tr_b16 v[34:35], v6 offset:1024
  v_mfma_f32_16x16x32_bf16 a[192:195], v[68:71], v[52:55], a[192:195]
  ds_read_b64_tr_b16 v[36:37], v6 offset:8192
  ds_read_b64_tr_b16 v[38:39], v6 offset:9216
  v_mfma_f32_16x16x32_bf16 a[224:227], v[64:67], v[56:59], a[224:227]
  ds_read_b64_tr_b16 v[40:41], v7 offset:0
  ds_read_b64_tr_b16 v[42:43], v7 offset:1024
  v_mfma_f32_16x16x32_bf16 a[224:227], v[68:71], v[60:63], a[224:227]
  ds_read_b128 v[64:67], v2 offset:16384
  v_mfma_f32_16x16x32_bf16 a[228:231], v[72:75], v[56:59], a[228:231]
  s_add_u32 m0, s69, 65536
  ds_read_b128 v[68:71], v3 offset:16384
  v_mfma_f32_16x16x32_bf16 a[228:231], v[76:79], v[60:63], a[228:231]
  ds_read_b64_tr_b16 v[44:45], v7 offset:8192
  ds_read_b64_tr_b16 v[46:47], v7 offset:9216
  v_mfma_f32_16x16x32_bf16 a[196:199], v[72:75], v[48:51], a[196:199]
  buffer_load_dwordx4 v22, s[40:43], s66 offen offset:0 sc1 lds
  v_mfma_f32_16x16x32_bf16 a[196:199], v[76:79], v[52:55], a[196:199]
  ds_read_b128 v[72:75], v2 offset:18432
  v_mfma_f32_16x16x32_bf16 a[200:203], v[80:83], v[48:51], a[200:203]
  ds_read_b128 v[76:79], v3 offset:18432
  v_mfma_f32_16x16x32_bf16 a[200:203], v[84:87], v[52:55], a[200:203]
  buffer_load_dword a64, v31, s[56:59], s97 offen
  v_mfma_f32_16x16x32_bf16 a[232:235], v[80:83], v[56:59], a[232:235]
  v_mfma_f32_16x16x32_bf16 a[232:235], v[84:87], v[60:63], a[232:235]
  ds_read_b128 v[80:83], v2 offset:20480
  v_mfma_f32_16x16x32_bf16 a[236:239], v[88:91], v[56:59], a[236:239]
  ds_read_b128 v[84:87], v3 offset:20480
  v_mfma_f32_16x16x32_bf16 a[236:239], v[92:95], v[60:63], a[236:239]
  buffer_load_dwordx4 v23, s[40:43], s66 offen offset:1024 sc1 lds
  v_mfma_f32_16x16x32_bf16 a[204:207], v[88:91], v[48:51], a[204:207]
  v_mfma_f32_16x16x32_bf16 a[204:207], v[92:95], v[52:55], a[204:207]
  ds_read_b128 v[88:91], v2 offset:22528
  v_mfma_f32_16x16x32_bf16 a[208:211], v[96:99], v[48:51], a[208:211]
  ds_read_b128 v[92:95], v3 offset:22528
  v_mfma_f32_16x16x32_bf16 a[208:211], v[100:103], v[52:55], a[208:211]
  v_mfma_f32_16x16x32_bf16 a[240:243], v[96:99], v[56:59], a[240:243]
  v_mfma_f32_16x16x32_bf16 a[240:243], v[100:103], v[60:63], a[240:243]
  ds_read_b128 v[96:99], v2 offset:32768
  v_mfma_f32_16x16x32_bf16 a[244:247], v[104:107], v[56:59], a[244:247]
  ds_read_b128 v[100:103], v3 offset:32768
  v_mfma_f32_16x16x32_bf16 a[244:247], v[108:111], v[60:63], a[244:247]
  buffer_load_dwordx4 v24, s[40:43], s66 offen offset:2048 sc1 lds
  v_mfma_f32_16x16x32_bf16 a[212:215], v[104:107], v[48:51], a[212:215]
  v_mfma_f32_16x16x32_bf16 a[212:215], v[108:111], v[52:55], a[212:215]
  ds_read_b128 v[104:107], v2 offset:34816
  v_mfma_f32_16x16x32_bf16 a[216:219], v[112:115], v[48:51], a[216:219]
  s_add_u32 s97, s97, 28672
  ds_read_b128 v[108:111], v3 offset:34816
  v_mfma_f32_16x16x32_bf16 a[216:219], v[116:119], v[52:55], a[216:219]
  v_mfma_f32_16x16x32_bf16 a[248:251], v[112:115], v[56:59], a[248:251]
  v_mfma_f32_16x16x32_bf16 a[248:251], v[116:119], v[60:63], a[248:251]
  ds_read_b128 v[112:115], v2 offset:36864
  v_mfma_f32_16x16x32_bf16 a[252:255], v[120:123], v[56:59], a[252:255]
  ds_read_b128 v[116:119], v3 offset:36864
  v_mfma_f32_16x16x32_bf16 a[252:255], v[124:127], v[60:63], a[252:255]
  buffer_load_dwordx4 v25, s[40:43], s66 offen offset:3072 sc1 lds
  v_mfma_f32_16x16x32_bf16 a[220:223], v[120:123], v[48:51], a[220:223]
  s_add_u32 s66, s66, 524288
  v_mfma_f32_16x16x32_bf16 a[220:223], v[124:127], v[52:55], a[220:223]
  s_waitcnt lgkmcnt(6)
  ds_read_b128 v[120:123], v2 offset:38912
  ds_read_b128 v[124:127], v3 offset:38912
L_c1:
  v_mfma_f32_16x16x32_bf16 v[128:131], v[32:35], v[64:67], v[128:131]
  ds_read_b64_tr_b16 v[48:49], v8 offset:0
  v_mfma_f32_16x16x32_bf16 v[128:131], v[36:39], v[68:71], v[128:131]
  v_mfma_f32_16x16x32_bf16 v[132:135], v[40:43], v[64:67], v[132:135]
  s_add_u32 m0, s69, 114688
  ds_read_b64_tr_b16 v[50:51], v8 offset:1024
  v_mfma_f32_16x16x32_bf16 v[132:135], v[44:47], v[68:71], v[132:135]
  buffer_load_dwordx4 v22, s[44:47], s67 offen offset:0 sc1 lds
  v_mfma_f32_16x16x32_bf16 v[140:143], v[40:43], v[72:75], v[140:143]
  ds_read_b64_tr_b16 v[52:53], v8 offset:8192
  v_mfma_f32_16x16x32_bf16 v[140:143], v[44:47], v[76:79], v[140:143]
  v_mfma_f32_16x16x32_bf16 v[136:139], v[32:35], v[72:75], v[136:139]
  ds_read_b64_tr_b16 v[54:55], v8 offset:9216
  v_mfma_f32_16x16x32_bf16 v[136:139], v[36:39], v[76:79], v[136:139]
  buffer_load_dword a64, v31, s[56:59], s97 offen
  v_mfma_f32_16x16x32_bf16 v[144:147], v[32:35], v[80:83], v[144:147]
  ds_read_b64_tr_b16 v[56:57], v9 offset:0
  v_mfma_f32_16x16x32_bf16 v[144:147], v[36:39], v[84:87], v[144:147]
  v_mfma_f32_16x16x32_bf16 v[148:151], v[40:43], v[80:83], v[148:151]
  ds_read_b64_tr_b16 v[58:59], v9 offset:1024
  v_mfma_f32_16x16x32_bf16 v[148:151], v[44:47], v[84:87], v[148:151]
  buffer_load_dwordx4 v23, s[44:47], s67 offen offset:1024 sc1 lds
  v_mfma_f32_16x16x32_bf16 v[156:159], v[40:43], v[88:91], v[156:159]
  ds_read_b64_tr_b16 v[60:61], v9 offset:8192
  v_mfma_f32_16x16x32_bf16 v[156:159], v[44:47], v[92:95], v[156:159]
  v_mfma_f32_16x16x32_bf16 v[152:155], v[32:35], v[88:91], v[152:155]
  ds_read_b64_tr_b16 v[62:63], v9 offset:9216
  v_mfma_f32_16x16x32_bf16 v[152:155], v[36:39], v[92:95], v[152:155]
  s_waitcnt lgkmcnt(8)
  v_mfma_f32_16x16x32_bf16 v[160:163], v[32:35], v[96:99], v[160:163]
  v_mfma_f32_16x16x32_bf16 v[160:163], v[36:39], v[100:103], v[160:163]
  v_mfma_f32_16x16x32_bf16 v[164:167], v[40:43], v[96:99], v[164:167]
  v_mfma_f32_16x16x32_bf16 v[164:167], v[44:47], v[100:103], v[164:167]
  buffer_load_dwordx4 v24, s[44:47], s67 offen offset:2048 sc1 lds
  v_mfma_f32_16x16x32_bf16 v[172:175], v[40:43], v[104:107], v[172:175]
  v_mfma_f32_16x16x32_bf16 v[172:175], v[44:47], v[108:111], v[172:175]
  v_mfma_f32_16x16x32_bf16 v[168:171], v[32:35], v[104:107], v[168:171]
  v_mfma_f32_16x16x32_bf16 v[168:171], v[36:39], v[108:111], v[168:171]
  s_add_u32 s97, s97, 28672
  v_mfma_f32_16x16x32_bf16 v[176:179], v[32:35], v[112:115], v[176:179]
  v_mfma_f32_16x16x32_bf16 v[176:179], v[36:39], v[116:119], v[176:179]
  v_mfma_f32_16x16x32_bf16 v[180:183], v[40:43], v[112:115], v[180:183]
  v_mfma_f32_16x16x32_bf16 v[180:183], v[44:47], v[116:119], v[180:183]
  buffer_load_dwordx4 v25, s[44:47], s67 offen offset:3072 sc1 lds
  v_mfma_f32_16x16x32_bf16 v[188:191], v[40:43], v[120:123], v[188:191]
  s_add_u32 s67, s67, 524288
  v_mfma_f32_16x16x32_bf16 v[188:191], v[44:47], v[124:127], v[188:191]
  v_mfma_f32_16x16x32_bf16 v[184:187], v[32:35], v[120:123], v[184:187]
  v_mfma_f32_16x16x32_bf16 v[184:187], v[36:39], v[124:127], v[184:187]
  s_waitcnt vmcnt(20) lgkmcnt(0)
  s_barrier
  s_mov_b32 s36, s4
  s_mov_b32 s37, s5
  s_mov_b32 s38, 2097152
  s_mov_b32 s39, 0x20000
  s_mov_b32 s40, s8
  s_mov_b32 s41, s9
  s_mov_b32 s42, 4194304
  s_mov_b32 s43, 0x20000
  s_cmp_eq_u32 s77, 0
  s_cselect_b32 s35, s16, s17
  s_lshl_b32 s64, s35, 17
  s_lshl_b32 s35, s76, 15
  s_add_u32 s64, s64, s35
  s_add_u32 s65, s64, 65536
  s_lshl_b32 s66, s34, 17
  s_lshl_b32 s35, s32, 8
  s_add_u32 s66, s66, s35
  v_mfma_f32_16x16x32_bf16 v[192:195], v[48:51], v[64:67], v[192:195]
  ds_read_b64_tr_b16 v[32:33], v6 offset:49152
  v_mfma_f32_16x16x32_bf16 v[192:195], v[52:55], v[68:71], v[192:195]
  v_mfma_f32_16x16x32_bf16 v[196:199], v[56:59], v[64:67], v[196:199]
  s_add_u32 m0, s69, 16384
  ds_read_b64_tr_b16 v[34:35], v6 offset:50176
  v_mfma_f32_16x16x32_bf16 v[196:199], v[60:63], v[68:71], v[196:199]
  buffer_load_dwordx4 v18, s[36:39], s64 offen offset:0 sc1 lds
  v_mfma_f32_16x16x32_bf16 v[204:207], v[56:59], v[72:75], v[204:207]
  ds_read_b64_tr_b16 v[36:37], v6 offset:57344
  v_mfma_f32_16x16x32_bf16 v[204:207], v[60:63], v[76:79], v[204:207]
  v_mfma_f32_16x16x32_bf16 v[200:203], v[48:51], v[72:75], v[200:203]
  ds_read_b64_tr_b16 v[38:39], v6 offset:58368
  v_mfma_f32_16x16x32_bf16 v[200:203], v[52:55], v[76:79], v[200:203]
  buffer_load_dword a64, v31, s[56:59], s97 offen
  v_mfma_f32_16x16x32_bf16 v[208:211], v[48:51], v[80:83], v[208:211]
  ds_read_b64_tr_b16 v[40:41], v7 offset:49152
  v_mfma_f32_16x16x32_bf16 v[208:211], v[52:55], v[84:87], v[208:211]
  v_mfma_f32_16x16x32_bf16 v[212:215], v[56:59], v[80:83], v[212:215]
  ds_read_b64_tr_b16 v[42:43], v7 offset:50176
  v_mfma_f32_16x16x32_bf16 v[212:215], v[60:63], v[84:87], v[212:215]
  buffer_load_dwordx4 v19, s[36:39], s64 offen offset:1024 sc1 lds
  v_mfma_f32_16x16x32_bf16 v[220:223], v[56:59], v[88:91], v[220:223]
  ds_read_b64_tr_b16 v[44:45], v7 offset:57344
  v_mfma_f32_16x16x32_bf16 v[220:223], v[60:63], v[92:95], v[220:223]
  v_mfma_f32_16x16x32_bf16 v[216:219], v[48:51], v[88:91], v[216:219]
  ds_read_b64_tr_b16 v[46:47], v7 offset:58368
  v_mfma_f32_16x16x32_bf16 v[216:219], v[52:55], v[92:95], v[216:219]
  v_mfma_f32_16x16x32_bf16 v[224:227], v[48:51], v[96:99], v[224:227]
  v_mfma_f32_16x16x32_bf16 v[224:227], v[52:55], v[100:103], v[224:227]
  v_mfma_f32_16x16x32_bf16 v[228:231], v[56:59], v[96:99], v[228:231]
  v_mfma_f32_16x16x32_bf16 v[228:231], v[60:63], v[100:103], v[228:231]
  buffer_load_dwordx4 v20, s[36:39], s64 offen offset:2048 sc1 lds
  v_mfma_f32_16x16x32_bf16 v[236:239], v[56:59], v[104:107], v[236:239]
  v_mfma_f32_16x16x32_bf16 v[236:239], v[60:63], v[108:111], v[236:239]
  v_mfma_f32_16x16x32_bf16 v[232:235], v[48:51], v[104:107], v[232:235]
  v_mfma_f32_16x16x32_bf16 v[232:235], v[52:55], v[108:111], v[232:235]
  v_mfma_f32_16x16x32_bf16 v[240:243], v[48:51], v[112:115], v[240:243]
  s_add_u32 s97, s97, 28672
  v_mfma_f32_16x16x32_bf16 v[240:243], v[52:55], v[116:119], v[240:243]
  v_mfma_f32_16x16x32_bf16 v[244:247], v[56:59], v[112:115], v[244:247]
  v_mfma_f32_16x16x32_bf16 v[244:247], v[60:63], v[116:119], v[244:247]
  buffer_load_dwordx4 v21, s[36:39], s64 offen offset:3072 sc1 lds
  v_mfma_f32_16x16x32_bf16 v[252:255], v[56:59], v[120:123], v[252:255]
  s_add_u32 s64, s64, 128
  v_mfma_f32_16x16x32_bf16 v[252:255], v[60:63], v[124:127], v[252:255]
  s_waitcnt lgkmcnt(0)
  v_mfma_f32_16x16x32_bf16 v[248:251], v[48:51], v[120:123], v[248:251]
  v_mfma_f32_16x16x32_bf16 v[248:251], v[52:55], v[124:127], v[248:251]
  v_mfma_f32_16x16x32_bf16 a[128:131], v[64:67], v[32:35], a[128:131]
  ds_read_b64_tr_b16 v[48:49], v8 offset:49152
  v_mfma_f32_16x16x32_bf16 a[128:131], v[68:71], v[36:39], a[128:131]
  v_mfma_f32_16x16x32_bf16 a[160:163], v[64:67], v[40:43], a[160:163]
  s_add_u32 m0, s69, 32768
  ds_read_b64_tr_b16 v[50:51], v8 offset:50176
  v_mfma_f32_16x16x32_bf16 a[160:163], v[68:71], v[44:47], a[160:163]
  buffer_load_dwordx4 v18, s[36:39], s65 offen offset:0 sc1 lds
  v_mfma_f32_16x16x32_bf16 a[164:167], v[72:75], v[40:43], a[164:167]
  ds_read_b64_tr_b16 v[52:53], v8 offset:57344
  v_mfma_f32_16x16x32_bf16 a[164:167], v[76:79], v[44:47], a[164:167]
  v_mfma_f32_16x16x32_bf16 a[132:135], v[72:75], v[32:35], a[132:135]
  ds_read_b64_tr_b16 v[54:55], v8 offset:58368
  v_mfma_f32_16x16x32_bf16 a[132:135], v[76:79], v[36:39], a[132:135]
  buffer_load_dword a64, v31, s[56:59], s97 offen
  v_mfma_f32_16x16x32_bf16 a[136:139], v[80:83], v[32:35], a[136:139]
  ds_read_b64_tr_b16 v[56:57], v9 offset:49152
  v_mfma_f32_16x16x32_bf16 a[136:139], v[84:87], v[36:39], a[136:139]
  v_mfma_f32_16x16x32_bf16 a[168:171], v[80:83], v[40:43], a[168:171]
  ds_read_b64_tr_b16 v[58:59], v9 offset:50176
  v_mfma_f32_16x16x32_bf16 a[168:171], v[84:87], v[44:47], a[168:171]
  buffer_load_dwordx4 v19, s[36:39], s65 offen offset:1024 sc1 lds
  v_mfma_f32_16x16x32_bf16 a[172:175], v[88:91], v[40:43], a[172:175]
  ds_read_b64_tr_b16 v[60:61], v9 offset:57344
  v_mfma_f32_16x16x32_bf16 a[172:175], v[92:95], v[44:47], a[172:175]
  v_mfma_f32_16x16x32_bf16 a[140:143], v[88:91], v[32:35], a[140:143]
  ds_read_b64_tr_b16 v[62:63], v9 offset:58368
  v_mfma_f32_16x16x32_bf16 a[140:143], v[92:95], v[36:39], a[140:143]
  v_mfma_f32_16x16x32_bf16 a[144:147], v[96:99], v[32:35], a[144:147]
  v_mfma_f32_16x16x32_bf16 a[144:147], v[100:103], v[36:39], a[144:147]
  v_mfma_f32_16x16x32_bf16 a[176:179], v[96:99], v[40:43], a[176:179]
  v_mfma_f32_16x16x32_bf16 a[176:179], v[100:103], v[44:47], a[176:179]
  buffer_load_dwordx4 v20, s[36:39], s65 offen offset:2048 sc1 lds
  v_mfma_f32_16x16x32_bf16 a[180:183], v[104:107], v[40:43], a[180:183]
  v_mfma_f32_16x16x32_bf16 a[180:183], v[108:111], v[44:47], a[180:183]
  v_mfma_f32_16x16x32_bf16 a[148:151], v[104:107], v[32:35], a[148:151]
  v_mfma_f32_16x16x32_bf16 a[148:151], v[108:111], v[36:39], a[148:151]
  s_add_u32 s97, s97, 28672
  v_mfma_f32_16x16x32_bf16 a[152:155], v[112:115], v[32:35], a[152:155]
  v_mfma_f32_16x16x32_bf16 a[152:155], v[116:119], v[36:39], a[152:155]
  v_mfma_f32_16x16x32_bf16 a[184:187], v[112:115], v[40:43], a[184:187]
  v_mfma_f32_16x16x32_bf16 a[184:187], v[116:119], v[44:47], a[184:187]
  buffer_load_dwordx4 v21, s[36:39], s65 offen offset:3072 sc1 lds
  v_mfma_f32_16x16x32_bf16 a[188:191], v[120:123], v[40:43], a[188:191]
  s_add_u32 s65, s65, 128
  v_mfma_f32_16x16x32_bf16 a[188:191], v[124:127], v[44:47], a[188:191]
  v_mfma_f32_16x16x32_bf16 a[156:159], v[120:123], v[32:35], a[156:159]
  v_mfma_f32_16x16x32_bf16 a[156:159], v[124:127], v[36:39], a[156:159]
  s_waitcnt vmcnt(15) lgkmcnt(0)
  s_barrier
  v_mfma_f32_16x16x32_bf16 a[192:195], v[64:67], v[48:51], a[192:195]
  ds_read_b64_tr_b16 v[32:33], v10 offset:0
  ds_read_b64_tr_b16 v[34:35], v10 offset:1024
  v_mfma_f32_16x16x32_bf16 a[192:195], v[68:71], v[52:55], a[192:195]
  ds_read_b64_tr_b16 v[36:37], v10 offset:8192
  ds_read_b64_tr_b16 v[38:39], v10 offset:9216
  v_mfma_f32_16x16x32_bf16 a[224:227], v[64:67], v[56:59], a[224:227]
  ds_read_b64_tr_b16 v[40:41], v11 offset:0
  ds_read_b64_tr_b16 v[42:43], v11 offset:1024
  v_mfma_f32_16x16x32_bf16 a[224:227], v[68:71], v[60:63], a[224:227]
  ds_read_b128 v[64:67], v4 offset:16384
  v_mfma_f32_16x16x32_bf16 a[228:231], v[72:75], v[56:59], a[228:231]
  s_add_u32 m0, s69, 0
  ds_read_b128 v[68:71], v5 offset:16384
  v_mfma_f32_16x16x32_bf16 a[228:231], v[76:79], v[60:63], a[228:231]
  ds_read_b64_tr_b16 v[44:45], v11 offset:8192
  ds_read_b64_tr_b16 v[46:47], v11 offset:9216
  v_mfma_f32_16x16x32_bf16 a[196:199], v[72:75], v[48:51], a[196:199]
  buffer_load_dwordx4 v22, s[40:43], s66 offen offset:0 sc1 lds
  v_mfma_f32_16x16x32_bf16 a[196:199], v[76:79], v[52:55], a[196:199]
  ds_read_b128 v[72:75], v4 offset:18432
  v_mfma_f32_16x16x32_bf16 a[200:203], v[80:83], v[48:51], a[200:203]
  ds_read_b128 v[76:79], v5 offset:18432
  v_mfma_f32_16x16x32_bf16 a[200:203], v[84:87], v[52:55], a[200:203]
  buffer_load_dword a64, v31, s[56:59], s97 offen
  v_mfma_f32_16x16x32_bf16 a[232:235], v[80:83], v[56:59], a[232:235]
  v_mfma_f32_16x16x32_bf16 a[232:235], v[84:87], v[60:63], a[232:235]
  ds_read_b128 v[80:83], v4 offset:20480
  v_mfma_f32_16x16x32_bf16 a[236:239], v[88:91], v[56:59], a[236:239]
  ds_read_b128 v[84:87], v5 offset:20480
  v_mfma_f32_16x16x32_bf16 a[236:239], v[92:95], v[60:63], a[236:239]
  buffer_load_dwordx4 v23, s[40:43], s66 offen offset:1024 sc1 lds
  v_mfma_f32_16x16x32_bf16 a[204:207], v[88:91], v[48:51], a[204:207]
  v_mfma_f32_16x16x32_bf16 a[204:207], v[92:95], v[52:55], a[204:207]
  ds_read_b128 v[88:91], v4 offset:22528
  v_mfma_f32_16x16x32_bf16 a[208:211], v[96:99], v[48:51], a[208:211]
  ds_read_b128 v[92:95], v5 offset:22528
  v_mfma_f32_16x16x32_bf16 a[208:211], v[100:103], v[52:55], a[208:211]
  v_mfma_f32_16x16x32_bf16 a[240:243], v[96:99], v[56:59], a[240:243]
  v_mfma_f32_16x16x32_bf16 a[240:243], v[100:103], v[60:63], a[240:243]
  ds_read_b128 v[96:99], v4 offset:32768
  v_mfma_f32_16x16x32_bf16 a[244:247], v[104:107], v[56:59], a[244:247]
  ds_read_b128 v[100:103], v5 offset:32768
  v_mfma_f32_16x16x32_bf16 a[244:247], v[108:111], v[60:63], a[244:247]
  buffer_load_dwordx4 v24, s[40:43], s66 offen offset:2048 sc1 lds
  v_mfma_f32_16x16x32_bf16 a[212:215], v[104:107], v[48:51], a[212:215]
  v_mfma_f32_16x16x32_bf16 a[212:215], v[108:111], v[52:55], a[212:215]
  ds_read_b128 v[104:107], v4 offset:34816
  v_mfma_f32_16x16x32_bf16 a[216:219], v[112:115], v[48:51], a[216:219]
  s_add_u32 s97, s97, 28672
  ds_read_b128 v[108:111], v5 offset:34816
  v_mfma_f32_16x16x32_bf16 a[216:219], v[116:119], v[52:55], a[216:219]
  v_mfma_f32_16x16x32_bf16 a[248:251], v[112:115], v[56:59], a[248:251]
  v_mfma_f32_16x16x32_bf16 a[248:251], v[116:119], v[60:63], a[248:251]
  ds_read_b128 v[112:115], v4 offset:36864
  v_mfma_f32_16x16x32_bf16 a[252:255], v[120:123], v[56:59], a[252:255]
  ds_read_b128 v[116:119], v5 offset:36864
  v_mfma_f32_16x16x32_bf16 a[252:255], v[124:127], v[60:63], a[252:255]
  buffer_load_dwordx4 v25, s[40:43], s66 offen offset:3072 sc1 lds
  v_mfma_f32_16x16x32_bf16 a[220:223], v[120:123], v[48:51], a[220:223]
  s_add_u32 s66, s66, 524288
  v_mfma_f32_16x16x32_bf16 a[220:223], v[124:127], v[52:55], a[220:223]
  s_waitcnt lgkmcnt(6)
  ds_read_b128 v[120:123], v4 offset:38912
  ds_read_b128 v[124:127], v5 offset:38912
  s_cmp_eq_u32 s77, 0
  s_cselect_b32 s44, s18, s20
  s_cselect_b32 s45, s19, s21
  s_mul_i32 s46, s98, 1835008
  s_mul_i32 s67, s76, 114688
  s_lshl_b32 s35, s71, 7
  s_add_u32 s67, s67, s35
  s_mov_b32 s96, 0x3e0293ee
  v_mfma_f32_16x16x32_bf16 v[128:131], v[32:35], v[64:67], v[128:131]
  ds_read_b64_tr_b16 v[48:49], v12 offset:0
  v_mfma_f32_16x16x32_bf16 v[128:131], v[36:39], v[68:71], v[128:131]
  v_mfma_f32_16x16x32_bf16 v[132:135], v[40:43], v[64:67], v[132:135]
  s_add_u32 m0, s69, 49152
  ds_read_b64_tr_b16 v[50:51], v12 offset:1024
  v_mfma_f32_16x16x32_bf16 v[132:135], v[44:47], v[68:71], v[132:135]
  buffer_load_dwordx4 v26, s[44:47], s67 offen offset:0 sc1 lds
  v_mfma_f32_16x16x32_bf16 v[140:143], v[40:43], v[72:75], v[140:143]
  ds_read_b64_tr_b16 v[52:53], v12 offset:8192
  v_mfma_f32_16x16x32_bf16 v[140:143], v[44:47], v[76:79], v[140:143]
  v_mfma_f32_16x16x32_bf16 v[136:139], v[32:35], v[72:75], v[136:139]
  ds_read_b64_tr_b16 v[54:55], v12 offset:9216
  v_mfma_f32_16x16x32_bf16 v[136:139], v[36:39], v[76:79], v[136:139]
  v_mfma_f32_16x16x32_bf16 v[144:147], v[32:35], v[80:83], v[144:147]
  ds_read_b64_tr_b16 v[56:57], v13 offset:0
  v_mfma_f32_16x16x32_bf16 v[144:147], v[36:39], v[84:87], v[144:147]
  v_mul_f32 v128, s96, v128
  v_mul_f32 v129, s96, v129
  v_mfma_f32_16x16x32_bf16 v[148:151], v[40:43], v[80:83], v[148:151]
  ds_read_b64_tr_b16 v[58:59], v13 offset:1024
  v_mul_f32 v130, s96, v130
  v_mfma_f32_16x16x32_bf16 v[148:151], v[44:47], v[84:87], v[148:151]
  buffer_load_dwordx4 v27, s[44:47], s67 offen offset:1024 sc1 lds
  v_mul_f32 v131, s96, v131
  v_mfma_f32_16x16x32_bf16 v[156:159], v[40:43], v[88:91], v[156:159]
  ds_read_b64_tr_b16 v[60:61], v13 offset:8192
  v_cvt_pk_bf16_f32 v128, v128, v129
  v_mfma_f32_16x16x32_bf16 v[156:159], v[44:47], v[92:95], v[156:159]
  v_cvt_pk_bf16_f32 v129, v130, v131
  v_mul_f32 v132, s96, v132
  v_mfma_f32_16x16x32_bf16 v[152:155], v[32:35], v[88:91], v[152:155]
  ds_read_b64_tr_b16 v[62:63], v13 offset:9216
  v_mul_f32 v133, s96, v133
  v_mfma_f32_16x16x32_bf16 v[152:155], v[36:39], v[92:95], v[152:155]
  s_waitcnt lgkmcnt(8)
  v_mul_f32 v134, s96, v134
  v_mul_f32 v135, s96, v135
  v_mfma_f32_16x16x32_bf16 v[160:163], v[32:35], v[96:99], v[160:163]
  v_cvt_pk_bf16_f32 v130, v132, v133
  v_cvt_pk_bf16_f32 v131, v134, v135
  v_mfma_f32_16x16x32_bf16 v[160:163], v[36:39], v[100:103], v[160:163]
  v_mul_f32 v136, s96, v136
  v_mul_f32 v137, s96, v137
  v_mfma_f32_16x16x32_bf16 v[164:167], v[40:43], v[96:99], v[164:167]
  v_mul_f32 v138, s96, v138
  v_mul_f32 v139, s96, v139
  v_mfma_f32_16x16x32_bf16 v[164:167], v[44:47], v[100:103], v[164:167]
  buffer_load_dwordx4 v28, s[44:47], s67 offen offset:2048 sc1 lds
  v_mfma_f32_16x16x32_bf16 v[172:175], v[40:43], v[104:107], v[172:175]
  v_cvt_pk_bf16_f32 v136, v136, v137
  v_cvt_pk_bf16_f32 v137, v138, v139
  v_mfma_f32_16x16x32_bf16 v[172:175], v[44:47], v[108:111], v[172:175]
  v_mul_f32 v140, s96, v140
  v_mul_f32 v141, s96, v141
  v_mfma_f32_16x16x32_bf16 v[168:171], v[32:35], v[104:107], v[168:171]
  v_mul_f32 v142, s96, v142
  v_mul_f32 v143, s96, v143
  v_mfma_f32_16x16x32_bf16 v[168:171], v[36:39], v[108:111], v[168:171]
  v_cvt_pk_bf16_f32 v138, v140, v141
  v_cvt_pk_bf16_f32 v139, v142, v143
  v_mfma_f32_16x16x32_bf16 v[176:179], v[32:35], v[112:115], v[176:179]
  v_mul_f32 v144, s96, v144
  v_mul_f32 v145, s96, v145
  v_mfma_f32_16x16x32_bf16 v[176:179], v[36:39], v[116:119], v[176:179]
  v_mul_f32 v146, s96, v146
  v_mul_f32 v147, s96, v147
  v_mfma_f32_16x16x32_bf16 v[180:183], v[40:43], v[112:115], v[180:183]
  v_cvt_pk_bf16_f32 v144, v144, v145
  v_cvt_pk_bf16_f32 v145, v146, v147
  v_mfma_f32_16x16x32_bf16 v[180:183], v[44:47], v[116:119], v[180:183]
  buffer_load_dwordx4 v29, s[44:47], s67 offen offset:3072 sc1 lds
  v_mfma_f32_16x16x32_bf16 v[188:191], v[40:43], v[120:123], v[188:191]
  s_add_u32 s67, s67, 229376
  v_mul_f32 v148, s96, v148
  v_mul_f32 v149, s96, v149
  v_mfma_f32_16x16x32_bf16 v[188:191], v[44:47], v[124:127], v[188:191]
  v_mul_f32 v150, s96, v150
  v_mul_f32 v151, s96, v151
  v_mfma_f32_16x16x32_bf16 v[184:187], v[32:35], v[120:123], v[184:187]
  v_cvt_pk_bf16_f32 v146, v148, v149
  v_cvt_pk_bf16_f32 v147, v150, v151
  v_mfma_f32_16x16x32_bf16 v[184:187], v[36:39], v[124:127], v[184:187]
  s_waitcnt vmcnt(19) lgkmcnt(0)
  s_barrier
  v_mfma_f32_16x16x32_bf16 v[192:195], v[48:51], v[64:67], v[192:195]
  ds_read_b64_tr_b16 v[32:33], v10 offset:49152
  v_mul_f32 v152, s96, v152
  v_mul_f32 v153, s96, v153
  v_mfma_f32_16x16x32_bf16 v[192:195], v[52:55], v[68:71], v[192:195]
  v_mul_f32 v154, s96, v154
  v_mul_f32 v155, s96, v155
  v_mfma_f32_16x16x32_bf16 v[196:199], v[56:59], v[64:67], v[196:199]
  s_add_u32 m0, s69, 81920
  ds_read_b64_tr_b16 v[34:35], v10 offset:50176
  v_cvt_pk_bf16_f32 v152, v152, v153
  v_cvt_pk_bf16_f32 v153, v154, v155
  v_mfma_f32_16x16x32_bf16 v[196:199], v[60:63], v[68:71], v[196:199]
  buffer_load_dwordx4 v18, s[36:39], s64 offen offset:0 sc1 lds
  v_mul_f32 v156, s96, v156
  v_mfma_f32_16x16x32_bf16 v[204:207], v[56:59], v[72:75], v[204:207]
  ds_read_b64_tr_b16 v[36:37], v10 offset:57344
  v_mul_f32 v157, s96, v157
  v_mul_f32 v158, s96, v158
  v_mfma_f32_16x16x32_bf16 v[204:207], v[60:63], v[76:79], v[204:207]
  v_mul_f32 v159, s96, v159
  v_cvt_pk_bf16_f32 v154, v156, v157
  v_mfma_f32_16x16x32_bf16 v[200:203], v[48:51], v[72:75], v[200:203]
  ds_read_b64_tr_b16 v[38:39], v10 offset:58368
  v_cvt_pk_bf16_f32 v155, v158, v159
  v_mul_f32 v160, s96, v160
  v_mfma_f32_16x16x32_bf16 v[200:203], v[52:55], v[76:79], v[200:203]
  v_mul_f32 v161, s96, v161
  v_mul_f32 v162, s96, v162
  v_mfma_f32_16x16x32_bf16 v[208:211], v[48:51], v[80:83], v[208:211]
  ds_read_b64_tr_b16 v[40:41], v11 offset:49152
  v_mul_f32 v163, s96, v163
  v_cvt_pk_bf16_f32 v160, v160, v161
  v_mfma_f32_16x16x32_bf16 v[208:211], v[52:55], v[84:87], v[208:211]
  v_cvt_pk_bf16_f32 v161, v162, v163
  v_mul_f32 v164, s96, v164
  v_mfma_f32_16x16x32_bf16 v[212:215], v[56:59], v[80:83], v[212:215]
  ds_read_b64_tr_b16 v[42:43], v11 offset:50176
  v_mul_f32 v165, s96, v165
  v_mul_f32 v166, s96, v166
  v_mfma_f32_16x16x32_bf16 v[212:215], v[60:63], v[84:87], v[212:215]
  buffer_load_dwordx4 v19, s[36:39], s64 offen offset:1024 sc1 lds
  v_mul_f32 v167, s96, v167
  v_mfma_f32_16x16x32_bf16 v[220:223], v[56:59], v[88:91], v[220:223]
  ds_read_b64_tr_b16 v[44:45], v11 offset:57344
  v_cvt_pk_bf16_f32 v162, v164, v165
  v_cvt_pk_bf16_f32 v163, v166, v167
  v_mfma_f32_16x16x32_bf16 v[220:223], v[60:63], v[92:95], v[220:223]
  v_mul_f32 v168, s96, v168
  v_mul_f32 v169, s96, v169
  v_mfma_f32_16x16x32_bf16 v[216:219], v[48:51], v[88:91], v[216:219]
  ds_read_b64_tr_b16 v[46:47], v11 offset:58368
  v_mul_f32 v170, s96, v170
  v_mul_f32 v171, s96, v171
  v_mfma_f32_16x16x32_bf16 v[216:219], v[52:55], v[92:95], v[216:219]
  v_cvt_pk_bf16_f32 v168, v168, v169
  v_cvt_pk_bf16_f32 v169, v170, v171
  v_mfma_f32_16x16x32_bf16 v[224:227], v[48:51], v[96:99], v[224:227]
  v_mul_f32 v172, s96, v172
  v_mul_f32 v173, s96, v173
  v_mfma_f32_16x16x32_bf16 v[224:227], v[52:55], v[100:103], v[224:227]
  v_mul_f32 v174, s96, v174
  v_mul_f32 v175, s96, v175
  v_mfma_f32_16x16x32_bf16 v[228:231], v[56:59], v[96:99], v[228:231]
  v_cvt_pk_bf16_f32 v170, v172, v173
  v_cvt_pk_bf16_f32 v171, v174, v175
  v_mfma_f32_16x16x32_bf16 v[228:231], v[60:63], v[100:103], v[228:231]
  buffer_load_dwordx4 v20, s[36:39], s64 offen offset:2048 sc1 lds
  v_mul_f32 v176, s96, v176
  v_mfma_f32_16x16x32_bf16 v[236:239], v[56:59], v[104:107], v[236:239]
  v_mul_f32 v177, s96, v177
  v_mul_f32 v178, s96, v178
  v_mfma_f32_16x16x32_bf16 v[236:239], v[60:63], v[108:111], v[236:239]
  v_mul_f32 v179, s96, v179
  v_cvt_pk_bf16_f32 v176, v176, v177
  v_mfma_f32_16x16x32_bf16 v[232:235], v[48:51], v[104:107], v[232:235]
  v_cvt_pk_bf16_f32 v177, v178, v179
  v_mul_f32 v180, s96, v180
  v_mfma_f32_16x16x32_bf16 v[232:235], v[52:55], v[108:111], v[232:235]
  v_mul_f32 v181, s96, v181
  v_mul_f32 v182, s96, v182
  v_mfma_f32_16x16x32_bf16 v[240:243], v[48:51], v[112:115], v[240:243]
  v_mul_f32 v183, s96, v183
  v_cvt_pk_bf16_f32 v178, v180, v181
  v_mfma_f32_16x16x32_bf16 v[240:243], v[52:55], v[116:119], v[240:243]
  v_cvt_pk_bf16_f32 v179, v182, v183
  v_mul_f32 v184, s96, v184
  v_mfma_f32_16x16x32_bf16 v[244:247], v[56:59], v[112:115], v[244:247]
  v_mul_f32 v185, s96, v185
  v_mul_f32 v186, s96, v186
  v_mfma_f32_16x16x32_bf16 v[244:247], v[60:63], v[116:119], v[244:247]
  buffer_load_dwordx4 v21, s[36:39], s64 offen offset:3072 sc1 lds
  v_mul_f32 v187, s96, v187
  v_mfma_f32_16x16x32_bf16 v[252:255], v[56:59], v[120:123], v[252:255]
  s_add_u32 s64, s64, 128
  v_cvt_pk_bf16_f32 v184, v184, v185
  v_cvt_pk_bf16_f32 v185, v186, v187
  v_mfma_f32_16x16x32_bf16 v[252:255], v[60:63], v[124:127], v[252:255]
  s_waitcnt lgkmcnt(0)
  v_mul_f32 v188, s96, v188
  v_mul_f32 v189, s96, v189
  v_mfma_f32_16x16x32_bf16 v[248:251], v[48:51], v[120:123], v[248:251]
  v_mul_f32 v190, s96, v190
  v_mul_f32 v191, s96, v191
  v_mfma_f32_16x16x32_bf16 v[248:251], v[52:55], v[124:127], v[248:251]
  v_cvt_pk_bf16_f32 v186, v188, v189
  v_cvt_pk_bf16_f32 v187, v190, v191
  v_mfma_f32_16x16x32_bf16 a[128:131], v[64:67], v[32:35], a[128:131]
L_pg3:
  s_cbranch_execz L_pg7
  ds_read_b64_tr_b16 v[48:49], v12 offset:49152
  v_mul_f32 v192, s96, v192
  v_mul_f32 v193, s96, v193
  v_mfma_f32_16x16x32_bf16 a[128:131], v[68:71], v[36:39], a[128:131]
  v_mul_f32 v194, s96, v194
  v_mul_f32 v195, s96, v195
  v_mfma_f32_16x16x32_bf16 a[160:163], v[64:67], v[40:43], a[160:163]
  s_add_u32 m0, s69, 98304
  ds_read_b64_tr_b16 v[50:51], v12 offset:50176
  v_cvt_pk_bf16_f32 v192, v192, v193
  v_cvt_pk_bf16_f32 v193, v194, v195
  v_mfma_f32_16x16x32_bf16 a[160:163], v[68:71], v[44:47], a[160:163]
  buffer_load_dwordx4 v18, s[36:39], s65 offen offset:0 sc1 lds
  v_mul_f32 v196, s96, v196
  v_mul_f32 v197, s96, v197
  v_mfma_f32_16x16x32_bf16 a[164:167], v[72:75], v[40:43], a[164:167]
  ds_read_b64_tr_b16 v[52:53], v12 offset:57344
  v_mul_f32 v198, s96, v198
  v_mul_f32 v199, s96, v199
  v_mfma_f32_16x16x32_bf16 a[164:167], v[76:79], v[44:47], a[164:167]
  v_cvt_pk_bf16_f32 v194, v196, v197
  v_cvt_pk_bf16_f32 v195, v198, v199
  v_mfma_f32_16x16x32_bf16 a[132:135], v[72:75], v[32:35], a[132:135]
  ds_read_b64_tr_b16 v[54:55], v12 offset:58368
  v_mul_f32 v200, s96, v200
  v_mul_f32 v201, s96, v201
  v_mfma_f32_16x16x32_bf16 a[132:135], v[76:79], v[36:39], a[132:135]
  v_mul_f32 v202, s96, v202
  v_mul_f32 v203, s96, v203
  v_mfma_f32_16x16x32_bf16 a[136:139], v[80:83], v[32:35], a[136:139]
  ds_read_b64_tr_b16 v[56:57], v13 offset:49152
  v_cvt_pk_bf16_f32 v200, v200, v201
  v_cvt_pk_bf16_f32 v201, v202, v203
  v_mfma_f32_16x16x32_bf16 a[136:139], v[84:87], v[36:39], a[136:139]
  v_mul_f32 v204, s96, v204
  v_mul_f32 v205, s96, v205
  v_mfma_f32_16x16x32_bf16 a[168:171], v[80:83], v[40:43], a[168:171]
  ds_read_b64_tr_b16 v[58:59], v13 offset:50176
  buffer_store_dwordx4 v[128:131], v30, s[48:51], s68 offen offset:0 sc1
  v_mul_f32 v206, s96, v206
  v_mfma_f32_16x16x32_bf16 a[168:171], v[84:87], v[44:47], a[168:171]
  buffer_load_dwordx4 v19, s[36:39], s65 offen offset:1024 sc1 lds
  v_mul_f32 v207, s96, v207
  v_cvt_pk_bf16_f32 v202, v204, v205
  v_mfma_f32_16x16x32_bf16 a[172:175], v[88:91], v[40:43], a[172:175]
  ds_read_b64_tr_b16 v[60:61], v13 offset:57344
  v_cvt_pk_bf16_f32 v203, v206, v207
  v_mul_f32 v208, s96, v208
  v_mfma_f32_16x16x32_bf16 a[172:175], v[92:95], v[44:47], a[172:175]
  v_mul_f32 v209, s96, v209
  v_mul_f32 v210, s96, v210
  v_mfma_f32_16x16x32_bf16 a[140:143], v[88:91], v[32:35], a[140:143]
  ds_read_b64_tr_b16 v[62:63], v13 offset:58368
  v_mul_f32 v211, s96, v211
  v_cvt_pk_bf16_f32 v208, v208, v209
  v_mfma_f32_16x16x32_bf16 a[140:143], v[92:95], v[36:39], a[140:143]
  v_cvt_pk_bf16_f32 v209, v210, v211
  v_mul_f32 v212, s96, v212
  v_mul_f32 v213, s96, v213
  v_mfma_f32_16x16x32_bf16 a[144:147], v[96:99], v[32:35], a[144:147]
  v_mul_f32 v214, s96, v214
  v_mul_f32 v215, s96, v215
  v_mfma_f32_16x16x32_bf16 a[144:147], v[100:103], v[36:39], a[144:147]
  v_cvt_pk_bf16_f32 v210, v212, v213
  v_cvt_pk_bf16_f32 v211, v214, v215
  v_mfma_f32_16x16x32_bf16 a[176:179], v[96:99], v[40:43], a[176:179]
  v_mul_f32 v216, s96, v216
  v_mul_f32 v217, s96, v217
  v_mfma_f32_16x16x32_bf16 a[176:179], v[100:103], v[44:47], a[176:179]
  buffer_load_dwordx4 v20, s[36:39], s65 offen offset:2048 sc1 lds
  v_mul_f32 v218, s96, v218
  v_mul_f32 v219, s96, v219
  v_mfma_f32_16x16x32_bf16 a[180:183], v[104:107], v[40:43], a[180:183]
  buffer_store_dwordx4 v[136:139], v30, s[48:51], s68 offen offset:1024 sc1
  v_cvt_pk_bf16_f32 v216, v216, v217
  v_mfma_f32_16x16x32_bf16 a[180:183], v[108:111], v[44:47], a[180:183]
  v_cvt_pk_bf16_f32 v217, v218, v219
  v_mul_f32 v220, s96, v220
  v_mfma_f32_16x16x32_bf16 a[148:151], v[104:107], v[32:35], a[148:151]
  v_mul_f32 v221, s96, v221
  v_mul_f32 v222, s96, v222
  v_mfma_f32_16x16x32_bf16 a[148:151], v[108:111], v[36:39], a[148:151]
  v_mul_f32 v223, s96, v223
  v_cvt_pk_bf16_f32 v218, v220, v221
  v_mfma_f32_16x16x32_bf16 a[152:155], v[112:115], v[32:35], a[152:155]
  v_cvt_pk_bf16_f32 v219, v222, v223
  v_mul_f32 v224, s96, v224
  v_mfma_f32_16x16x32_bf16 a[152:155], v[116:119], v[36:39], a[152:155]
  v_mul_f32 v225, s96, v225
  v_mul_f32 v226, s96, v226
  v_mfma_f32_16x16x32_bf16 a[184:187], v[112:115], v[40:43], a[184:187]
  v_mul_f32 v227, s96, v227
  v_cvt_pk_bf16_f32 v224, v224, v225
  v_mfma_f32_16x16x32_bf16 a[184:187], v[116:119], v[44:47], a[184:187]
  buffer_load_dwordx4 v21, s[36:39], s65 offen offset:3072 sc1 lds
  v_cvt_pk_bf16_f32 v225, v226, v227
  v_mul_f32 v228, s96, v228
  v_mfma_f32_16x16x32_bf16 a[188:191], v[120:123], v[40:43], a[188:191]
  s_add_u32 s65, s65, 128
  v_mul_f32 v229, s96, v229
  v_mul_f32 v230, s96, v230
  v_mfma_f32_16x16x32_bf16 a[188:191], v[124:127], v[44:47], a[188:191]
  v_mul_f32 v231, s96, v231
  v_cvt_pk_bf16_f32 v226, v228, v229
  v_mfma_f32_16x16x32_bf16 a[156:159], v[120:123], v[32:35], a[156:159]
  v_cvt_pk_bf16_f32 v227, v230, v231
  s_add_u32 s68, s68, 8192
  v_mfma_f32_16x16x32_bf16 a[156:159], v[124:127], v[36:39], a[156:159]
  s_waitcnt vmcnt(14) lgkmcnt(0)
  s_barrier
  v_mfma_f32_16x16x32_bf16 a[192:195], v[64:67], v[48:51], a[192:195]
  ds_read_b64_tr_b16 v[32:33], v6 offset:0
  ds_read_b64_tr_b16 v[34:35], v6 offset:1024
  v_mul_f32 v232, s96, v232
  v_mfma_f32_16x16x32_bf16 a[192:195], v[68:71], v[52:55], a[192:195]
  ds_read_b64_tr_b16 v[36:37], v6 offset:8192
  ds_read_b64_tr_b16 v[38:39], v6 offset:9216
  v_mul_f32 v233, s96, v233
  v_mul_f32 v234, s96, v234
  v_mfma_f32_16x16x32_bf16 a[224:227], v[64:67], v[56:59], a[224:227]
  ds_read_b64_tr_b16 v[40:41], v7 offset:0
  ds_read_b64_tr_b16 v[42:43], v7 offset:1024
  v_mul_f32 v235, s96, v235
  v_mfma_f32_16x16x32_bf16 a[224:227], v[68:71], v[60:63], a[224:227]
  ds_read_b128 v[64:67], v2 offset:16384
  v_cvt_pk_bf16_f32 v232, v232, v233
  v_mfma_f32_16x16x32_bf16 a[228:231], v[72:75], v[56:59], a[228:231]
  s_add_u32 m0, s69, 65536
  ds_read_b128 v[68:71], v3 offset:16384
  v_cvt_pk_bf16_f32 v233, v234, v235
  v_mul_f32 v236, s96, v236
  v_mfma_f32_16x16x32_bf16 a[228:231], v[76:79], v[60:63], a[228:231]
  ds_read_b64_tr_b16 v[44:45], v7 offset:8192
  ds_read_b64_tr_b16 v[46:47], v7 offset:9216
  v_mul_f32 v237, s96, v237
  v_mfma_f32_16x16x32_bf16 a[196:199], v[72:75], v[48:51], a[196:199]
  buffer_load_dwordx4 v22, s[40:43], s66 offen offset:0 sc1 lds
  v_mul_f32 v238, s96, v238
  v_mfma_f32_16x16x32_bf16 a[196:199], v[76:79], v[52:55], a[196:199]
  ds_read_b128 v[72:75], v2 offset:18432
  v_mul_f32 v239, s96, v239
  v_mfma_f32_16x16x32_bf16 a[200:203], v[80:83], v[48:51], a[200:203]
  ds_read_b128 v[76:79], v3 offset:18432
  v_cvt_pk_bf16_f32 v234, v236, v237
  v_mfma_f32_16x16x32_bf16 a[200:203], v[84:87], v[52:55], a[200:203]
  v_cvt_pk_bf16_f32 v235, v238, v239
  v_mul_f32 v240, s96, v240
  v_mfma_f32_16x16x32_bf16 a[232:235], v[80:83], v[56:59], a[232:235]
  v_mul_f32 v241, s96, v241
  v_mul_f32 v242, s96, v242
  v_mfma_f32_16x16x32_bf16 a[232:235], v[84:87], v[60:63], a[232:235]
  ds_read_b128 v[80:83], v2 offset:20480
  v_mul_f32 v243, s96, v243
  v_mfma_f32_16x16x32_bf16 a[236:239], v[88:91], v[56:59], a[236:239]
  ds_read_b128 v[84:87], v3 offset:20480
  v_cvt_pk_bf16_f32 v240, v240, v241
  v_mfma_f32_16x16x32_bf16 a[236:239], v[92:95], v[60:63], a[236:239]
  buffer_load_dwordx4 v23, s[40:43], s66 offen offset:1024 sc1 lds
  v_cvt_pk_bf16_f32 v241, v242, v243
  v_mfma_f32_16x16x32_bf16 a[204:207], v[88:91], v[48:51], a[204:207]
  v_mul_f32 v244, s96, v244
  v_mul_f32 v245, s96, v245
  v_mfma_f32_16x16x32_bf16 a[204:207], v[92:95], v[52:55], a[204:207]
  ds_read_b128 v[88:91], v2 offset:22528
  v_mul_f32 v246, s96, v246
  v_mfma_f32_16x16x32_bf16 a[208:211], v[96:99], v[48:51], a[208:211]
  ds_read_b128 v[92:95], v3 offset:22528
  v_mul_f32 v247, s96, v247
  v_mfma_f32_16x16x32_bf16 a[208:211], v[100:103], v[52:55], a[208:211]
  v_cvt_pk_bf16_f32 v242, v244, v245
  v_cvt_pk_bf16_f32 v243, v246, v247
  v_mfma_f32_16x16x32_bf16 a[240:243], v[96:99], v[56:59], a[240:243]
  v_mul_f32 v248, s96, v248
  v_mul_f32 v249, s96, v249
  v_mfma_f32_16x16x32_bf16 a[240:243], v[100:103], v[60:63], a[240:243]
  ds_read_b128 v[96:99], v2 offset:32768
  v_mul_f32 v250, s96, v250
  v_mfma_f32_16x16x32_bf16 a[244:247], v[104:107], v[56:59], a[244:247]
  ds_read_b128 v[100:103], v3 offset:32768
  v_mul_f32 v251, s96, v251
  v_mfma_f32_16x16x32_bf16 a[244:247], v[108:111], v[60:63], a[244:247]
  buffer_load_dwordx4 v24, s[40:43], s66 offen offset:2048 sc1 lds
  v_cvt_pk_bf16_f32 v248, v248, v249
  v_mfma_f32_16x16x32_bf16 a[212:215], v[104:107], v[48:51], a[212:215]
  v_cvt_pk_bf16_f32 v249, v250, v251
  v_mul_f32 v252, s96, v252
  v_mfma_f32_16x16x32_bf16 a[212:215], v[108:111], v[52:55], a[212:215]
  ds_read_b128 v[104:107], v2 offset:34816
  v_mul_f32 v253, s96, v253
  v_mfma_f32_16x16x32_bf16 a[216:219], v[112:115], v[48:51], a[216:219]
  ds_read_b128 v[108:111], v3 offset:34816
  v_mul_f32 v254, s96, v254
  v_mfma_f32_16x16x32_bf16 a[216:219], v[116:119], v[52:55], a[216:219]
  v_mul_f32 v255, s96, v255
  v_cvt_pk_bf16_f32 v250, v252, v253
  v_mfma_f32_16x16x32_bf16 a[248:251], v[112:115], v[56:59], a[248:251]
  v_cvt_pk_bf16_f32 v251, v254, v255
  v_accvgpr_read_b32 v132, a128
  v_mfma_f32_16x16x32_bf16 a[248:251], v[116:119], v[60:63], a[248:251]
  ds_read_b128 v[112:115], v2 offset:36864
  v_accvgpr_read_b32 v0, a129
  v_mfma_f32_16x16x32_bf16 a[252:255], v[120:123], v[56:59], a[252:255]
  ds_read_b128 v[116:119], v3 offset:36864
  v_accvgpr_read_b32 v133, a130
  v_mfma_f32_16x16x32_bf16 a[252:255], v[124:127], v[60:63], a[252:255]
  buffer_load_dwordx4 v25, s[40:43], s66 offen offset:3072 sc1 lds
  v_accvgpr_read_b32 v1, a131
  v_mfma_f32_16x16x32_bf16 a[220:223], v[120:123], v[48:51], a[220:223]
  s_add_u32 s66, s66, 524288
  v_cvt_pk_bf16_f32 v132, v132, v0
  v_cvt_pk_bf16_f32 v133, v133, v1
  v_mfma_f32_16x16x32_bf16 a[220:223], v[124:127], v[52:55], a[220:223]
  s_waitcnt lgkmcnt(6)
  ds_read_b128 v[120:123], v2 offset:38912
  ds_read_b128 v[124:127], v3 offset:38912
  buffer_store_dwordx4 v[144:147], v30, s[48:51], s68 offen offset:0 sc1
  s_cmp_eq_u32 s98, 0
  s_cbranch_scc1 L_p2n
  v_mfma_f32_16x16x32_bf16 a[0:3], v[32:35], v[64:67], 0
  ds_read_b64_tr_b16 v[48:49], v8 offset:0
  v_accvgpr_read_b32 v134, a132
  v_accvgpr_read_b32 v0, a133
  v_mfma_f32_16x16x32_bf16 a[0:3], v[36:39], v[68:71], a[0:3]
  v_accvgpr_read_b32 v135, a134
  v_accvgpr_read_b32 v1, a135
  v_mfma_f32_16x16x32_bf16 a[32:35], v[40:43], v[64:67], 0
  s_add_u32 m0, s69, 114688
  ds_read_b64_tr_b16 v[50:51], v8 offset:1024
  v_cvt_pk_bf16_f32 v134, v134, v0
  v_mfma_f32_16x16x32_bf16 a[32:35], v[44:47], v[68:71], a[32:35]
  buffer_load_dwordx4 v26, s[44:47], s67 offen offset:0 sc1 lds
  v_cvt_pk_bf16_f32 v135, v135, v1
  v_accvgpr_read_b32 v140, a160
  v_mfma_f32_16x16x32_bf16 a[36:39], v[40:43], v[72:75], 0
  ds_read_b64_tr_b16 v[52:53], v8 offset:8192
  v_accvgpr_read_b32 v0, a161
  v_accvgpr_read_b32 v141, a162
  v_mfma_f32_16x16x32_bf16 a[36:39], v[44:47], v[76:79], a[36:39]
  v_accvgpr_read_b32 v1, a163
  v_cvt_pk_bf16_f32 v140, v140, v0
  v_mfma_f32_16x16x32_bf16 a[4:7], v[32:35], v[72:75], 0
  ds_read_b64_tr_b16 v[54:55], v8 offset:9216
  v_cvt_pk_bf16_f32 v141, v141, v1
  v_accvgpr_read_b32 v142, a164
  v_mfma_f32_16x16x32_bf16 a[4:7], v[36:39], v[76:79], a[4:7]
  v_accvgpr_read_b32 v0, a165
  v_accvgpr_read_b32 v143, a166
  v_mfma_f32_16x16x32_bf16 a[8:11], v[32:35], v[80:83], 0
  ds_read_b64_tr_b16 v[56:57], v9 offset:0
  v_accvgpr_read_b32 v1, a167
  v_mfma_f32_16x16x32_bf16 a[8:11], v[36:39], v[84:87], a[8:11]
  v_cvt_pk_bf16_f32 v142, v142, v0
  v_cvt_pk_bf16_f32 v143, v143, v1
  v_mfma_f32_16x16x32_bf16 a[40:43], v[40:43], v[80:83], 0
  ds_read_b64_tr_b16 v[58:59], v9 offset:1024
  v_accvgpr_read_b32 v148, a136
  v_accvgpr_read_b32 v0, a137
  v_mfma_f32_16x16x32_bf16 a[40:43], v[44:47], v[84:87], a[40:43]
  buffer_load_dwordx4 v27, s[44:47], s67 offen offset:1024 sc1 lds
  v_accvgpr_read_b32 v149, a138
  v_mfma_f32_16x16x32_bf16 a[44:47], v[40:43], v[88:91], 0
  ds_read_b64_tr_b16 v[60:61], v9 offset:8192
  v_accvgpr_read_b32 v1, a139
  v_mfma_f32_16x16x32_bf16 a[44:47], v[44:47], v[92:95], a[44:47]
  v_cvt_pk_bf16_f32 v148, v148, v0
  v_cvt_pk_bf16_f32 v149, v149, v1
  v_mfma_f32_16x16x32_bf16 a[12:15], v[32:35], v[88:91], 0
  ds_read_b64_tr_b16 v[62:63], v9 offset:9216
  v_accvgpr_read_b32 v150, a140
  v_mfma_f32_16x16x32_bf16 a[12:15], v[36:39], v[92:95], a[12:15]
  s_waitcnt lgkmcnt(8)
  v_accvgpr_read_b32 v0, a141
  v_accvgpr_read_b32 v151, a142
  v_mfma_f32_16x16x32_bf16 a[16:19], v[32:35], v[96:99], 0
  buffer_store_dwordx4 v[152:155], v30, s[48:51], s68 offen offset:1024 sc1
  v_accvgpr_read_b32 v1, a143
  v_cvt_pk_bf16_f32 v150, v150, v0
  v_mfma_f32_16x16x32_bf16 a[16:19], v[36:39], v[100:103], a[16:19]
  v_cvt_pk_bf16_f32 v151, v151, v1
  v_accvgpr_read_b32 v156, a168
  v_mfma_f32_16x16x32_bf16 a[48:51], v[40:43], v[96:99], 0
  v_accvgpr_read_b32 v0, a169
  v_accvgpr_read_b32 v157, a170
  v_mfma_f32_16x16x32_bf16 a[48:51], v[44:47], v[100:103], a[48:51]
  buffer_load_dwordx4 v28, s[44:47], s67 offen offset:2048 sc1 lds
  v_accvgpr_read_b32 v1, a171
  v_mfma_f32_16x16x32_bf16 a[52:55], v[40:43], v[104:107], 0
  v_cvt_pk_bf16_f32 v156, v156, v0
  v_cvt_pk_bf16_f32 v157, v157, v1
  v_mfma_f32_16x16x32_bf16 a[52:55], v[44:47], v[108:111], a[52:55]
  v_accvgpr_read_b32 v158, a172
  v_accvgpr_read_b32 v0, a173
  v_mfma_f32_16x16x32_bf16 a[20:23], v[32:35], v[104:107], 0
  v_accvgpr_read_b32 v159, a174
  v_accvgpr_read_b32 v1, a175
  v_mfma_f32_16x16x32_bf16 a[20:23], v[36:39], v[108:111], a[20:23]
  v_cvt_pk_bf16_f32 v158, v158, v0
  v_cvt_pk_bf16_f32 v159, v159, v1
  v_mfma_f32_16x16x32_bf16 a[24:27], v[32:35], v[112:115], 0
  v_accvgpr_read_b32 v164, a144
  v_accvgpr_read_b32 v0, a145
  v_mfma_f32_16x16x32_bf16 a[24:27], v[36:39], v[116:119], a[24:27]
  v_accvgpr_read_b32 v165, a146
  v_accvgpr_read_b32 v1, a147
  v_mfma_f32_16x16x32_bf16 a[56:59], v[40:43], v[112:115], 0
  v_cvt_pk_bf16_f32 v164, v164, v0
  v_cvt_pk_bf16_f32 v165, v165, v1
  v_mfma_f32_16x16x32_bf16 a[56:59], v[44:47], v[116:119], a[56:59]
  buffer_load_dwordx4 v29, s[44:47], s67 offen offset:3072 sc1 lds
  v_accvgpr_read_b32 v166, a148
  v_mfma_f32_16x16x32_bf16 a[60:63], v[40:43], v[120:123], 0
  s_add_u32 s67, s67, 229376
  v_accvgpr_read_b32 v0, a149
  v_accvgpr_read_b32 v167, a150
  v_mfma_f32_16x16x32_bf16 a[60:63], v[44:47], v[124:127], a[60:63]
  v_accvgpr_read_b32 v1, a151
  v_cvt_pk_bf16_f32 v166, v166, v0
  v_mfma_f32_16x16x32_bf16 a[28:31], v[32:35], v[120:123], 0
  v_cvt_pk_bf16_f32 v167, v167, v1
  s_add_u32 s68, s68, 8192
  v_mfma_f32_16x16x32_bf16 a[28:31], v[36:39], v[124:127], a[28:31]
  s_waitcnt vmcnt(20) lgkmcnt(0)
  s_barrier
  v_mfma_f32_16x16x32_bf16 a[64:67], v[48:51], v[64:67], 0
  ds_read_b64_tr_b16 v[32:33], v14 offset:49152
  v_accvgpr_read_b32 v172, a176
  v_accvgpr_read_b32 v0, a177
  v_mfma_f32_16x16x32_bf16 a[64:67], v[52:55], v[68:71], a[64:67]
  v_accvgpr_read_b32 v173, a178
  v_accvgpr_read_b32 v1, a179
  v_mfma_f32_16x16x32_bf16 a[96:99], v[56:59], v[64:67], 0
  s_add_u32 m0, s69, 16384
  ds_read_b64_tr_b16 v[34:35], v14 offset:49664
  v_cvt_pk_bf16_f32 v172, v172, v0
  v_mfma_f32_16x16x32_bf16 a[96:99], v[60:63], v[68:71], a[96:99]
  buffer_load_dwordx4 v18, s[36:39], s64 offen offset:0 sc1 lds
  v_cvt_pk_bf16_f32 v173, v173, v1
  v_accvgpr_read_b32 v174, a180
  v_mfma_f32_16x16x32_bf16 a[100:103], v[56:59], v[72:75], 0
  ds_read_b64_tr_b16 v[36:37], v14 offset:53248
  v_accvgpr_read_b32 v0, a181
  v_mfma_f32_16x16x32_bf16 a[100:103], v[60:63], v[76:79], a[100:103]
  v_accvgpr_read_b32 v175, a182
  v_accvgpr_read_b32 v1, a183
  v_mfma_f32_16x16x32_bf16 a[68:71], v[48:51], v[72:75], 0
  ds_read_b64_tr_b16 v[38:39], v14 offset:53760
  v_cvt_pk_bf16_f32 v174, v174, v0
  v_cvt_pk_bf16_f32 v175, v175, v1
  v_mfma_f32_16x16x32_bf16 a[68:71], v[52:55], v[76:79], a[68:71]
  v_accvgpr_read_b32 v180, a152
  v_accvgpr_read_b32 v0, a153
  v_mfma_f32_16x16x32_bf16 a[72:75], v[48:51], v[80:83], 0
  ds_read_b64_tr_b16 v[40:41], v14 offset:57344
  v_accvgpr_read_b32 v181, a154
  v_mfma_f32_16x16x32_bf16 a[72:75], v[52:55], v[84:87], a[72:75]
  v_accvgpr_read_b32 v1, a155
  v_cvt_pk_bf16_f32 v180, v180, v0
  v_mfma_f32_16x16x32_bf16 a[104:107], v[56:59], v[80:83], 0
  ds_read_b64_tr_b16 v[42:43], v14 offset:57856
  v_cvt_pk_bf16_f32 v181, v181, v1
  v_accvgpr_read_b32 v182, a156
  v_mfma_f32_16x16x32_bf16 a[104:107], v[60:63], v[84:87], a[104:107]
  buffer_load_dwordx4 v19, s[36:39], s64 offen offset:1024 sc1 lds
  v_accvgpr_read_b32 v0, a157
  v_accvgpr_read_b32 v183, a158
  v_mfma_f32_16x16x32_bf16 a[108:111], v[56:59], v[88:91], 0
  ds_read_b64_tr_b16 v[44:45], v14 offset:61440
  v_accvgpr_read_b32 v1, a159
  v_mfma_f32_16x16x32_bf16 a[108:111], v[60:63], v[92:95], a[108:111]
  v_cvt_pk_bf16_f32 v182, v182, v0
  v_cvt_pk_bf16_f32 v183, v183, v1
  v_mfma_f32_16x16x32_bf16 a[76:79], v[48:51], v[88:91], 0
  ds_read_b64_tr_b16 v[46:47], v14 offset:61952
  v_accvgpr_read_b32 v188, a184
  v_mfma_f32_16x16x32_bf16 a[76:79], v[52:55], v[92:95], a[76:79]
  v_accvgpr_read_b32 v0, a185
  v_accvgpr_read_b32 v189, a186
  v_mfma_f32_16x16x32_bf16 a[80:83], v[48:51], v[96:99], 0
  v_accvgpr_read_b32 v1, a187
  v_cvt_pk_bf16_f32 v188, v188, v0
  v_mfma_f32_16x16x32_bf16 a[80:83], v[52:55], v[100:103], a[80:83]
  v_cvt_pk_bf16_f32 v189, v189, v1
  v_accvgpr_read_b32 v190, a188
  v_mfma_f32_16x16x32_bf16 a[112:115], v[56:59], v[96:99], 0
  v_accvgpr_read_b32 v0, a189
  v_accvgpr_read_b32 v191, a190
  v_mfma_f32_16x16x32_bf16 a[112:115], v[60:63], v[100:103], a[112:115]
  buffer_load_dwordx4 v20, s[36:39], s64 offen offset:2048 sc1 lds
  v_mfma_f32_16x16x32_bf16 a[116:119], v[56:59], v[104:107], 0
  v_accvgpr_read_b32 v1, a191
  v_cvt_pk_bf16_f32 v190, v190, v0
  v_mfma_f32_16x16x32_bf16 a[116:119], v[60:63], v[108:111], a[116:119]
  v_cvt_pk_bf16_f32 v191, v191, v1
  v_accvgpr_read_b32 v196, a192
  v_mfma_f32_16x16x32_bf16 a[84:87], v[48:51], v[104:107], 0
  v_accvgpr_read_b32 v0, a193
  v_accvgpr_read_b32 v197, a194
  v_mfma_f32_16x16x32_bf16 a[84:87], v[52:55], v[108:111], a[84:87]
  v_accvgpr_read_b32 v1, a195
  v_cvt_pk_bf16_f32 v196, v196, v0
  v_mfma_f32_16x16x32_bf16 a[88:91], v[48:51], v[112:115], 0
  v_cvt_pk_bf16_f32 v197, v197, v1
  v_accvgpr_read_b32 v198, a196
  v_mfma_f32_16x16x32_bf16 a[88:91], v[52:55], v[116:119], a[88:91]
  v_accvgpr_read_b32 v0, a197
  v_accvgpr_read_b32 v199, a198
  v_mfma_f32_16x16x32_bf16 a[120:123], v[56:59], v[112:115], 0
  v_accvgpr_read_b32 v1, a199
  v_cvt_pk_bf16_f32 v198, v198, v0
  v_mfma_f32_16x16x32_bf16 a[120:123], v[60:63], v[116:119], a[120:123]
  buffer_load_dwordx4 v21, s[36:39], s64 offen offset:3072 sc1 lds
  v_cvt_pk_bf16_f32 v199, v199, v1
  v_mfma_f32_16x16x32_bf16 a[124:127], v[56:59], v[120:123], 0
  s_add_u32 s64, s64, 128
  v_accvgpr_read_b32 v204, a224
  v_accvgpr_read_b32 v0, a225
  v_mfma_f32_16x16x32_bf16 a[124:127], v[60:63], v[124:127], a[124:127]
  s_waitcnt lgkmcnt(0)
  v_accvgpr_read_b32 v205, a226
  v_accvgpr_read_b32 v1, a227
  v_mfma_f32_16x16x32_bf16 a[92:95], v[48:51], v[120:123], 0
  v_cvt_pk_bf16_f32 v204, v204, v0
  v_cvt_pk_bf16_f32 v205, v205, v1
  v_mfma_f32_16x16x32_bf16 a[92:95], v[52:55], v[124:127], a[92:95]
  buffer_store_dwordx4 v[160:163], v30, s[48:51], s68 offen offset:0 sc1
  v_mfma_f32_16x16x32_bf16 a[128:131], v[32:35], v[64:67], 0
  ds_read_b64_tr_b16 v[48:49], v15 offset:49152
  v_accvgpr_read_b32 v206, a228
  v_accvgpr_read_b32 v0, a229
  v_mfma_f32_16x16x32_bf16 a[128:131], v[36:39], v[68:71], a[128:131]
  v_accvgpr_read_b32 v207, a230
  v_accvgpr_read_b32 v1, a231
  v_mfma_f32_16x16x32_bf16 a[160:163], v[40:43], v[64:67], 0
  s_add_u32 m0, s69, 32768
  ds_read_b64_tr_b16 v[50:51], v15 offset:49664
  v_cvt_pk_bf16_f32 v206, v206, v0
  v_cvt_pk_bf16_f32 v207, v207, v1
  v_mfma_f32_16x16x32_bf16 a[160:163], v[44:47], v[68:71], a[160:163]
  buffer_load_dwordx4 v18, s[36:39], s65 offen offset:0 sc1 lds
  v_accvgpr_read_b32 v212, a200
  v_mfma_f32_16x16x32_bf16 a[164:167], v[40:43], v[72:75], 0
  ds_read_b64_tr_b16 v[52:53], v15 offset:53248
  v_accvgpr_read_b32 v0, a201
  v_accvgpr_read_b32 v213, a202
  v_mfma_f32_16x16x32_bf16 a[164:167], v[44:47], v[76:79], a[164:167]
  v_accvgpr_read_b32 v1, a203
  v_cvt_pk_bf16_f32 v212, v212, v0
  v_mfma_f32_16x16x32_bf16 a[132:135], v[32:35], v[72:75], 0
  ds_read_b64_tr_b16 v[54:55], v15 offset:53760
  v_cvt_pk_bf16_f32 v213, v213, v1
  v_accvgpr_read_b32 v214, a204
  v_mfma_f32_16x16x32_bf16 a[132:135], v[36:39], v[76:79], a[132:135]
  v_accvgpr_read_b32 v0, a205
  v_accvgpr_read_b32 v215, a206
  v_mfma_f32_16x16x32_bf16 a[136:139], v[32:35], v[80:83], 0
  ds_read_b64_tr_b16 v[56:57], v15 offset:57344
  v_accvgpr_read_b32 v1, a207
  v_mfma_f32_16x16x32_bf16 a[136:139], v[36:39], v[84:87], a[136:139]
  v_cvt_pk_bf16_f32 v214, v214, v0
  v_cvt_pk_bf16_f32 v215, v215, v1
  v_mfma_f32_16x16x32_bf16 a[168:171], v[40:43], v[80:83], 0
  ds_read_b64_tr_b16 v[58:59], v15 offset:57856
  buffer_store_dwordx4 v[168:171], v30, s[48:51], s68 offen offset:1024 sc1
  v_accvgpr_read_b32 v220, a232
  v_mfma_f32_16x16x32_bf16 a[168:171], v[44:47], v[84:87], a[168:171]
  buffer_load_dwordx4 v19, s[36:39], s65 offen offset:1024 sc1 lds
  v_accvgpr_read_b32 v0, a233
  v_accvgpr_read_b32 v221, a234
  v_mfma_f32_16x16x32_bf16 a[172:175], v[40:43], v[88:91], 0
  ds_read_b64_tr_b16 v[60:61], v15 offset:61440
  v_accvgpr_read_b32 v1, a235
  v_cvt_pk_bf16_f32 v220, v220, v0
  v_mfma_f32_16x16x32_bf16 a[172:175], v[44:47], v[92:95], a[172:175]
  v_cvt_pk_bf16_f32 v221, v221, v1
  v_accvgpr_read_b32 v222, a236
  v_mfma_f32_16x16x32_bf16 a[140:143], v[32:35], v[88:91], 0
  ds_read_b64_tr_b16 v[62:63], v15 offset:61952
  v_accvgpr_read_b32 v0, a237
  v_mfma_f32_16x16x32_bf16 a[140:143], v[36:39], v[92:95], a[140:143]
  v_accvgpr_read_b32 v223, a238
  v_accvgpr_read_b32 v1, a239
  v_mfma_f32_16x16x32_bf16 a[144:147], v[32:35], v[96:99], 0
  v_cvt_pk_bf16_f32 v222, v222, v0
  v_cvt_pk_bf16_f32 v223, v223, v1
  v_mfma_f32_16x16x32_bf16 a[144:147], v[36:39], v[100:103], a[144:147]
  v_accvgpr_read_b32 v228, a208
  v_accvgpr_read_b32 v0, a209
  v_mfma_f32_16x16x32_bf16 a[176:179], v[40:43], v[96:99], 0
  v_accvgpr_read_b32 v229, a210
  v_accvgpr_read_b32 v1, a211
  v_mfma_f32_16x16x32_bf16 a[176:179], v[44:47], v[100:103], a[176:179]
  buffer_load_dwordx4 v20, s[36:39], s65 offen offset:2048 sc1 lds
  v_mfma_f32_16x16x32_bf16 a[180:183], v[40:43], v[104:107], 0
  v_cvt_pk_bf16_f32 v228, v228, v0
  v_cvt_pk_bf16_f32 v229, v229, v1
  v_mfma_f32_16x16x32_bf16 a[180:183], v[44:47], v[108:111], a[180:183]
  s_add_u32 s68, s68, 8192
  v_accvgpr_read_b32 v230, a212
  v_accvgpr_read_b32 v0, a213
  v_mfma_f32_16x16x32_bf16 a[148:151], v[32:35], v[104:107], 0
  v_accvgpr_read_b32 v231, a214
  v_accvgpr_read_b32 v1, a215
  v_mfma_f32_16x16x32_bf16 a[148:151], v[36:39], v[108:111], a[148:151]
  v_cvt_pk_bf16_f32 v230, v230, v0
  v_cvt_pk_bf16_f32 v231, v231, v1
  v_mfma_f32_16x16x32_bf16 a[152:155], v[32:35], v[112:115], 0
  v_accvgpr_read_b32 v236, a240
  v_accvgpr_read_b32 v0, a241
  v_mfma_f32_16x16x32_bf16 a[152:155], v[36:39], v[116:119], a[152:155]
  v_accvgpr_read_b32 v237, a242
  v_accvgpr_read_b32 v1, a243
  v_mfma_f32_16x16x32_bf16 a[184:187], v[40:43], v[112:115], 0
  v_cvt_pk_bf16_f32 v236, v236, v0
  v_cvt_pk_bf16_f32 v237, v237, v1
  v_mfma_f32_16x16x32_bf16 a[184:187], v[44:47], v[116:119], a[184:187]
  buffer_load_dwordx4 v21, s[36:39], s65 offen offset:3072 sc1 lds
  v_accvgpr_read_b32 v238, a244
  v_accvgpr_read_b32 v0, a245
  v_mfma_f32_16x16x32_bf16 a[188:191], v[40:43], v[120:123], 0
  s_add_u32 s65, s65, 128
  v_accvgpr_read_b32 v239, a246
  v_accvgpr_read_b32 v1, a247
  v_mfma_f32_16x16x32_bf16 a[188:191], v[44:47], v[124:127], a[188:191]
  v_cvt_pk_bf16_f32 v238, v238, v0
  v_cvt_pk_bf16_f32 v239, v239, v1
  v_mfma_f32_16x16x32_bf16 a[156:159], v[32:35], v[120:123], 0
  buffer_store_dwordx4 v[176:179], v30, s[48:51], s68 offen offset:0 sc1
  v_mfma_f32_16x16x32_bf16 a[156:159], v[36:39], v[124:127], a[156:159]
  s_waitcnt vmcnt(17) lgkmcnt(0)
  s_barrier
  v_mfma_f32_16x16x32_bf16 a[192:195], v[48:51], v[64:67], 0
  ds_read_b64_tr_b16 v[32:33], v10 offset:0
  ds_read_b64_tr_b16 v[34:35], v10 offset:1024
  v_accvgpr_read_b32 v244, a216
  v_mfma_f32_16x16x32_bf16 a[192:195], v[52:55], v[68:71], a[192:195]
  ds_read_b64_tr_b16 v[36:37], v10 offset:8192
  ds_read_b64_tr_b16 v[38:39], v10 offset:9216
  v_accvgpr_read_b32 v0, a217
  v_mfma_f32_16x16x32_bf16 a[224:227], v[56:59], v[64:67], 0
  ds_read_b64_tr_b16 v[40:41], v11 offset:0
  ds_read_b64_tr_b16 v[42:43], v11 offset:1024
  v_accvgpr_read_b32 v245, a218
  v_mfma_f32_16x16x32_bf16 a[224:227], v[60:63], v[68:71], a[224:227]
  ds_read_b128 v[64:67], v4 offset:16384
  v_accvgpr_read_b32 v1, a219
  v_mfma_f32_16x16x32_bf16 a[228:231], v[56:59], v[72:75], 0
  s_add_u32 m0, s69, 0
  ds_read_b128 v[68:71], v5 offset:16384
  v_cvt_pk_bf16_f32 v244, v244, v0
  v_mfma_f32_16x16x32_bf16 a[228:231], v[60:63], v[76:79], a[228:231]
L_pg4:
  s_cbranch_execz L_pg8
  ds_read_b64_tr_b16 v[44:45], v11 offset:8192
  ds_read_b64_tr_b16 v[46:47], v11 offset:9216
  v_cvt_pk_bf16_f32 v245, v245, v1
  v_mfma_f32_16x16x32_bf16 a[196:199], v[48:51], v[72:75], 0
  buffer_load_dwordx4 v22, s[40:43], s66 offen offset:0 sc1 lds
  v_mfma_f32_16x16x32_bf16 a[196:199], v[52:55], v[76:79], a[196:199]
  ds_read_b128 v[72:75], v4 offset:18432
  v_accvgpr_read_b32 v246, a220
  v_mfma_f32_16x16x32_bf16 a[200:203], v[48:51], v[80:83], 0
  ds_read_b128 v[76:79], v5 offset:18432
  v_accvgpr_read_b32 v0, a221
  v_mfma_f32_16x16x32_bf16 a[200:203], v[52:55], v[84:87], a[200:203]
  v_accvgpr_read_b32 v247, a222
  v_accvgpr_read_b32 v1, a223
  v_mfma_f32_16x16x32_bf16 a[232:235], v[56:59], v[80:83], 0
  v_cvt_pk_bf16_f32 v246, v246, v0
  v_cvt_pk_bf16_f32 v247, v247, v1
  v_mfma_f32_16x16x32_bf16 a[232:235], v[60:63], v[84:87], a[232:235]
  ds_read_b128 v[80:83], v4 offset:20480
  v_accvgpr_read_b32 v252, a248
  v_mfma_f32_16x16x32_bf16 a[236:239], v[56:59], v[88:91], 0
  ds_read_b128 v[84:87], v5 offset:20480
  v_accvgpr_read_b32 v0, a249
  v_mfma_f32_16x16x32_bf16 a[236:239], v[60:63], v[92:95], a[236:239]
  buffer_load_dwordx4 v23, s[40:43], s66 offen offset:1024 sc1 lds
  v_mfma_f32_16x16x32_bf16 a[204:207], v[48:51], v[88:91], 0
  v_accvgpr_read_b32 v253, a250
  v_accvgpr_read_b32 v1, a251
  v_mfma_f32_16x16x32_bf16 a[204:207], v[52:55], v[92:95], a[204:207]
  ds_read_b128 v[88:91], v4 offset:22528
  v_cvt_pk_bf16_f32 v252, v252, v0
  v_mfma_f32_16x16x32_bf16 a[208:211], v[48:51], v[96:99], 0
  ds_read_b128 v[92:95], v5 offset:22528
  v_cvt_pk_bf16_f32 v253, v253, v1
  v_mfma_f32_16x16x32_bf16 a[208:211], v[52:55], v[100:103], a[208:211]
  v_accvgpr_read_b32 v254, a252
  v_accvgpr_read_b32 v0, a253
  v_mfma_f32_16x16x32_bf16 a[240:243], v[56:59], v[96:99], 0
  v_accvgpr_read_b32 v255, a254
  v_accvgpr_read_b32 v1, a255
  v_mfma_f32_16x16x32_bf16 a[240:243], v[60:63], v[100:103], a[240:243]
  ds_read_b128 v[96:99], v4 offset:32768
  v_cvt_pk_bf16_f32 v254, v254, v0
  v_mfma_f32_16x16x32_bf16 a[244:247], v[56:59], v[104:107], 0
  ds_read_b128 v[100:103], v5 offset:32768
  v_cvt_pk_bf16_f32 v255, v255, v1
  v_mfma_f32_16x16x32_bf16 a[244:247], v[60:63], v[108:111], a[244:247]
  buffer_load_dwordx4 v24, s[40:43], s66 offen offset:2048 sc1 lds
  v_mfma_f32_16x16x32_bf16 a[212:215], v[48:51], v[104:107], 0
  buffer_store_dwordx4 v[184:187], v30, s[48:51], s68 offen offset:1024 sc1
  v_mfma_f32_16x16x32_bf16 a[212:215], v[52:55], v[108:111], a[212:215]
  ds_read_b128 v[104:107], v4 offset:34816
  v_mfma_f32_16x16x32_bf16 a[216:219], v[48:51], v[112:115], 0
  s_sub_u32 s68, s68, 24576
  ds_read_b128 v[108:111], v5 offset:34816
  v_mfma_f32_16x16x32_bf16 a[216:219], v[52:55], v[116:119], a[216:219]
  v_mfma_f32_16x16x32_bf16 a[248:251], v[56:59], v[112:115], 0
  v_mfma_f32_16x16x32_bf16 a[248:251], v[60:63], v[116:119], a[248:251]
  ds_read_b128 v[112:115], v4 offset:36864
  v_mfma_f32_16x16x32_bf16 a[252:255], v[56:59], v[120:123], 0
  ds_read_b128 v[116:119], v5 offset:36864
  v_mfma_f32_16x16x32_bf16 a[252:255], v[60:63], v[124:127], a[252:255]
  buffer_load_dwordx4 v25, s[40:43], s66 offen offset:3072 sc1 lds
  v_mfma_f32_16x16x32_bf16 a[220:223], v[48:51], v[120:123], 0
  s_add_u32 s66, s66, 524288
  v_mfma_f32_16x16x32_bf16 a[220:223], v[52:55], v[124:127], a[220:223]
  s_waitcnt lgkmcnt(6)
  ds_read_b128 v[120:123], v4 offset:38912
  ds_read_b128 v[124:127], v5 offset:38912
  v_mfma_f32_16x16x32_bf16 a[0:3], v[32:35], v[64:67], a[0:3]
  ds_read_b64_tr_b16 v[48:49], v12 offset:0
  v_mfma_f32_16x16x32_bf16 a[0:3], v[36:39], v[68:71], a[0:3]
  v_mfma_f32_16x16x32_bf16 a[32:35], v[40:43], v[64:67], a[32:35]
  s_add_u32 m0, s69, 49152
  ds_read_b64_tr_b16 v[50:51], v12 offset:1024
  v_mfma_f32_16x16x32_bf16 a[32:35], v[44:47], v[68:71], a[32:35]
  buffer_load_dwordx4 v26, s[44:47], s67 offen offset:0 sc1 lds
  v_mfma_f32_16x16x32_bf16 a[36:39], v[40:43], v[72:75], a[36:39]
  ds_read_b64_tr_b16 v[52:53], v12 offset:8192
  v_mfma_f32_16x16x32_bf16 a[36:39], v[44:47], v[76:79], a[36:39]
  v_mfma_f32_16x16x32_bf16 a[4:7], v[32:35], v[72:75], a[4:7]
  ds_read_b64_tr_b16 v[54:55], v12 offset:9216
  v_mfma_f32_16x16x32_bf16 a[4:7], v[36:39], v[76:79], a[4:7]
  v_mfma_f32_16x16x32_bf16 a[8:11], v[32:35], v[80:83], a[8:11]
  ds_read_b64_tr_b16 v[56:57], v13 offset:0
  v_mfma_f32_16x16x32_bf16 a[8:11], v[36:39], v[84:87], a[8:11]
  v_mfma_f32_16x16x32_bf16 a[40:43], v[40:43], v[80:83], a[40:43]
  ds_read_b64_tr_b16 v[58:59], v13 offset:1024
  v_mfma_f32_16x16x32_bf16 a[40:43], v[44:47], v[84:87], a[40:43]
  buffer_load_dwordx4 v27, s[44:47], s67 offen offset:1024 sc1 lds
  v_mfma_f32_16x16x32_bf16 a[44:47], v[40:43], v[88:91], a[44:47]
  ds_read_b64_tr_b16 v[60:61], v13 offset:8192
  v_mfma_f32_16x16x32_bf16 a[44:47], v[44:47], v[92:95], a[44:47]
  v_mfma_f32_16x16x32_bf16 a[12:15], v[32:35], v[88:91], a[12:15]
  ds_read_b64_tr_b16 v[62:63], v13 offset:9216
  v_mfma_f32_16x16x32_bf16 a[12:15], v[36:39], v[92:95], a[12:15]
  s_waitcnt lgkmcnt(8)
  v_mfma_f32_16x16x32_bf16 a[16:19], v[32:35], v[96:99], a[16:19]
  buffer_store_dwordx4 v[192:195], v30, s[48:51], s68 offen offset:2048 sc1
  v_mfma_f32_16x16x32_bf16 a[16:19], v[36:39], v[100:103], a[16:19]
  v_mfma_f32_16x16x32_bf16 a[48:51], v[40:43], v[96:99], a[48:51]
  v_mfma_f32_16x16x32_bf16 a[48:51], v[44:47], v[100:103], a[48:51]
  buffer_load_dwordx4 v28, s[44:47], s67 offen offset:2048 sc1 lds
  v_mfma_f32_16x16x32_bf16 a[52:55], v[40:43], v[104:107], a[52:55]
  v_mfma_f32_16x16x32_bf16 a[52:55], v[44:47], v[108:111], a[52:55]
  v_mfma_f32_16x16x32_bf16 a[20:23], v[32:35], v[104:107], a[20:23]
  v_mfma_f32_16x16x32_bf16 a[20:23], v[36:39], v[108:111], a[20:23]
  v_mfma_f32_16x16x32_bf16 a[24:27], v[32:35], v[112:115], a[24:27]
  v_mfma_f32_16x16x32_bf16 a[24:27], v[36:39], v[116:119], a[24:27]
  v_mfma_f32_16x16x32_bf16 a[56:59], v[40:43], v[112:115], a[56:59]
  v_mfma_f32_16x16x32_bf16 a[56:59], v[44:47], v[116:119], a[56:59]
  buffer_load_dwordx4 v29, s[44:47], s67 offen offset:3072 sc1 lds
  v_mfma_f32_16x16x32_bf16 a[60:63], v[40:43], v[120:123], a[60:63]
  s_add_u32 s67, s67, 229376
  v_mfma_f32_16x16x32_bf16 a[60:63], v[44:47], v[124:127], a[60:63]
  v_mfma_f32_16x16x32_bf16 a[28:31], v[32:35], v[120:123], a[28:31]
  v_mfma_f32_16x16x32_bf16 a[28:31], v[36:39], v[124:127], a[28:31]
  s_waitcnt vmcnt(21) lgkmcnt(0)
  s_barrier
  v_mfma_f32_16x16x32_bf16 a[64:67], v[48:51], v[64:67], a[64:67]
  ds_read_b64_tr_b16 v[32:33], v16 offset:49152
  v_mfma_f32_16x16x32_bf16 a[64:67], v[52:55], v[68:71], a[64:67]
  v_mfma_f32_16x16x32_bf16 a[96:99], v[56:59], v[64:67], a[96:99]
  s_add_u32 m0, s69, 81920
  ds_read_b64_tr_b16 v[34:35], v16 offset:49664
  v_mfma_f32_16x16x32_bf16 a[96:99], v[60:63], v[68:71], a[96:99]
  buffer_load_dwordx4 v18, s[36:39], s64 offen offset:0 sc1 lds
  v_mfma_f32_16x16x32_bf16 a[100:103], v[56:59], v[72:75], a[100:103]
  ds_read_b64_tr_b16 v[36:37], v16 offset:53248
  v_mfma_f32_16x16x32_bf16 a[100:103], v[60:63], v[76:79], a[100:103]
  v_mfma_f32_16x16x32_bf16 a[68:71], v[48:51], v[72:75], a[68:71]
  ds_read_b64_tr_b16 v[38:39], v16 offset:53760
  v_mfma_f32_16x16x32_bf16 a[68:71], v[52:55], v[76:79], a[68:71]
  buffer_store_dwordx4 v[200:203], v30, s[48:51], s68 offen offset:3072 sc1
  v_mfma_f32_16x16x32_bf16 a[72:75], v[48:51], v[80:83], a[72:75]
  ds_read_b64_tr_b16 v[40:41], v16 offset:57344
  v_mfma_f32_16x16x32_bf16 a[72:75], v[52:55], v[84:87], a[72:75]
  v_mfma_f32_16x16x32_bf16 a[104:107], v[56:59], v[80:83], a[104:107]
  ds_read_b64_tr_b16 v[42:43], v16 offset:57856
  v_mfma_f32_16x16x32_bf16 a[104:107], v[60:63], v[84:87], a[104:107]
  buffer_load_dwordx4 v19, s[36:39], s64 offen offset:1024 sc1 lds
  v_mfma_f32_16x16x32_bf16 a[108:111], v[56:59], v[88:91], a[108:111]
  ds_read_b64_tr_b16 v[44:45], v16 offset:61440
  v_mfma_f32_16x16x32_bf16 a[108:111], v[60:63], v[92:95], a[108:111]
  v_mfma_f32_16x16x32_bf16 a[76:79], v[48:51], v[88:91], a[76:79]
  ds_read_b64_tr_b16 v[46:47], v16 offset:61952
  v_mfma_f32_16x16x32_bf16 a[76:79], v[52:55], v[92:95], a[76:79]
  v_mfma_f32_16x16x32_bf16 a[80:83], v[48:51], v[96:99], a[80:83]
  v_mfma_f32_16x16x32_bf16 a[80:83], v[52:55], v[100:103], a[80:83]
  v_mfma_f32_16x16x32_bf16 a[112:115], v[56:59], v[96:99], a[112:115]
  v_mfma_f32_16x16x32_bf16 a[112:115], v[60:63], v[100:103], a[112:115]
  buffer_load_dwordx4 v20, s[36:39], s64 offen offset:2048 sc1 lds
  v_mfma_f32_16x16x32_bf16 a[116:119], v[56:59], v[104:107], a[116:119]
  v_mfma_f32_16x16x32_bf16 a[116:119], v[60:63], v[108:111], a[116:119]
  v_mfma_f32_16x16x32_bf16 a[84:87], v[48:51], v[104:107], a[84:87]
  v_mfma_f32_16x16x32_bf16 a[84:87], v[52:55], v[108:111], a[84:87]
  v_mfma_f32_16x16x32_bf16 a[88:91], v[48:51], v[112:115], a[88:91]
  s_add_u32 s68, s68, 8192
  v_mfma_f32_16x16x32_bf16 a[88:91], v[52:55], v[116:119], a[88:91]
  v_mfma_f32_16x16x32_bf16 a[120:123], v[56:59], v[112:115], a[120:123]
  v_mfma_f32_16x16x32_bf16 a[120:123], v[60:63], v[116:119], a[120:123]
  buffer_load_dwordx4 v21, s[36:39], s64 offen offset:3072 sc1 lds
  v_mfma_f32_16x16x32_bf16 a[124:127], v[56:59], v[120:123], a[124:127]
  s_add_u32 s64, s64, 128
  v_mfma_f32_16x16x32_bf16 a[124:127], v[60:63], v[124:127], a[124:127]
  s_waitcnt lgkmcnt(0)
  v_mfma_f32_16x16x32_bf16 a[92:95], v[48:51], v[120:123], a[92:95]
  v_mfma_f32_16x16x32_bf16 a[92:95], v[52:55], v[124:127], a[92:95]
  v_mfma_f32_16x16x32_bf16 a[128:131], v[32:35], v[64:67], a[128:131]
  ds_read_b64_tr_b16 v[48:49], v17 offset:49152
  v_mfma_f32_16x16x32_bf16 a[128:131], v[36:39], v[68:71], a[128:131]
  v_mfma_f32_16x16x32_bf16 a[160:163], v[40:43], v[64:67], a[160:163]
  s_add_u32 m0, s69, 98304
  ds_read_b64_tr_b16 v[50:51], v17 offset:49664
  v_mfma_f32_16x16x32_bf16 a[160:163], v[44:47], v[68:71], a[160:163]
  buffer_load_dwordx4 v18, s[36:39], s65 offen offset:0 sc1 lds
  v_mfma_f32_16x16x32_bf16 a[164:167], v[40:43], v[72:75], a[164:167]
  ds_read_b64_tr_b16 v[52:53], v17 offset:53248
  v_mfma_f32_16x16x32_bf16 a[164:167], v[44:47], v[76:79], a[164:167]
  buffer_store_dwordx4 v[208:211], v30, s[48:51], s68 offen offset:2048 sc1
  v_mfma_f32_16x16x32_bf16 a[132:135], v[32:35], v[72:75], a[132:135]
  ds_read_b64_tr_b16 v[54:55], v17 offset:53760
  v_mfma_f32_16x16x32_bf16 a[132:135], v[36:39], v[76:79], a[132:135]
  v_mfma_f32_16x16x32_bf16 a[136:139], v[32:35], v[80:83], a[136:139]
  ds_read_b64_tr_b16 v[56:57], v17 offset:57344
  v_mfma_f32_16x16x32_bf16 a[136:139], v[36:39], v[84:87], a[136:139]
  v_mfma_f32_16x16x32_bf16 a[168:171], v[40:43], v[80:83], a[168:171]
  ds_read_b64_tr_b16 v[58:59], v17 offset:57856
  v_mfma_f32_16x16x32_bf16 a[168:171], v[44:47], v[84:87], a[168:171]
  buffer_load_dwordx4 v19, s[36:39], s65 offen offset:1024 sc1 lds
  v_mfma_f32_16x16x32_bf16 a[172:175], v[40:43], v[88:91], a[172:175]
  ds_read_b64_tr_b16 v[60:61], v17 offset:61440
  v_mfma_f32_16x16x32_bf16 a[172:175], v[44:47], v[92:95], a[172:175]
  v_mfma_f32_16x16x32_bf16 a[140:143], v[32:35], v[88:91], a[140:143]
  ds_read_b64_tr_b16 v[62:63], v17 offset:61952
  v_mfma_f32_16x16x32_bf16 a[140:143], v[36:39], v[92:95], a[140:143]
  buffer_store_dwordx4 v[216:219], v30, s[48:51], s68 offen offset:3072 sc1
  v_mfma_f32_16x16x32_bf16 a[144:147], v[32:35], v[96:99], a[144:147]
  v_mfma_f32_16x16x32_bf16 a[144:147], v[36:39], v[100:103], a[144:147]
  v_mfma_f32_16x16x32_bf16 a[176:179], v[40:43], v[96:99], a[176:179]
  v_mfma_f32_16x16x32_bf16 a[176:179], v[44:47], v[100:103], a[176:179]
  buffer_load_dwordx4 v20, s[36:39], s65 offen offset:2048 sc1 lds
  v_mfma_f32_16x16x32_bf16 a[180:183], v[40:43], v[104:107], a[180:183]
  v_mfma_f32_16x16x32_bf16 a[180:183], v[44:47], v[108:111], a[180:183]
  v_mfma_f32_16x16x32_bf16 a[148:151], v[32:35], v[104:107], a[148:151]
  v_mfma_f32_16x16x32_bf16 a[148:151], v[36:39], v[108:111], a[148:151]
  v_mfma_f32_16x16x32_bf16 a[152:155], v[32:35], v[112:115], a[152:155]
  v_mfma_f32_16x16x32_bf16 a[152:155], v[36:39], v[116:119], a[152:155]
  s_add_u32 s68, s68, 8192
  v_mfma_f32_16x16x32_bf16 a[184:187], v[40:43], v[112:115], a[184:187]
  v_mfma_f32_16x16x32_bf16 a[184:187], v[44:47], v[116:119], a[184:187]
  buffer_load_dwordx4 v21, s[36:39], s65 offen offset:3072 sc1 lds
  v_mfma_f32_16x16x32_bf16 a[188:191], v[40:43], v[120:123], a[188:191]
  s_add_u32 s65, s65, 128
  v_mfma_f32_16x16x32_bf16 a[188:191], v[44:47], v[124:127], a[188:191]
  v_mfma_f32_16x16x32_bf16 a[156:159], v[32:35], v[120:123], a[156:159]
  v_mfma_f32_16x16x32_bf16 a[156:159], v[36:39], v[124:127], a[156:159]
  s_waitcnt vmcnt(16) lgkmcnt(0)
  s_barrier
  v_mfma_f32_16x16x32_bf16 a[192:195], v[48:51], v[64:67], a[192:195]
  ds_read_b64_tr_b16 v[32:33], v6 offset:0
  ds_read_b64_tr_b16 v[34:35], v6 offset:1024
  v_mfma_f32_16x16x32_bf16 a[192:195], v[52:55], v[68:71], a[192:195]
  ds_read_b64_tr_b16 v[36:37], v6 offset:8192
  ds_read_b64_tr_b16 v[38:39], v6 offset:9216
  v_mfma_f32_16x16x32_bf16 a[224:227], v[56:59], v[64:67], a[224:227]
  ds_read_b64_tr_b16 v[40:41], v7 offset:0
  ds_read_b64_tr_b16 v[42:43], v7 offset:1024
  v_mfma_f32_16x16x32_bf16 a[224:227], v[60:63], v[68:71], a[224:227]
  ds_read_b128 v[64:67], v2 offset:16384
  v_mfma_f32_16x16x32_bf16 a[228:231], v[56:59], v[72:75], a[228:231]
  s_add_u32 m0, s69, 65536
  ds_read_b128 v[68:71], v3 offset:16384
  v_mfma_f32_16x16x32_bf16 a[228:231], v[60:63], v[76:79], a[228:231]
  ds_read_b64_tr_b16 v[44:45], v7 offset:8192
  ds_read_b64_tr_b16 v[46:47], v7 offset:9216
  v_mfma_f32_16x16x32_bf16 a[196:199], v[48:51], v[72:75], a[196:199]
  buffer_load_dwordx4 v22, s[40:43], s66 offen offset:0 sc1 lds
  v_mfma_f32_16x16x32_bf16 a[196:199], v[52:55], v[76:79], a[196:199]
  ds_read_b128 v[72:75], v2 offset:18432
  v_mfma_f32_16x16x32_bf16 a[200:203], v[48:51], v[80:83], a[200:203]
  ds_read_b128 v[76:79], v3 offset:18432
  v_mfma_f32_16x16x32_bf16 a[200:203], v[52:55], v[84:87], a[200:203]
  v_mfma_f32_16x16x32_bf16 a[232:235], v[56:59], v[80:83], a[232:235]
  v_mfma_f32_16x16x32_bf16 a[232:235], v[60:63], v[84:87], a[232:235]
  ds_read_b128 v[80:83], v2 offset:20480
  v_mfma_f32_16x16x32_bf16 a[236:239], v[56:59], v[88:91], a[236:239]
  ds_read_b128 v[84:87], v3 offset:20480
  v_mfma_f32_16x16x32_bf16 a[236:239], v[60:63], v[92:95], a[236:239]
  buffer_load_dwordx4 v23, s[40:43], s66 offen offset:1024 sc1 lds
  v_mfma_f32_16x16x32_bf16 a[204:207], v[48:51], v[88:91], a[204:207]
  v_mfma_f32_16x16x32_bf16 a[204:207], v[52:55], v[92:95], a[204:207]
  ds_read_b128 v[88:91], v2 offset:22528
  v_mfma_f32_16x16x32_bf16 a[208:211], v[48:51], v[96:99], a[208:211]
  ds_read_b128 v[92:95], v3 offset:22528
  v_mfma_f32_16x16x32_bf16 a[208:211], v[52:55], v[100:103], a[208:211]
  buffer_store_dwordx4 v[224:227], v30, s[48:51], s68 offen offset:2048 sc1
  v_mfma_f32_16x16x32_bf16 a[240:243], v[56:59], v[96:99], a[240:243]
  v_mfma_f32_16x16x32_bf16 a[240:243], v[60:63], v[100:103], a[240:243]
  ds_read_b128 v[96:99], v2 offset:32768
  v_mfma_f32_16x16x32_bf16 a[244:247], v[56:59], v[104:107], a[244:247]
  ds_read_b128 v[100:103], v3 offset:32768
  v_mfma_f32_16x16x32_bf16 a[244:247], v[60:63], v[108:111], a[244:247]
  buffer_load_dwordx4 v24, s[40:43], s66 offen offset:2048 sc1 lds
  v_mfma_f32_16x16x32_bf16 a[212:215], v[48:51], v[104:107], a[212:215]
  v_mfma_f32_16x16x32_bf16 a[212:215], v[52:55], v[108:111], a[212:215]
  ds_read_b128 v[104:107], v2 offset:34816
  v_mfma_f32_16x16x32_bf16 a[216:219], v[48:51], v[112:115], a[216:219]
  ds_read_b128 v[108:111], v3 offset:34816
  v_mfma_f32_16x16x32_bf16 a[216:219], v[52:55], v[116:119], a[216:219]
  v_mfma_f32_16x16x32_bf16 a[248:251], v[56:59], v[112:115], a[248:251]
  v_mfma_f32_16x16x32_bf16 a[248:251], v[60:63], v[116:119], a[248:251]
  ds_read_b128 v[112:115], v2 offset:36864
  v_mfma_f32_16x16x32_bf16 a[252:255], v[56:59], v[120:123], a[252:255]
  ds_read_b128 v[116:119], v3 offset:36864
  v_mfma_f32_16x16x32_bf16 a[252:255], v[60:63], v[124:127], a[252:255]
  buffer_load_dwordx4 v25, s[40:43], s66 offen offset:3072 sc1 lds
  v_mfma_f32_16x16x32_bf16 a[220:223], v[48:51], v[120:123], a[220:223]
  s_add_u32 s66, s66, 524288
  v_mfma_f32_16x16x32_bf16 a[220:223], v[52:55], v[124:127], a[220:223]
  s_waitcnt lgkmcnt(6)
  ds_read_b128 v[120:123], v2 offset:38912
  ds_read_b128 v[124:127], v3 offset:38912
  v_mfma_f32_16x16x32_bf16 a[0:3], v[32:35], v[64:67], a[0:3]
  ds_read_b64_tr_b16 v[48:49], v8 offset:0
  v_mfma_f32_16x16x32_bf16 a[0:3], v[36:39], v[68:71], a[0:3]
  v_mfma_f32_16x16x32_bf16 a[32:35], v[40:43], v[64:67], a[32:35]
  s_add_u32 m0, s69, 114688
  ds_read_b64_tr_b16 v[50:51], v8 offset:1024
  v_mfma_f32_16x16x32_bf16 a[32:35], v[44:47], v[68:71], a[32:35]
  buffer_load_dwordx4 v26, s[44:47], s67 offen offset:0 sc1 lds
  v_mfma_f32_16x16x32_bf16 a[36:39], v[40:43], v[72:75], a[36:39]
  ds_read_b64_tr_b16 v[52:53], v8 offset:8192
  v_mfma_f32_16x16x32_bf16 a[36:39], v[44:47], v[76:79], a[36:39]
  v_mfma_f32_16x16x32_bf16 a[4:7], v[32:35], v[72:75], a[4:7]
  ds_read_b64_tr_b16 v[54:55], v8 offset:9216
  v_mfma_f32_16x16x32_bf16 a[4:7], v[36:39], v[76:79], a[4:7]
  buffer_store_dwordx4 v[232:235], v30, s[48:51], s68 offen offset:3072 sc1
  v_mfma_f32_16x16x32_bf16 a[8:11], v[32:35], v[80:83], a[8:11]
  ds_read_b64_tr_b16 v[56:57], v9 offset:0
  v_mfma_f32_16x16x32_bf16 a[8:11], v[36:39], v[84:87], a[8:11]
  v_mfma_f32_16x16x32_bf16 a[40:43], v[40:43], v[80:83], a[40:43]
  ds_read_b64_tr_b16 v[58:59], v9 offset:1024
  v_mfma_f32_16x16x32_bf16 a[40:43], v[44:47], v[84:87], a[40:43]
  buffer_load_dwordx4 v27, s[44:47], s67 offen offset:1024 sc1 lds
  v_mfma_f32_16x16x32_bf16 a[44:47], v[40:43], v[88:91], a[44:47]
  ds_read_b64_tr_b16 v[60:61], v9 offset:8192
  v_mfma_f32_16x16x32_bf16 a[44:47], v[44:47], v[92:95], a[44:47]
  v_mfma_f32_16x16x32_bf16 a[12:15], v[32:35], v[88:91], a[12:15]
  ds_read_b64_tr_b16 v[62:63], v9 offset:9216
  v_mfma_f32_16x16x32_bf16 a[12:15], v[36:39], v[92:95], a[12:15]
  s_waitcnt lgkmcnt(8)
  v_mfma_f32_16x16x32_bf16 a[16:19], v[32:35], v[96:99], a[16:19]
  v_mfma_f32_16x16x32_bf16 a[16:19], v[36:39], v[100:103], a[16:19]
  v_mfma_f32_16x16x32_bf16 a[48:51], v[40:43], v[96:99], a[48:51]
  v_mfma_f32_16x16x32_bf16 a[48:51], v[44:47], v[100:103], a[48:51]
  buffer_load_dwordx4 v28, s[44:47], s67 offen offset:2048 sc1 lds
  v_mfma_f32_16x16x32_bf16 a[52:55], v[40:43], v[104:107], a[52:55]
  v_mfma_f32_16x16x32_bf16 a[52:55], v[44:47], v[108:111], a[52:55]
  v_mfma_f32_16x16x32_bf16 a[20:23], v[32:35], v[104:107], a[20:23]
  v_mfma_f32_16x16x32_bf16 a[20:23], v[36:39], v[108:111], a[20:23]
  s_add_u32 s68, s68, 8192
  v_mfma_f32_16x16x32_bf16 a[24:27], v[32:35], v[112:115], a[24:27]
  v_mfma_f32_16x16x32_bf16 a[24:27], v[36:39], v[116:119], a[24:27]
  v_mfma_f32_16x16x32_bf16 a[56:59], v[40:43], v[112:115], a[56:59]
  v_mfma_f32_16x16x32_bf16 a[56:59], v[44:47], v[116:119], a[56:59]
  buffer_load_dwordx4 v29, s[44:47], s67 offen offset:3072 sc1 lds
  v_mfma_f32_16x16x32_bf16 a[60:63], v[40:43], v[120:123], a[60:63]
  s_add_u32 s67, s67, 229376
  v_mfma_f32_16x16x32_bf16 a[60:63], v[44:47], v[124:127], a[60:63]
  v_mfma_f32_16x16x32_bf16 a[28:31], v[32:35], v[120:123], a[28:31]
  v_mfma_f32_16x16x32_bf16 a[28:31], v[36:39], v[124:127], a[28:31]
  s_waitcnt vmcnt(21) lgkmcnt(0)
  s_barrier
  v_mfma_f32_16x16x32_bf16 a[64:67], v[48:51], v[64:67], a[64:67]
  ds_read_b64_tr_b16 v[32:33], v14 offset:49152
  v_mfma_f32_16x16x32_bf16 a[64:67], v[52:55], v[68:71], a[64:67]
  v_mfma_f32_16x16x32_bf16 a[96:99], v[56:59], v[64:67], a[96:99]
  s_add_u32 m0, s69, 16384
  ds_read_b64_tr_b16 v[34:35], v14 offset:49664
  v_mfma_f32_16x16x32_bf16 a[96:99], v[60:63], v[68:71], a[96:99]
  buffer_load_dwordx4 v18, s[36:39], s64 offen offset:0 sc1 lds
  v_mfma_f32_16x16x32_bf16 a[100:103], v[56:59], v[72:75], a[100:103]
  ds_read_b64_tr_b16 v[36:37], v14 offset:53248
  v_mfma_f32_16x16x32_bf16 a[100:103], v[60:63], v[76:79], a[100:103]
  v_mfma_f32_16x16x32_bf16 a[68:71], v[48:51], v[72:75], a[68:71]
  ds_read_b64_tr_b16 v[38:39], v14 offset:53760
  v_mfma_f32_16x16x32_bf16 a[68:71], v[52:55], v[76:79], a[68:71]
  v_mfma_f32_16x16x32_bf16 a[72:75], v[48:51], v[80:83], a[72:75]
  ds_read_b64_tr_b16 v[40:41], v14 offset:57344
  v_mfma_f32_16x16x32_bf16 a[72:75], v[52:55], v[84:87], a[72:75]
  v_mfma_f32_16x16x32_bf16 a[104:107], v[56:59], v[80:83], a[104:107]
  ds_read_b64_tr_b16 v[42:43], v14 offset:57856
  v_mfma_f32_16x16x32_bf16 a[104:107], v[60:63], v[84:87], a[104:107]
  buffer_load_dwordx4 v19, s[36:39], s64 offen offset:1024 sc1 lds
  v_mfma_f32_16x16x32_bf16 a[108:111], v[56:59], v[88:91], a[108:111]
  ds_read_b64_tr_b16 v[44:45], v14 offset:61440
  v_mfma_f32_16x16x32_bf16 a[108:111], v[60:63], v[92:95], a[108:111]
  v_mfma_f32_16x16x32_bf16 a[76:79], v[48:51], v[88:91], a[76:79]
  ds_read_b64_tr_b16 v[46:47], v14 offset:61952
  v_mfma_f32_16x16x32_bf16 a[76:79], v[52:55], v[92:95], a[76:79]
  v_mfma_f32_16x16x32_bf16 a[80:83], v[48:51], v[96:99], a[80:83]
  buffer_store_dwordx4 v[240:243], v30, s[48:51], s68 offen offset:2048 sc1
  v_mfma_f32_16x16x32_bf16 a[80:83], v[52:55], v[100:103], a[80:83]
  v_mfma_f32_16x16x32_bf16 a[112:115], v[56:59], v[96:99], a[112:115]
  v_mfma_f32_16x16x32_bf16 a[112:115], v[60:63], v[100:103], a[112:115]
  buffer_load_dwordx4 v20, s[36:39], s64 offen offset:2048 sc1 lds
  v_mfma_f32_16x16x32_bf16 a[116:119], v[56:59], v[104:107], a[116:119]
  v_mfma_f32_16x16x32_bf16 a[116:119], v[60:63], v[108:111], a[116:119]
  v_mfma_f32_16x16x32_bf16 a[84:87], v[48:51], v[104:107], a[84:87]
  v_mfma_f32_16x16x32_bf16 a[84:87], v[52:55], v[108:111], a[84:87]
  v_mfma_f32_16x16x32_bf16 a[88:91], v[48:51], v[112:115], a[88:91]
  v_mfma_f32_16x16x32_bf16 a[88:91], v[52:55], v[116:119], a[88:91]
  v_mfma_f32_16x16x32_bf16 a[120:123], v[56:59], v[112:115], a[120:123]
  v_mfma_f32_16x16x32_bf16 a[120:123], v[60:63], v[116:119], a[120:123]
  buffer_load_dwordx4 v21, s[36:39], s64 offen offset:3072 sc1 lds
  v_mfma_f32_16x16x32_bf16 a[124:127], v[56:59], v[120:123], a[124:127]
  s_add_u32 s64, s64, 128
  v_mfma_f32_16x16x32_bf16 a[124:127], v[60:63], v[124:127], a[124:127]
  s_waitcnt lgkmcnt(0)
  v_mfma_f32_16x16x32_bf16 a[92:95], v[48:51], v[120:123], a[92:95]
  v_mfma_f32_16x16x32_bf16 a[92:95], v[52:55], v[124:127], a[92:95]
  v_mfma_f32_16x16x32_bf16 a[128:131], v[32:35], v[64:67], a[128:131]
  ds_read_b64_tr_b16 v[48:49], v15 offset:49152
  v_mfma_f32_16x16x32_bf16 a[128:131], v[36:39], v[68:71], a[128:131]
  v_mfma_f32_16x16x32_bf16 a[160:163], v[40:43], v[64:67], a[160:163]
  s_add_u32 m0, s69, 32768
  ds_read_b64_tr_b16 v[50:51], v15 offset:49664
  v_mfma_f32_16x16x32_bf16 a[160:163], v[44:47], v[68:71], a[160:163]
  buffer_load_dwordx4 v18, s[36:39], s65 offen offset:0 sc1 lds
  v_mfma_f32_16x16x32_bf16 a[164:167], v[40:43], v[72:75], a[164:167]
  ds_read_b64_tr_b16 v[52:53], v15 offset:53248
  v_mfma_f32_16x16x32_bf16 a[164:167], v[44:47], v[76:79], a[164:167]
  v_mfma_f32_16x16x32_bf16 a[132:135], v[32:35], v[72:75], a[132:135]
  ds_read_b64_tr_b16 v[54:55], v15 offset:53760
  v_mfma_f32_16x16x32_bf16 a[132:135], v[36:39], v[76:79], a[132:135]
  buffer_store_dwordx4 v[248:251], v30, s[48:51], s68 offen offset:3072 sc1
  v_mfma_f32_16x16x32_bf16 a[136:139], v[32:35], v[80:83], a[136:139]
  ds_read_b64_tr_b16 v[56:57], v15 offset:57344
  v_mfma_f32_16x16x32_bf16 a[136:139], v[36:39], v[84:87], a[136:139]
  v_mfma_f32_16x16x32_bf16 a[168:171], v[40:43], v[80:83], a[168:171]
  ds_read_b64_tr_b16 v[58:59], v15 offset:57856
  v_mfma_f32_16x16x32_bf16 a[168:171], v[44:47], v[84:87], a[168:171]
  buffer_load_dwordx4 v19, s[36:39], s65 offen offset:1024 sc1 lds
  v_mfma_f32_16x16x32_bf16 a[172:175], v[40:43], v[88:91], a[172:175]
  ds_read_b64_tr_b16 v[60:61], v15 offset:61440
  v_mfma_f32_16x16x32_bf16 a[172:175], v[44:47], v[92:95], a[172:175]
  v_mfma_f32_16x16x32_bf16 a[140:143], v[32:35], v[88:91], a[140:143]
  ds_read_b64_tr_b16 v[62:63], v15 offset:61952
  v_mfma_f32_16x16x32_bf16 a[140:143], v[36:39], v[92:95], a[140:143]
  v_mfma_f32_16x16x32_bf16 a[144:147], v[32:35], v[96:99], a[144:147]
  v_mfma_f32_16x16x32_bf16 a[144:147], v[36:39], v[100:103], a[144:147]
  v_mfma_f32_16x16x32_bf16 a[176:179], v[40:43], v[96:99], a[176:179]
  v_mfma_f32_16x16x32_bf16 a[176:179], v[44:47], v[100:103], a[176:179]
  buffer_load_dwordx4 v20, s[36:39], s65 offen offset:2048 sc1 lds
  v_mfma_f32_16x16x32_bf16 a[180:183], v[40:43], v[104:107], a[180:183]
  v_mfma_f32_16x16x32_bf16 a[180:183], v[44:47], v[108:111], a[180:183]
  v_mfma_f32_16x16x32_bf16 a[148:151], v[32:35], v[104:107], a[148:151]
  v_mfma_f32_16x16x32_bf16 a[148:151], v[36:39], v[108:111], a[148:151]
  s_sub_u32 s68, s68, 24576
  v_mfma_f32_16x16x32_bf16 a[152:155], v[32:35], v[112:115], a[152:155]
  v_mfma_f32_16x16x32_bf16 a[152:155], v[36:39], v[116:119], a[152:155]
  v_mfma_f32_16x16x32_bf16 a[184:187], v[40:43], v[112:115], a[184:187]
  v_mfma_f32_16x16x32_bf16 a[184:187], v[44:47], v[116:119], a[184:187]
  buffer_load_dwordx4 v21, s[36:39], s65 offen offset:3072 sc1 lds
  v_mfma_f32_16x16x32_bf16 a[188:191], v[40:43], v[120:123], a[188:191]
  s_add_u32 s65, s65, 128
  v_mfma_f32_16x16x32_bf16 a[188:191], v[44:47], v[124:127], a[188:191]
  v_mfma_f32_16x16x32_bf16 a[156:159], v[32:35], v[120:123], a[156:159]
  v_mfma_f32_16x16x32_bf16 a[156:159], v[36:39], v[124:127], a[156:159]
  s_waitcnt vmcnt(15) lgkmcnt(0)
  s_barrier
  v_mfma_f32_16x16x32_bf16 a[192:195], v[48:51], v[64:67], a[192:195]
  ds_read_b64_tr_b16 v[32:33], v10 offset:0
  ds_read_b64_tr_b16 v[34:35], v10 offset:1024
  v_mfma_f32_16x16x32_bf16 a[192:195], v[52:55], v[68:71], a[192:195]
  ds_read_b64_tr_b16 v[36:37], v10 offset:8192
  ds_read_b64_tr_b16 v[38:39], v10 offset:9216
  v_mfma_f32_16x16x32_bf16 a[224:227], v[56:59], v[64:67], a[224:227]
  ds_read_b64_tr_b16 v[40:41], v11 offset:0
  ds_read_b64_tr_b16 v[42:43], v11 offset:1024
  v_mfma_f32_16x16x32_bf16 a[224:227], v[60:63], v[68:71], a[224:227]
  ds_read_b128 v[64:67], v4 offset:16384
  v_mfma_f32_16x16x32_bf16 a[228:231], v[56:59], v[72:75], a[228:231]
  s_add_u32 m0, s69, 0
  ds_read_b128 v[68:71], v5 offset:16384
  v_mfma_f32_16x16x32_bf16 a[228:231], v[60:63], v[76:79], a[228:231]
  ds_read_b64_tr_b16 v[44:45], v11 offset:8192
  ds_read_b64_tr_b16 v[46:47], v11 offset:9216
  v_mfma_f32_16x16x32_bf16 a[196:199], v[48:51], v[72:75], a[196:199]
  buffer_load_dwordx4 v22, s[40:43], s66 offen offset:0 sc1 lds
  v_mfma_f32_16x16x32_bf16 a[196:199], v[52:55], v[76:79], a[196:199]
  ds_read_b128 v[72:75], v4 offset:18432
  v_mfma_f32_16x16x32_bf16 a[200:203], v[48:51], v[80:83], a[200:203]
  ds_read_b128 v[76:79], v5 offset:18432
  v_mfma_f32_16x16x32_bf16 a[200:203], v[52:55], v[84:87], a[200:203]
  buffer_store_dwordx4 v[132:135], v30, s[48:51], s99 offen offset:0 sc1
  v_mfma_f32_16x16x32_bf16 a[232:235], v[56:59], v[80:83], a[232:235]
  v_mfma_f32_16x16x32_bf16 a[232:235], v[60:63], v[84:87], a[232:235]
  ds_read_b128 v[80:83], v4 offset:20480
  v_mfma_f32_16x16x32_bf16 a[236:239], v[56:59], v[88:91], a[236:239]
  ds_read_b128 v[84:87], v5 offset:20480
  v_mfma_f32_16x16x32_bf16 a[236:239], v[60:63], v[92:95], a[236:239]
  buffer_load_dwordx4 v23, s[40:43], s66 offen offset:1024 sc1 lds
  v_mfma_f32_16x16x32_bf16 a[204:207], v[48:51], v[88:91], a[204:207]
  buffer_store_dwordx4 v[140:143], v30, s[48:51], s99 offen offset:1024 sc1
  v_mfma_f32_16x16x32_bf16 a[204:207], v[52:55], v[92:95], a[204:207]
  ds_read_b128 v[88:91], v4 offset:22528
  v_mfma_f32_16x16x32_bf16 a[208:211], v[48:51], v[96:99], a[208:211]
  ds_read_b128 v[92:95], v5 offset:22528
  v_mfma_f32_16x16x32_bf16 a[208:211], v[52:55], v[100:103], a[208:211]
  v_mfma_f32_16x16x32_bf16 a[240:243], v[56:59], v[96:99], a[240:243]
  v_mfma_f32_16x16x32_bf16 a[240:243], v[60:63], v[100:103], a[240:243]
  ds_read_b128 v[96:99], v4 offset:32768
  v_mfma_f32_16x16x32_bf16 a[244:247], v[56:59], v[104:107], a[244:247]
  ds_read_b128 v[100:103], v5 offset:32768
  v_mfma_f32_16x16x32_bf16 a[244:247], v[60:63], v[108:111], a[244:247]
  buffer_load_dwordx4 v24, s[40:43], s66 offen offset:2048 sc1 lds
  v_mfma_f32_16x16x32_bf16 a[212:215], v[48:51], v[104:107], a[212:215]
  v_mfma_f32_16x16x32_bf16 a[212:215], v[52:55], v[108:111], a[212:215]
  ds_read_b128 v[104:107], v4 offset:34816
  v_mfma_f32_16x16x32_bf16 a[216:219], v[48:51], v[112:115], a[216:219]
  ds_read_b128 v[108:111], v5 offset:34816
  v_mfma_f32_16x16x32_bf16 a[216:219], v[52:55], v[116:119], a[216:219]
  v_mfma_f32_16x16x32_bf16 a[248:251], v[56:59], v[112:115], a[248:251]
  s_add_u32 s99, s99, 8192
  v_mfma_f32_16x16x32_bf16 a[248:251], v[60:63], v[116:119], a[248:251]
  ds_read_b128 v[112:115], v4 offset:36864
  v_mfma_f32_16x16x32_bf16 a[252:255], v[56:59], v[120:123], a[252:255]
  ds_read_b128 v[116:119], v5 offset:36864
  v_mfma_f32_16x16x32_bf16 a[252:255], v[60:63], v[124:127], a[252:255]
  buffer_load_dwordx4 v25, s[40:43], s66 offen offset:3072 sc1 lds
  v_mfma_f32_16x16x32_bf16 a[220:223], v[48:51], v[120:123], a[220:223]
  s_add_u32 s66, s66, 524288
  v_mfma_f32_16x16x32_bf16 a[220:223], v[52:55], v[124:127], a[220:223]
  s_waitcnt lgkmcnt(6)
  ds_read_b128 v[120:123], v4 offset:38912
  ds_read_b128 v[124:127], v5 offset:38912
  v_mfma_f32_16x16x32_bf16 a[0:3], v[32:35], v[64:67], a[0:3]
  ds_read_b64_tr_b16 v[48:49], v12 offset:0
  v_mfma_f32_16x16x32_bf16 a[0:3], v[36:39], v[68:71], a[0:3]
  v_mfma_f32_16x16x32_bf16 a[32:35], v[40:43], v[64:67], a[32:35]
  s_add_u32 m0, s69, 49152
  ds_read_b64_tr_b16 v[50:51], v12 offset:1024
  v_mfma_f32_16x16x32_bf16 a[32:35], v[44:47], v[68:71], a[32:35]
  buffer_load_dwordx4 v26, s[44:47], s67 offen offset:0 sc1 lds
  v_mfma_f32_16x16x32_bf16 a[36:39], v[40:43], v[72:75], a[36:39]
  ds_read_b64_tr_b16 v[52:53], v12 offset:8192
  v_mfma_f32_16x16x32_bf16 a[36:39], v[44:47], v[76:79], a[36:39]
  v_mfma_f32_16x16x32_bf16 a[4:7], v[32:35], v[72:75], a[4:7]
  ds_read_b64_tr_b16 v[54:55], v12 offset:9216
  v_mfma_f32_16x16x32_bf16 a[4:7], v[36:39], v[76:79], a[4:7]
  v_mfma_f32_16x16x32_bf16 a[8:11], v[32:35], v[80:83], a[8:11]
  ds_read_b64_tr_b16 v[56:57], v13 offset:0
  v_mfma_f32_16x16x32_bf16 a[8:11], v[36:39], v[84:87], a[8:11]
  v_mfma_f32_16x16x32_bf16 a[40:43], v[40:43], v[80:83], a[40:43]
  ds_read_b64_tr_b16 v[58:59], v13 offset:1024
  v_mfma_f32_16x16x32_bf16 a[40:43], v[44:47], v[84:87], a[40:43]
L_pg5:
  s_cbranch_execz L_pg9
  buffer_load_dwordx4 v27, s[44:47], s67 offen offset:1024 sc1 lds
  v_mfma_f32_16x16x32_bf16 a[44:47], v[40:43], v[88:91], a[44:47]
  ds_read_b64_tr_b16 v[60:61], v13 offset:8192
  v_mfma_f32_16x16x32_bf16 a[44:47], v[44:47], v[92:95], a[44:47]
  v_mfma_f32_16x16x32_bf16 a[12:15], v[32:35], v[88:91], a[12:15]
  ds_read_b64_tr_b16 v[62:63], v13 offset:9216
  v_mfma_f32_16x16x32_bf16 a[12:15], v[36:39], v[92:95], a[12:15]
  s_waitcnt lgkmcnt(8)
  v_mfma_f32_16x16x32_bf16 a[16:19], v[32:35], v[96:99], a[16:19]
  buffer_store_dwordx4 v[148:151], v30, s[48:51], s99 offen offset:0 sc1
  v_mfma_f32_16x16x32_bf16 a[16:19], v[36:39], v[100:103], a[16:19]
  v_mfma_f32_16x16x32_bf16 a[48:51], v[40:43], v[96:99], a[48:51]
  v_mfma_f32_16x16x32_bf16 a[48:51], v[44:47], v[100:103], a[48:51]
  buffer_load_dwordx4 v28, s[44:47], s67 offen offset:2048 sc1 lds
  v_mfma_f32_16x16x32_bf16 a[52:55], v[40:43], v[104:107], a[52:55]
  v_mfma_f32_16x16x32_bf16 a[52:55], v[44:47], v[108:111], a[52:55]
  v_mfma_f32_16x16x32_bf16 a[20:23], v[32:35], v[104:107], a[20:23]
  v_mfma_f32_16x16x32_bf16 a[20:23], v[36:39], v[108:111], a[20:23]
  v_mfma_f32_16x16x32_bf16 a[24:27], v[32:35], v[112:115], a[24:27]
  v_mfma_f32_16x16x32_bf16 a[24:27], v[36:39], v[116:119], a[24:27]
  v_mfma_f32_16x16x32_bf16 a[56:59], v[40:43], v[112:115], a[56:59]
  v_mfma_f32_16x16x32_bf16 a[56:59], v[44:47], v[116:119], a[56:59]
  buffer_load_dwordx4 v29, s[44:47], s67 offen offset:3072 sc1 lds
  v_mfma_f32_16x16x32_bf16 a[60:63], v[40:43], v[120:123], a[60:63]
  s_add_u32 s67, s67, 229376
  v_mfma_f32_16x16x32_bf16 a[60:63], v[44:47], v[124:127], a[60:63]
  v_mfma_f32_16x16x32_bf16 a[28:31], v[32:35], v[120:123], a[28:31]
  v_mfma_f32_16x16x32_bf16 a[28:31], v[36:39], v[124:127], a[28:31]
  s_waitcnt vmcnt(21) lgkmcnt(0)
  s_barrier
  v_mfma_f32_16x16x32_bf16 a[64:67], v[48:51], v[64:67], a[64:67]
  ds_read_b64_tr_b16 v[32:33], v16 offset:49152
  v_mfma_f32_16x16x32_bf16 a[64:67], v[52:55], v[68:71], a[64:67]
  buffer_store_dwordx4 v[156:159], v30, s[48:51], s99 offen offset:1024 sc1
  v_mfma_f32_16x16x32_bf16 a[96:99], v[56:59], v[64:67], a[96:99]
  s_add_u32 m0, s69, 81920
  ds_read_b64_tr_b16 v[34:35], v16 offset:49664
  v_mfma_f32_16x16x32_bf16 a[96:99], v[60:63], v[68:71], a[96:99]
  buffer_load_dwordx4 v18, s[36:39], s64 offen offset:0 sc1 lds
  v_mfma_f32_16x16x32_bf16 a[100:103], v[56:59], v[72:75], a[100:103]
  ds_read_b64_tr_b16 v[36:37], v16 offset:53248
  v_mfma_f32_16x16x32_bf16 a[100:103], v[60:63], v[76:79], a[100:103]
  v_mfma_f32_16x16x32_bf16 a[68:71], v[48:51], v[72:75], a[68:71]
  ds_read_b64_tr_b16 v[38:39], v16 offset:53760
  v_mfma_f32_16x16x32_bf16 a[68:71], v[52:55], v[76:79], a[68:71]
  v_mfma_f32_16x16x32_bf16 a[72:75], v[48:51], v[80:83], a[72:75]
  s_add_u32 s99, s99, 8192
  ds_read_b64_tr_b16 v[40:41], v16 offset:57344
  v_mfma_f32_16x16x32_bf16 a[72:75], v[52:55], v[84:87], a[72:75]
  v_mfma_f32_16x16x32_bf16 a[104:107], v[56:59], v[80:83], a[104:107]
  ds_read_b64_tr_b16 v[42:43], v16 offset:57856
  v_mfma_f32_16x16x32_bf16 a[104:107], v[60:63], v[84:87], a[104:107]
  buffer_load_dwordx4 v19, s[36:39], s64 offen offset:1024 sc1 lds
  v_mfma_f32_16x16x32_bf16 a[108:111], v[56:59], v[88:91], a[108:111]
  ds_read_b64_tr_b16 v[44:45], v16 offset:61440
  v_mfma_f32_16x16x32_bf16 a[108:111], v[60:63], v[92:95], a[108:111]
  s_lshl_b32 s90, s32, 5
  v_mfma_f32_16x16x32_bf16 a[76:79], v[48:51], v[88:91], a[76:79]
  ds_read_b64_tr_b16 v[46:47], v16 offset:61952
  v_mfma_f32_16x16x32_bf16 a[76:79], v[52:55], v[92:95], a[76:79]
  v_mfma_f32_16x16x32_bf16 a[80:83], v[48:51], v[96:99], a[80:83]
  v_mfma_f32_16x16x32_bf16 a[80:83], v[52:55], v[100:103], a[80:83]
  v_mfma_f32_16x16x32_bf16 a[112:115], v[56:59], v[96:99], a[112:115]
  s_add_u32 s90, s90, s33
  v_mfma_f32_16x16x32_bf16 a[112:115], v[60:63], v[100:103], a[112:115]
  buffer_load_dwordx4 v20, s[36:39], s64 offen offset:2048 sc1 lds
  v_mfma_f32_16x16x32_bf16 a[116:119], v[56:59], v[104:107], a[116:119]
  v_mfma_f32_16x16x32_bf16 a[116:119], v[60:63], v[108:111], a[116:119]
  v_mfma_f32_16x16x32_bf16 a[84:87], v[48:51], v[104:107], a[84:87]
  v_mfma_f32_16x16x32_bf16 a[84:87], v[52:55], v[108:111], a[84:87]
  v_mfma_f32_16x16x32_bf16 a[88:91], v[48:51], v[112:115], a[88:91]
  s_lshl_b32 s90, s90, 2
  v_mfma_f32_16x16x32_bf16 a[88:91], v[52:55], v[116:119], a[88:91]
  v_mfma_f32_16x16x32_bf16 a[120:123], v[56:59], v[112:115], a[120:123]
  v_mfma_f32_16x16x32_bf16 a[120:123], v[60:63], v[116:119], a[120:123]
  buffer_load_dwordx4 v21, s[36:39], s64 offen offset:3072 sc1 lds
  v_mfma_f32_16x16x32_bf16 a[124:127], v[56:59], v[120:123], a[124:127]
  s_add_u32 s64, s64, 128
  v_mfma_f32_16x16x32_bf16 a[124:127], v[60:63], v[124:127], a[124:127]
  s_waitcnt lgkmcnt(0)
  s_add_u32 s90, s90, 67117056
  v_mfma_f32_16x16x32_bf16 a[92:95], v[48:51], v[120:123], a[92:95]
  v_mfma_f32_16x16x32_bf16 a[92:95], v[52:55], v[124:127], a[92:95]
  v_mfma_f32_16x16x32_bf16 a[128:131], v[32:35], v[64:67], a[128:131]
  ds_read_b64_tr_b16 v[48:49], v17 offset:49152
  v_mfma_f32_16x16x32_bf16 a[128:131], v[36:39], v[68:71], a[128:131]
  v_mfma_f32_16x16x32_bf16 a[160:163], v[40:43], v[64:67], a[160:163]
  s_add_u32 m0, s69, 98304
  ds_read_b64_tr_b16 v[50:51], v17 offset:49664
  v_mfma_f32_16x16x32_bf16 a[160:163], v[44:47], v[68:71], a[160:163]
  buffer_load_dwordx4 v18, s[36:39], s65 offen offset:0 sc1 lds
  v_mfma_f32_16x16x32_bf16 a[164:167], v[40:43], v[72:75], a[164:167]
  ds_read_b64_tr_b16 v[52:53], v17 offset:53248
  v_mfma_f32_16x16x32_bf16 a[164:167], v[44:47], v[76:79], a[164:167]
  v_mfma_f32_16x16x32_bf16 a[132:135], v[32:35], v[72:75], a[132:135]
  ds_read_b64_tr_b16 v[54:55], v17 offset:53760
  v_mfma_f32_16x16x32_bf16 a[132:135], v[36:39], v[76:79], a[132:135]
  v_mfma_f32_16x16x32_bf16 a[136:139], v[32:35], v[80:83], a[136:139]
  ds_read_b64_tr_b16 v[56:57], v17 offset:57344
  v_mfma_f32_16x16x32_bf16 a[136:139], v[36:39], v[84:87], a[136:139]
  v_mfma_f32_16x16x32_bf16 a[168:171], v[40:43], v[80:83], a[168:171]
  ds_read_b64_tr_b16 v[58:59], v17 offset:57856
  v_mfma_f32_16x16x32_bf16 a[168:171], v[44:47], v[84:87], a[168:171]
  buffer_load_dwordx4 v19, s[36:39], s65 offen offset:1024 sc1 lds
  v_mfma_f32_16x16x32_bf16 a[172:175], v[40:43], v[88:91], a[172:175]
  ds_read_b64_tr_b16 v[60:61], v17 offset:61440
  v_mfma_f32_16x16x32_bf16 a[172:175], v[44:47], v[92:95], a[172:175]
  v_mfma_f32_16x16x32_bf16 a[140:143], v[32:35], v[88:91], a[140:143]
  ds_read_b64_tr_b16 v[62:63], v17 offset:61952
  v_mfma_f32_16x16x32_bf16 a[140:143], v[36:39], v[92:95], a[140:143]
  buffer_store_dwordx4 v[164:167], v30, s[48:51], s99 offen offset:0 sc1
  v_mfma_f32_16x16x32_bf16 a[144:147], v[32:35], v[96:99], a[144:147]
  v_mfma_f32_16x16x32_bf16 a[144:147], v[36:39], v[100:103], a[144:147]
  v_mfma_f32_16x16x32_bf16 a[176:179], v[40:43], v[96:99], a[176:179]
  v_mfma_f32_16x16x32_bf16 a[176:179], v[44:47], v[100:103], a[176:179]
  buffer_load_dwordx4 v20, s[36:39], s65 offen offset:2048 sc1 lds
  v_mfma_f32_16x16x32_bf16 a[180:183], v[40:43], v[104:107], a[180:183]
  v_mfma_f32_16x16x32_bf16 a[180:183], v[44:47], v[108:111], a[180:183]
  v_mfma_f32_16x16x32_bf16 a[148:151], v[32:35], v[104:107], a[148:151]
  v_mfma_f32_16x16x32_bf16 a[148:151], v[36:39], v[108:111], a[148:151]
  v_mfma_f32_16x16x32_bf16 a[152:155], v[32:35], v[112:115], a[152:155]
  v_mfma_f32_16x16x32_bf16 a[152:155], v[36:39], v[116:119], a[152:155]
  v_mfma_f32_16x16x32_bf16 a[184:187], v[40:43], v[112:115], a[184:187]
  v_mfma_f32_16x16x32_bf16 a[184:187], v[44:47], v[116:119], a[184:187]
  buffer_load_dwordx4 v21, s[36:39], s65 offen offset:3072 sc1 lds
  v_mfma_f32_16x16x32_bf16 a[188:191], v[40:43], v[120:123], a[188:191]
  s_add_u32 s65, s65, 128
  v_mfma_f32_16x16x32_bf16 a[188:191], v[44:47], v[124:127], a[188:191]
  v_mfma_f32_16x16x32_bf16 a[156:159], v[32:35], v[120:123], a[156:159]
  v_mfma_f32_16x16x32_bf16 a[156:159], v[36:39], v[124:127], a[156:159]
  s_waitcnt vmcnt(15) lgkmcnt(0)
  s_barrier
  v_mfma_f32_16x16x32_bf16 a[192:195], v[48:51], v[64:67], a[192:195]
  ds_read_b64_tr_b16 v[32:33], v6 offset:0
  ds_read_b64_tr_b16 v[34:35], v6 offset:1024
  v_mfma_f32_16x16x32_bf16 a[192:195], v[52:55], v[68:71], a[192:195]
  ds_read_b64_tr_b16 v[36:37], v6 offset:8192
  ds_read_b64_tr_b16 v[38:39], v6 offset:9216
  v_mfma_f32_16x16x32_bf16 a[224:227], v[56:59], v[64:67], a[224:227]
  ds_read_b64_tr_b16 v[40:41], v7 offset:0
  ds_read_b64_tr_b16 v[42:43], v7 offset:1024
  v_mfma_f32_16x16x32_bf16 a[224:227], v[60:63], v[68:71], a[224:227]
  ds_read_b128 v[64:67], v2 offset:16384
  v_mfma_f32_16x16x32_bf16 a[228:231], v[56:59], v[72:75], a[228:231]
  s_add_u32 m0, s69, 65536
  ds_read_b128 v[68:71], v3 offset:16384
  v_mfma_f32_16x16x32_bf16 a[228:231], v[60:63], v[76:79], a[228:231]
  ds_read_b64_tr_b16 v[44:45], v7 offset:8192
  ds_read_b64_tr_b16 v[46:47], v7 offset:9216
  v_mfma_f32_16x16x32_bf16 a[196:199], v[48:51], v[72:75], a[196:199]
  buffer_load_dwordx4 v22, s[40:43], s66 offen offset:0 sc1 lds
  v_mfma_f32_16x16x32_bf16 a[196:199], v[52:55], v[76:79], a[196:199]
  ds_read_b128 v[72:75], v2 offset:18432
  v_mfma_f32_16x16x32_bf16 a[200:203], v[48:51], v[80:83], a[200:203]
  ds_read_b128 v[76:79], v3 offset:18432
  v_mfma_f32_16x16x32_bf16 a[200:203], v[52:55], v[84:87], a[200:203]
  buffer_store_dwordx4 v[172:175], v30, s[48:51], s99 offen offset:1024 sc1
  v_mfma_f32_16x16x32_bf16 a[232:235], v[56:59], v[80:83], a[232:235]
  v_mfma_f32_16x16x32_bf16 a[232:235], v[60:63], v[84:87], a[232:235]
  ds_read_b128 v[80:83], v2 offset:20480
  v_mfma_f32_16x16x32_bf16 a[236:239], v[56:59], v[88:91], a[236:239]
  ds_read_b128 v[84:87], v3 offset:20480
  v_mfma_f32_16x16x32_bf16 a[236:239], v[60:63], v[92:95], a[236:239]
  buffer_load_dwordx4 v23, s[40:43], s66 offen offset:1024 sc1 lds
  v_mfma_f32_16x16x32_bf16 a[204:207], v[48:51], v[88:91], a[204:207]
  v_mfma_f32_16x16x32_bf16 a[204:207], v[52:55], v[92:95], a[204:207]
  ds_read_b128 v[88:91], v2 offset:22528
  v_mfma_f32_16x16x32_bf16 a[208:211], v[48:51], v[96:99], a[208:211]
  s_add_u32 s99, s99, 8192
  ds_read_b128 v[92:95], v3 offset:22528
  v_mfma_f32_16x16x32_bf16 a[208:211], v[52:55], v[100:103], a[208:211]
  v_mfma_f32_16x16x32_bf16 a[240:243], v[56:59], v[96:99], a[240:243]
  v_mfma_f32_16x16x32_bf16 a[240:243], v[60:63], v[100:103], a[240:243]
  ds_read_b128 v[96:99], v2 offset:32768
  v_mfma_f32_16x16x32_bf16 a[244:247], v[56:59], v[104:107], a[244:247]
  ds_read_b128 v[100:103], v3 offset:32768
  v_mfma_f32_16x16x32_bf16 a[244:247], v[60:63], v[108:111], a[244:247]
  buffer_load_dwordx4 v24, s[40:43], s66 offen offset:2048 sc1 lds
  v_mfma_f32_16x16x32_bf16 a[212:215], v[48:51], v[104:107], a[212:215]
  v_mfma_f32_16x16x32_bf16 a[212:215], v[52:55], v[108:111], a[212:215]
  ds_read_b128 v[104:107], v2 offset:34816
  v_mfma_f32_16x16x32_bf16 a[216:219], v[48:51], v[112:115], a[216:219]
  ds_read_b128 v[108:111], v3 offset:34816
  v_mfma_f32_16x16x32_bf16 a[216:219], v[52:55], v[116:119], a[216:219]
  v_mfma_f32_16x16x32_bf16 a[248:251], v[56:59], v[112:115], a[248:251]
  buffer_store_dwordx4 v[180:183], v30, s[48:51], s99 offen offset:0 sc1
  v_mfma_f32_16x16x32_bf16 a[248:251], v[60:63], v[116:119], a[248:251]
  ds_read_b128 v[112:115], v2 offset:36864
  v_mfma_f32_16x16x32_bf16 a[252:255], v[56:59], v[120:123], a[252:255]
  ds_read_b128 v[116:119], v3 offset:36864
  v_mfma_f32_16x16x32_bf16 a[252:255], v[60:63], v[124:127], a[252:255]
  buffer_load_dwordx4 v25, s[40:43], s66 offen offset:3072 sc1 lds
  v_mfma_f32_16x16x32_bf16 a[220:223], v[48:51], v[120:123], a[220:223]
  s_add_u32 s66, s66, 524288
  v_mfma_f32_16x16x32_bf16 a[220:223], v[52:55], v[124:127], a[220:223]
  s_waitcnt lgkmcnt(6)
  ds_read_b128 v[120:123], v2 offset:38912
  ds_read_b128 v[124:127], v3 offset:38912
  v_mfma_f32_16x16x32_bf16 a[0:3], v[32:35], v[64:67], a[0:3]
  ds_read_b64_tr_b16 v[48:49], v8 offset:0
  v_mfma_f32_16x16x32_bf16 a[0:3], v[36:39], v[68:71], a[0:3]
  v_mfma_f32_16x16x32_bf16 a[32:35], v[40:43], v[64:67], a[32:35]
  s_add_u32 m0, s69, 114688
  ds_read_b64_tr_b16 v[50:51], v8 offset:1024
  v_mfma_f32_16x16x32_bf16 a[32:35], v[44:47], v[68:71], a[32:35]
  buffer_load_dwordx4 v26, s[44:47], s67 offen offset:0 sc1 lds
  v_mfma_f32_16x16x32_bf16 a[36:39], v[40:43], v[72:75], a[36:39]
  ds_read_b64_tr_b16 v[52:53], v8 offset:8192
  v_mfma_f32_16x16x32_bf16 a[36:39], v[44:47], v[76:79], a[36:39]
  v_mfma_f32_16x16x32_bf16 a[4:7], v[32:35], v[72:75], a[4:7]
  ds_read_b64_tr_b16 v[54:55], v8 offset:9216
  v_mfma_f32_16x16x32_bf16 a[4:7], v[36:39], v[76:79], a[4:7]
  buffer_store_dwordx4 v[188:191], v30, s[48:51], s99 offen offset:1024 sc1
  v_mfma_f32_16x16x32_bf16 a[8:11], v[32:35], v[80:83], a[8:11]
  ds_read_b64_tr_b16 v[56:57], v9 offset:0
  v_mfma_f32_16x16x32_bf16 a[8:11], v[36:39], v[84:87], a[8:11]
  v_mfma_f32_16x16x32_bf16 a[40:43], v[40:43], v[80:83], a[40:43]
  ds_read_b64_tr_b16 v[58:59], v9 offset:1024
  v_mfma_f32_16x16x32_bf16 a[40:43], v[44:47], v[84:87], a[40:43]
  buffer_load_dwordx4 v27, s[44:47], s67 offen offset:1024 sc1 lds
  v_mfma_f32_16x16x32_bf16 a[44:47], v[40:43], v[88:91], a[44:47]
  ds_read_b64_tr_b16 v[60:61], v9 offset:8192
  v_mfma_f32_16x16x32_bf16 a[44:47], v[44:47], v[92:95], a[44:47]
  v_mfma_f32_16x16x32_bf16 a[12:15], v[32:35], v[88:91], a[12:15]
  ds_read_b64_tr_b16 v[62:63], v9 offset:9216
  v_mfma_f32_16x16x32_bf16 a[12:15], v[36:39], v[92:95], a[12:15]
  s_waitcnt lgkmcnt(8)
  v_mfma_f32_16x16x32_bf16 a[16:19], v[32:35], v[96:99], a[16:19]
  v_mfma_f32_16x16x32_bf16 a[16:19], v[36:39], v[100:103], a[16:19]
  v_mfma_f32_16x16x32_bf16 a[48:51], v[40:43], v[96:99], a[48:51]
  v_mfma_f32_16x16x32_bf16 a[48:51], v[44:47], v[100:103], a[48:51]
  buffer_load_dwordx4 v28, s[44:47], s67 offen offset:2048 sc1 lds
  v_mfma_f32_16x16x32_bf16 a[52:55], v[40:43], v[104:107], a[52:55]
  v_mfma_f32_16x16x32_bf16 a[52:55], v[44:47], v[108:111], a[52:55]
  v_mfma_f32_16x16x32_bf16 a[20:23], v[32:35], v[104:107], a[20:23]
  v_mfma_f32_16x16x32_bf16 a[20:23], v[36:39], v[108:111], a[20:23]
  s_sub_u32 s99, s99, 24576
  v_mfma_f32_16x16x32_bf16 a[24:27], v[32:35], v[112:115], a[24:27]
  v_mfma_f32_16x16x32_bf16 a[24:27], v[36:39], v[116:119], a[24:27]
  v_mfma_f32_16x16x32_bf16 a[56:59], v[40:43], v[112:115], a[56:59]
  v_mfma_f32_16x16x32_bf16 a[56:59], v[44:47], v[116:119], a[56:59]
  buffer_load_dwordx4 v29, s[44:47], s67 offen offset:3072 sc1 lds
  v_mfma_f32_16x16x32_bf16 a[60:63], v[40:43], v[120:123], a[60:63]
  s_add_u32 s67, s67, 229376
  v_mfma_f32_16x16x32_bf16 a[60:63], v[44:47], v[124:127], a[60:63]
  v_mfma_f32_16x16x32_bf16 a[28:31], v[32:35], v[120:123], a[28:31]
  v_mfma_f32_16x16x32_bf16 a[28:31], v[36:39], v[124:127], a[28:31]
  s_waitcnt vmcnt(21) lgkmcnt(0)
  s_barrier
  v_mfma_f32_16x16x32_bf16 a[64:67], v[48:51], v[64:67], a[64:67]
  ds_read_b64_tr_b16 v[32:33], v14 offset:49152
  v_mfma_f32_16x16x32_bf16 a[64:67], v[52:55], v[68:71], a[64:67]
  v_mfma_f32_16x16x32_bf16 a[96:99], v[56:59], v[64:67], a[96:99]
  s_add_u32 m0, s69, 16384
  ds_read_b64_tr_b16 v[34:35], v14 offset:49664
  v_mfma_f32_16x16x32_bf16 a[96:99], v[60:63], v[68:71], a[96:99]
  buffer_load_dwordx4 v18, s[36:39], s64 offen offset:0 sc1 lds
  v_mfma_f32_16x16x32_bf16 a[100:103], v[56:59], v[72:75], a[100:103]
  ds_read_b64_tr_b16 v[36:37], v14 offset:53248
  v_mfma_f32_16x16x32_bf16 a[100:103], v[60:63], v[76:79], a[100:103]
  v_mfma_f32_16x16x32_bf16 a[68:71], v[48:51], v[72:75], a[68:71]
  ds_read_b64_tr_b16 v[38:39], v14 offset:53760
  v_mfma_f32_16x16x32_bf16 a[68:71], v[52:55], v[76:79], a[68:71]
  v_mfma_f32_16x16x32_bf16 a[72:75], v[48:51], v[80:83], a[72:75]
  ds_read_b64_tr_b16 v[40:41], v14 offset:57344
  v_mfma_f32_16x16x32_bf16 a[72:75], v[52:55], v[84:87], a[72:75]
  v_mfma_f32_16x16x32_bf16 a[104:107], v[56:59], v[80:83], a[104:107]
  ds_read_b64_tr_b16 v[42:43], v14 offset:57856
  v_mfma_f32_16x16x32_bf16 a[104:107], v[60:63], v[84:87], a[104:107]
  buffer_load_dwordx4 v19, s[36:39], s64 offen offset:1024 sc1 lds
  v_mfma_f32_16x16x32_bf16 a[108:111], v[56:59], v[88:91], a[108:111]
  ds_read_b64_tr_b16 v[44:45], v14 offset:61440
  v_mfma_f32_16x16x32_bf16 a[108:111], v[60:63], v[92:95], a[108:111]
  v_mfma_f32_16x16x32_bf16 a[76:79], v[48:51], v[88:91], a[76:79]
  ds_read_b64_tr_b16 v[46:47], v14 offset:61952
  v_mfma_f32_16x16x32_bf16 a[76:79], v[52:55], v[92:95], a[76:79]
  v_mfma_f32_16x16x32_bf16 a[80:83], v[48:51], v[96:99], a[80:83]
  buffer_store_dwordx4 v[196:199], v30, s[48:51], s99 offen offset:2048 sc1
  v_mfma_f32_16x16x32_bf16 a[80:83], v[52:55], v[100:103], a[80:83]
  v_mfma_f32_16x16x32_bf16 a[112:115], v[56:59], v[96:99], a[112:115]
  v_mfma_f32_16x16x32_bf16 a[112:115], v[60:63], v[100:103], a[112:115]
  buffer_load_dwordx4 v20, s[36:39], s64 offen offset:2048 sc1 lds
  v_mfma_f32_16x16x32_bf16 a[116:119], v[56:59], v[104:107], a[116:119]
  v_mfma_f32_16x16x32_bf16 a[116:119], v[60:63], v[108:111], a[116:119]
  v_mfma_f32_16x16x32_bf16 a[84:87], v[48:51], v[104:107], a[84:87]
  v_mfma_f32_16x16x32_bf16 a[84:87], v[52:55], v[108:111], a[84:87]
  v_mfma_f32_16x16x32_bf16 a[88:91], v[48:51], v[112:115], a[88:91]
  v_mfma_f32_16x16x32_bf16 a[88:91], v[52:55], v[116:119], a[88:91]
  v_mfma_f32_16x16x32_bf16 a[120:123], v[56:59], v[112:115], a[120:123]
  v_mfma_f32_16x16x32_bf16 a[120:123], v[60:63], v[116:119], a[120:123]
  buffer_load_dwordx4 v21, s[36:39], s64 offen offset:3072 sc1 lds
  v_mfma_f32_16x16x32_bf16 a[124:127], v[56:59], v[120:123], a[124:127]
  s_add_u32 s64, s64, 128
  v_mfma_f32_16x16x32_bf16 a[124:127], v[60:63], v[124:127], a[124:127]
  s_waitcnt lgkmcnt(0)
  v_mfma_f32_16x16x32_bf16 a[92:95], v[48:51], v[120:123], a[92:95]
  v_mfma_f32_16x16x32_bf16 a[92:95], v[52:55], v[124:127], a[92:95]
  v_mfma_f32_16x16x32_bf16 a[128:131], v[32:35], v[64:67], a[128:131]
  ds_read_b64_tr_b16 v[48:49], v15 offset:49152
  v_mfma_f32_16x16x32_bf16 a[128:131], v[36:39], v[68:71], a[128:131]
  v_mfma_f32_16x16x32_bf16 a[160:163], v[40:43], v[64:67], a[160:163]
  s_add_u32 m0, s69, 32768
  ds_read_b64_tr_b16 v[50:51], v15 offset:49664
  v_mfma_f32_16x16x32_bf16 a[160:163], v[44:47], v[68:71], a[160:163]
  buffer_load_dwordx4 v18, s[36:39], s65 offen offset:0 sc1 lds
  v_mfma_f32_16x16x32_bf16 a[164:167], v[40:43], v[72:75], a[164:167]
  ds_read_b64_tr_b16 v[52:53], v15 offset:53248
  v_mfma_f32_16x16x32_bf16 a[164:167], v[44:47], v[76:79], a[164:167]
  v_mfma_f32_16x16x32_bf16 a[132:135], v[32:35], v[72:75], a[132:135]
  ds_read_b64_tr_b16 v[54:55], v15 offset:53760
  v_mfma_f32_16x16x32_bf16 a[132:135], v[36:39], v[76:79], a[132:135]
  buffer_store_dwordx4 v[204:207], v30, s[48:51], s99 offen offset:3072 sc1
  v_mfma_f32_16x16x32_bf16 a[136:139], v[32:35], v[80:83], a[136:139]
  ds_read_b64_tr_b16 v[56:57], v15 offset:57344
  v_mfma_f32_16x16x32_bf16 a[136:139], v[36:39], v[84:87], a[136:139]
  v_mfma_f32_16x16x32_bf16 a[168:171], v[40:43], v[80:83], a[168:171]
  ds_read_b64_tr_b16 v[58:59], v15 offset:57856
  v_mfma_f32_16x16x32_bf16 a[168:171], v[44:47], v[84:87], a[168:171]
  buffer_load_dwordx4 v19, s[36:39], s65 offen offset:1024 sc1 lds
  v_mfma_f32_16x16x32_bf16 a[172:175], v[40:43], v[88:91], a[172:175]
  ds_read_b64_tr_b16 v[60:61], v15 offset:61440
  v_mfma_f32_16x16x32_bf16 a[172:175], v[44:47], v[92:95], a[172:175]
  v_mfma_f32_16x16x32_bf16 a[140:143], v[32:35], v[88:91], a[140:143]
  ds_read_b64_tr_b16 v[62:63], v15 offset:61952
  v_mfma_f32_16x16x32_bf16 a[140:143], v[36:39], v[92:95], a[140:143]
  v_mfma_f32_16x16x32_bf16 a[144:147], v[32:35], v[96:99], a[144:147]
  v_mfma_f32_16x16x32_bf16 a[144:147], v[36:39], v[100:103], a[144:147]
  v_mfma_f32_16x16x32_bf16 a[176:179], v[40:43], v[96:99], a[176:179]
  v_mfma_f32_16x16x32_bf16 a[176:179], v[44:47], v[100:103], a[176:179]
  buffer_load_dwordx4 v20, s[36:39], s65 offen offset:2048 sc1 lds
  v_mfma_f32_16x16x32_bf16 a[180:183], v[40:43], v[104:107], a[180:183]
  v_mfma_f32_16x16x32_bf16 a[180:183], v[44:47], v[108:111], a[180:183]
  v_mfma_f32_16x16x32_bf16 a[148:151], v[32:35], v[104:107], a[148:151]
  v_mfma_f32_16x16x32_bf16 a[148:151], v[36:39], v[108:111], a[148:151]
  s_add_u32 s99, s99, 8192
  v_mfma_f32_16x16x32_bf16 a[152:155], v[32:35], v[112:115], a[152:155]
  v_mfma_f32_16x16x32_bf16 a[152:155], v[36:39], v[116:119], a[152:155]
  v_mfma_f32_16x16x32_bf16 a[184:187], v[40:43], v[112:115], a[184:187]
  v_mfma_f32_16x16x32_bf16 a[184:187], v[44:47], v[116:119], a[184:187]
  buffer_load_dwordx4 v21, s[36:39], s65 offen offset:3072 sc1 lds
  v_mfma_f32_16x16x32_bf16 a[188:191], v[40:43], v[120:123], a[188:191]
  s_add_u32 s65, s65, 128
  v_mfma_f32_16x16x32_bf16 a[188:191], v[44:47], v[124:127], a[188:191]
  v_mfma_f32_16x16x32_bf16 a[156:159], v[32:35], v[120:123], a[156:159]
  v_mfma_f32_16x16x32_bf16 a[156:159], v[36:39], v[124:127], a[156:159]
  s_waitcnt vmcnt(15) lgkmcnt(0)
  s_barrier
  v_mfma_f32_16x16x32_bf16 a[192:195], v[48:51], v[64:67], a[192:195]
  ds_read_b64_tr_b16 v[32:33], v10 offset:0
  ds_read_b64_tr_b16 v[34:35], v10 offset:1024
  v_mfma_f32_16x16x32_bf16 a[192:195], v[52:55], v[68:71], a[192:195]
  ds_read_b64_tr_b16 v[36:37], v10 offset:8192
  ds_read_b64_tr_b16 v[38:39], v10 offset:9216
  v_mfma_f32_16x16x32_bf16 a[224:227], v[56:59], v[64:67], a[224:227]
  ds_read_b64_tr_b16 v[40:41], v11 offset:0
  ds_read_b64_tr_b16 v[42:43], v11 offset:1024
  v_mfma_f32_16x16x32_bf16 a[224:227], v[60:63], v[68:71], a[224:227]
  ds_read_b128 v[64:67], v4 offset:16384
  v_accvgpr_read_b32 v128, a128
  v_mfma_f32_16x16x32_bf16 a[228:231], v[56:59], v[72:75], a[228:231]
  s_add_u32 m0, s69, 0
  ds_read_b128 v[68:71], v5 offset:16384
  v_accvgpr_read_b32 v129, a129
  v_mfma_f32_16x16x32_bf16 a[228:231], v[60:63], v[76:79], a[228:231]
  ds_read_b64_tr_b16 v[44:45], v11 offset:8192
  ds_read_b64_tr_b16 v[46:47], v11 offset:9216
  v_mfma_f32_16x16x32_bf16 a[196:199], v[48:51], v[72:75], a[196:199]
  buffer_load_dwordx4 v22, s[40:43], s66 offen offset:0 sc1 lds
  v_mfma_f32_16x16x32_bf16 a[196:199], v[52:55], v[76:79], a[196:199]
  ds_read_b128 v[72:75], v4 offset:18432
  v_accvgpr_read_b32 v130, a130
  v_mfma_f32_16x16x32_bf16 a[200:203], v[48:51], v[80:83], a[200:203]
  ds_read_b128 v[76:79], v5 offset:18432
  v_mfma_f32_16x16x32_bf16 a[200:203], v[52:55], v[84:87], a[200:203]
  buffer_store_dwordx4 v[212:215], v30, s[48:51], s99 offen offset:2048 sc1
  v_mfma_f32_16x16x32_bf16 a[232:235], v[56:59], v[80:83], a[232:235]
  v_accvgpr_read_b32 v131, a131
  v_mfma_f32_16x16x32_bf16 a[232:235], v[60:63], v[84:87], a[232:235]
  ds_read_b128 v[80:83], v4 offset:20480
  v_mfma_f32_16x16x32_bf16 a[236:239], v[56:59], v[88:91], a[236:239]
  ds_read_b128 v[84:87], v5 offset:20480
  v_accvgpr_read_b32 v132, a160
  v_mfma_f32_16x16x32_bf16 a[236:239], v[60:63], v[92:95], a[236:239]
  buffer_load_dwordx4 v23, s[40:43], s66 offen offset:1024 sc1 lds
  v_mfma_f32_16x16x32_bf16 a[204:207], v[48:51], v[88:91], a[204:207]
  v_accvgpr_read_b32 v133, a161
  v_mfma_f32_16x16x32_bf16 a[204:207], v[52:55], v[92:95], a[204:207]
  ds_read_b128 v[88:91], v4 offset:22528
  v_mfma_f32_16x16x32_bf16 a[208:211], v[48:51], v[96:99], a[208:211]
  ds_read_b128 v[92:95], v5 offset:22528
  v_mfma_f32_16x16x32_bf16 a[208:211], v[52:55], v[100:103], a[208:211]
  v_accvgpr_read_b32 v134, a162
  v_mfma_f32_16x16x32_bf16 a[240:243], v[56:59], v[96:99], a[240:243]
  buffer_store_dwordx4 v[220:223], v30, s[48:51], s99 offen offset:3072 sc1
  v_mfma_f32_16x16x32_bf16 a[240:243], v[60:63], v[100:103], a[240:243]
  ds_read_b128 v[96:99], v4 offset:32768
  v_accvgpr_read_b32 v135, a163
  v_mfma_f32_16x16x32_bf16 a[244:247], v[56:59], v[104:107], a[244:247]
  ds_read_b128 v[100:103], v5 offset:32768
  v_mfma_f32_16x16x32_bf16 a[244:247], v[60:63], v[108:111], a[244:247]
  buffer_load_dwordx4 v24, s[40:43], s66 offen offset:2048 sc1 lds
  v_mfma_f32_16x16x32_bf16 a[212:215], v[48:51], v[104:107], a[212:215]
  v_accvgpr_read_b32 v136, a132
  v_mfma_f32_16x16x32_bf16 a[212:215], v[52:55], v[108:111], a[212:215]
  ds_read_b128 v[104:107], v4 offset:34816
  v_mfma_f32_16x16x32_bf16 a[216:219], v[48:51], v[112:115], a[216:219]
  ds_read_b128 v[108:111], v5 offset:34816
  v_accvgpr_read_b32 v137, a133
  v_mfma_f32_16x16x32_bf16 a[216:219], v[52:55], v[116:119], a[216:219]
  v_mfma_f32_16x16x32_bf16 a[248:251], v[56:59], v[112:115], a[248:251]
  s_add_u32 s99, s99, 8192
  v_accvgpr_read_b32 v138, a134
  v_mfma_f32_16x16x32_bf16 a[248:251], v[60:63], v[116:119], a[248:251]
  ds_read_b128 v[112:115], v4 offset:36864
  v_mfma_f32_16x16x32_bf16 a[252:255], v[56:59], v[120:123], a[252:255]
  ds_read_b128 v[116:119], v5 offset:36864
  v_accvgpr_read_b32 v139, a135
  v_mfma_f32_16x16x32_bf16 a[252:255], v[60:63], v[124:127], a[252:255]
  buffer_load_dwordx4 v25, s[40:43], s66 offen offset:3072 sc1 lds
  v_mfma_f32_16x16x32_bf16 a[220:223], v[48:51], v[120:123], a[220:223]
  s_add_u32 s66, s66, 524288
  v_mfma_f32_16x16x32_bf16 a[220:223], v[52:55], v[124:127], a[220:223]
  s_waitcnt lgkmcnt(6)
  ds_read_b128 v[120:123], v4 offset:38912
  ds_read_b128 v[124:127], v5 offset:38912
  v_mfma_f32_16x16x32_bf16 a[0:3], v[32:35], v[64:67], a[0:3]
  ds_read_b64_tr_b16 v[48:49], v12 offset:0
  v_mfma_f32_16x16x32_bf16 a[0:3], v[36:39], v[68:71], a[0:3]
  buffer_store_dwordx4 v[228:231], v30, s[48:51], s99 offen offset:2048 sc1
  v_mfma_f32_16x16x32_bf16 a[32:35], v[40:43], v[64:67], a[32:35]
  s_add_u32 m0, s69, 49152
  ds_read_b64_tr_b16 v[50:51], v12 offset:1024
  v_accvgpr_read_b32 v140, a164
  v_mfma_f32_16x16x32_bf16 a[32:35], v[44:47], v[68:71], a[32:35]
  buffer_load_dwordx4 v26, s[44:47], s67 offen offset:0 sc1 lds
  v_mfma_f32_16x16x32_bf16 a[36:39], v[40:43], v[72:75], a[36:39]
  ds_read_b64_tr_b16 v[52:53], v12 offset:8192
  v_accvgpr_read_b32 v141, a165
  v_mfma_f32_16x16x32_bf16 a[36:39], v[44:47], v[76:79], a[36:39]
  v_accvgpr_read_b32 v142, a166
  v_accvgpr_read_b32 v143, a167
  v_mfma_f32_16x16x32_bf16 a[4:7], v[32:35], v[72:75], a[4:7]
  ds_read_b64_tr_b16 v[54:55], v12 offset:9216
  v_accvgpr_read_b32 v144, a136
  v_mfma_f32_16x16x32_bf16 a[4:7], v[36:39], v[76:79], a[4:7]
  v_accvgpr_read_b32 v145, a137
  v_mfma_f32_16x16x32_bf16 a[8:11], v[32:35], v[80:83], a[8:11]
  ds_read_b64_tr_b16 v[56:57], v13 offset:0
  v_accvgpr_read_b32 v146, a138
  v_mfma_f32_16x16x32_bf16 a[8:11], v[36:39], v[84:87], a[8:11]
  v_accvgpr_read_b32 v147, a139
  v_mfma_f32_16x16x32_bf16 a[40:43], v[40:43], v[80:83], a[40:43]
  ds_read_b64_tr_b16 v[58:59], v13 offset:1024
  v_accvgpr_read_b32 v148, a168
  v_mfma_f32_16x16x32_bf16 a[40:43], v[44:47], v[84:87], a[40:43]
  buffer_load_dwordx4 v27, s[44:47], s67 offen offset:1024 sc1 lds
  v_mfma_f32_16x16x32_bf16 a[44:47], v[40:43], v[88:91], a[44:47]
  ds_read_b64_tr_b16 v[60:61], v13 offset:8192
  v_accvgpr_read_b32 v149, a169
  v_mfma_f32_16x16x32_bf16 a[44:47], v[44:47], v[92:95], a[44:47]
  v_accvgpr_read_b32 v150, a170
  v_mfma_f32_16x16x32_bf16 a[12:15], v[32:35], v[88:91], a[12:15]
  ds_read_b64_tr_b16 v[62:63], v13 offset:9216
  v_accvgpr_read_b32 v151, a171
  v_mfma_f32_16x16x32_bf16 a[12:15], v[36:39], v[92:95], a[12:15]
  s_waitcnt lgkmcnt(8)
  v_accvgpr_read_b32 v152, a140
  v_mfma_f32_16x16x32_bf16 a[16:19], v[32:35], v[96:99], a[16:19]
  v_accvgpr_read_b32 v153, a141
  v_mfma_f32_16x16x32_bf16 a[16:19], v[36:39], v[100:103], a[16:19]
  v_accvgpr_read_b32 v154, a142
  v_mfma_f32_16x16x32_bf16 a[48:51], v[40:43], v[96:99], a[48:51]
  v_accvgpr_read_b32 v155, a143
  v_mfma_f32_16x16x32_bf16 a[48:51], v[44:47], v[100:103], a[48:51]
  buffer_load_dwordx4 v28, s[44:47], s67 offen offset:2048 sc1 lds
  v_mfma_f32_16x16x32_bf16 a[52:55], v[40:43], v[104:107], a[52:55]
  v_accvgpr_read_b32 v156, a172
  v_mfma_f32_16x16x32_bf16 a[52:55], v[44:47], v[108:111], a[52:55]
  v_accvgpr_read_b32 v157, a173
  v_mfma_f32_16x16x32_bf16 a[20:23], v[32:35], v[104:107], a[20:23]
  v_accvgpr_read_b32 v158, a174
  v_mfma_f32_16x16x32_bf16 a[20:23], v[36:39], v[108:111], a[20:23]
  v_accvgpr_read_b32 v159, a175
  v_mfma_f32_16x16x32_bf16 a[24:27], v[32:35], v[112:115], a[24:27]
  v_accvgpr_read_b32 v160, a144
  v_mfma_f32_16x16x32_bf16 a[24:27], v[36:39], v[116:119], a[24:27]
  v_accvgpr_read_b32 v161, a145
  v_mfma_f32_16x16x32_bf16 a[56:59], v[40:43], v[112:115], a[56:59]
  v_accvgpr_read_b32 v162, a146
  v_accvgpr_read_b32 v163, a147
  v_mfma_f32_16x16x32_bf16 a[56:59], v[44:47], v[116:119], a[56:59]
  buffer_load_dwordx4 v29, s[44:47], s67 offen offset:3072 sc1 lds
  v_mfma_f32_16x16x32_bf16 a[60:63], v[40:43], v[120:123], a[60:63]
  s_add_u32 s67, s67, 229376
  v_accvgpr_read_b32 v164, a176
  v_mfma_f32_16x16x32_bf16 a[60:63], v[44:47], v[124:127], a[60:63]
  v_accvgpr_read_b32 v165, a177
  v_mfma_f32_16x16x32_bf16 a[28:31], v[32:35], v[120:123], a[28:31]
  v_mfma_f32_16x16x32_bf16 a[28:31], v[36:39], v[124:127], a[28:31]
  s_waitcnt vmcnt(21) lgkmcnt(0)
  s_barrier
  v_mfma_f32_16x16x32_bf16 a[64:67], v[48:51], v[64:67], a[64:67]
  ds_read_b64_tr_b16 v[32:33], v16 offset:49152
  v_mfma_f32_16x16x32_bf16 a[64:67], v[52:55], v[68:71], a[64:67]
  buffer_store_dwordx4 v[236:239], v30, s[48:51], s99 offen offset:3072 sc1
  v_mfma_f32_16x16x32_bf16 a[96:99], v[56:59], v[64:67], a[96:99]
  s_add_u32 m0, s69, 81920
  ds_read_b64_tr_b16 v[34:35], v16 offset:49664
  v_accvgpr_read_b32 v166, a178
  v_mfma_f32_16x16x32_bf16 a[96:99], v[60:63], v[68:71], a[96:99]
  buffer_load_dwordx4 v18, s[36:39], s64 offen offset:0 sc1 lds
  v_mfma_f32_16x16x32_bf16 a[100:103], v[56:59], v[72:75], a[100:103]
  ds_read_b64_tr_b16 v[36:37], v16 offset:53248
  v_accvgpr_read_b32 v167, a179
  v_mfma_f32_16x16x32_bf16 a[100:103], v[60:63], v[76:79], a[100:103]
  v_accvgpr_read_b32 v168, a148
  v_accvgpr_read_b32 v169, a149
  v_mfma_f32_16x16x32_bf16 a[68:71], v[48:51], v[72:75], a[68:71]
  ds_read_b64_tr_b16 v[38:39], v16 offset:53760
  v_accvgpr_read_b32 v170, a150
  v_mfma_f32_16x16x32_bf16 a[68:71], v[52:55], v[76:79], a[68:71]
L_pg6:
  s_cbranch_execz L_pg10
  v_accvgpr_read_b32 v171, a151
  v_mfma_f32_16x16x32_bf16 a[72:75], v[48:51], v[80:83], a[72:75]
  ds_read_b64_tr_b16 v[40:41], v16 offset:57344
  v_accvgpr_read_b32 v172, a180
  v_mfma_f32_16x16x32_bf16 a[72:75], v[52:55], v[84:87], a[72:75]
  v_accvgpr_read_b32 v173, a181
  v_mfma_f32_16x16x32_bf16 a[104:107], v[56:59], v[80:83], a[104:107]
  ds_read_b64_tr_b16 v[42:43], v16 offset:57856
  v_accvgpr_read_b32 v174, a182
  v_mfma_f32_16x16x32_bf16 a[104:107], v[60:63], v[84:87], a[104:107]
  buffer_load_dwordx4 v19, s[36:39], s64 offen offset:1024 sc1 lds
  v_mfma_f32_16x16x32_bf16 a[108:111], v[56:59], v[88:91], a[108:111]
  ds_read_b64_tr_b16 v[44:45], v16 offset:61440
  v_accvgpr_read_b32 v175, a183
  v_mfma_f32_16x16x32_bf16 a[108:111], v[60:63], v[92:95], a[108:111]
  v_accvgpr_read_b32 v176, a152
  v_mfma_f32_16x16x32_bf16 a[76:79], v[48:51], v[88:91], a[76:79]
  ds_read_b64_tr_b16 v[46:47], v16 offset:61952
  v_accvgpr_read_b32 v177, a153
  v_mfma_f32_16x16x32_bf16 a[76:79], v[52:55], v[92:95], a[76:79]
  v_accvgpr_read_b32 v178, a154
  v_mfma_f32_16x16x32_bf16 a[80:83], v[48:51], v[96:99], a[80:83]
  v_accvgpr_read_b32 v179, a155
  v_mfma_f32_16x16x32_bf16 a[80:83], v[52:55], v[100:103], a[80:83]
  v_accvgpr_read_b32 v180, a184
  v_mfma_f32_16x16x32_bf16 a[112:115], v[56:59], v[96:99], a[112:115]
  v_accvgpr_read_b32 v181, a185
  v_mfma_f32_16x16x32_bf16 a[112:115], v[60:63], v[100:103], a[112:115]
  buffer_load_dwordx4 v20, s[36:39], s64 offen offset:2048 sc1 lds
  v_mfma_f32_16x16x32_bf16 a[116:119], v[56:59], v[104:107], a[116:119]
  v_accvgpr_read_b32 v182, a186
  v_mfma_f32_16x16x32_bf16 a[116:119], v[60:63], v[108:111], a[116:119]
  v_accvgpr_read_b32 v183, a187
  v_mfma_f32_16x16x32_bf16 a[84:87], v[48:51], v[104:107], a[84:87]
  v_accvgpr_read_b32 v184, a156
  v_mfma_f32_16x16x32_bf16 a[84:87], v[52:55], v[108:111], a[84:87]
  v_accvgpr_read_b32 v185, a157
  v_mfma_f32_16x16x32_bf16 a[88:91], v[48:51], v[112:115], a[88:91]
  s_add_u32 s99, s99, 8192
  v_accvgpr_read_b32 v186, a158
  v_mfma_f32_16x16x32_bf16 a[88:91], v[52:55], v[116:119], a[88:91]
  v_accvgpr_read_b32 v187, a159
  v_mfma_f32_16x16x32_bf16 a[120:123], v[56:59], v[112:115], a[120:123]
  v_accvgpr_read_b32 v188, a188
  v_accvgpr_read_b32 v189, a189
  v_mfma_f32_16x16x32_bf16 a[120:123], v[60:63], v[116:119], a[120:123]
  buffer_load_dwordx4 v21, s[36:39], s64 offen offset:3072 sc1 lds
  v_mfma_f32_16x16x32_bf16 a[124:127], v[56:59], v[120:123], a[124:127]
  s_add_u32 s64, s64, 128
  v_accvgpr_read_b32 v190, a190
  v_mfma_f32_16x16x32_bf16 a[124:127], v[60:63], v[124:127], a[124:127]
  s_waitcnt lgkmcnt(0)
  v_accvgpr_read_b32 v191, a191
  v_mfma_f32_16x16x32_bf16 a[92:95], v[48:51], v[120:123], a[92:95]
  v_mfma_f32_16x16x32_bf16 a[92:95], v[52:55], v[124:127], a[92:95]
  v_mfma_f32_16x16x32_bf16 v[128:131], v[32:35], v[64:67], v[128:131]
  ds_read_b64_tr_b16 v[48:49], v17 offset:49152
  v_mfma_f32_16x16x32_bf16 v[128:131], v[36:39], v[68:71], v[128:131]
  v_mfma_f32_16x16x32_bf16 v[132:135], v[40:43], v[64:67], v[132:135]
  s_add_u32 m0, s69, 98304
  ds_read_b64_tr_b16 v[50:51], v17 offset:49664
  v_mfma_f32_16x16x32_bf16 v[132:135], v[44:47], v[68:71], v[132:135]
  buffer_load_dwordx4 v18, s[36:39], s65 offen offset:0 sc1 lds
  v_mfma_f32_16x16x32_bf16 v[140:143], v[40:43], v[72:75], v[140:143]
  ds_read_b64_tr_b16 v[52:53], v17 offset:53248
  v_mfma_f32_16x16x32_bf16 v[140:143], v[44:47], v[76:79], v[140:143]
  v_mfma_f32_16x16x32_bf16 v[136:139], v[32:35], v[72:75], v[136:139]
  ds_read_b64_tr_b16 v[54:55], v17 offset:53760
  v_mfma_f32_16x16x32_bf16 v[136:139], v[36:39], v[76:79], v[136:139]
  v_mfma_f32_16x16x32_bf16 v[144:147], v[32:35], v[80:83], v[144:147]
  ds_read_b64_tr_b16 v[56:57], v17 offset:57344
  v_mfma_f32_16x16x32_bf16 v[144:147], v[36:39], v[84:87], v[144:147]
  v_mfma_f32_16x16x32_bf16 v[148:151], v[40:43], v[80:83], v[148:151]
  ds_read_b64_tr_b16 v[58:59], v17 offset:57856
  v_mfma_f32_16x16x32_bf16 v[148:151], v[44:47], v[84:87], v[148:151]
  buffer_load_dwordx4 v19, s[36:39], s65 offen offset:1024 sc1 lds
  v_mfma_f32_16x16x32_bf16 v[156:159], v[40:43], v[88:91], v[156:159]
  ds_read_b64_tr_b16 v[60:61], v17 offset:61440
  v_mfma_f32_16x16x32_bf16 v[156:159], v[44:47], v[92:95], v[156:159]
  v_mfma_f32_16x16x32_bf16 v[152:155], v[32:35], v[88:91], v[152:155]
  ds_read_b64_tr_b16 v[62:63], v17 offset:61952
  v_mfma_f32_16x16x32_bf16 v[152:155], v[36:39], v[92:95], v[152:155]
  buffer_store_dwordx4 v[244:247], v30, s[48:51], s99 offen offset:2048 sc1
  v_mfma_f32_16x16x32_bf16 v[160:163], v[32:35], v[96:99], v[160:163]
  v_mfma_f32_16x16x32_bf16 v[160:163], v[36:39], v[100:103], v[160:163]
  v_mfma_f32_16x16x32_bf16 v[164:167], v[40:43], v[96:99], v[164:167]
  v_mfma_f32_16x16x32_bf16 v[164:167], v[44:47], v[100:103], v[164:167]
  buffer_load_dwordx4 v20, s[36:39], s65 offen offset:2048 sc1 lds
  v_mfma_f32_16x16x32_bf16 v[172:175], v[40:43], v[104:107], v[172:175]
  v_mfma_f32_16x16x32_bf16 v[172:175], v[44:47], v[108:111], v[172:175]
  v_mfma_f32_16x16x32_bf16 v[168:171], v[32:35], v[104:107], v[168:171]
  v_mfma_f32_16x16x32_bf16 v[168:171], v[36:39], v[108:111], v[168:171]
  v_mfma_f32_16x16x32_bf16 v[176:179], v[32:35], v[112:115], v[176:179]
  v_mfma_f32_16x16x32_bf16 v[176:179], v[36:39], v[116:119], v[176:179]
  v_mfma_f32_16x16x32_bf16 v[180:183], v[40:43], v[112:115], v[180:183]
  v_mfma_f32_16x16x32_bf16 v[180:183], v[44:47], v[116:119], v[180:183]
  buffer_load_dwordx4 v21, s[36:39], s65 offen offset:3072 sc1 lds
  v_mfma_f32_16x16x32_bf16 v[188:191], v[40:43], v[120:123], v[188:191]
  s_add_u32 s65, s65, 128
  v_mfma_f32_16x16x32_bf16 v[188:191], v[44:47], v[124:127], v[188:191]
  v_mfma_f32_16x16x32_bf16 v[184:187], v[32:35], v[120:123], v[184:187]
  v_mfma_f32_16x16x32_bf16 v[184:187], v[36:39], v[124:127], v[184:187]
  s_waitcnt vmcnt(15) lgkmcnt(0)
  s_barrier
  v_mfma_f32_16x16x32_bf16 a[192:195], v[48:51], v[64:67], a[192:195]
  ds_read_b64_tr_b16 v[32:33], v6 offset:0
  ds_read_b64_tr_b16 v[34:35], v6 offset:1024
  v_mfma_f32_16x16x32_bf16 a[192:195], v[52:55], v[68:71], a[192:195]
  ds_read_b64_tr_b16 v[36:37], v6 offset:8192
  ds_read_b64_tr_b16 v[38:39], v6 offset:9216
  v_mfma_f32_16x16x32_bf16 a[224:227], v[56:59], v[64:67], a[224:227]
  ds_read_b64_tr_b16 v[40:41], v7 offset:0
  ds_read_b64_tr_b16 v[42:43], v7 offset:1024
  v_mfma_f32_16x16x32_bf16 a[224:227], v[60:63], v[68:71], a[224:227]
  ds_read_b128 v[64:67], v2 offset:16384
  v_mfma_f32_16x16x32_bf16 a[228:231], v[56:59], v[72:75], a[228:231]
  s_add_u32 m0, s69, 65536
  ds_read_b128 v[68:71], v3 offset:16384
  v_mfma_f32_16x16x32_bf16 a[228:231], v[60:63], v[76:79], a[228:231]
  ds_read_b64_tr_b16 v[44:45], v7 offset:8192
  ds_read_b64_tr_b16 v[46:47], v7 offset:9216
  v_mfma_f32_16x16x32_bf16 a[196:199], v[48:51], v[72:75], a[196:199]
  buffer_load_dwordx4 v22, s[40:43], s66 offen offset:0 sc1 lds
  v_mfma_f32_16x16x32_bf16 a[196:199], v[52:55], v[76:79], a[196:199]
  ds_read_b128 v[72:75], v2 offset:18432
  v_mfma_f32_16x16x32_bf16 a[200:203], v[48:51], v[80:83], a[200:203]
  ds_read_b128 v[76:79], v3 offset:18432
  v_mfma_f32_16x16x32_bf16 a[200:203], v[52:55], v[84:87], a[200:203]
  buffer_store_dwordx4 v[252:255], v30, s[48:51], s99 offen offset:3072 sc1
  v_mfma_f32_16x16x32_bf16 a[232:235], v[56:59], v[80:83], a[232:235]
  v_mfma_f32_16x16x32_bf16 a[232:235], v[60:63], v[84:87], a[232:235]
  ds_read_b128 v[80:83], v2 offset:20480
  v_mfma_f32_16x16x32_bf16 a[236:239], v[56:59], v[88:91], a[236:239]
  ds_read_b128 v[84:87], v3 offset:20480
  v_mfma_f32_16x16x32_bf16 a[236:239], v[60:63], v[92:95], a[236:239]
  buffer_load_dwordx4 v23, s[40:43], s66 offen offset:1024 sc1 lds
  v_mfma_f32_16x16x32_bf16 a[204:207], v[48:51], v[88:91], a[204:207]
  v_mfma_f32_16x16x32_bf16 a[204:207], v[52:55], v[92:95], a[204:207]
  ds_read_b128 v[88:91], v2 offset:22528
  v_mfma_f32_16x16x32_bf16 a[208:211], v[48:51], v[96:99], a[208:211]
  ds_read_b128 v[92:95], v3 offset:22528
  v_mfma_f32_16x16x32_bf16 a[208:211], v[52:55], v[100:103], a[208:211]
  v_mfma_f32_16x16x32_bf16 a[240:243], v[56:59], v[96:99], a[240:243]
  v_mfma_f32_16x16x32_bf16 a[240:243], v[60:63], v[100:103], a[240:243]
  ds_read_b128 v[96:99], v2 offset:32768
  v_mfma_f32_16x16x32_bf16 a[244:247], v[56:59], v[104:107], a[244:247]
  ds_read_b128 v[100:103], v3 offset:32768
  v_mfma_f32_16x16x32_bf16 a[244:247], v[60:63], v[108:111], a[244:247]
  buffer_load_dwordx4 v24, s[40:43], s66 offen offset:2048 sc1 lds
  v_mfma_f32_16x16x32_bf16 a[212:215], v[48:51], v[104:107], a[212:215]
  v_mfma_f32_16x16x32_bf16 a[212:215], v[52:55], v[108:111], a[212:215]
  ds_read_b128 v[104:107], v2 offset:34816
  v_mfma_f32_16x16x32_bf16 a[216:219], v[48:51], v[112:115], a[216:219]
  s_sub_u32 s99, s99, 24576
  ds_read_b128 v[108:111], v3 offset:34816
  v_mfma_f32_16x16x32_bf16 a[216:219], v[52:55], v[116:119], a[216:219]
  v_mfma_f32_16x16x32_bf16 a[248:251], v[56:59], v[112:115], a[248:251]
  v_mfma_f32_16x16x32_bf16 a[248:251], v[60:63], v[116:119], a[248:251]
  ds_read_b128 v[112:115], v2 offset:36864
  v_mfma_f32_16x16x32_bf16 a[252:255], v[56:59], v[120:123], a[252:255]
  ds_read_b128 v[116:119], v3 offset:36864
  v_mfma_f32_16x16x32_bf16 a[252:255], v[60:63], v[124:127], a[252:255]
  buffer_load_dwordx4 v25, s[40:43], s66 offen offset:3072 sc1 lds
  v_mfma_f32_16x16x32_bf16 a[220:223], v[48:51], v[120:123], a[220:223]
  s_add_u32 s66, s66, 524288
  v_mfma_f32_16x16x32_bf16 a[220:223], v[52:55], v[124:127], a[220:223]
  s_waitcnt lgkmcnt(6)
  ds_read_b128 v[120:123], v2 offset:38912
  ds_read_b128 v[124:127], v3 offset:38912
  v_mfma_f32_16x16x32_bf16 a[0:3], v[32:35], v[64:67], a[0:3]
  ds_read_b64_tr_b16 v[48:49], v8 offset:0
  v_mfma_f32_16x16x32_bf16 a[0:3], v[36:39], v[68:71], a[0:3]
  v_mov_b32 v18, -1
  v_mfma_f32_16x16x32_bf16 a[32:35], v[40:43], v[64:67], a[32:35]
  s_add_u32 m0, s69, 114688
  ds_read_b64_tr_b16 v[50:51], v8 offset:1024
  v_accvgpr_read_b32 v192, a192
  v_mfma_f32_16x16x32_bf16 a[32:35], v[44:47], v[68:71], a[32:35]
  buffer_load_dwordx4 v26, s[44:47], s67 offen offset:0 sc1 lds
  v_mfma_f32_16x16x32_bf16 a[36:39], v[40:43], v[72:75], a[36:39]
  ds_read_b64_tr_b16 v[52:53], v8 offset:8192
  v_accvgpr_read_b32 v193, a193
  v_mfma_f32_16x16x32_bf16 a[36:39], v[44:47], v[76:79], a[36:39]
  v_accvgpr_read_b32 v194, a194
  v_mov_b32 v19, -1
  v_mfma_f32_16x16x32_bf16 a[4:7], v[32:35], v[72:75], a[4:7]
  ds_read_b64_tr_b16 v[54:55], v8 offset:9216
  v_accvgpr_read_b32 v195, a195
  v_mfma_f32_16x16x32_bf16 a[4:7], v[36:39], v[76:79], a[4:7]
  v_mov_b32 v20, -1
  v_mfma_f32_16x16x32_bf16 a[8:11], v[32:35], v[80:83], a[8:11]
  ds_read_b64_tr_b16 v[56:57], v9 offset:0
  v_accvgpr_read_b32 v196, a224
  v_mfma_f32_16x16x32_bf16 a[8:11], v[36:39], v[84:87], a[8:11]
  v_accvgpr_read_b32 v197, a225
  v_mov_b32 v21, -1
  v_mfma_f32_16x16x32_bf16 a[40:43], v[40:43], v[80:83], a[40:43]
  ds_read_b64_tr_b16 v[58:59], v9 offset:1024
  v_accvgpr_read_b32 v198, a226
  v_mfma_f32_16x16x32_bf16 a[40:43], v[44:47], v[84:87], a[40:43]
  buffer_load_dwordx4 v27, s[44:47], s67 offen offset:1024 sc1 lds
  v_mfma_f32_16x16x32_bf16 a[44:47], v[40:43], v[88:91], a[44:47]
  s_lshr_b32 s72, s32, 3
  ds_read_b64_tr_b16 v[60:61], v9 offset:8192
  v_accvgpr_read_b32 v199, a227
  v_mfma_f32_16x16x32_bf16 a[44:47], v[44:47], v[92:95], a[44:47]
  v_accvgpr_read_b32 v200, a196
  v_mfma_f32_16x16x32_bf16 a[12:15], v[32:35], v[88:91], a[12:15]
  ds_read_b64_tr_b16 v[62:63], v9 offset:9216
  v_mfma_f32_16x16x32_bf16 a[12:15], v[36:39], v[92:95], a[12:15]
  s_waitcnt lgkmcnt(8)
  v_accvgpr_read_b32 v201, a197
  s_xor_b32 s35, s72, 1
  v_mfma_f32_16x16x32_bf16 a[16:19], v[32:35], v[96:99], a[16:19]
  v_accvgpr_read_b32 v202, a198
  v_mfma_f32_16x16x32_bf16 a[16:19], v[36:39], v[100:103], a[16:19]
  v_mfma_f32_16x16x32_bf16 a[48:51], v[40:43], v[96:99], a[48:51]
  s_lshl_b32 s35, s35, 15
  v_accvgpr_read_b32 v203, a199
  v_mfma_f32_16x16x32_bf16 a[48:51], v[44:47], v[100:103], a[48:51]
  buffer_load_dwordx4 v28, s[44:47], s67 offen offset:2048 sc1 lds
  v_mfma_f32_16x16x32_bf16 a[52:55], v[40:43], v[104:107], a[52:55]
  v_accvgpr_read_b32 v204, a228
  v_mfma_f32_16x16x32_bf16 a[52:55], v[44:47], v[108:111], a[52:55]
  s_add_u32 s35, s35, s3
  v_accvgpr_read_b32 v205, a229
  v_mfma_f32_16x16x32_bf16 a[20:23], v[32:35], v[104:107], a[20:23]
  v_accvgpr_read_b32 v206, a230
  v_mfma_f32_16x16x32_bf16 a[20:23], v[36:39], v[108:111], a[20:23]
  s_add_u32 s35, s35, 8192
  v_accvgpr_read_b32 v207, a231
  v_mfma_f32_16x16x32_bf16 a[24:27], v[32:35], v[112:115], a[24:27]
  buffer_store_dwordx4 v[18:21], v30, s[48:51], s35 offen offset:0 sc1
  v_mfma_f32_16x16x32_bf16 a[24:27], v[36:39], v[116:119], a[24:27]
  v_accvgpr_read_b32 v208, a200
  v_mfma_f32_16x16x32_bf16 a[56:59], v[40:43], v[112:115], a[56:59]
  v_accvgpr_read_b32 v209, a201
  v_mfma_f32_16x16x32_bf16 a[56:59], v[44:47], v[116:119], a[56:59]
  buffer_load_dwordx4 v29, s[44:47], s67 offen offset:3072 sc1 lds
  v_mfma_f32_16x16x32_bf16 a[60:63], v[40:43], v[120:123], a[60:63]
  s_add_u32 s67, s67, 229376
  v_accvgpr_read_b32 v210, a202
  v_mfma_f32_16x16x32_bf16 a[60:63], v[44:47], v[124:127], a[60:63]
  v_accvgpr_read_b32 v211, a203
  v_mfma_f32_16x16x32_bf16 a[28:31], v[32:35], v[120:123], a[28:31]
  buffer_store_dwordx4 v[18:21], v30, s[48:51], s35 offen offset:1024 sc1
  v_mfma_f32_16x16x32_bf16 a[28:31], v[36:39], v[124:127], a[28:31]
  s_waitcnt vmcnt(9) lgkmcnt(0)
  s_barrier
  s_cmp_lg_u32 s34, 0
  s_cbranch_scc1 L_sig_kv_g
  s_mov_b64 exec, 1
  v_mov_b32 v0, s101
  buffer_store_dword v0, off, s[48:51], s90 sc1
  s_mov_b64 exec, -1
L_sig_kv_g:
  v_mfma_f32_16x16x32_bf16 a[64:67], v[48:51], v[64:67], a[64:67]
  s_xor_b32 s35, s72, 2
  ds_read_b64_tr_b16 v[32:33], v14 offset:49152
  v_mfma_f32_16x16x32_bf16 a[64:67], v[52:55], v[68:71], a[64:67]
  s_lshl_b32 s35, s35, 15
  s_add_u32 s35, s35, s3
  v_mfma_f32_16x16x32_bf16 a[96:99], v[56:59], v[64:67], a[96:99]
  s_add_u32 s35, s35, 16384
  ds_read_b64_tr_b16 v[34:35], v14 offset:49664
  v_accvgpr_read_b32 v212, a232
  v_mfma_f32_16x16x32_bf16 a[96:99], v[60:63], v[68:71], a[96:99]
  buffer_store_dwordx4 v[18:21], v30, s[48:51], s35 offen offset:0 sc1
  v_mfma_f32_16x16x32_bf16 a[100:103], v[56:59], v[72:75], a[100:103]
  ds_read_b64_tr_b16 v[36:37], v14 offset:53248
  v_accvgpr_read_b32 v213, a233
  v_mfma_f32_16x16x32_bf16 a[100:103], v[60:63], v[76:79], a[100:103]
  v_accvgpr_read_b32 v214, a234
  v_mfma_f32_16x16x32_bf16 a[68:71], v[48:51], v[72:75], a[68:71]
  ds_read_b64_tr_b16 v[38:39], v14 offset:53760
  v_accvgpr_read_b32 v215, a235
  v_mfma_f32_16x16x32_bf16 a[68:71], v[52:55], v[76:79], a[68:71]
  buffer_store_dwordx4 v[18:21], v30, s[48:51], s35 offen offset:1024 sc1
  v_mfma_f32_16x16x32_bf16 a[72:75], v[48:51], v[80:83], a[72:75]
  s_xor_b32 s35, s72, 3
  ds_read_b64_tr_b16 v[40:41], v14 offset:57344
  v_accvgpr_read_b32 v216, a204
  v_mfma_f32_16x16x32_bf16 a[72:75], v[52:55], v[84:87], a[72:75]
  s_lshl_b32 s35, s35, 15
  v_accvgpr_read_b32 v217, a205
  v_mfma_f32_16x16x32_bf16 a[104:107], v[56:59], v[80:83], a[104:107]
  s_add_u32 s35, s35, s3
  ds_read_b64_tr_b16 v[42:43], v14 offset:57856
  v_mfma_f32_16x16x32_bf16 a[104:107], v[60:63], v[84:87], a[104:107]
  s_add_u32 s35, s35, 24576
  v_accvgpr_read_b32 v218, a206
  v_mfma_f32_16x16x32_bf16 a[108:111], v[56:59], v[88:91], a[108:111]
  ds_read_b64_tr_b16 v[44:45], v14 offset:61440
  v_accvgpr_read_b32 v219, a207
  v_mfma_f32_16x16x32_bf16 a[108:111], v[60:63], v[92:95], a[108:111]
  v_accvgpr_read_b32 v220, a236
  v_mfma_f32_16x16x32_bf16 a[76:79], v[48:51], v[88:91], a[76:79]
  ds_read_b64_tr_b16 v[46:47], v14 offset:61952
  v_mfma_f32_16x16x32_bf16 a[76:79], v[52:55], v[92:95], a[76:79]
  v_accvgpr_read_b32 v221, a237
  v_mfma_f32_16x16x32_bf16 a[80:83], v[48:51], v[96:99], a[80:83]
  v_accvgpr_read_b32 v222, a238
  v_mfma_f32_16x16x32_bf16 a[80:83], v[52:55], v[100:103], a[80:83]
  buffer_store_dwordx4 v[18:21], v30, s[48:51], s35 offen offset:0 sc1
  v_mfma_f32_16x16x32_bf16 a[112:115], v[56:59], v[96:99], a[112:115]
  v_accvgpr_read_b32 v223, a239
  v_mfma_f32_16x16x32_bf16 a[112:115], v[60:63], v[100:103], a[112:115]
  v_accvgpr_read_b32 v224, a208
  v_mfma_f32_16x16x32_bf16 a[116:119], v[56:59], v[104:107], a[116:119]
  v_accvgpr_read_b32 v225, a209
  v_mfma_f32_16x16x32_bf16 a[116:119], v[60:63], v[108:111], a[116:119]
  buffer_store_dwordx4 v[18:21], v30, s[48:51], s35 offen offset:1024 sc1
  v_mfma_f32_16x16x32_bf16 a[84:87], v[48:51], v[104:107], a[84:87]
  s_mov_b32 s40, s22
  v_accvgpr_read_b32 v226, a210
  v_mfma_f32_16x16x32_bf16 a[84:87], v[52:55], v[108:111], a[84:87]
  s_mov_b32 s41, s23
  v_accvgpr_read_b32 v227, a211
  v_mfma_f32_16x16x32_bf16 a[88:91], v[48:51], v[112:115], a[88:91]
  s_mov_b32 s42, 1835008
  s_mov_b32 s43, 0x20000
  s_mov_b32 s44, s14
  v_mfma_f32_16x16x32_bf16 a[88:91], v[52:55], v[116:119], a[88:91]
  s_mov_b32 s45, s15
  v_accvgpr_read_b32 v228, a240
  v_mfma_f32_16x16x32_bf16 a[120:123], v[56:59], v[112:115], a[120:123]
  s_mov_b32 s46, 4194304
  v_accvgpr_read_b32 v229, a241
  v_mfma_f32_16x16x32_bf16 a[120:123], v[60:63], v[116:119], a[120:123]
  s_mov_b32 s47, 0x20000
  v_accvgpr_read_b32 v230, a242
  v_mfma_f32_16x16x32_bf16 a[124:127], v[56:59], v[120:123], a[124:127]
  s_lshr_b32 s9, s32, 3
  s_bfe_u32 s72, s32, 0x10002
  s_sub_u32 s73, s17, s16
  v_mfma_f32_16x16x32_bf16 a[124:127], v[60:63], v[124:127], a[124:127]
  s_waitcnt lgkmcnt(0)
  v_accvgpr_read_b32 v231, a243
  s_mul_i32 s73, s73, s72
  v_mfma_f32_16x16x32_bf16 a[92:95], v[48:51], v[120:123], a[92:95]
  s_add_u32 s0, s16, s73
  v_mfma_f32_16x16x32_bf16 a[92:95], v[52:55], v[124:127], a[92:95]
  s_and_b32 s21, s33, 6
  v_mfma_f32_16x16x32_bf16 v[128:131], v[32:35], v[64:67], v[128:131]
  s_or_b32 s21, s21, s72
  ds_read_b64_tr_b16 v[48:49], v15 offset:49152
  v_mfma_f32_16x16x32_bf16 v[128:131], v[36:39], v[68:71], v[128:131]
  s_and_b32 s73, s32, 3
  v_mfma_f32_16x16x32_bf16 v[132:135], v[40:43], v[64:67], v[132:135]
  s_lshl_b32 s73, s73, 8
  ds_read_b64_tr_b16 v[50:51], v15 offset:49664
  v_accvgpr_read_b32 v232, a212
  v_mfma_f32_16x16x32_bf16 v[132:135], v[44:47], v[68:71], v[132:135]
  s_lshl_b32 s72, s34, 14
  v_accvgpr_read_b32 v233, a213
  v_mfma_f32_16x16x32_bf16 v[140:143], v[40:43], v[72:75], v[140:143]
  s_add_u32 s73, s73, s72
  ds_read_b64_tr_b16 v[52:53], v15 offset:53248
  v_accvgpr_read_b32 v234, a214
  v_mfma_f32_16x16x32_bf16 v[140:143], v[44:47], v[76:79], v[140:143]
  s_mul_i32 s66, s9, 458752
  v_mfma_f32_16x16x32_bf16 v[136:139], v[32:35], v[72:75], v[136:139]
  s_add_u32 s66, s66, s73
  ds_read_b64_tr_b16 v[54:55], v15 offset:53760
  v_accvgpr_read_b32 v235, a215
  v_mfma_f32_16x16x32_bf16 v[136:139], v[36:39], v[76:79], v[136:139]
  v_accvgpr_read_b32 v236, a244
  v_mfma_f32_16x16x32_bf16 v[144:147], v[32:35], v[80:83], v[144:147]
  s_lshl_b32 s10, s9, 20
  ds_read_b64_tr_b16 v[56:57], v15 offset:57344
  v_accvgpr_read_b32 v237, a245
  v_mfma_f32_16x16x32_bf16 v[144:147], v[36:39], v[84:87], v[144:147]
  s_add_u32 s10, s10, s73
  v_accvgpr_read_b32 v238, a246
  v_mfma_f32_16x16x32_bf16 v[148:151], v[40:43], v[80:83], v[148:151]
  s_and_b32 s73, s32, 7
  ds_read_b64_tr_b16 v[58:59], v15 offset:57856
  v_accvgpr_read_b32 v239, a247
  v_mfma_f32_16x16x32_bf16 v[148:151], v[44:47], v[84:87], v[148:151]
  s_lshl_b32 s72, s73, 17
  v_accvgpr_read_b32 v240, a216
  v_mfma_f32_16x16x32_bf16 v[156:159], v[40:43], v[88:91], v[156:159]
  s_add_u32 s10, s10, s72
  ds_read_b64_tr_b16 v[60:61], v15 offset:61440
  v_mfma_f32_16x16x32_bf16 v[156:159], v[44:47], v[92:95], v[156:159]
  s_mov_b32 s67, s10
  v_accvgpr_read_b32 v241, a217
  v_mfma_f32_16x16x32_bf16 v[152:155], v[32:35], v[88:91], v[152:155]
  s_lshl_b32 s4, s73, 13
  ds_read_b64_tr_b16 v[62:63], v15 offset:61952
  v_accvgpr_read_b32 v242, a218
  v_mfma_f32_16x16x32_bf16 v[152:155], v[36:39], v[92:95], v[152:155]
  s_mov_b32 s72, 1
  v_accvgpr_read_b32 v243, a219
  v_mfma_f32_16x16x32_bf16 v[160:163], v[32:35], v[96:99], v[160:163]
  s_lshl_b32 s8, s72, 17
  v_accvgpr_read_b32 v244, a248
  v_mfma_f32_16x16x32_bf16 v[160:163], v[36:39], v[100:103], v[160:163]
  s_lshl_b32 s70, s72, 13
  v_accvgpr_read_b32 v245, a249
  v_mfma_f32_16x16x32_bf16 v[164:167], v[40:43], v[96:99], v[164:167]
  s_lshl_b32 s73, s0, 2
  v_accvgpr_read_b32 v246, a250
  v_mfma_f32_16x16x32_bf16 v[164:167], v[44:47], v[100:103], v[164:167]
  s_add_u32 s73, s73, s34
  v_mfma_f32_16x16x32_bf16 v[172:175], v[40:43], v[104:107], v[172:175]
  s_mul_i32 s72, s73, 376832
  v_accvgpr_read_b32 v247, a251
  v_mfma_f32_16x16x32_bf16 v[172:175], v[44:47], v[108:111], v[172:175]
  s_add_u32 s72, s72, 33554432
  v_accvgpr_read_b32 v248, a220
  v_mfma_f32_16x16x32_bf16 v[168:171], v[32:35], v[104:107], v[168:171]
  s_mul_i32 s64, s9, 28672
  v_accvgpr_read_b32 v249, a221
  v_mfma_f32_16x16x32_bf16 v[168:171], v[36:39], v[108:111], v[168:171]
  v_accvgpr_read_b32 v250, a222
  v_mfma_f32_16x16x32_bf16 v[176:179], v[32:35], v[112:115], v[176:179]
  s_add_u32 s64, s64, s72
  v_accvgpr_read_b32 v251, a223
  v_mfma_f32_16x16x32_bf16 v[176:179], v[36:39], v[116:119], v[176:179]
  s_lshl_b32 s1, s9, 16
  v_accvgpr_read_b32 v252, a252
  v_mfma_f32_16x16x32_bf16 v[180:183], v[40:43], v[112:115], v[180:183]
  s_add_u32 s1, s1, s72
  v_mfma_f32_16x16x32_bf16 v[180:183], v[44:47], v[116:119], v[180:183]
  s_add_u32 s1, s1, 114688
  v_accvgpr_read_b32 v253, a253
  v_mfma_f32_16x16x32_bf16 v[188:191], v[40:43], v[120:123], v[188:191]
  s_lshl_b32 s11, s73, 7
  v_accvgpr_read_b32 v254, a254
  v_mfma_f32_16x16x32_bf16 v[188:191], v[44:47], v[124:127], v[188:191]
  s_add_u32 s11, s11, 67174400
  v_accvgpr_read_b32 v255, a255
  v_mfma_f32_16x16x32_bf16 v[184:187], v[32:35], v[120:123], v[184:187]
  s_add_u32 s65, s1, s4
  v_mfma_f32_16x16x32_bf16 v[184:187], v[36:39], v[124:127], v[184:187]
  s_waitcnt vmcnt(10) lgkmcnt(0)
  s_barrier
  s_lshl_b32 s35, s32, 19
  s_add_u32 s56, s30, s35
  s_addc_u32 s57, s31, 0
  s_add_u32 s60, s56, 16777216
  s_addc_u32 s61, s57, 0
  v_mfma_f32_16x16x32_bf16 v[192:195], v[48:51], v[64:67], v[192:195]
  s_add_u32 s35, s17, 1
  ds_read_b64_tr_b16 v[32:33], v10 offset:0
  ds_read_b64_tr_b16 v[34:35], v10 offset:1024
  v_mfma_f32_16x16x32_bf16 v[192:195], v[52:55], v[68:71], v[192:195]
  s_lshl_b32 s58, s35, 15
  ds_read_b64_tr_b16 v[36:37], v10 offset:8192
  ds_read_b64_tr_b16 v[38:39], v10 offset:9216
  v_mfma_f32_16x16x32_bf16 v[196:199], v[56:59], v[64:67], v[196:199]
  s_mov_b32 s62, s58
  ds_read_b64_tr_b16 v[40:41], v11 offset:0
  ds_read_b64_tr_b16 v[42:43], v11 offset:1024
  v_mfma_f32_16x16x32_bf16 v[196:199], v[60:63], v[68:71], v[196:199]
  s_mov_b32 s59, 0x20000
  ds_read_b128 v[64:67], v4 offset:16384
  v_mfma_f32_16x16x32_bf16 v[204:207], v[56:59], v[72:75], v[204:207]
  s_mov_b32 s63, 0x20000
  ds_read_b128 v[68:71], v5 offset:16384
  v_mfma_f32_16x16x32_bf16 v[204:207], v[60:63], v[76:79], v[204:207]
  ds_read_b64_tr_b16 v[44:45], v11 offset:8192
  ds_read_b64_tr_b16 v[46:47], v11 offset:9216
  v_mfma_f32_16x16x32_bf16 v[200:203], v[48:51], v[72:75], v[200:203]
  v_mbcnt_lo_u32_b32 v25, -1, 0
  v_mbcnt_hi_u32_b32 v25, -1, v25
  v_mfma_f32_16x16x32_bf16 v[200:203], v[52:55], v[76:79], v[200:203]
  ds_read_b128 v[72:75], v4 offset:18432
  v_and_b32 v26, 7, v25
  v_mfma_f32_16x16x32_bf16 v[208:211], v[48:51], v[80:83], v[208:211]
  ds_read_b128 v[76:79], v5 offset:18432
  v_lshlrev_b32 v26, 2, v26
  v_mfma_f32_16x16x32_bf16 v[208:211], v[52:55], v[84:87], v[208:211]
  s_lshl_b32 s74, s32, 7
  s_add_u32 s74, s74, 67117056
  v_lshl_add_u32 v19, v25, 4, s69
  v_mfma_f32_16x16x32_bf16 v[212:215], v[56:59], v[80:83], v[212:215]
  s_mov_b32 s82, 0
  s_mov_b32 s81, 0x10000
  s_lshl_b32 s79, s16, 1
  v_mfma_f32_16x16x32_bf16 v[212:215], v[60:63], v[84:87], v[212:215]
  s_lshl_b32 s80, s17, 1
  ds_read_b128 v[80:83], v4 offset:20480
  v_mfma_f32_16x16x32_bf16 v[220:223], v[56:59], v[88:91], v[220:223]
  s_mov_b32 s85, 0x4e800000
  ds_read_b128 v[84:87], v5 offset:20480
  v_mfma_f32_16x16x32_bf16 v[220:223], v[60:63], v[92:95], v[220:223]
  s_add_u32 s78, s79, 2
  s_lshl_b32 s78, s78, 14
  s_lshl_b32 s92, s33, 5
  v_mfma_f32_16x16x32_bf16 v[216:219], v[48:51], v[88:91], v[216:219]
  s_add_u32 s92, s92, s32
  s_lshl_b32 s92, s92, 2
  v_mfma_f32_16x16x32_bf16 v[216:219], v[52:55], v[92:95], v[216:219]
  s_add_u32 s92, s92, 67121152
  ds_read_b128 v[88:91], v4 offset:22528
  v_mfma_f32_16x16x32_bf16 v[224:227], v[48:51], v[96:99], v[224:227]
  s_sub_u32 s68, s34, 1
  ds_read_b128 v[92:95], v5 offset:22528
  v_mfma_f32_16x16x32_bf16 v[224:227], v[52:55], v[100:103], v[224:227]
  s_and_b32 s68, s68, 0x80000000
  s_or_b32 s68, s68, 0x7f800000
  v_mfma_f32_16x16x32_bf16 v[228:231], v[56:59], v[96:99], v[228:231]
  s_sub_u32 s99, s34, 2
  s_and_b32 s99, s99, 0x80000000
  v_mfma_f32_16x16x32_bf16 v[228:231], v[60:63], v[100:103], v[228:231]
  s_or_b32 s99, s99, 0x7f800000
  ds_read_b128 v[96:99], v4 offset:32768
  v_mfma_f32_16x16x32_bf16 v[236:239], v[56:59], v[104:107], v[236:239]
  s_sub_u32 s20, s34, 3
  ds_read_b128 v[100:103], v5 offset:32768
  v_mfma_f32_16x16x32_bf16 v[236:239], v[60:63], v[108:111], v[236:239]
  s_and_b32 s20, s20, 0x80000000
  s_or_b32 s20, s20, 0x7f800000
  v_mfma_f32_16x16x32_bf16 v[232:235], v[48:51], v[104:107], v[232:235]
  v_lshlrev_b32 v18, 4, v25
  v_mfma_f32_16x16x32_bf16 v[232:235], v[52:55], v[108:111], v[232:235]
  ds_read_b128 v[104:107], v4 offset:34816
  v_lshlrev_b32 v22, 4, v25
  v_mfma_f32_16x16x32_bf16 v[240:243], v[48:51], v[112:115], v[240:243]
  ds_read_b128 v[108:111], v5 offset:34816
  v_and_b32 v0, 15, v25
  v_mfma_f32_16x16x32_bf16 v[240:243], v[52:55], v[116:119], v[240:243]
  v_lshrrev_b32 v1, 4, v25
  v_lshlrev_b32 v1, 2, v1
  v_mfma_f32_16x16x32_bf16 v[244:247], v[56:59], v[112:115], v[244:247]
  v_sub_u32 v20, v0, v1
  v_mov_b32 v21, 0xff800000
  v_mfma_f32_16x16x32_bf16 v[244:247], v[60:63], v[116:119], v[244:247]
  s_lshl_b32 s35, s76, 15
  ds_read_b128 v[112:115], v4 offset:36864
  v_mfma_f32_16x16x32_bf16 v[252:255], v[56:59], v[120:123], v[252:255]
  s_lshl_b32 s72, s77, 12
  ds_read_b128 v[116:119], v5 offset:36864
  v_mfma_f32_16x16x32_bf16 v[252:255], v[60:63], v[124:127], v[252:255]
  s_add_u32 s35, s35, s72
  s_add_u32 s35, s35, 0x10000
  v_add_u32 v23, s35, v18
  v_mfma_f32_16x16x32_bf16 v[248:251], v[48:51], v[120:123], v[248:251]
  s_lshl_b32 s35, s76, 15
  v_add_u32 v24, s35, v23
  v_mfma_f32_16x16x32_bf16 v[248:251], v[52:55], v[124:127], v[248:251]
  s_waitcnt lgkmcnt(6)
  ds_read_b128 v[120:123], v4 offset:38912
  ds_read_b128 v[124:127], v5 offset:38912
  buffer_load_dword v28, v26, s[48:51], s74 offen sc1
  v_mfma_f32_16x16x32_bf16 a[0:3], v[32:35], v[64:67], a[0:3]
  s_lshl_b32 s35, s77, 13
  ds_read_b64_tr_b16 v[48:49], v12 offset:0
  v_mfma_f32_16x16x32_bf16 a[0:3], v[36:39], v[68:71], a[0:3]
  s_lshl_b32 s72, s76, 10
  s_add_u32 s35, s35, s72
  s_add_u32 s18, s35, 0x10000
  v_mfma_f32_16x16x32_bf16 a[32:35], v[40:43], v[64:67], a[32:35]
  s_sub_u32 s19, 91136, s35
  ds_read_b64_tr_b16 v[50:51], v12 offset:1024
  v_mfma_f32_16x16x32_bf16 a[32:35], v[44:47], v[68:71], a[32:35]
  s_sub_u32 s35, s17, s16
  s_mul_i32 s35, s35, s76
  s_add_u32 s35, s35, s16
  v_mfma_f32_16x16x32_bf16 a[36:39], v[40:43], v[72:75], a[36:39]
  s_mul_i32 s35, s35, 736
  ds_read_b64_tr_b16 v[52:53], v12 offset:8192
  v_mfma_f32_16x16x32_bf16 a[36:39], v[44:47], v[76:79], a[36:39]
  s_lshl_b32 s72, s71, 1
  s_add_u32 s35, s35, s72
  s_add_u32 s35, s35, s77
  v_mfma_f32_16x16x32_bf16 a[4:7], v[32:35], v[72:75], a[4:7]
  s_lshl_b32 s35, s35, 11
  ds_read_b64_tr_b16 v[54:55], v12 offset:9216
L_pg7:
  s_cbranch_execz L_pg11
  v_mfma_f32_16x16x32_bf16 a[4:7], v[36:39], v[76:79], a[4:7]
  s_add_u32 s6, s35, 33554432
  v_and_b32 v27, 3, v25
  v_subrev_u32 v27, 1, v27
  v_mfma_f32_16x16x32_bf16 a[8:11], v[32:35], v[80:83], a[8:11]
  ds_read_b64_tr_b16 v[56:57], v13 offset:0
  v_ashrrev_i32 v27, 31, v27
  v_mfma_f32_16x16x32_bf16 a[8:11], v[36:39], v[84:87], a[8:11]
  v_accvgpr_read_b32 v2, a0
  v_accvgpr_read_b32 v0, a1
  v_mfma_f32_16x16x32_bf16 a[40:43], v[40:43], v[80:83], a[40:43]
  ds_read_b64_tr_b16 v[58:59], v13 offset:1024
  v_accvgpr_read_b32 v3, a2
  v_mfma_f32_16x16x32_bf16 a[40:43], v[44:47], v[84:87], a[40:43]
  v_accvgpr_read_b32 v1, a3
  v_cvt_pk_bf16_f32 v2, v2, v0
  v_mfma_f32_16x16x32_bf16 a[44:47], v[40:43], v[88:91], a[44:47]
  ds_read_b64_tr_b16 v[60:61], v13 offset:8192
  v_cvt_pk_bf16_f32 v3, v3, v1
  v_mfma_f32_16x16x32_bf16 a[44:47], v[44:47], v[92:95], a[44:47]
  v_accvgpr_read_b32 v4, a32
  v_accvgpr_read_b32 v0, a33
  v_mfma_f32_16x16x32_bf16 a[12:15], v[32:35], v[88:91], a[12:15]
  ds_read_b64_tr_b16 v[62:63], v13 offset:9216
  v_accvgpr_read_b32 v5, a34
  v_mfma_f32_16x16x32_bf16 a[12:15], v[36:39], v[92:95], a[12:15]
  s_waitcnt lgkmcnt(8)
  v_accvgpr_read_b32 v1, a35
  v_and_b32 v27, 0x3f803f80, v27
  v_mfma_f32_16x16x32_bf16 a[16:19], v[32:35], v[96:99], a[16:19]
  v_cvt_pk_bf16_f32 v4, v4, v0
  v_cvt_pk_bf16_f32 v5, v5, v1
  v_mfma_f32_16x16x32_bf16 a[16:19], v[36:39], v[100:103], a[16:19]
  s_mov_b32 s35, 0x7fffffff
  v_accvgpr_read_b32 v6, a4
  v_accvgpr_read_b32 v0, a5
  v_mfma_f32_16x16x32_bf16 a[48:51], v[40:43], v[96:99], a[48:51]
  v_accvgpr_read_b32 v7, a6
  v_subrev_u32 v29, 0, v20
  v_mfma_f32_16x16x32_bf16 a[48:51], v[44:47], v[100:103], a[48:51]
  v_accvgpr_read_b32 v1, a7
  v_cvt_pk_bf16_f32 v6, v6, v0
  v_mfma_f32_16x16x32_bf16 a[52:55], v[40:43], v[104:107], a[52:55]
  v_cvt_pk_bf16_f32 v7, v7, v1
  v_accvgpr_read_b32 v8, a36
  v_mfma_f32_16x16x32_bf16 a[52:55], v[44:47], v[108:111], a[52:55]
  v_accvgpr_read_b32 v0, a37
  v_accvgpr_read_b32 v9, a38
  v_mfma_f32_16x16x32_bf16 a[20:23], v[32:35], v[104:107], a[20:23]
  v_accvgpr_read_b32 v1, a39
  v_bfi_b32 v29, s35, v21, v29
  v_mfma_f32_16x16x32_bf16 a[20:23], v[36:39], v[108:111], a[20:23]
  v_cvt_pk_bf16_f32 v8, v8, v0
  v_cvt_pk_bf16_f32 v9, v9, v1
  v_mfma_f32_16x16x32_bf16 a[24:27], v[32:35], v[112:115], a[24:27]
  v_accvgpr_read_b32 v10, a8
  v_accvgpr_read_b32 v0, a9
  v_subrev_u32 v30, 1, v20
  v_mfma_f32_16x16x32_bf16 a[24:27], v[36:39], v[116:119], a[24:27]
  v_accvgpr_read_b32 v11, a10
  v_bfi_b32 v30, s35, v21, v30
  v_mfma_f32_16x16x32_bf16 a[56:59], v[40:43], v[112:115], a[56:59]
  v_accvgpr_read_b32 v1, a11
  v_cvt_pk_bf16_f32 v10, v10, v0
  v_subrev_u32 v31, 2, v20
  v_mfma_f32_16x16x32_bf16 a[56:59], v[44:47], v[116:119], a[56:59]
  v_cvt_pk_bf16_f32 v11, v11, v1
  v_accvgpr_read_b32 v12, a40
  v_mfma_f32_16x16x32_bf16 a[60:63], v[40:43], v[120:123], a[60:63]
  v_accvgpr_read_b32 v0, a41
  v_accvgpr_read_b32 v13, a42
  v_bfi_b32 v31, s35, v21, v31
  v_mfma_f32_16x16x32_bf16 a[60:63], v[44:47], v[124:127], a[60:63]
  v_accvgpr_read_b32 v1, a43
  v_subrev_u32 v14, 3, v20
  v_mfma_f32_16x16x32_bf16 a[28:31], v[32:35], v[120:123], a[28:31]
  v_cvt_pk_bf16_f32 v12, v12, v0
  v_cvt_pk_bf16_f32 v13, v13, v1
  v_bfi_b32 v14, s35, v21, v14
  v_mfma_f32_16x16x32_bf16 a[28:31], v[36:39], v[124:127], a[28:31]
  s_waitcnt vmcnt(6) lgkmcnt(0)
  s_barrier
  v_mfma_f32_16x16x32_bf16 a[64:67], v[48:51], v[64:67], a[64:67]
  ds_read_b64_tr_b16 v[32:33], v16 offset:49152
  v_mfma_f32_16x16x32_bf16 a[64:67], v[52:55], v[68:71], a[64:67]
  ds_write_b128 v23, v[2:5] offset:0
  v_mfma_f32_16x16x32_bf16 a[96:99], v[56:59], v[64:67], a[96:99]
  ds_read_b64_tr_b16 v[34:35], v16 offset:49664
  v_mfma_f32_16x16x32_bf16 a[96:99], v[60:63], v[68:71], a[96:99]
  v_accvgpr_read_b32 v2, a12
  v_accvgpr_read_b32 v0, a13
  v_mfma_f32_16x16x32_bf16 a[100:103], v[56:59], v[72:75], a[100:103]
  ds_read_b64_tr_b16 v[36:37], v16 offset:53248
  v_accvgpr_read_b32 v3, a14
  v_accvgpr_read_b32 v1, a15
  v_mfma_f32_16x16x32_bf16 a[100:103], v[60:63], v[76:79], a[100:103]
  ds_write_b128 v23, v[6:9] offset:1024
  v_cvt_pk_bf16_f32 v2, v2, v0
  v_cvt_pk_bf16_f32 v3, v3, v1
  v_mfma_f32_16x16x32_bf16 a[68:71], v[48:51], v[72:75], a[68:71]
  ds_read_b64_tr_b16 v[38:39], v16 offset:53760
  v_accvgpr_read_b32 v4, a44
  v_accvgpr_read_b32 v0, a45
  v_mfma_f32_16x16x32_bf16 a[68:71], v[52:55], v[76:79], a[68:71]
  v_accvgpr_read_b32 v5, a46
  v_accvgpr_read_b32 v1, a47
  v_mfma_f32_16x16x32_bf16 a[72:75], v[48:51], v[80:83], a[72:75]
  ds_read_b64_tr_b16 v[40:41], v16 offset:57344
  v_cvt_pk_bf16_f32 v4, v4, v0
  v_cvt_pk_bf16_f32 v5, v5, v1
  v_mfma_f32_16x16x32_bf16 a[72:75], v[52:55], v[84:87], a[72:75]
  ds_write_b128 v23, v[10:13] offset:8192
  ds_write_b128 v23, v[2:5] offset:9216
  v_accvgpr_read_b32 v6, a16
  v_mfma_f32_16x16x32_bf16 a[104:107], v[56:59], v[80:83], a[104:107]
  ds_read_b64_tr_b16 v[42:43], v16 offset:57856
  v_accvgpr_read_b32 v0, a17
  v_mfma_f32_16x16x32_bf16 a[104:107], v[60:63], v[84:87], a[104:107]
  v_accvgpr_read_b32 v7, a18
  v_accvgpr_read_b32 v1, a19
  v_mfma_f32_16x16x32_bf16 a[108:111], v[56:59], v[88:91], a[108:111]
  ds_read_b64_tr_b16 v[44:45], v16 offset:61440
  v_cvt_pk_bf16_f32 v6, v6, v0
  v_mfma_f32_16x16x32_bf16 a[108:111], v[60:63], v[92:95], a[108:111]
  v_cvt_pk_bf16_f32 v7, v7, v1
  v_accvgpr_read_b32 v8, a48
  v_mfma_f32_16x16x32_bf16 a[76:79], v[48:51], v[88:91], a[76:79]
  ds_read_b64_tr_b16 v[46:47], v16 offset:61952
  v_accvgpr_read_b32 v0, a49
  v_mfma_f32_16x16x32_bf16 a[76:79], v[52:55], v[92:95], a[76:79]
  v_accvgpr_read_b32 v9, a50
  v_accvgpr_read_b32 v1, a51
  v_mfma_f32_16x16x32_bf16 a[80:83], v[48:51], v[96:99], a[80:83]
  v_cvt_pk_bf16_f32 v8, v8, v0
  v_cvt_pk_bf16_f32 v9, v9, v1
  v_mfma_f32_16x16x32_bf16 a[80:83], v[52:55], v[100:103], a[80:83]
  ds_write_b128 v24, v[6:9] offset:16384
  v_accvgpr_read_b32 v10, a20
  v_accvgpr_read_b32 v0, a21
  v_mfma_f32_16x16x32_bf16 a[112:115], v[56:59], v[96:99], a[112:115]
  v_accvgpr_read_b32 v11, a22
  v_accvgpr_read_b32 v1, a23
  v_mfma_f32_16x16x32_bf16 a[112:115], v[60:63], v[100:103], a[112:115]
  v_cvt_pk_bf16_f32 v10, v10, v0
  v_cvt_pk_bf16_f32 v11, v11, v1
  v_mfma_f32_16x16x32_bf16 a[116:119], v[56:59], v[104:107], a[116:119]
  v_accvgpr_read_b32 v12, a52
  v_accvgpr_read_b32 v0, a53
  v_mfma_f32_16x16x32_bf16 a[116:119], v[60:63], v[108:111], a[116:119]
  v_accvgpr_read_b32 v13, a54
  v_accvgpr_read_b32 v1, a55
  v_mfma_f32_16x16x32_bf16 a[84:87], v[48:51], v[104:107], a[84:87]
  v_cvt_pk_bf16_f32 v12, v12, v0
  v_cvt_pk_bf16_f32 v13, v13, v1
  v_mfma_f32_16x16x32_bf16 a[84:87], v[52:55], v[108:111], a[84:87]
  ds_write_b128 v24, v[10:13] offset:17408
  v_accvgpr_read_b32 v2, a24
  v_accvgpr_read_b32 v0, a25
  v_mfma_f32_16x16x32_bf16 a[88:91], v[48:51], v[112:115], a[88:91]
  s_waitcnt lgkmcnt(2)
  v_accvgpr_read_b32 v3, a26
  v_accvgpr_read_b32 v1, a27
  v_mfma_f32_16x16x32_bf16 a[88:91], v[52:55], v[116:119], a[88:91]
  v_cvt_pk_bf16_f32 v2, v2, v0
  v_cvt_pk_bf16_f32 v3, v3, v1
  v_mfma_f32_16x16x32_bf16 a[120:123], v[56:59], v[112:115], a[120:123]
  v_accvgpr_read_b32 v4, a56
  v_accvgpr_read_b32 v0, a57
  v_mfma_f32_16x16x32_bf16 a[120:123], v[60:63], v[116:119], a[120:123]
  v_accvgpr_read_b32 v5, a58
  v_accvgpr_read_b32 v1, a59
  v_mfma_f32_16x16x32_bf16 a[124:127], v[56:59], v[120:123], a[124:127]
  v_cvt_pk_bf16_f32 v4, v4, v0
  v_cvt_pk_bf16_f32 v5, v5, v1
  v_mfma_f32_16x16x32_bf16 a[124:127], v[60:63], v[124:127], a[124:127]
  s_waitcnt vmcnt(0)
  ds_write_b128 v24, v[2:5] offset:24576
  v_accvgpr_read_b32 v6, a28
  v_cmp_ne_u32 vcc, s101, v28
  v_mfma_f32_16x16x32_bf16 a[92:95], v[48:51], v[120:123], a[92:95]
  v_accvgpr_read_b32 v0, a29
  v_accvgpr_read_b32 v7, a30
  v_mfma_f32_16x16x32_bf16 a[92:95], v[52:55], v[124:127], a[92:95]
  s_cbranch_vccnz L_spin_kvg
L_spin_kvg_r:
  v_mfma_f32_16x16x32_bf16 v[128:131], v[32:35], v[64:67], v[128:131]
  ds_read_b64_tr_b16 v[48:49], v17 offset:49152
  v_accvgpr_read_b32 v1, a31
  v_cvt_pk_bf16_f32 v6, v6, v0
  v_mfma_f32_16x16x32_bf16 v[128:131], v[36:39], v[68:71], v[128:131]
  v_cvt_pk_bf16_f32 v7, v7, v1
  v_accvgpr_read_b32 v8, a60
  v_mfma_f32_16x16x32_bf16 v[132:135], v[40:43], v[64:67], v[132:135]
  ds_read_b64_tr_b16 v[50:51], v17 offset:49664
  v_accvgpr_read_b32 v0, a61
  v_mfma_f32_16x16x32_bf16 v[132:135], v[44:47], v[68:71], v[132:135]
  s_add_u32 m0, s69, 0x20000
  v_accvgpr_read_b32 v9, a62
  v_accvgpr_read_b32 v1, a63
  v_mfma_f32_16x16x32_bf16 v[140:143], v[40:43], v[72:75], v[140:143]
  ds_read_b64_tr_b16 v[52:53], v17 offset:53248
  v_cvt_pk_bf16_f32 v8, v8, v0
  v_cvt_pk_bf16_f32 v9, v9, v1
  v_mfma_f32_16x16x32_bf16 v[140:143], v[44:47], v[76:79], v[140:143]
  ds_write_b128 v24, v[6:9] offset:25600
  buffer_load_dwordx4 v19, s[56:59], 0 offen offset:0 sc1 lds
  v_mfma_f32_16x16x32_bf16 v[136:139], v[32:35], v[72:75], v[136:139]
  ds_read_b64_tr_b16 v[54:55], v17 offset:53760
  v_accvgpr_read_b32 v10, a64
  v_accvgpr_read_b32 v0, a65
  v_mfma_f32_16x16x32_bf16 v[136:139], v[36:39], v[76:79], v[136:139]
  v_accvgpr_read_b32 v11, a66
  v_accvgpr_read_b32 v1, a67
  v_mfma_f32_16x16x32_bf16 v[144:147], v[32:35], v[80:83], v[144:147]
  ds_read_b64_tr_b16 v[56:57], v17 offset:57344
  v_cvt_pk_bf16_f32 v10, v10, v0
  v_mfma_f32_16x16x32_bf16 v[144:147], v[36:39], v[84:87], v[144:147]
  buffer_load_dwordx4 v19, s[56:59], 0 offen offset:1024 sc1 lds
  v_cvt_pk_bf16_f32 v11, v11, v1
  v_mfma_f32_16x16x32_bf16 v[148:151], v[40:43], v[80:83], v[148:151]
  ds_read_b64_tr_b16 v[58:59], v17 offset:57856
  v_accvgpr_read_b32 v12, a96
  v_accvgpr_read_b32 v0, a97
  v_mfma_f32_16x16x32_bf16 v[148:151], v[44:47], v[84:87], v[148:151]
  v_accvgpr_read_b32 v13, a98
  v_accvgpr_read_b32 v1, a99
  v_mfma_f32_16x16x32_bf16 v[156:159], v[40:43], v[88:91], v[156:159]
  ds_read_b64_tr_b16 v[60:61], v17 offset:61440
  buffer_load_dwordx4 v19, s[56:59], 0 offen offset:2048 sc1 lds
  v_mfma_f32_16x16x32_bf16 v[156:159], v[44:47], v[92:95], v[156:159]
  v_cvt_pk_bf16_f32 v12, v12, v0
  v_cvt_pk_bf16_f32 v13, v13, v1
  v_mfma_f32_16x16x32_bf16 v[152:155], v[32:35], v[88:91], v[152:155]
  ds_read_b64_tr_b16 v[62:63], v17 offset:61952
  ds_write_b128 v23, v[10:13] offset:2048
  v_mfma_f32_16x16x32_bf16 v[152:155], v[36:39], v[92:95], v[152:155]
  v_accvgpr_read_b32 v2, a68
  v_accvgpr_read_b32 v0, a69
  v_mfma_f32_16x16x32_bf16 v[160:163], v[32:35], v[96:99], v[160:163]
  buffer_load_dwordx4 v19, s[56:59], 0 offen offset:3072 sc1 lds
  v_accvgpr_read_b32 v3, a70
  v_accvgpr_read_b32 v1, a71
  v_mfma_f32_16x16x32_bf16 v[160:163], v[36:39], v[100:103], v[160:163]
  v_cvt_pk_bf16_f32 v2, v2, v0
  v_cvt_pk_bf16_f32 v3, v3, v1
  v_mfma_f32_16x16x32_bf16 v[164:167], v[40:43], v[96:99], v[164:167]
  v_accvgpr_read_b32 v4, a100
  v_accvgpr_read_b32 v0, a101
  v_mfma_f32_16x16x32_bf16 v[164:167], v[44:47], v[100:103], v[164:167]
  s_add_u32 m0, s69, 16384
  v_accvgpr_read_b32 v5, a102
  v_accvgpr_read_b32 v1, a103
  v_mfma_f32_16x16x32_bf16 v[172:175], v[40:43], v[104:107], v[172:175]
  v_cvt_pk_bf16_f32 v4, v4, v0
  v_cvt_pk_bf16_f32 v5, v5, v1
  v_mfma_f32_16x16x32_bf16 v[172:175], v[44:47], v[108:111], v[172:175]
  ds_write_b128 v23, v[2:5] offset:3072
  buffer_load_dwordx4 v19, s[60:63], 0 offen offset:0 sc1 lds
  v_accvgpr_read_b32 v6, a72
  v_mfma_f32_16x16x32_bf16 v[168:171], v[32:35], v[104:107], v[168:171]
  v_accvgpr_read_b32 v0, a73
  v_accvgpr_read_b32 v7, a74
  v_mfma_f32_16x16x32_bf16 v[168:171], v[36:39], v[108:111], v[168:171]
  v_accvgpr_read_b32 v1, a75
  v_cvt_pk_bf16_f32 v6, v6, v0
  v_mfma_f32_16x16x32_bf16 v[176:179], v[32:35], v[112:115], v[176:179]
  buffer_load_dwordx4 v19, s[60:63], 0 offen offset:1024 sc1 lds
  v_cvt_pk_bf16_f32 v7, v7, v1
  v_mfma_f32_16x16x32_bf16 v[176:179], v[36:39], v[116:119], v[176:179]
  s_waitcnt lgkmcnt(2)
  v_accvgpr_read_b32 v8, a104
  v_accvgpr_read_b32 v0, a105
  v_mfma_f32_16x16x32_bf16 v[180:183], v[40:43], v[112:115], v[180:183]
  v_accvgpr_read_b32 v9, a106
  v_accvgpr_read_b32 v1, a107
  v_mfma_f32_16x16x32_bf16 v[180:183], v[44:47], v[116:119], v[180:183]
  buffer_load_dwordx4 v19, s[60:63], 0 offen offset:2048 sc1 lds
  v_cvt_pk_bf16_f32 v8, v8, v0
  v_mfma_f32_16x16x32_bf16 v[188:191], v[40:43], v[120:123], v[188:191]
  v_cvt_pk_bf16_f32 v9, v9, v1
  v_mfma_f32_16x16x32_bf16 v[188:191], v[44:47], v[124:127], v[188:191]
  ds_write_b128 v23, v[6:9] offset:10240
  v_accvgpr_read_b32 v10, a76
  v_accvgpr_read_b32 v0, a77
  v_mfma_f32_16x16x32_bf16 v[184:187], v[32:35], v[120:123], v[184:187]
  buffer_load_dwordx4 v19, s[60:63], 0 offen offset:3072 sc1 lds
  v_accvgpr_read_b32 v11, a78
  v_mfma_f32_16x16x32_bf16 v[184:187], v[36:39], v[124:127], v[184:187]
  v_mfma_f32_16x16x32_bf16 v[192:195], v[48:51], v[64:67], v[192:195]
  v_accvgpr_read_b32 v1, a79
  v_cvt_pk_bf16_f32 v10, v10, v0
  v_mfma_f32_16x16x32_bf16 v[192:195], v[52:55], v[68:71], v[192:195]
  v_cvt_pk_bf16_f32 v11, v11, v1
  v_accvgpr_read_b32 v12, a108
  v_mfma_f32_16x16x32_bf16 v[196:199], v[56:59], v[64:67], v[196:199]
  v_accvgpr_read_b32 v0, a109
  v_accvgpr_read_b32 v13, a110
  v_mfma_f32_16x16x32_bf16 v[196:199], v[60:63], v[68:71], v[196:199]
  v_accvgpr_read_b32 v1, a111
  s_xor_b32 m0, m0, 0x4000
  v_mfma_f32_16x16x32_bf16 v[204:207], v[56:59], v[72:75], v[204:207]
  v_cvt_pk_bf16_f32 v12, v12, v0
  v_cvt_pk_bf16_f32 v13, v13, v1
  v_mfma_f32_16x16x32_bf16 v[204:207], v[60:63], v[76:79], v[204:207]
  ds_write_b128 v23, v[10:13] offset:11264
  v_accvgpr_read_b32 v2, a80
  v_mfma_f32_16x16x32_bf16 v[200:203], v[48:51], v[72:75], v[200:203]
  v_accvgpr_read_b32 v0, a81
  v_accvgpr_read_b32 v3, a82
  v_mfma_f32_16x16x32_bf16 v[200:203], v[52:55], v[76:79], v[200:203]
  v_accvgpr_read_b32 v1, a83
  v_cvt_pk_bf16_f32 v2, v2, v0
  v_mfma_f32_16x16x32_bf16 v[208:211], v[48:51], v[80:83], v[208:211]
  s_add_u32 s82, s82, 16384
  v_cvt_pk_bf16_f32 v3, v3, v1
  v_accvgpr_read_b32 v4, a112
  v_mfma_f32_16x16x32_bf16 v[208:211], v[52:55], v[84:87], v[208:211]
  v_accvgpr_read_b32 v0, a113
  v_accvgpr_read_b32 v5, a114
  v_accvgpr_read_b32 v1, a115
  v_mfma_f32_16x16x32_bf16 v[212:215], v[56:59], v[80:83], v[212:215]
  v_cvt_pk_bf16_f32 v4, v4, v0
  v_cvt_pk_bf16_f32 v5, v5, v1
  v_mfma_f32_16x16x32_bf16 v[212:215], v[60:63], v[84:87], v[212:215]
  ds_write_b128 v24, v[2:5] offset:18432
  v_add_u32 v19, 0x4000, v19
  v_mfma_f32_16x16x32_bf16 v[220:223], v[56:59], v[88:91], v[220:223]
  v_accvgpr_read_b32 v6, a84
  v_accvgpr_read_b32 v0, a85
  v_mfma_f32_16x16x32_bf16 v[220:223], v[60:63], v[92:95], v[220:223]
  v_accvgpr_read_b32 v7, a86
  v_accvgpr_read_b32 v1, a87
  v_mfma_f32_16x16x32_bf16 v[216:219], v[48:51], v[88:91], v[216:219]
  v_cvt_pk_bf16_f32 v6, v6, v0
  v_cvt_pk_bf16_f32 v7, v7, v1
  v_accvgpr_read_b32 v8, a116
  v_mfma_f32_16x16x32_bf16 v[216:219], v[52:55], v[92:95], v[216:219]
  buffer_load_dwordx4 v19, s[56:59], 0 offen offset:0 sc1 lds
  v_accvgpr_read_b32 v0, a117
  v_mfma_f32_16x16x32_bf16 v[224:227], v[48:51], v[96:99], v[224:227]
  v_accvgpr_read_b32 v9, a118
  v_accvgpr_read_b32 v1, a119
  v_mfma_f32_16x16x32_bf16 v[224:227], v[52:55], v[100:103], v[224:227]
  v_cvt_pk_bf16_f32 v8, v8, v0
  v_cvt_pk_bf16_f32 v9, v9, v1
  v_mfma_f32_16x16x32_bf16 v[228:231], v[56:59], v[96:99], v[228:231]
  ds_write_b128 v24, v[6:9] offset:19456
  v_accvgpr_read_b32 v10, a88
  v_mfma_f32_16x16x32_bf16 v[228:231], v[60:63], v[100:103], v[228:231]
  v_accvgpr_read_b32 v0, a89
  v_mfma_f32_16x16x32_bf16 v[236:239], v[56:59], v[104:107], v[236:239]
  buffer_load_dwordx4 v19, s[56:59], 0 offen offset:1024 sc1 lds
  v_accvgpr_read_b32 v11, a90
  v_accvgpr_read_b32 v1, a91
  v_mfma_f32_16x16x32_bf16 v[236:239], v[60:63], v[108:111], v[236:239]
  v_cvt_pk_bf16_f32 v10, v10, v0
  v_cvt_pk_bf16_f32 v11, v11, v1
  v_mfma_f32_16x16x32_bf16 v[232:235], v[48:51], v[104:107], v[232:235]
  v_accvgpr_read_b32 v12, a120
  v_accvgpr_read_b32 v0, a121
  v_mfma_f32_16x16x32_bf16 v[232:235], v[52:55], v[108:111], v[232:235]
  v_accvgpr_read_b32 v13, a122
  v_accvgpr_read_b32 v1, a123
  v_mfma_f32_16x16x32_bf16 v[240:243], v[48:51], v[112:115], v[240:243]
  buffer_load_dwordx4 v19, s[56:59], 0 offen offset:2048 sc1 lds
  v_cvt_pk_bf16_f32 v12, v12, v0
  v_cvt_pk_bf16_f32 v13, v13, v1
  v_mfma_f32_16x16x32_bf16 v[240:243], v[52:55], v[116:119], v[240:243]
  ds_write_b128 v24, v[10:13] offset:26624
  v_accvgpr_read_b32 v2, a92
  v_mfma_f32_16x16x32_bf16 v[244:247], v[56:59], v[112:115], v[244:247]
  v_accvgpr_read_b32 v0, a93
  v_accvgpr_read_b32 v3, a94
  v_accvgpr_read_b32 v1, a95
  v_mfma_f32_16x16x32_bf16 v[244:247], v[60:63], v[116:119], v[244:247]
  buffer_load_dwordx4 v19, s[56:59], 0 offen offset:3072 sc1 lds
  v_cvt_pk_bf16_f32 v2, v2, v0
  v_mfma_f32_16x16x32_bf16 v[252:255], v[56:59], v[120:123], v[252:255]
  v_cvt_pk_bf16_f32 v3, v3, v1
  v_accvgpr_read_b32 v4, a124
  v_mfma_f32_16x16x32_bf16 v[252:255], v[60:63], v[124:127], v[252:255]
  v_accvgpr_read_b32 v0, a125
  v_accvgpr_read_b32 v5, a126
  v_mfma_f32_16x16x32_bf16 v[248:251], v[48:51], v[120:123], v[248:251]
  v_accvgpr_read_b32 v1, a127
  v_cvt_pk_bf16_f32 v4, v4, v0
  v_cvt_pk_bf16_f32 v5, v5, v1
  v_mfma_f32_16x16x32_bf16 v[248:251], v[52:55], v[124:127], v[248:251]
  ds_write_b128 v24, v[2:5] offset:27648
  v_add_u32 v36, s18, v18
  v_add_u32 v37, s19, v18
  v_add_u32 v34, 0x20000, v18
  v_add_u32 v38, 0x10000, v37
  s_mov_b32 s96, 0xbfb8aa3b
  s_mov_b32 s97, 0xbfb8aa3b
  s_nop 1
  v_pk_mul_f32 v[128:129], v[128:129], s[96:97]
  v_pk_mul_f32 v[130:131], v[130:131], s[96:97]
  v_pk_mul_f32 v[192:193], v[192:193], s[96:97]
  v_pk_mul_f32 v[194:195], v[194:195], s[96:97]
  v_exp_f32 v128, v128
  v_exp_f32 v129, v129
  v_exp_f32 v130, v130
  v_exp_f32 v131, v131
  v_exp_f32 v192, v192
  v_exp_f32 v193, v193
  v_exp_f32 v194, v194
  v_exp_f32 v195, v195
  v_pk_add_f32 v[128:129], v[128:129], 1.0 op_sel_hi:[1,0]
  v_pk_add_f32 v[130:131], v[130:131], 1.0 op_sel_hi:[1,0]
  v_pk_add_f32 v[192:193], v[192:193], 1.0 op_sel_hi:[1,0]
  v_pk_add_f32 v[194:195], v[194:195], 1.0 op_sel_hi:[1,0]
  v_rcp_f32 v128, v128
  v_rcp_f32 v129, v129
  v_rcp_f32 v130, v130
  v_rcp_f32 v131, v131
  v_rcp_f32 v192, v192
  v_rcp_f32 v193, v193
  v_rcp_f32 v194, v194
  v_rcp_f32 v195, v195
  s_waitcnt vmcnt(8) lgkmcnt(0)
  s_barrier
  ds_read_b128 a[64:67], v34 offset:0
  ds_read_b128 a[72:75], v34 offset:2048
  ds_read_b128 a[80:83], v34 offset:4096
  ds_read_b128 a[88:91], v34 offset:6144
  ds_read_b128 a[0:3], v36 offset:0
  ds_read_b128 a[8:11], v36 offset:2048
  ds_read_b128 a[16:19], v36 offset:4096
  ds_read_b128 a[24:27], v36 offset:6144
  v_pk_mul_f32 v[128:129], v[128:129], v[132:133]
  v_pk_mul_f32 v[130:131], v[130:131], v[134:135]
  v_pk_mul_f32 v[192:193], v[192:193], v[196:197]
  v_pk_mul_f32 v[194:195], v[194:195], v[198:199]
  v_cvt_pk_bf16_f32 v196, v128, v129
  v_cvt_pk_bf16_f32 v197, v130, v131
  v_cvt_pk_bf16_f32 v198, v192, v193
  v_cvt_pk_bf16_f32 v199, v194, v195
  buffer_store_dwordx4 v[196:199], v18, s[48:51], s6 offen offset:0 sc1
  ds_read_b128 a[4:7], v37 offset:0
  ds_read_b128 a[12:15], v37 offset:2048
  ds_read_b128 a[20:23], v37 offset:4096
  ds_read_b128 a[28:31], v37 offset:6144
  ds_read_b128 a[32:35], v36 offset:32768
  ds_read_b128 a[40:43], v36 offset:34816
  ds_read_b128 a[48:51], v36 offset:36864
  ds_read_b128 a[56:59], v36 offset:38912
  v_pk_mul_f32 v[136:137], v[136:137], s[96:97]
  v_pk_mul_f32 v[138:139], v[138:139], s[96:97]
  v_pk_mul_f32 v[200:201], v[200:201], s[96:97]
  v_pk_mul_f32 v[202:203], v[202:203], s[96:97]
  v_exp_f32 v136, v136
  v_exp_f32 v137, v137
  v_exp_f32 v138, v138
  v_exp_f32 v139, v139
  v_exp_f32 v200, v200
  v_exp_f32 v201, v201
  ds_read_b128 a[36:39], v38 offset:0
  ds_read_b128 a[44:47], v38 offset:2048
  ds_read_b128 a[52:55], v38 offset:4096
  ds_read_b128 a[60:63], v38 offset:6144
  ds_read_b128 a[68:71], v34 offset:1024
  ds_read_b128 a[76:79], v34 offset:3072
  ds_read_b128 a[84:87], v34 offset:5120
  ds_read_b128 a[92:95], v34 offset:7168
  v_exp_f32 v202, v202
  v_exp_f32 v203, v203
  v_pk_add_f32 v[136:137], v[136:137], 1.0 op_sel_hi:[1,0]
  v_pk_add_f32 v[138:139], v[138:139], 1.0 op_sel_hi:[1,0]
  v_pk_add_f32 v[200:201], v[200:201], 1.0 op_sel_hi:[1,0]
  v_pk_add_f32 v[202:203], v[202:203], 1.0 op_sel_hi:[1,0]
  v_rcp_f32 v136, v136
  v_rcp_f32 v137, v137
  v_rcp_f32 v138, v138
  v_rcp_f32 v139, v139
  v_rcp_f32 v200, v200
  v_rcp_f32 v201, v201
  v_rcp_f32 v202, v202
  v_rcp_f32 v203, v203
  v_pk_mul_f32 v[136:137], v[136:137], v[140:141]
  v_pk_mul_f32 v[138:139], v[138:139], v[142:143]
  v_pk_mul_f32 v[200:201], v[200:201], v[204:205]
  v_pk_mul_f32 v[202:203], v[202:203], v[206:207]
  v_cvt_pk_bf16_f32 v204, v136, v137
  v_cvt_pk_bf16_f32 v205, v138, v139
  v_cvt_pk_bf16_f32 v206, v200, v201
  v_cvt_pk_bf16_f32 v207, v202, v203
  buffer_store_dwordx4 v[204:207], v18, s[48:51], s6 offen offset:1024 sc1
  s_add_u32 s6, s6, 376832
  v_mov_b64 v[128:129], 0
  v_mov_b64 v[130:131], 0
  v_mov_b64 v[132:133], 0
  v_mov_b64 v[134:135], 0
  v_mov_b64 v[44:45], 0
  v_mov_b64 v[46:47], 0
  s_cmp_eq_u32 s79, 0
  s_cbranch_scc1 L_pf0g
L_pf0g_r:
  s_waitcnt lgkmcnt(0)
  v_mfma_f32_16x16x32_bf16 v[64:67], a[64:67], a[0:3], v[128:131]
  s_waitcnt vmcnt(2)
  s_barrier
  v_mfma_f32_16x16x32_bf16 v[64:67], a[72:75], a[8:11], v[64:67]
  s_xor_b32 s81, s81, 0x18000
  v_mul_f32 v144, s96, v144
  v_mfma_f32_16x16x32_bf16 v[64:67], a[80:83], a[16:19], v[64:67]
  s_xor_b32 m0, m0, s81
  ds_read_b128 a[96:99], v18 offset:16384
  v_mul_f32 v145, s96, v145
  v_mfma_f32_16x16x32_bf16 v[64:67], a[88:91], a[24:27], v[64:67]
  s_xor_b32 m0, m0, 0x4000
  v_mul_f32 v146, s96, v146
  v_mul_f32 v147, s96, v147
  v_mfma_f32_16x16x32_bf16 v[72:75], a[88:91], a[28:31], 0
  buffer_load_dwordx4 v19, s[60:63], 0 offen offset:0 sc1 lds
  ds_read_b128 a[100:103], v18 offset:17408
  v_mfma_f32_16x16x32_bf16 v[72:75], a[80:83], a[20:23], v[72:75]
  v_mul_f32 v208, s96, v208
  v_mul_f32 v209, s96, v209
  v_mfma_f32_16x16x32_bf16 v[72:75], a[72:75], a[12:15], v[72:75]
  ds_read_b128 a[104:107], v18 offset:18432
  v_mul_f32 v210, s96, v210
  v_mfma_f32_16x16x32_bf16 v[72:75], a[64:67], a[4:7], v[72:75]
  buffer_load_dwordx4 v19, s[60:63], 0 offen offset:1024 sc1 lds
  v_mul_f32 v211, s96, v211
  v_mfma_f32_16x16x32_bf16 v[96:99], a[64:67], a[32:35], 0
  ds_read_b128 a[108:111], v18 offset:19456
  v_exp_f32 v144, v144
  v_mfma_f32_16x16x32_bf16 v[96:99], a[72:75], a[40:43], v[96:99]
  v_exp_f32 v145, v145
  v_mfma_f32_16x16x32_bf16 v[96:99], a[80:83], a[48:51], v[96:99]
  buffer_load_dwordx4 v19, s[60:63], 0 offen offset:2048 sc1 lds
  ds_read_b128 a[112:115], v18 offset:20480
  v_mfma_f32_16x16x32_bf16 v[96:99], a[88:91], a[56:59], v[96:99]
  v_exp_f32 v146, v146
  v_mfma_f32_16x16x32_bf16 v[104:107], a[88:91], a[60:63], 0
  ds_read_b128 a[116:119], v18 offset:21504
  v_exp_f32 v147, v147
  v_mfma_f32_16x16x32_bf16 v[104:107], a[80:83], a[52:55], v[104:107]
  buffer_load_dwordx4 v19, s[60:63], 0 offen offset:3072 sc1 lds
  v_exp_f32 v208, v208
  v_mfma_f32_16x16x32_bf16 v[104:107], a[72:75], a[44:47], v[104:107]
  ds_read_b128 a[120:123], v18 offset:22528
  v_exp_f32 v209, v209
  v_mfma_f32_16x16x32_bf16 v[104:107], a[64:67], a[36:39], v[104:107]
  s_xor_b32 m0, m0, 0x4000
  v_add_u32 v19, 0x4000, v19
  v_exp_f32 v210, v210
  v_mfma_f32_16x16x32_bf16 v[108:111], a[68:71], a[36:39], 0
  s_add_u32 s82, s82, 16384
  v_exp_f32 v211, v211
  v_mfma_f32_16x16x32_bf16 v[108:111], a[76:79], a[44:47], v[108:111]
L_pg8:
  s_cbranch_execz L_pg12
  ds_read_b128 a[64:67], v34 offset:8192
  v_add_f32 v144, 1.0, v144
  v_mfma_f32_16x16x32_bf16 v[108:111], a[84:87], a[52:55], v[108:111]
  buffer_load_dwordx4 v19, s[56:59], 0 offen offset:0 sc1 lds
  v_add_f32 v145, 1.0, v145
  v_mfma_f32_16x16x32_bf16 v[108:111], a[92:95], a[60:63], v[108:111]
  v_add_f32 v146, 1.0, v146
  v_mfma_f32_16x16x32_bf16 v[100:103], a[92:95], a[56:59], 0
  ds_read_b128 a[72:75], v34 offset:10240
  v_add_f32 v147, 1.0, v147
  v_mfma_f32_16x16x32_bf16 v[100:103], a[84:87], a[48:51], v[100:103]
  buffer_load_dwordx4 v19, s[56:59], 0 offen offset:1024 sc1 lds
  v_add_f32 v208, 1.0, v208
  v_mfma_f32_16x16x32_bf16 v[100:103], a[76:79], a[40:43], v[100:103]
  v_add_f32 v209, 1.0, v209
  v_mfma_f32_16x16x32_bf16 v[100:103], a[68:71], a[32:35], v[100:103]
  ds_read_b128 a[80:83], v34 offset:12288
  v_add_f32 v210, 1.0, v210
  v_mfma_f32_16x16x32_bf16 v[76:79], a[68:71], a[4:7], 0
  buffer_load_dwordx4 v19, s[56:59], 0 offen offset:2048 sc1 lds
  v_add_f32 v211, 1.0, v211
  v_mfma_f32_16x16x32_bf16 v[76:79], a[76:79], a[12:15], v[76:79]
  v_rcp_f32 v144, v144
  v_mfma_f32_16x16x32_bf16 v[76:79], a[84:87], a[20:23], v[76:79]
  ds_read_b128 a[88:91], v34 offset:14336
  v_rcp_f32 v145, v145
  v_mfma_f32_16x16x32_bf16 v[76:79], a[92:95], a[28:31], v[76:79]
  buffer_load_dwordx4 v19, s[56:59], 0 offen offset:3072 sc1 lds
  v_rcp_f32 v146, v146
  v_mfma_f32_16x16x32_bf16 v[68:71], a[92:95], a[24:27], v[132:135]
  v_rcp_f32 v147, v147
  v_mfma_f32_16x16x32_bf16 v[68:71], a[84:87], a[16:19], v[68:71]
  v_rcp_f32 v208, v208
  v_mfma_f32_16x16x32_bf16 v[68:71], a[76:79], a[8:11], v[68:71]
  v_rcp_f32 v209, v209
  v_mfma_f32_16x16x32_bf16 v[68:71], a[68:71], a[0:3], v[68:71]
  ds_read_b128 a[68:71], v34 offset:9216
  ds_read_b128 a[76:79], v34 offset:11264
  ds_read_b128 a[84:87], v34 offset:13312
  ds_read_b128 a[92:95], v34 offset:15360
  v_rcp_f32 v210, v210
  v_rcp_f32 v211, v211
  v_pk_mul_f32 v[144:145], v[144:145], v[148:149]
  v_pk_mul_f32 v[146:147], v[146:147], v[150:151]
  v_pk_mul_f32 v[208:209], v[208:209], v[212:213]
  v_pk_mul_f32 v[210:211], v[210:211], v[214:215]
  v_cvt_pk_bf16_f32 v212, v144, v145
  v_cvt_pk_bf16_f32 v213, v146, v147
  v_cvt_pk_bf16_f32 v214, v208, v209
  v_cvt_pk_bf16_f32 v215, v210, v211
  buffer_store_dwordx4 v[212:215], v18, s[48:51], s6 offen offset:0 sc1
  v_pk_mul_f32 v[152:153], v[152:153], s[96:97]
  v_pk_mul_f32 v[154:155], v[154:155], s[96:97]
  v_pk_mul_f32 v[216:217], v[216:217], s[96:97]
  v_pk_mul_f32 v[218:219], v[218:219], s[96:97]
  v_exp_f32 v152, v152
  v_exp_f32 v153, v153
  v_exp_f32 v154, v154
  v_exp_f32 v155, v155
  v_exp_f32 v216, v216
  v_exp_f32 v217, v217
  v_exp_f32 v218, v218
  v_exp_f32 v219, v219
  v_pk_add_f32 v[152:153], v[152:153], 1.0 op_sel_hi:[1,0]
  v_pk_add_f32 v[154:155], v[154:155], 1.0 op_sel_hi:[1,0]
  v_pk_add_f32 v[216:217], v[216:217], 1.0 op_sel_hi:[1,0]
  v_pk_add_f32 v[218:219], v[218:219], 1.0 op_sel_hi:[1,0]
  v_rcp_f32 v152, v152
  v_rcp_f32 v153, v153
  v_rcp_f32 v154, v154
  v_rcp_f32 v155, v155
  v_rcp_f32 v216, v216
  v_rcp_f32 v217, v217
  v_rcp_f32 v218, v218
  v_rcp_f32 v219, v219
  v_pk_mul_f32 v[152:153], v[152:153], v[156:157]
  v_pk_mul_f32 v[154:155], v[154:155], v[158:159]
  v_pk_mul_f32 v[216:217], v[216:217], v[220:221]
  v_pk_mul_f32 v[218:219], v[218:219], v[222:223]
  v_cvt_pk_bf16_f32 v220, v152, v153
  v_cvt_pk_bf16_f32 v221, v154, v155
  v_cvt_pk_bf16_f32 v222, v216, v217
  v_cvt_pk_bf16_f32 v223, v218, v219
  buffer_store_dwordx4 v[220:223], v18, s[48:51], s6 offen offset:1024 sc1
  s_add_u32 s6, s6, 376832
  v_pk_mul_f32 v[168:169], v[168:169], s[96:97]
  v_pk_mul_f32 v[160:161], v[160:161], s[96:97]
  v_pk_mul_f32 v[170:171], v[170:171], s[96:97]
  v_pk_mul_f32 v[162:163], v[162:163], s[96:97]
  v_pk_mul_f32 v[232:233], v[232:233], s[96:97]
  v_pk_mul_f32 v[224:225], v[224:225], s[96:97]
  v_pk_mul_f32 v[234:235], v[234:235], s[96:97]
  v_pk_mul_f32 v[226:227], v[226:227], s[96:97]
  v_exp_f32 v168, v168
  v_exp_f32 v160, v160
  v_exp_f32 v169, v169
  v_exp_f32 v161, v161
  v_exp_f32 v170, v170
  v_exp_f32 v162, v162
  v_exp_f32 v171, v171
  v_exp_f32 v163, v163
  v_exp_f32 v232, v232
  v_exp_f32 v224, v224
  v_exp_f32 v233, v233
  v_exp_f32 v225, v225
  v_exp_f32 v234, v234
  v_exp_f32 v226, v226
  v_exp_f32 v235, v235
  v_exp_f32 v227, v227
  v_pk_add_f32 v[168:169], v[168:169], 1.0 op_sel_hi:[1,0]
  v_pk_add_f32 v[160:161], v[160:161], 1.0 op_sel_hi:[1,0]
  v_pk_add_f32 v[170:171], v[170:171], 1.0 op_sel_hi:[1,0]
  v_pk_add_f32 v[162:163], v[162:163], 1.0 op_sel_hi:[1,0]
  v_pk_add_f32 v[232:233], v[232:233], 1.0 op_sel_hi:[1,0]
  v_pk_add_f32 v[224:225], v[224:225], 1.0 op_sel_hi:[1,0]
  v_pk_add_f32 v[234:235], v[234:235], 1.0 op_sel_hi:[1,0]
  v_pk_add_f32 v[226:227], v[226:227], 1.0 op_sel_hi:[1,0]
  v_rcp_f32 v168, v168
  v_rcp_f32 v160, v160
  v_rcp_f32 v169, v169
  v_rcp_f32 v161, v161
  v_rcp_f32 v170, v170
  v_rcp_f32 v162, v162
  v_rcp_f32 v171, v171
  v_rcp_f32 v163, v163
  v_rcp_f32 v232, v232
  v_rcp_f32 v224, v224
  v_rcp_f32 v233, v233
  v_rcp_f32 v225, v225
  v_rcp_f32 v234, v234
  v_rcp_f32 v226, v226
  v_rcp_f32 v235, v235
  v_rcp_f32 v227, v227
  v_pk_mul_f32 v[168:169], v[168:169], v[172:173]
  v_pk_mul_f32 v[160:161], v[160:161], v[164:165]
  v_pk_mul_f32 v[170:171], v[170:171], v[174:175]
  v_pk_mul_f32 v[162:163], v[162:163], v[166:167]
  v_pk_mul_f32 v[232:233], v[232:233], v[236:237]
  v_pk_mul_f32 v[224:225], v[224:225], v[228:229]
  v_pk_mul_f32 v[234:235], v[234:235], v[238:239]
  v_pk_mul_f32 v[226:227], v[226:227], v[230:231]
  v_cvt_pk_bf16_f32 v236, v168, v169
  v_cvt_pk_bf16_f32 v228, v160, v161
  v_cvt_pk_bf16_f32 v237, v170, v171
  v_cvt_pk_bf16_f32 v229, v162, v163
  v_cvt_pk_bf16_f32 v238, v232, v233
  v_cvt_pk_bf16_f32 v230, v224, v225
  v_cvt_pk_bf16_f32 v239, v234, v235
  v_cvt_pk_bf16_f32 v231, v226, v227
  buffer_store_dwordx4 v[236:239], v18, s[48:51], s6 offen offset:1024 sc1
  buffer_store_dwordx4 v[228:231], v18, s[48:51], s6 offen offset:0 sc1
  s_add_u32 s6, s6, 376832
  v_pk_mul_f32 v[184:185], v[184:185], s[96:97]
  v_pk_mul_f32 v[176:177], v[176:177], s[96:97]
  v_pk_mul_f32 v[186:187], v[186:187], s[96:97]
  v_pk_mul_f32 v[178:179], v[178:179], s[96:97]
  v_pk_mul_f32 v[248:249], v[248:249], s[96:97]
  v_pk_mul_f32 v[240:241], v[240:241], s[96:97]
  v_pk_mul_f32 v[250:251], v[250:251], s[96:97]
  v_pk_mul_f32 v[242:243], v[242:243], s[96:97]
  v_exp_f32 v184, v184
  v_exp_f32 v176, v176
  v_exp_f32 v185, v185
  v_exp_f32 v177, v177
  v_exp_f32 v186, v186
  v_exp_f32 v178, v178
  v_exp_f32 v187, v187
  v_exp_f32 v179, v179
  v_exp_f32 v248, v248
  v_exp_f32 v240, v240
  v_exp_f32 v249, v249
  v_exp_f32 v241, v241
  v_exp_f32 v250, v250
  v_exp_f32 v242, v242
  v_exp_f32 v251, v251
  v_exp_f32 v243, v243
  v_pk_add_f32 v[184:185], v[184:185], 1.0 op_sel_hi:[1,0]
  v_pk_add_f32 v[176:177], v[176:177], 1.0 op_sel_hi:[1,0]
  v_pk_add_f32 v[186:187], v[186:187], 1.0 op_sel_hi:[1,0]
  v_pk_add_f32 v[178:179], v[178:179], 1.0 op_sel_hi:[1,0]
  v_pk_add_f32 v[248:249], v[248:249], 1.0 op_sel_hi:[1,0]
  v_pk_add_f32 v[240:241], v[240:241], 1.0 op_sel_hi:[1,0]
  v_pk_add_f32 v[250:251], v[250:251], 1.0 op_sel_hi:[1,0]
  v_pk_add_f32 v[242:243], v[242:243], 1.0 op_sel_hi:[1,0]
  v_rcp_f32 v184, v184
  v_rcp_f32 v176, v176
  v_rcp_f32 v185, v185
  v_rcp_f32 v177, v177
  v_rcp_f32 v186, v186
  v_rcp_f32 v178, v178
  v_rcp_f32 v187, v187
  v_rcp_f32 v179, v179
  v_rcp_f32 v248, v248
  v_rcp_f32 v240, v240
  v_rcp_f32 v249, v249
  v_rcp_f32 v241, v241
  v_rcp_f32 v250, v250
  v_rcp_f32 v242, v242
  v_rcp_f32 v251, v251
  v_rcp_f32 v243, v243
  v_pk_mul_f32 v[184:185], v[184:185], v[188:189]
  v_pk_mul_f32 v[176:177], v[176:177], v[180:181]
  v_pk_mul_f32 v[186:187], v[186:187], v[190:191]
  v_pk_mul_f32 v[178:179], v[178:179], v[182:183]
  v_pk_mul_f32 v[248:249], v[248:249], v[252:253]
  v_pk_mul_f32 v[240:241], v[240:241], v[244:245]
  v_pk_mul_f32 v[250:251], v[250:251], v[254:255]
  v_pk_mul_f32 v[242:243], v[242:243], v[246:247]
  v_cvt_pk_bf16_f32 v252, v184, v185
  v_cvt_pk_bf16_f32 v244, v176, v177
  v_cvt_pk_bf16_f32 v253, v186, v187
  v_cvt_pk_bf16_f32 v245, v178, v179
  v_cvt_pk_bf16_f32 v254, v248, v249
  v_cvt_pk_bf16_f32 v246, v240, v241
  v_cvt_pk_bf16_f32 v255, v250, v251
  v_cvt_pk_bf16_f32 v247, v242, v243
  buffer_store_dwordx4 v[252:255], v18, s[48:51], s6 offen offset:1024 sc1
  buffer_store_dwordx4 v[244:247], v18, s[48:51], s6 offen offset:0 sc1
  s_add_u32 s6, s6, 376832
  v_mfma_f32_32x32x16_bf16 a[128:143], v[44:47], v[44:47], 0
  s_xor_b32 s81, s81, 0x18000
  v_max3_f32 v36, v64, v65, v66
  v_max3_f32 v38, v72, v73, v74
  v_max3_f32 v40, v96, v97, v98
  v_max3_f32 v42, v104, v105, v106
  v_max3_f32 v36, v36, v67, v68
  v_max3_f32 v38, v38, v75, v76
  v_mfma_f32_32x32x16_bf16 a[144:159], v[44:47], v[44:47], 0
  s_xor_b32 m0, m0, s81
  v_max3_f32 v40, v40, v99, v100
  v_max3_f32 v42, v42, v107, v108
  v_max3_f32 v36, v36, v69, v70
  v_max3_f32 v38, v38, v77, v78
  v_max3_f32 v40, v40, v101, v102
  v_max3_f32 v42, v42, v109, v110
  v_mfma_f32_32x32x16_bf16 a[160:175], v[44:47], v[44:47], 0
  s_xor_b32 m0, m0, 0x4000
  v_max_f32 v36, v36, v71
  v_max_f32 v38, v38, v79
  v_max_f32 v40, v40, v103
  v_max_f32 v42, v42, v111
  v_mov_b32 v37, v36
  v_mov_b32 v39, v38
  v_mfma_f32_32x32x16_bf16 a[176:191], v[44:47], v[44:47], 0
  v_mov_b32 v41, v40
  v_mov_b32 v43, v42
  v_permlane32_swap_b32 v36, v37
  v_permlane32_swap_b32 v38, v39
  v_permlane32_swap_b32 v40, v41
  v_permlane32_swap_b32 v42, v43
  v_mfma_f32_32x32x16_bf16 a[192:207], v[44:47], v[44:47], 0
  v_max_f32 v36, v36, v37
  v_max_f32 v38, v38, v39
  v_max_f32 v40, v40, v41
  v_max_f32 v42, v42, v43
  v_mov_b32 v37, v36
  v_mov_b32 v39, v38
  v_mov_b32 v41, v40
  v_mov_b32 v43, v42
  v_permlane16_swap_b32 v36, v37
  v_permlane16_swap_b32 v38, v39
  v_permlane16_swap_b32 v40, v41
  v_permlane16_swap_b32 v42, v43
  v_max_f32 v36, v36, v37
  v_max_f32 v38, v38, v39
  v_max_f32 v40, v40, v41
  v_max_f32 v42, v42, v43
  v_mov_b32 v37, v36
  v_mov_b32 v39, v38
  v_mov_b32 v41, v40
  v_mov_b32 v43, v42
  v_mov_b32 v232, v27
  v_mov_b32 v233, v27
  v_mov_b32 v234, v27
  v_mov_b32 v235, v27
  buffer_load_dwordx4 v19, s[60:63], 0 offen offset:0 sc1 lds
  v_pk_add_f32 v[128:129], v[128:129], v[36:37] neg_lo:[0,1] neg_hi:[0,1]
  v_pk_add_f32 v[130:131], v[130:131], v[36:37] neg_lo:[0,1] neg_hi:[0,1]
  v_pk_add_f32 v[132:133], v[132:133], v[36:37] neg_lo:[0,1] neg_hi:[0,1]
  v_pk_add_f32 v[134:135], v[134:135], v[36:37] neg_lo:[0,1] neg_hi:[0,1]
  v_pk_add_f32 v[144:145], 0, v[40:41] neg_lo:[0,1] neg_hi:[0,1]
  v_pk_add_f32 v[146:147], 0, v[40:41] neg_lo:[0,1] neg_hi:[0,1]
  v_pk_add_f32 v[148:149], 0, v[40:41] neg_lo:[0,1] neg_hi:[0,1]
  v_pk_add_f32 v[150:151], 0, v[40:41] neg_lo:[0,1] neg_hi:[0,1]
  v_pk_add_f32 v[64:65], v[64:65], v[36:37] neg_lo:[0,1] neg_hi:[0,1]
  v_pk_add_f32 v[66:67], v[66:67], v[36:37] neg_lo:[0,1] neg_hi:[0,1]
  v_pk_add_f32 v[68:69], v[68:69], v[36:37] neg_lo:[0,1] neg_hi:[0,1]
  v_pk_add_f32 v[70:71], v[70:71], v[36:37] neg_lo:[0,1] neg_hi:[0,1]
  v_pk_add_f32 v[96:97], v[96:97], v[40:41] neg_lo:[0,1] neg_hi:[0,1]
  v_pk_add_f32 v[98:99], v[98:99], v[40:41] neg_lo:[0,1] neg_hi:[0,1]
  v_pk_add_f32 v[100:101], v[100:101], v[40:41] neg_lo:[0,1] neg_hi:[0,1]
  v_pk_add_f32 v[102:103], v[102:103], v[40:41] neg_lo:[0,1] neg_hi:[0,1]
  buffer_load_dwordx4 v19, s[60:63], 0 offen offset:1024 sc1 lds
  v_pk_add_f32 v[136:137], 0, v[38:39] neg_lo:[0,1] neg_hi:[0,1]
  v_pk_add_f32 v[138:139], 0, v[38:39] neg_lo:[0,1] neg_hi:[0,1]
  v_pk_add_f32 v[140:141], 0, v[38:39] neg_lo:[0,1] neg_hi:[0,1]
  v_pk_add_f32 v[142:143], 0, v[38:39] neg_lo:[0,1] neg_hi:[0,1]
  v_pk_add_f32 v[152:153], 0, v[42:43] neg_lo:[0,1] neg_hi:[0,1]
  v_pk_add_f32 v[154:155], 0, v[42:43] neg_lo:[0,1] neg_hi:[0,1]
  v_pk_add_f32 v[156:157], 0, v[42:43] neg_lo:[0,1] neg_hi:[0,1]
  v_pk_add_f32 v[158:159], 0, v[42:43] neg_lo:[0,1] neg_hi:[0,1]
  v_pk_add_f32 v[72:73], v[72:73], v[38:39] neg_lo:[0,1] neg_hi:[0,1]
  v_pk_add_f32 v[74:75], v[74:75], v[38:39] neg_lo:[0,1] neg_hi:[0,1]
  v_pk_add_f32 v[76:77], v[76:77], v[38:39] neg_lo:[0,1] neg_hi:[0,1]
  v_pk_add_f32 v[78:79], v[78:79], v[38:39] neg_lo:[0,1] neg_hi:[0,1]
  v_pk_add_f32 v[104:105], v[104:105], v[42:43] neg_lo:[0,1] neg_hi:[0,1]
  v_pk_add_f32 v[106:107], v[106:107], v[42:43] neg_lo:[0,1] neg_hi:[0,1]
  v_pk_add_f32 v[108:109], v[108:109], v[42:43] neg_lo:[0,1] neg_hi:[0,1]
  v_pk_add_f32 v[110:111], v[110:111], v[42:43] neg_lo:[0,1] neg_hi:[0,1]
  s_cmp_eq_u32 s79, 0
  s_cbranch_scc1 L_pf1g
L_pf1g_r:
  s_waitcnt lgkmcnt(0)
  v_mfma_f32_16x16x32_bf16 v[80:83], a[64:67], a[0:3], v[128:131]
  v_exp_f32 v192, v64
  v_mfma_f32_16x16x32_bf16 v[80:83], a[72:75], a[8:11], v[80:83]
  buffer_load_dwordx4 v19, s[60:63], 0 offen offset:2048 sc1 lds
  v_exp_f32 v193, v65
  v_mfma_f32_16x16x32_bf16 v[80:83], a[80:83], a[16:19], v[80:83]
  v_exp_f32 v194, v66
  v_mfma_f32_16x16x32_bf16 v[80:83], a[88:91], a[24:27], v[80:83]
  v_cvt_pk_bf16_f32 v160, v192, v193
  v_exp_f32 v195, v67
  v_mfma_f32_16x16x32_bf16 v[88:91], a[88:91], a[28:31], v[136:139]
  buffer_load_dwordx4 v19, s[60:63], 0 offen offset:3072 sc1 lds
  v_exp_f32 v196, v68
  v_mfma_f32_16x16x32_bf16 v[88:91], a[80:83], a[20:23], v[88:91]
  s_xor_b32 m0, m0, 0x4000
  v_cvt_pk_bf16_f32 v161, v194, v195
  v_add_u32 v19, 0x4000, v19
  v_mfma_f32_16x16x32_bf16 v[88:91], a[72:75], a[12:15], v[88:91]
  s_add_u32 s82, s82, 16384
  v_exp_f32 v197, v69
  v_mfma_f32_16x16x32_bf16 v[88:91], a[64:67], a[4:7], v[88:91]
  v_exp_f32 v198, v70
  v_mfma_f32_16x16x32_bf16 v[112:115], a[64:67], a[32:35], v[144:147]
  buffer_load_dwordx4 v19, s[56:59], 0 offen offset:0 sc1 lds
  v_exp_f32 v199, v71
  v_mfma_f32_16x16x32_bf16 v[112:115], a[72:75], a[40:43], v[112:115]
  v_cvt_pk_bf16_f32 v162, v196, v197
  v_cvt_pk_bf16_f32 v163, v198, v199
  v_mfma_f32_16x16x32_bf16 v[112:115], a[80:83], a[48:51], v[112:115]
  v_exp_f32 v192, v72
  v_mfma_f32_16x16x32_bf16 v[200:203], v[232:235], v[160:163], 0
  buffer_load_dwordx4 v19, s[56:59], 0 offen offset:1024 sc1 lds
  v_exp_f32 v193, v73
  v_mfma_f32_16x16x32_bf16 v[112:115], a[88:91], a[56:59], v[112:115]
  v_exp_f32 v194, v74
  v_mfma_f32_16x16x32_bf16 v[120:123], a[88:91], a[60:63], v[152:155]
  v_cvt_pk_bf16_f32 v164, v192, v193
  v_exp_f32 v195, v75
  v_mfma_f32_16x16x32_bf16 v[120:123], a[80:83], a[52:55], v[120:123]
  v_exp_f32 v196, v76
  v_mfma_f32_16x16x32_bf16 v[120:123], a[72:75], a[44:47], v[120:123]
  buffer_load_dwordx4 v19, s[56:59], 0 offen offset:2048 sc1 lds
  v_cvt_pk_bf16_f32 v165, v194, v195
  v_mfma_f32_16x16x32_bf16 v[120:123], a[64:67], a[36:39], v[120:123]
  v_exp_f32 v197, v77
  v_mfma_f32_16x16x32_bf16 v[124:127], a[68:71], a[36:39], v[156:159]
  v_exp_f32 v198, v78
  v_mfma_f32_16x16x32_bf16 v[124:127], a[76:79], a[44:47], v[124:127]
  v_exp_f32 v199, v79
  v_mfma_f32_16x16x32_bf16 v[124:127], a[84:87], a[52:55], v[124:127]
  buffer_load_dwordx4 v19, s[56:59], 0 offen offset:3072 sc1 lds
  v_cvt_pk_bf16_f32 v166, v196, v197
  v_cvt_pk_bf16_f32 v167, v198, v199
  v_mfma_f32_16x16x32_bf16 v[124:127], a[92:95], a[60:63], v[124:127]
  s_xor_b32 s81, s81, 0x18000
  s_xor_b32 m0, m0, s81
  v_exp_f32 v192, v96
  v_mfma_f32_16x16x32_bf16 v[208:211], v[232:235], v[164:167], 0
  s_xor_b32 m0, m0, 0x4000
  v_exp_f32 v193, v97
  v_mfma_f32_16x16x32_bf16 v[116:119], a[92:95], a[56:59], v[148:151]
  buffer_load_dwordx4 v19, s[60:63], 0 offen offset:0 sc1 lds
  ds_read_b128 a[64:67], v18 offset:0
  v_mfma_f32_16x16x32_bf16 v[116:119], a[84:87], a[48:51], v[116:119]
  v_exp_f32 v194, v98
  v_mfma_f32_16x16x32_bf16 v[116:119], a[76:79], a[40:43], v[116:119]
  v_cvt_pk_bf16_f32 v176, v192, v193
  v_exp_f32 v195, v99
  v_mfma_f32_16x16x32_bf16 v[116:119], a[68:71], a[32:35], v[116:119]
  v_exp_f32 v196, v100
  v_mfma_f32_16x16x32_bf16 v[92:95], a[68:71], a[4:7], v[140:143]
  buffer_load_dwordx4 v19, s[60:63], 0 offen offset:1024 sc1 lds
  v_cvt_pk_bf16_f32 v177, v194, v195
  v_exp_f32 v197, v101
  v_mfma_f32_16x16x32_bf16 v[92:95], a[76:79], a[12:15], v[92:95]
  v_exp_f32 v198, v102
  v_mfma_f32_16x16x32_bf16 v[92:95], a[84:87], a[20:23], v[92:95]
  v_exp_f32 v199, v103
  v_mfma_f32_16x16x32_bf16 v[92:95], a[92:95], a[28:31], v[92:95]
  buffer_load_dwordx4 v19, s[60:63], 0 offen offset:2048 sc1 lds
  v_cvt_pk_bf16_f32 v178, v196, v197
  v_cvt_pk_bf16_f32 v179, v198, v199
  v_mfma_f32_16x16x32_bf16 v[84:87], a[92:95], a[24:27], v[132:135]
  ds_read_b128 a[72:75], v18 offset:2048
  ds_read_b128 a[80:83], v18 offset:4096
  v_mfma_f32_16x16x32_bf16 v[216:219], v[232:235], v[176:179], 0
  v_exp_f32 v192, v104
  v_mfma_f32_16x16x32_bf16 v[84:87], a[84:87], a[16:19], v[84:87]
  v_exp_f32 v193, v105
  v_mfma_f32_16x16x32_bf16 v[84:87], a[76:79], a[8:11], v[84:87]
  buffer_load_dwordx4 v19, s[60:63], 0 offen offset:3072 sc1 lds
  ds_read_b128 a[88:91], v18 offset:6144
  v_mfma_f32_16x16x32_bf16 v[84:87], a[68:71], a[0:3], v[84:87]
  ds_read_b128 a[68:71], v18 offset:1024
  v_mfma_f32_32x32x16_bf16 a[208:223], v[44:47], v[44:47], 0
  ds_read_b128 a[76:79], v18 offset:3072
  v_exp_f32 v194, v106
  v_cvt_pk_bf16_f32 v180, v192, v193
  v_exp_f32 v195, v107
  v_mfma_f32_32x32x16_bf16 a[224:239], v[44:47], v[44:47], 0
  ds_read_b128 a[84:87], v18 offset:5120
  v_exp_f32 v196, v108
  v_cvt_pk_bf16_f32 v181, v194, v195
  v_exp_f32 v197, v109
  v_mfma_f32_32x32x16_bf16 a[240:255], v[44:47], v[44:47], 0
  v_exp_f32 v198, v110
  v_exp_f32 v199, v111
  v_cvt_pk_bf16_f32 v182, v196, v197
  v_cvt_pk_bf16_f32 v183, v198, v199
  s_nop 1
  v_mfma_f32_16x16x32_bf16 v[224:227], v[232:235], v[180:183], 0
  ds_read_b128 a[92:95], v18 offset:7168
  s_waitcnt lgkmcnt(4)
L_p2_done:
  s_cmp_eq_u32 s79, 0
  s_cbranch_scc1 L_T0
  s_cmp_eq_u32 s34, 0
  s_cselect_b32 s88, 65536, s78
  s_branch L_D
.fill 329, 4, 0xbf800000
L_pg9:
  s_cbranch_execz L_walk1
L_D:
  v_mfma_f32_16x16x32_bf16 v[64:67], a[64:67], a[0:3], v[128:131]
  s_xor_b32 m0, m0, 0x4000
  ds_read_b128 a[124:127], v18 offset:23552
  v_add_u32 v19, 0x4000, v19
  v_mfma_f32_16x16x32_bf16 v[64:67], a[72:75], a[8:11], v[64:67]
  s_add_u32 s82, s82, 16384
  v_exp_f32 v192, v80
  v_mfma_f32_16x16x32_bf16 v[64:67], a[80:83], a[16:19], v[64:67]
  v_exp_f32 v193, v81
  v_mfma_f32_16x16x32_bf16 v[64:67], a[88:91], a[24:27], v[64:67]
  v_exp_f32 v194, v82
  v_mfma_f32_16x16x32_bf16 v[72:75], a[88:91], a[28:31], v[136:139]
  v_cvt_pk_bf16_f32 v168, v192, v193
  v_mfma_f32_16x16x32_bf16 v[72:75], a[80:83], a[20:23], v[72:75]
  v_exp_f32 v195, v83
  v_mfma_f32_16x16x32_bf16 v[72:75], a[72:75], a[12:15], v[72:75]
  s_waitcnt lgkmcnt(1)
  v_exp_f32 v196, v84
  v_mfma_f32_16x16x32_bf16 v[72:75], a[64:67], a[4:7], v[72:75]
  v_cvt_pk_bf16_f32 v169, v194, v195
  v_mfma_f32_16x16x32_bf16 v[96:99], a[64:67], a[32:35], v[144:147]
  s_cmp_eq_u32 s82, s88
  v_exp_f32 v197, v85
  v_mfma_f32_16x16x32_bf16 v[96:99], a[72:75], a[40:43], v[96:99]
  s_cselect_b32 s89, -1.0, s85
  v_exp_f32 v198, v86
  v_mfma_f32_16x16x32_bf16 v[96:99], a[80:83], a[48:51], v[96:99]
  v_exp_f32 v199, v87
  v_mfma_f32_16x16x32_bf16 v[96:99], a[88:91], a[56:59], v[96:99]
  v_cvt_pk_bf16_f32 v170, v196, v197
  v_mfma_f32_16x16x32_bf16 v[104:107], a[88:91], a[60:63], v[152:155]
  ds_read_b128 a[88:91], v18 offset:14336
  v_mfma_f32_16x16x32_bf16 v[104:107], a[80:83], a[52:55], v[104:107]
  ds_read_b128 a[80:83], v18 offset:12288
  v_mfma_f32_16x16x32_bf16 v[104:107], a[72:75], a[44:47], v[104:107]
  ds_read_b128 a[72:75], v18 offset:10240
  v_mfma_f32_16x16x32_bf16 v[104:107], a[64:67], a[36:39], v[104:107]
  ds_read_b128 a[64:67], v18 offset:8192
  v_cvt_pk_bf16_f32 v171, v198, v199
  v_mfma_f32_16x16x32_bf16 v[108:111], a[68:71], a[36:39], v[156:159]
  v_exp_f32 v192, v88
  v_mfma_f32_16x16x32_bf16 v[204:207], v[232:235], v[168:171], v[200:203]
  v_exp_f32 v193, v89
  v_mfma_f32_16x16x32_bf16 v[108:111], a[76:79], a[44:47], v[108:111]
  v_exp_f32 v194, v90
  v_mfma_f32_16x16x32_bf16 v[108:111], a[84:87], a[52:55], v[108:111]
  v_cvt_pk_bf16_f32 v172, v192, v193
  v_mfma_f32_16x16x32_bf16 v[108:111], a[92:95], a[60:63], v[108:111]
  v_exp_f32 v195, v91
  v_mfma_f32_16x16x32_bf16 v[100:103], a[92:95], a[56:59], v[148:151]
  v_exp_f32 v196, v92
  v_mfma_f32_16x16x32_bf16 v[100:103], a[84:87], a[48:51], v[100:103]
  v_cvt_pk_bf16_f32 v173, v194, v195
  v_mfma_f32_16x16x32_bf16 v[100:103], a[76:79], a[40:43], v[100:103]
  v_exp_f32 v197, v93
  v_mfma_f32_16x16x32_bf16 v[100:103], a[68:71], a[32:35], v[100:103]
  v_exp_f32 v198, v94
  v_mfma_f32_16x16x32_bf16 v[76:79], a[68:71], a[4:7], v[140:143]
  v_exp_f32 v199, v95
  v_mfma_f32_16x16x32_bf16 v[76:79], a[76:79], a[12:15], v[76:79]
  buffer_load_dwordx4 v19, s[56:59], 0 offen offset:0 sc1 lds
  v_mfma_f32_16x16x32_bf16 v[76:79], a[84:87], a[20:23], v[76:79]
  v_cvt_pk_bf16_f32 v174, v196, v197
  v_mfma_f32_16x16x32_bf16 v[76:79], a[92:95], a[28:31], v[76:79]
  v_cvt_pk_bf16_f32 v175, v198, v199
  v_mfma_f32_16x16x32_bf16 v[68:71], a[92:95], a[24:27], v[132:135]
  ds_read_b128 a[92:95], v18 offset:15360
  v_mfma_f32_16x16x32_bf16 v[68:71], a[84:87], a[16:19], v[68:71]
  ds_read_b128 a[84:87], v18 offset:13312
  v_mfma_f32_16x16x32_bf16 v[68:71], a[76:79], a[8:11], v[68:71]
  ds_read_b128 a[76:79], v18 offset:11264
  v_mfma_f32_16x16x32_bf16 v[212:215], v[232:235], v[172:175], v[208:211]
  v_exp_f32 v192, v112
  v_mfma_f32_16x16x32_bf16 v[68:71], a[68:71], a[0:3], v[68:71]
  ds_read_b128 a[68:71], v18 offset:9216
  v_mfma_f32_16x16x32_bf16 a[128:131], a[96:99], v[160:163], a[128:131]
  v_exp_f32 v193, v113
  v_mfma_f32_16x16x32_bf16 a[160:163], a[96:99], v[164:167], a[160:163]
  v_exp_f32 v194, v114
  v_mfma_f32_16x16x32_bf16 a[192:195], a[96:99], v[176:179], a[192:195]
  v_cvt_pk_bf16_f32 v184, v192, v193
  v_mfma_f32_16x16x32_bf16 a[224:227], a[96:99], v[180:183], a[224:227]
  ds_read_b128 a[96:99], v18 offset:24576
  v_mfma_f32_16x16x32_bf16 a[228:231], a[100:103], v[180:183], a[228:231]
  buffer_load_dwordx4 v19, s[56:59], 0 offen offset:1024 sc1 lds
  v_mfma_f32_16x16x32_bf16 a[196:199], a[100:103], v[176:179], a[196:199]
  v_exp_f32 v195, v115
  v_mfma_f32_16x16x32_bf16 a[164:167], a[100:103], v[164:167], a[164:167]
  s_waitcnt lgkmcnt(1)
  v_exp_f32 v196, v116
  v_mfma_f32_16x16x32_bf16 a[132:135], a[100:103], v[160:163], a[132:135]
  ds_read_b128 a[100:103], v18 offset:25600
  v_cvt_pk_bf16_f32 v185, v194, v195
  v_mfma_f32_16x16x32_bf16 a[136:139], a[104:107], v[160:163], a[136:139]
  v_exp_f32 v197, v117
  v_mfma_f32_16x16x32_bf16 a[168:171], a[104:107], v[164:167], a[168:171]
  v_exp_f32 v198, v118
  v_mfma_f32_16x16x32_bf16 a[200:203], a[104:107], v[176:179], a[200:203]
  v_exp_f32 v199, v119
  v_mfma_f32_16x16x32_bf16 a[232:235], a[104:107], v[180:183], a[232:235]
  v_cvt_pk_bf16_f32 v186, v196, v197
  v_cvt_pk_bf16_f32 v187, v198, v199
  v_mfma_f32_16x16x32_bf16 a[236:239], a[108:111], v[180:183], a[236:239]
  ds_read_b128 a[104:107], v18 offset:26624
  v_mfma_f32_16x16x32_bf16 v[220:223], v[232:235], v[184:187], v[216:219]
  v_exp_f32 v192, v120
  v_mfma_f32_16x16x32_bf16 a[204:207], a[108:111], v[176:179], a[204:207]
  v_exp_f32 v193, v121
  v_mfma_f32_16x16x32_bf16 a[172:175], a[108:111], v[164:167], a[172:175]
  v_exp_f32 v194, v122
  v_mfma_f32_16x16x32_bf16 a[140:143], a[108:111], v[160:163], a[140:143]
  buffer_load_dwordx4 v19, s[56:59], 0 offen offset:2048 sc1 lds
  v_mfma_f32_16x16x32_bf16 a[144:147], a[112:115], v[160:163], a[144:147]
  ds_read_b128 a[108:111], v18 offset:27648
  v_cvt_pk_bf16_f32 v188, v192, v193
  v_mfma_f32_16x16x32_bf16 a[176:179], a[112:115], v[164:167], a[176:179]
  v_exp_f32 v195, v123
  v_mfma_f32_16x16x32_bf16 a[208:211], a[112:115], v[176:179], a[208:211]
  v_exp_f32 v196, v124
  v_mfma_f32_16x16x32_bf16 a[240:243], a[112:115], v[180:183], a[240:243]
  ds_read_b128 a[112:115], v18 offset:28672
  v_cvt_pk_bf16_f32 v189, v194, v195
  v_mfma_f32_16x16x32_bf16 a[244:247], a[116:119], v[180:183], a[244:247]
  v_exp_f32 v197, v125
  v_mfma_f32_16x16x32_bf16 a[212:215], a[116:119], v[176:179], a[212:215]
  v_exp_f32 v198, v126
  v_mfma_f32_16x16x32_bf16 a[180:183], a[116:119], v[164:167], a[180:183]
  v_exp_f32 v199, v127
  v_mfma_f32_16x16x32_bf16 a[148:151], a[116:119], v[160:163], a[148:151]
  ds_read_b128 a[116:119], v18 offset:29696
  v_mfma_f32_16x16x32_bf16 a[152:155], a[120:123], v[160:163], a[152:155]
  v_cvt_pk_bf16_f32 v190, v196, v197
  v_cvt_pk_bf16_f32 v191, v198, v199
  v_mfma_f32_16x16x32_bf16 a[184:187], a[120:123], v[164:167], a[184:187]
  s_nop 0
  v_mfma_f32_16x16x32_bf16 v[228:231], v[232:235], v[188:191], v[224:227]
  v_mfma_f32_16x16x32_bf16 a[216:219], a[120:123], v[176:179], a[216:219]
  buffer_load_dwordx4 v19, s[56:59], 0 offen offset:3072 sc1 lds
  v_mfma_f32_16x16x32_bf16 a[248:251], a[120:123], v[180:183], a[248:251]
  ds_read_b128 a[120:123], v18 offset:30720
  v_mfma_f32_16x16x32_bf16 a[252:255], a[124:127], v[180:183], a[252:255]
  v_max3_f32 v252, v204, v212, v220
  v_mfma_f32_16x16x32_bf16 a[220:223], a[124:127], v[176:179], a[220:223]
  s_waitcnt lgkmcnt(1)
  v_add_f32 v252, v252, v228
  v_cmp_nge_f32 vcc, s85, v252
  v_mfma_f32_16x16x32_bf16 a[188:191], a[124:127], v[164:167], a[188:191]
  v_mfma_f32_16x16x32_bf16 a[156:159], a[124:127], v[160:163], a[156:159]
  s_cbranch_vccnz L_DA_rare
L_DA_rarer:
  v_mfma_f32_16x16x32_bf16 v[80:83], a[64:67], a[0:3], v[128:131]
  ds_read_b128 a[124:127], v18 offset:31744
  v_xor_b32 v18, s81, v18
  v_mfma_f32_16x16x32_bf16 v[80:83], a[72:75], a[8:11], v[80:83]
  s_xor_b32 s81, s81, 0x18000
  v_exp_f32 v192, v64
  v_mfma_f32_16x16x32_bf16 v[80:83], a[80:83], a[16:19], v[80:83]
  s_xor_b32 m0, m0, s81
  v_exp_f32 v193, v65
  v_mfma_f32_16x16x32_bf16 v[80:83], a[88:91], a[24:27], v[80:83]
  s_xor_b32 m0, m0, 0x4000
  v_exp_f32 v194, v66
  v_mfma_f32_16x16x32_bf16 v[88:91], a[88:91], a[28:31], v[136:139]
  v_cvt_pk_bf16_f32 v160, v192, v193
  v_mfma_f32_16x16x32_bf16 v[88:91], a[80:83], a[20:23], v[88:91]
  v_exp_f32 v195, v67
  v_mfma_f32_16x16x32_bf16 v[88:91], a[72:75], a[12:15], v[88:91]
  s_waitcnt vmcnt(16) lgkmcnt(0)
  s_barrier
  v_mfma_f32_16x16x32_bf16 v[88:91], a[64:67], a[4:7], v[88:91]
  v_exp_f32 v196, v68
  v_mfma_f32_16x16x32_bf16 v[112:115], a[64:67], a[32:35], v[144:147]
  v_cvt_pk_bf16_f32 v161, v194, v195
  v_mfma_f32_16x16x32_bf16 v[112:115], a[72:75], a[40:43], v[112:115]
  v_exp_f32 v197, v69
  v_mfma_f32_16x16x32_bf16 v[112:115], a[80:83], a[48:51], v[112:115]
  v_exp_f32 v198, v70
  v_mfma_f32_16x16x32_bf16 v[112:115], a[88:91], a[56:59], v[112:115]
  v_exp_f32 v199, v71
  v_mfma_f32_16x16x32_bf16 v[120:123], a[88:91], a[60:63], v[152:155]
  ds_read_b128 a[88:91], v18 offset:6144
  v_mfma_f32_16x16x32_bf16 v[120:123], a[80:83], a[52:55], v[120:123]
  ds_read_b128 a[80:83], v18 offset:4096
  v_mfma_f32_16x16x32_bf16 v[120:123], a[72:75], a[44:47], v[120:123]
  ds_read_b128 a[72:75], v18 offset:2048
  v_cvt_pk_bf16_f32 v162, v196, v197
  v_mfma_f32_16x16x32_bf16 v[120:123], a[64:67], a[36:39], v[120:123]
  ds_read_b128 a[64:67], v18 offset:0
  v_cvt_pk_bf16_f32 v163, v198, v199
  v_mfma_f32_16x16x32_bf16 v[124:127], a[68:71], a[36:39], v[156:159]
  v_exp_f32 v192, v72
  v_mfma_f32_16x16x32_bf16 v[200:203], v[232:235], v[160:163], v[204:207]
  v_exp_f32 v193, v73
  v_mfma_f32_16x16x32_bf16 v[124:127], a[76:79], a[44:47], v[124:127]
  v_exp_f32 v194, v74
  v_mfma_f32_16x16x32_bf16 v[124:127], a[84:87], a[52:55], v[124:127]
  v_cvt_pk_bf16_f32 v164, v192, v193
  v_mfma_f32_16x16x32_bf16 v[124:127], a[92:95], a[60:63], v[124:127]
  v_exp_f32 v195, v75
  v_mfma_f32_16x16x32_bf16 v[116:119], a[92:95], a[56:59], v[148:151]
  v_exp_f32 v196, v76
  v_mfma_f32_16x16x32_bf16 v[116:119], a[84:87], a[48:51], v[116:119]
  v_cvt_pk_bf16_f32 v165, v194, v195
  v_mfma_f32_16x16x32_bf16 v[116:119], a[76:79], a[40:43], v[116:119]
  v_exp_f32 v197, v77
  v_mfma_f32_16x16x32_bf16 v[116:119], a[68:71], a[32:35], v[116:119]
  v_exp_f32 v198, v78
  v_mfma_f32_16x16x32_bf16 v[92:95], a[68:71], a[4:7], v[140:143]
  v_exp_f32 v199, v79
  v_mfma_f32_16x16x32_bf16 v[92:95], a[76:79], a[12:15], v[92:95]
  buffer_load_dwordx4 v19, s[60:63], 0 offen offset:0 sc1 lds
  v_mfma_f32_16x16x32_bf16 v[92:95], a[84:87], a[20:23], v[92:95]
  v_cvt_pk_bf16_f32 v166, v196, v197
  v_mfma_f32_16x16x32_bf16 v[92:95], a[92:95], a[28:31], v[92:95]
  v_cvt_pk_bf16_f32 v167, v198, v199
  v_mfma_f32_16x16x32_bf16 v[84:87], a[92:95], a[24:27], v[132:135]
  ds_read_b128 a[92:95], v18 offset:7168
  v_mfma_f32_16x16x32_bf16 v[84:87], a[84:87], a[16:19], v[84:87]
  ds_read_b128 a[84:87], v18 offset:5120
  v_mfma_f32_16x16x32_bf16 v[84:87], a[76:79], a[8:11], v[84:87]
  ds_read_b128 a[76:79], v18 offset:3072
  v_mfma_f32_16x16x32_bf16 v[208:211], v[232:235], v[164:167], v[212:215]
  v_exp_f32 v192, v96
  v_mfma_f32_16x16x32_bf16 v[84:87], a[68:71], a[0:3], v[84:87]
  ds_read_b128 a[68:71], v18 offset:1024
  v_mfma_f32_16x16x32_bf16 a[128:131], a[96:99], v[168:171], a[128:131]
  v_exp_f32 v193, v97
  v_mfma_f32_16x16x32_bf16 a[160:163], a[96:99], v[172:175], a[160:163]
  v_exp_f32 v194, v98
  v_mfma_f32_16x16x32_bf16 a[192:195], a[96:99], v[184:187], a[192:195]
  v_cvt_pk_bf16_f32 v176, v192, v193
  v_mfma_f32_16x16x32_bf16 a[224:227], a[96:99], v[188:191], a[224:227]
  ds_read_b128 a[96:99], v18 offset:16384
  v_mfma_f32_16x16x32_bf16 a[228:231], a[100:103], v[188:191], a[228:231]
  buffer_load_dwordx4 v19, s[60:63], 0 offen offset:1024 sc1 lds
  v_mfma_f32_16x16x32_bf16 a[196:199], a[100:103], v[184:187], a[196:199]
  v_exp_f32 v195, v99
  v_mfma_f32_16x16x32_bf16 a[164:167], a[100:103], v[172:175], a[164:167]
  s_waitcnt lgkmcnt(1)
  v_exp_f32 v196, v100
  v_mfma_f32_16x16x32_bf16 a[132:135], a[100:103], v[168:171], a[132:135]
  ds_read_b128 a[100:103], v18 offset:17408
  v_cvt_pk_bf16_f32 v177, v194, v195
  v_mfma_f32_16x16x32_bf16 a[136:139], a[104:107], v[168:171], a[136:139]
  v_exp_f32 v197, v101
  v_mfma_f32_16x16x32_bf16 a[168:171], a[104:107], v[172:175], a[168:171]
  v_exp_f32 v198, v102
  v_mfma_f32_16x16x32_bf16 a[200:203], a[104:107], v[184:187], a[200:203]
  v_exp_f32 v199, v103
  v_mfma_f32_16x16x32_bf16 a[232:235], a[104:107], v[188:191], a[232:235]
  v_cvt_pk_bf16_f32 v178, v196, v197
  v_cvt_pk_bf16_f32 v179, v198, v199
  v_mfma_f32_16x16x32_bf16 a[236:239], a[108:111], v[188:191], a[236:239]
  ds_read_b128 a[104:107], v18 offset:18432
  v_mfma_f32_16x16x32_bf16 v[216:219], v[232:235], v[176:179], v[220:223]
  v_exp_f32 v192, v104
  v_mfma_f32_16x16x32_bf16 a[204:207], a[108:111], v[184:187], a[204:207]
  v_exp_f32 v193, v105
  v_mfma_f32_16x16x32_bf16 a[172:175], a[108:111], v[172:175], a[172:175]
  v_exp_f32 v194, v106
  v_mfma_f32_16x16x32_bf16 a[140:143], a[108:111], v[168:171], a[140:143]
  buffer_load_dwordx4 v19, s[60:63], 0 offen offset:2048 sc1 lds
  v_mfma_f32_16x16x32_bf16 a[144:147], a[112:115], v[168:171], a[144:147]
  ds_read_b128 a[108:111], v18 offset:19456
  v_cvt_pk_bf16_f32 v180, v192, v193
  v_mfma_f32_16x16x32_bf16 a[176:179], a[112:115], v[172:175], a[176:179]
  v_exp_f32 v195, v107
  v_mfma_f32_16x16x32_bf16 a[208:211], a[112:115], v[184:187], a[208:211]
  v_exp_f32 v196, v108
  v_mfma_f32_16x16x32_bf16 a[240:243], a[112:115], v[188:191], a[240:243]
  ds_read_b128 a[112:115], v18 offset:20480
  v_cvt_pk_bf16_f32 v181, v194, v195
  v_mfma_f32_16x16x32_bf16 a[244:247], a[116:119], v[188:191], a[244:247]
  v_exp_f32 v197, v109
  v_mfma_f32_16x16x32_bf16 a[212:215], a[116:119], v[184:187], a[212:215]
  v_exp_f32 v198, v110
  v_mfma_f32_16x16x32_bf16 a[180:183], a[116:119], v[172:175], a[180:183]
  v_exp_f32 v199, v111
  v_mfma_f32_16x16x32_bf16 a[148:151], a[116:119], v[168:171], a[148:151]
  ds_read_b128 a[116:119], v18 offset:21504
  v_mfma_f32_16x16x32_bf16 a[152:155], a[120:123], v[168:171], a[152:155]
  v_cvt_pk_bf16_f32 v182, v196, v197
  v_cvt_pk_bf16_f32 v183, v198, v199
  v_mfma_f32_16x16x32_bf16 a[184:187], a[120:123], v[172:175], a[184:187]
  s_nop 0
  v_mfma_f32_16x16x32_bf16 v[224:227], v[232:235], v[180:183], v[228:231]
  v_mfma_f32_16x16x32_bf16 a[216:219], a[120:123], v[184:187], a[216:219]
  buffer_load_dwordx4 v19, s[60:63], 0 offen offset:3072 sc1 lds
  v_mfma_f32_16x16x32_bf16 a[248:251], a[120:123], v[188:191], a[248:251]
  ds_read_b128 a[120:123], v18 offset:22528
  v_mfma_f32_16x16x32_bf16 a[252:255], a[124:127], v[188:191], a[252:255]
  v_max3_f32 v252, v200, v208, v216
  v_mfma_f32_16x16x32_bf16 a[220:223], a[124:127], v[184:187], a[220:223]
  s_waitcnt lgkmcnt(1)
  v_add_f32 v252, v252, v224
  v_cmp_nge_f32 vcc, s89, v252
  v_mfma_f32_16x16x32_bf16 a[188:191], a[124:127], v[172:175], a[188:191]
  v_mfma_f32_16x16x32_bf16 a[156:159], a[124:127], v[168:171], a[156:159]
  s_cbranch_vccz L_D
  v_cmp_nge_f32 vcc, s85, v252
  s_cbranch_vccnz L_DB_rare
L_DB_rarer:
  s_cmp_lg_u32 s82, 65536
  s_cbranch_scc1 L_Dp
  s_cmp_lg_u32 s34, 0
  s_cbranch_scc1 L_sig_h1
  s_mov_b64 exec, 1
  v_mov_b32 v236, s101
  buffer_store_dword v236, off, s[48:51], s92 sc1
  s_mov_b64 exec, -1
L_sig_h1:
  s_mov_b32 s88, s78
  s_cmp_lg_u32 s79, 2
  s_cbranch_scc1 L_D
L_Dp:
  v_max_f32_e64 v248, s68, v29
  v_max_f32_e64 v249, s68, v30
  v_max_f32_e64 v250, s68, v31
  v_max_f32_e64 v251, s68, v14
  v_min_f32 v128, v128, v248
  v_min_f32 v129, v129, v249
  v_min_f32 v130, v130, v250
  v_min_f32 v131, v131, v251
  v_max_f32_e64 v248, s99, v29
  v_max_f32_e64 v249, s99, v30
  v_max_f32_e64 v250, s99, v31
  v_max_f32_e64 v251, s99, v14
  v_min3_f32 v132, v132, v248, s68
  v_min3_f32 v133, v133, v249, s68
  v_min3_f32 v134, v134, v250, s68
  v_min3_f32 v135, v135, v251, s68
  s_nop 1
  v_mfma_f32_16x16x32_bf16 v[64:67], a[64:67], a[0:3], v[128:131]
  s_xor_b32 m0, m0, 0x4000
  ds_read_b128 a[124:127], v18 offset:23552
  v_add_u32 v19, 0x4000, v19
  v_mfma_f32_16x16x32_bf16 v[64:67], a[72:75], a[8:11], v[64:67]
  s_add_u32 s82, s82, 16384
  v_exp_f32 v192, v80
  v_mfma_f32_16x16x32_bf16 v[64:67], a[80:83], a[16:19], v[64:67]
  v_exp_f32 v193, v81
  v_mfma_f32_16x16x32_bf16 v[64:67], a[88:91], a[24:27], v[64:67]
  v_exp_f32 v194, v82
  v_mfma_f32_16x16x32_bf16 v[72:75], a[88:91], a[28:31], v[136:139]
  v_cvt_pk_bf16_f32 v168, v192, v193
  v_mfma_f32_16x16x32_bf16 v[72:75], a[80:83], a[20:23], v[72:75]
  v_exp_f32 v195, v83
  v_mfma_f32_16x16x32_bf16 v[72:75], a[72:75], a[12:15], v[72:75]
  s_waitcnt lgkmcnt(1)
  v_exp_f32 v196, v84
  v_mfma_f32_16x16x32_bf16 v[72:75], a[64:67], a[4:7], v[72:75]
  v_cvt_pk_bf16_f32 v169, v194, v195
  v_mfma_f32_16x16x32_bf16 v[96:99], a[64:67], a[32:35], v[144:147]
  v_exp_f32 v197, v85
  v_mfma_f32_16x16x32_bf16 v[96:99], a[72:75], a[40:43], v[96:99]
  v_exp_f32 v198, v86
  v_mfma_f32_16x16x32_bf16 v[96:99], a[80:83], a[48:51], v[96:99]
  v_exp_f32 v199, v87
  v_mfma_f32_16x16x32_bf16 v[96:99], a[88:91], a[56:59], v[96:99]
  v_cvt_pk_bf16_f32 v170, v196, v197
  v_mfma_f32_16x16x32_bf16 v[104:107], a[88:91], a[60:63], v[152:155]
  ds_read_b128 a[88:91], v18 offset:14336
  v_mfma_f32_16x16x32_bf16 v[104:107], a[80:83], a[52:55], v[104:107]
  ds_read_b128 a[80:83], v18 offset:12288
  v_mfma_f32_16x16x32_bf16 v[104:107], a[72:75], a[44:47], v[104:107]
  ds_read_b128 a[72:75], v18 offset:10240
  v_mfma_f32_16x16x32_bf16 v[104:107], a[64:67], a[36:39], v[104:107]
  ds_read_b128 a[64:67], v18 offset:8192
  v_cvt_pk_bf16_f32 v171, v198, v199
  v_mfma_f32_16x16x32_bf16 v[108:111], a[68:71], a[36:39], v[156:159]
  v_exp_f32 v192, v88
  v_mfma_f32_16x16x32_bf16 v[204:207], v[232:235], v[168:171], v[200:203]
  v_exp_f32 v193, v89
  v_mfma_f32_16x16x32_bf16 v[108:111], a[76:79], a[44:47], v[108:111]
  v_exp_f32 v194, v90
  v_mfma_f32_16x16x32_bf16 v[108:111], a[84:87], a[52:55], v[108:111]
  v_cvt_pk_bf16_f32 v172, v192, v193
  v_mfma_f32_16x16x32_bf16 v[108:111], a[92:95], a[60:63], v[108:111]
  v_exp_f32 v195, v91
  v_mfma_f32_16x16x32_bf16 v[100:103], a[92:95], a[56:59], v[148:151]
  v_exp_f32 v196, v92
  v_mfma_f32_16x16x32_bf16 v[100:103], a[84:87], a[48:51], v[100:103]
  v_cvt_pk_bf16_f32 v173, v194, v195
  v_mfma_f32_16x16x32_bf16 v[100:103], a[76:79], a[40:43], v[100:103]
  v_exp_f32 v197, v93
  v_mfma_f32_16x16x32_bf16 v[100:103], a[68:71], a[32:35], v[100:103]
  v_exp_f32 v198, v94
  v_mfma_f32_16x16x32_bf16 v[76:79], a[68:71], a[4:7], v[140:143]
  v_exp_f32 v199, v95
  v_mfma_f32_16x16x32_bf16 v[76:79], a[76:79], a[12:15], v[76:79]
  buffer_load_dwordx4 v19, s[56:59], 0 offen offset:0 sc1 lds
  v_mfma_f32_16x16x32_bf16 v[76:79], a[84:87], a[20:23], v[76:79]
  v_cvt_pk_bf16_f32 v174, v196, v197
  v_mfma_f32_16x16x32_bf16 v[76:79], a[92:95], a[28:31], v[76:79]
  v_cvt_pk_bf16_f32 v175, v198, v199
  v_mfma_f32_16x16x32_bf16 v[68:71], a[92:95], a[24:27], v[132:135]
  ds_read_b128 a[92:95], v18 offset:15360
  v_mfma_f32_16x16x32_bf16 v[68:71], a[84:87], a[16:19], v[68:71]
  ds_read_b128 a[84:87], v18 offset:13312
  v_mfma_f32_16x16x32_bf16 v[68:71], a[76:79], a[8:11], v[68:71]
  ds_read_b128 a[76:79], v18 offset:11264
  v_mfma_f32_16x16x32_bf16 v[212:215], v[232:235], v[172:175], v[208:211]
  v_exp_f32 v192, v112
  v_mfma_f32_16x16x32_bf16 v[68:71], a[68:71], a[0:3], v[68:71]
  ds_read_b128 a[68:71], v18 offset:9216
  v_mfma_f32_16x16x32_bf16 a[128:131], a[96:99], v[160:163], a[128:131]
  v_exp_f32 v193, v113
  v_mfma_f32_16x16x32_bf16 a[160:163], a[96:99], v[164:167], a[160:163]
  v_exp_f32 v194, v114
  v_mfma_f32_16x16x32_bf16 a[192:195], a[96:99], v[176:179], a[192:195]
  v_cvt_pk_bf16_f32 v184, v192, v193
  v_max_f32_e64 v248, s20, v29
  v_mfma_f32_16x16x32_bf16 a[224:227], a[96:99], v[180:183], a[224:227]
  ds_read_b128 a[96:99], v18 offset:24576
  v_max_f32_e64 v249, s20, v30
  v_mfma_f32_16x16x32_bf16 a[228:231], a[100:103], v[180:183], a[228:231]
  buffer_load_dwordx4 v19, s[56:59], 0 offen offset:1024 sc1 lds
  v_max_f32_e64 v250, s20, v31
  v_mfma_f32_16x16x32_bf16 a[196:199], a[100:103], v[176:179], a[196:199]
  v_exp_f32 v195, v115
  v_mfma_f32_16x16x32_bf16 a[164:167], a[100:103], v[164:167], a[164:167]
  s_waitcnt lgkmcnt(1)
  v_exp_f32 v196, v116
  v_mfma_f32_16x16x32_bf16 a[132:135], a[100:103], v[160:163], a[132:135]
  ds_read_b128 a[100:103], v18 offset:25600
  v_cvt_pk_bf16_f32 v185, v194, v195
  v_mfma_f32_16x16x32_bf16 a[136:139], a[104:107], v[160:163], a[136:139]
  v_exp_f32 v197, v117
  v_mfma_f32_16x16x32_bf16 a[168:171], a[104:107], v[164:167], a[168:171]
  v_exp_f32 v198, v118
  v_mfma_f32_16x16x32_bf16 a[200:203], a[104:107], v[176:179], a[200:203]
  v_exp_f32 v199, v119
  v_mfma_f32_16x16x32_bf16 a[232:235], a[104:107], v[180:183], a[232:235]
  v_cvt_pk_bf16_f32 v186, v196, v197
  v_cvt_pk_bf16_f32 v187, v198, v199
  v_mfma_f32_16x16x32_bf16 a[236:239], a[108:111], v[180:183], a[236:239]
  ds_read_b128 a[104:107], v18 offset:26624
  v_max_f32_e64 v251, s20, v14
  v_mfma_f32_16x16x32_bf16 v[220:223], v[232:235], v[184:187], v[216:219]
  v_exp_f32 v192, v120
  v_mfma_f32_16x16x32_bf16 a[204:207], a[108:111], v[176:179], a[204:207]
  v_exp_f32 v193, v121
  v_mfma_f32_16x16x32_bf16 a[172:175], a[108:111], v[164:167], a[172:175]
  v_exp_f32 v194, v122
  v_mfma_f32_16x16x32_bf16 a[140:143], a[108:111], v[160:163], a[140:143]
  buffer_load_dwordx4 v19, s[56:59], 0 offen offset:2048 sc1 lds
  v_min3_f32 v128, v128, v248, s99
  v_mfma_f32_16x16x32_bf16 a[144:147], a[112:115], v[160:163], a[144:147]
  ds_read_b128 a[108:111], v18 offset:27648
  v_cvt_pk_bf16_f32 v188, v192, v193
  v_mfma_f32_16x16x32_bf16 a[176:179], a[112:115], v[164:167], a[176:179]
  v_exp_f32 v195, v123
  v_mfma_f32_16x16x32_bf16 a[208:211], a[112:115], v[176:179], a[208:211]
  v_exp_f32 v196, v124
  v_mfma_f32_16x16x32_bf16 a[240:243], a[112:115], v[180:183], a[240:243]
  ds_read_b128 a[112:115], v18 offset:28672
  v_cvt_pk_bf16_f32 v189, v194, v195
  v_mfma_f32_16x16x32_bf16 a[244:247], a[116:119], v[180:183], a[244:247]
  v_exp_f32 v197, v125
  v_mfma_f32_16x16x32_bf16 a[212:215], a[116:119], v[176:179], a[212:215]
  v_exp_f32 v198, v126
  v_mfma_f32_16x16x32_bf16 a[180:183], a[116:119], v[164:167], a[180:183]
  v_exp_f32 v199, v127
  v_mfma_f32_16x16x32_bf16 a[148:151], a[116:119], v[160:163], a[148:151]
  ds_read_b128 a[116:119], v18 offset:29696
  v_min3_f32 v129, v129, v249, s99
  v_mfma_f32_16x16x32_bf16 a[152:155], a[120:123], v[160:163], a[152:155]
  v_cvt_pk_bf16_f32 v190, v196, v197
  v_cvt_pk_bf16_f32 v191, v198, v199
  v_mfma_f32_16x16x32_bf16 a[184:187], a[120:123], v[164:167], a[184:187]
  v_min3_f32 v130, v130, v250, s99
  v_min3_f32 v131, v131, v251, s99
  v_mfma_f32_16x16x32_bf16 v[228:231], v[232:235], v[188:191], v[224:227]
  v_min3_f32 v132, v132, v29, s20
  v_mfma_f32_16x16x32_bf16 a[216:219], a[120:123], v[176:179], a[216:219]
  buffer_load_dwordx4 v19, s[56:59], 0 offen offset:3072 sc1 lds
  v_min3_f32 v133, v133, v30, s20
  v_mfma_f32_16x16x32_bf16 a[248:251], a[120:123], v[180:183], a[248:251]
  ds_read_b128 a[120:123], v18 offset:30720
  v_min3_f32 v134, v134, v31, s20
  v_mfma_f32_16x16x32_bf16 a[252:255], a[124:127], v[180:183], a[252:255]
  v_max3_f32 v252, v204, v212, v220
  v_mfma_f32_16x16x32_bf16 a[220:223], a[124:127], v[176:179], a[220:223]
  s_waitcnt lgkmcnt(1)
  v_add_f32 v252, v252, v228
  v_cmp_nge_f32 vcc, s85, v252
  v_mfma_f32_16x16x32_bf16 a[188:191], a[124:127], v[164:167], a[188:191]
  v_min3_f32 v135, v135, v14, s20
  v_mfma_f32_16x16x32_bf16 a[156:159], a[124:127], v[160:163], a[156:159]
  s_cbranch_vccnz L_DpA_rare
L_DpA_rarer:
  v_mfma_f32_16x16x32_bf16 v[80:83], a[64:67], a[0:3], v[128:131]
  ds_read_b128 a[124:127], v18 offset:31744
  v_xor_b32 v18, s81, v18
  v_mfma_f32_16x16x32_bf16 v[80:83], a[72:75], a[8:11], v[80:83]
  s_xor_b32 s81, s81, 0x18000
  v_exp_f32 v192, v64
  v_mfma_f32_16x16x32_bf16 v[80:83], a[80:83], a[16:19], v[80:83]
  s_xor_b32 m0, m0, s81
  v_exp_f32 v193, v65
  v_mfma_f32_16x16x32_bf16 v[80:83], a[88:91], a[24:27], v[80:83]
  s_xor_b32 m0, m0, 0x4000
  v_exp_f32 v194, v66
  v_mfma_f32_16x16x32_bf16 v[88:91], a[88:91], a[28:31], v[136:139]
  v_cvt_pk_bf16_f32 v160, v192, v193
  v_mfma_f32_16x16x32_bf16 v[88:91], a[80:83], a[20:23], v[88:91]
  v_exp_f32 v195, v67
  v_mfma_f32_16x16x32_bf16 v[88:91], a[72:75], a[12:15], v[88:91]
  s_waitcnt vmcnt(16) lgkmcnt(0)
  s_barrier
  v_mfma_f32_16x16x32_bf16 v[88:91], a[64:67], a[4:7], v[88:91]
  v_exp_f32 v196, v68
  v_mfma_f32_16x16x32_bf16 v[112:115], a[64:67], a[32:35], v[144:147]
  v_cvt_pk_bf16_f32 v161, v194, v195
  v_mfma_f32_16x16x32_bf16 v[112:115], a[72:75], a[40:43], v[112:115]
  v_exp_f32 v197, v69
  v_mfma_f32_16x16x32_bf16 v[112:115], a[80:83], a[48:51], v[112:115]
  v_exp_f32 v198, v70
  v_mfma_f32_16x16x32_bf16 v[112:115], a[88:91], a[56:59], v[112:115]
  v_exp_f32 v199, v71
  v_mfma_f32_16x16x32_bf16 v[120:123], a[88:91], a[60:63], v[152:155]
  ds_read_b128 a[88:91], v18 offset:6144
  v_mfma_f32_16x16x32_bf16 v[120:123], a[80:83], a[52:55], v[120:123]
  ds_read_b128 a[80:83], v18 offset:4096
  v_mfma_f32_16x16x32_bf16 v[120:123], a[72:75], a[44:47], v[120:123]
  ds_read_b128 a[72:75], v18 offset:2048
  v_cvt_pk_bf16_f32 v162, v196, v197
  v_mfma_f32_16x16x32_bf16 v[120:123], a[64:67], a[36:39], v[120:123]
  ds_read_b128 a[64:67], v18 offset:0
  v_cvt_pk_bf16_f32 v163, v198, v199
  v_mfma_f32_16x16x32_bf16 v[124:127], a[68:71], a[36:39], v[156:159]
  v_exp_f32 v192, v72
  v_mfma_f32_16x16x32_bf16 v[200:203], v[232:235], v[160:163], v[204:207]
  v_exp_f32 v193, v73
  v_mfma_f32_16x16x32_bf16 v[124:127], a[76:79], a[44:47], v[124:127]
  v_exp_f32 v194, v74
  v_mfma_f32_16x16x32_bf16 v[124:127], a[84:87], a[52:55], v[124:127]
  v_cvt_pk_bf16_f32 v164, v192, v193
  v_mfma_f32_16x16x32_bf16 v[124:127], a[92:95], a[60:63], v[124:127]
  v_exp_f32 v195, v75
  v_mfma_f32_16x16x32_bf16 v[116:119], a[92:95], a[56:59], v[148:151]
  v_exp_f32 v196, v76
  v_mfma_f32_16x16x32_bf16 v[116:119], a[84:87], a[48:51], v[116:119]
  v_cvt_pk_bf16_f32 v165, v194, v195
  v_mfma_f32_16x16x32_bf16 v[116:119], a[76:79], a[40:43], v[116:119]
  v_exp_f32 v197, v77
  v_mfma_f32_16x16x32_bf16 v[116:119], a[68:71], a[32:35], v[116:119]
  v_exp_f32 v198, v78
  v_mfma_f32_16x16x32_bf16 v[92:95], a[68:71], a[4:7], v[140:143]
  v_exp_f32 v199, v79
  v_mfma_f32_16x16x32_bf16 v[92:95], a[76:79], a[12:15], v[92:95]
  buffer_load_dwordx4 v19, s[60:63], 0 offen offset:0 sc1 lds
  v_mfma_f32_16x16x32_bf16 v[92:95], a[84:87], a[20:23], v[92:95]
  v_cvt_pk_bf16_f32 v166, v196, v197
  v_mfma_f32_16x16x32_bf16 v[92:95], a[92:95], a[28:31], v[92:95]
  v_cvt_pk_bf16_f32 v167, v198, v199
  v_mfma_f32_16x16x32_bf16 v[84:87], a[92:95], a[24:27], v[132:135]
  ds_read_b128 a[92:95], v18 offset:7168
  v_mfma_f32_16x16x32_bf16 v[84:87], a[84:87], a[16:19], v[84:87]
  ds_read_b128 a[84:87], v18 offset:5120
  v_mfma_f32_16x16x32_bf16 v[84:87], a[76:79], a[8:11], v[84:87]
  ds_read_b128 a[76:79], v18 offset:3072
  v_mfma_f32_16x16x32_bf16 v[208:211], v[232:235], v[164:167], v[212:215]
  v_exp_f32 v192, v96
  v_mfma_f32_16x16x32_bf16 v[84:87], a[68:71], a[0:3], v[84:87]
  ds_read_b128 a[68:71], v18 offset:1024
  v_mfma_f32_16x16x32_bf16 a[128:131], a[96:99], v[168:171], a[128:131]
  v_exp_f32 v193, v97
  v_mfma_f32_16x16x32_bf16 a[160:163], a[96:99], v[172:175], a[160:163]
  v_exp_f32 v194, v98
  v_mfma_f32_16x16x32_bf16 a[192:195], a[96:99], v[184:187], a[192:195]
  v_cvt_pk_bf16_f32 v176, v192, v193
  v_max_f32_e64 v248, -s20, v29
  v_mfma_f32_16x16x32_bf16 a[224:227], a[96:99], v[188:191], a[224:227]
  ds_read_b128 a[96:99], v18 offset:16384
  v_max_f32_e64 v249, -s20, v30
  v_mfma_f32_16x16x32_bf16 a[228:231], a[100:103], v[188:191], a[228:231]
  buffer_load_dwordx4 v19, s[60:63], 0 offen offset:1024 sc1 lds
  v_max_f32_e64 v250, -s20, v31
  v_mfma_f32_16x16x32_bf16 a[196:199], a[100:103], v[184:187], a[196:199]
  v_exp_f32 v195, v99
  v_mfma_f32_16x16x32_bf16 a[164:167], a[100:103], v[172:175], a[164:167]
  s_waitcnt lgkmcnt(1)
  v_exp_f32 v196, v100
  v_mfma_f32_16x16x32_bf16 a[132:135], a[100:103], v[168:171], a[132:135]
  ds_read_b128 a[100:103], v18 offset:17408
  v_cvt_pk_bf16_f32 v177, v194, v195
  v_mfma_f32_16x16x32_bf16 a[136:139], a[104:107], v[168:171], a[136:139]
  v_exp_f32 v197, v101
  v_max_f32_e64 v251, -s20, v14
  v_mfma_f32_16x16x32_bf16 a[168:171], a[104:107], v[172:175], a[168:171]
  v_exp_f32 v198, v102
  v_mfma_f32_16x16x32_bf16 a[200:203], a[104:107], v[184:187], a[200:203]
  v_exp_f32 v199, v103
  v_mfma_f32_16x16x32_bf16 a[232:235], a[104:107], v[188:191], a[232:235]
  v_cvt_pk_bf16_f32 v178, v196, v197
  v_cvt_pk_bf16_f32 v179, v198, v199
  v_mfma_f32_16x16x32_bf16 a[236:239], a[108:111], v[188:191], a[236:239]
  ds_read_b128 a[104:107], v18 offset:18432
  v_min_f32 v136, v136, v248
  v_mfma_f32_16x16x32_bf16 v[216:219], v[232:235], v[176:179], v[220:223]
L_pg10:
  s_cbranch_execz L_walk1
  v_exp_f32 v192, v104
  v_mfma_f32_16x16x32_bf16 a[204:207], a[108:111], v[184:187], a[204:207]
  v_exp_f32 v193, v105
  v_mfma_f32_16x16x32_bf16 a[172:175], a[108:111], v[172:175], a[172:175]
  v_exp_f32 v194, v106
  v_mfma_f32_16x16x32_bf16 a[140:143], a[108:111], v[168:171], a[140:143]
  buffer_load_dwordx4 v19, s[60:63], 0 offen offset:2048 sc1 lds
  v_min_f32 v137, v137, v249
  v_mfma_f32_16x16x32_bf16 a[144:147], a[112:115], v[168:171], a[144:147]
  ds_read_b128 a[108:111], v18 offset:19456
  v_cvt_pk_bf16_f32 v180, v192, v193
  v_mfma_f32_16x16x32_bf16 a[176:179], a[112:115], v[172:175], a[176:179]
  v_exp_f32 v195, v107
  v_mfma_f32_16x16x32_bf16 a[208:211], a[112:115], v[184:187], a[208:211]
  v_exp_f32 v196, v108
  v_mfma_f32_16x16x32_bf16 a[240:243], a[112:115], v[188:191], a[240:243]
  ds_read_b128 a[112:115], v18 offset:20480
  v_cvt_pk_bf16_f32 v181, v194, v195
  v_mfma_f32_16x16x32_bf16 a[244:247], a[116:119], v[188:191], a[244:247]
  v_exp_f32 v197, v109
  v_mfma_f32_16x16x32_bf16 a[212:215], a[116:119], v[184:187], a[212:215]
  v_exp_f32 v198, v110
  v_mfma_f32_16x16x32_bf16 a[180:183], a[116:119], v[172:175], a[180:183]
  v_exp_f32 v199, v111
  v_mfma_f32_16x16x32_bf16 a[148:151], a[116:119], v[168:171], a[148:151]
  ds_read_b128 a[116:119], v18 offset:21504
  v_min_f32 v138, v138, v250
  v_mfma_f32_16x16x32_bf16 a[152:155], a[120:123], v[168:171], a[152:155]
  v_cvt_pk_bf16_f32 v182, v196, v197
  v_cvt_pk_bf16_f32 v183, v198, v199
  v_mfma_f32_16x16x32_bf16 a[184:187], a[120:123], v[172:175], a[184:187]
  v_min_f32 v139, v139, v251
  v_max_f32_e64 v248, -s99, v29
  v_mfma_f32_16x16x32_bf16 v[224:227], v[232:235], v[180:183], v[228:231]
  v_max_f32_e64 v249, -s99, v30
  v_max_f32_e64 v250, -s99, v31
  v_mfma_f32_16x16x32_bf16 a[216:219], a[120:123], v[184:187], a[216:219]
  buffer_load_dwordx4 v19, s[60:63], 0 offen offset:3072 sc1 lds
  v_max_f32_e64 v251, -s99, v14
  v_mfma_f32_16x16x32_bf16 a[248:251], a[120:123], v[188:191], a[248:251]
  ds_read_b128 a[120:123], v18 offset:22528
  v_min3_f32 v140, v140, v248, -s20
  v_mfma_f32_16x16x32_bf16 a[252:255], a[124:127], v[188:191], a[252:255]
  v_max3_f32 v252, v200, v208, v216
  v_min3_f32 v141, v141, v249, -s20
  v_mfma_f32_16x16x32_bf16 a[220:223], a[124:127], v[184:187], a[220:223]
  s_waitcnt lgkmcnt(1)
  v_add_f32 v252, v252, v224
  v_cmp_nge_f32 vcc, s85, v252
  v_mfma_f32_16x16x32_bf16 a[188:191], a[124:127], v[172:175], a[188:191]
  v_min3_f32 v142, v142, v250, -s20
  v_min3_f32 v143, v143, v251, -s20
  v_mfma_f32_16x16x32_bf16 a[156:159], a[124:127], v[168:171], a[156:159]
  s_cbranch_vccnz L_DpB_rare
L_DpB_rarer:
L_T:
  s_cmp_eq_u32 s77, 0
  s_cselect_b32 s36, s14, s22
  s_cselect_b32 s37, s15, s23
  s_cselect_b32 s35, 64, 28
  s_lshl_b32 s38, s35, 16
  s_lshl_b32 s35, s76, 8
  s_add_u32 s35, s35, s2
  s_lshl_b32 s35, s35, 13
  v_lshlrev_b32 v26, 7, v25
  buffer_load_dword v253, v26, s[36:39], s35 offen
  v_mfma_f32_16x16x32_bf16 v[72:75], a[64:67], a[4:7], v[136:139]
  s_xor_b32 m0, m0, 0x4000
  ds_read_b128 a[124:127], v18 offset:23552
  v_add_u32 v19, 0x4000, v19
  v_mfma_f32_16x16x32_bf16 v[72:75], a[72:75], a[12:15], v[72:75]
  s_add_u32 s82, s82, 16384
  v_exp_f32 v192, v80
  v_mfma_f32_16x16x32_bf16 v[72:75], a[80:83], a[20:23], v[72:75]
  v_exp_f32 v193, v81
  v_mfma_f32_16x16x32_bf16 v[72:75], a[88:91], a[28:31], v[72:75]
  v_exp_f32 v194, v82
  v_mfma_f32_16x16x32_bf16 v[96:99], a[88:91], a[56:59], v[144:147]
  v_cvt_pk_bf16_f32 v168, v192, v193
  v_mfma_f32_16x16x32_bf16 v[96:99], a[80:83], a[48:51], v[96:99]
  v_exp_f32 v195, v83
  v_mfma_f32_16x16x32_bf16 v[96:99], a[72:75], a[40:43], v[96:99]
  s_waitcnt lgkmcnt(1)
  v_exp_f32 v196, v84
  v_mfma_f32_16x16x32_bf16 v[96:99], a[64:67], a[32:35], v[96:99]
  v_cvt_pk_bf16_f32 v169, v194, v195
  v_mfma_f32_16x16x32_bf16 v[104:107], a[64:67], a[36:39], v[152:155]
  ds_read_b128 a[64:67], v18 offset:8192
  v_mfma_f32_16x16x32_bf16 v[104:107], a[72:75], a[44:47], v[104:107]
  v_exp_f32 v197, v85
  v_mfma_f32_16x16x32_bf16 v[104:107], a[80:83], a[52:55], v[104:107]
  v_exp_f32 v198, v86
  v_mfma_f32_16x16x32_bf16 v[104:107], a[88:91], a[60:63], v[104:107]
  v_exp_f32 v199, v87
  v_mfma_f32_16x16x32_bf16 v[108:111], a[92:95], a[60:63], v[156:159]
  ds_read_b128 a[72:75], v18 offset:10240
  v_cvt_pk_bf16_f32 v170, v196, v197
  v_mfma_f32_16x16x32_bf16 v[108:111], a[84:87], a[52:55], v[108:111]
  ds_read_b128 a[80:83], v18 offset:12288
  v_cvt_pk_bf16_f32 v171, v198, v199
  v_mfma_f32_16x16x32_bf16 v[108:111], a[76:79], a[44:47], v[108:111]
  ds_read_b128 a[88:91], v18 offset:14336
  v_mfma_f32_16x16x32_bf16 v[204:207], v[232:235], v[168:171], v[200:203]
  v_exp_f32 v192, v88
  v_mfma_f32_16x16x32_bf16 v[108:111], a[68:71], a[36:39], v[108:111]
  v_exp_f32 v193, v89
  v_mfma_f32_16x16x32_bf16 v[100:103], a[68:71], a[32:35], v[148:151]
  v_exp_f32 v194, v90
  v_mfma_f32_16x16x32_bf16 v[100:103], a[76:79], a[40:43], v[100:103]
  v_cvt_pk_bf16_f32 v172, v192, v193
  v_mfma_f32_16x16x32_bf16 v[100:103], a[84:87], a[48:51], v[100:103]
  v_exp_f32 v195, v91
  v_mfma_f32_16x16x32_bf16 v[100:103], a[92:95], a[56:59], v[100:103]
  v_exp_f32 v196, v92
  v_mfma_f32_16x16x32_bf16 v[76:79], a[92:95], a[28:31], v[140:143]
  ds_read_b128 a[92:95], v18 offset:15360
  v_cvt_pk_bf16_f32 v173, v194, v195
  v_mfma_f32_16x16x32_bf16 v[76:79], a[84:87], a[20:23], v[76:79]
  v_exp_f32 v197, v93
  v_mfma_f32_16x16x32_bf16 v[76:79], a[76:79], a[12:15], v[76:79]
  v_exp_f32 v198, v94
  v_mfma_f32_16x16x32_bf16 v[76:79], a[68:71], a[4:7], v[76:79]
  v_exp_f32 v199, v95
  v_mfma_f32_16x16x32_bf16 a[128:131], a[96:99], v[160:163], a[128:131]
  ds_read_b128 a[84:87], v18 offset:13312
  v_cvt_pk_bf16_f32 v174, v196, v197
  v_mfma_f32_16x16x32_bf16 a[160:163], a[96:99], v[164:167], a[160:163]
  ds_read_b128 a[76:79], v18 offset:11264
  v_cvt_pk_bf16_f32 v175, v198, v199
  v_mfma_f32_16x16x32_bf16 a[192:195], a[96:99], v[176:179], a[192:195]
  v_exp_f32 v192, v112
  v_max_f32_e64 v248, -s68, v29
  v_mfma_f32_16x16x32_bf16 v[212:215], v[232:235], v[172:175], v[208:211]
  v_exp_f32 v193, v113
  v_mfma_f32_16x16x32_bf16 a[224:227], a[96:99], v[180:183], a[224:227]
  v_exp_f32 v194, v114
  v_mfma_f32_16x16x32_bf16 a[228:231], a[100:103], v[180:183], a[228:231]
  ds_read_b128 a[68:71], v18 offset:9216
  v_cvt_pk_bf16_f32 v184, v192, v193
  v_max_f32_e64 v249, -s68, v30
  v_mfma_f32_16x16x32_bf16 a[196:199], a[100:103], v[176:179], a[196:199]
  v_exp_f32 v195, v115
  v_mfma_f32_16x16x32_bf16 a[164:167], a[100:103], v[164:167], a[164:167]
  buffer_load_dwordx4 v19, s[56:59], 0 offen offset:0 sc1 lds
  ds_read_b128 a[96:99], v18 offset:24576
  v_max_f32_e64 v250, -s68, v31
  v_mfma_f32_16x16x32_bf16 a[132:135], a[100:103], v[160:163], a[132:135]
  v_exp_f32 v196, v116
  v_mfma_f32_16x16x32_bf16 a[136:139], a[104:107], v[160:163], a[136:139]
  ds_read_b128 a[100:103], v18 offset:25600
  v_cvt_pk_bf16_f32 v185, v194, v195
  v_mfma_f32_16x16x32_bf16 a[168:171], a[104:107], v[164:167], a[168:171]
  v_exp_f32 v197, v117
  v_mfma_f32_16x16x32_bf16 a[200:203], a[104:107], v[176:179], a[200:203]
  s_waitcnt lgkmcnt(3)
  v_exp_f32 v198, v118
  v_mfma_f32_16x16x32_bf16 a[232:235], a[104:107], v[180:183], a[232:235]
  v_exp_f32 v199, v119
  v_mfma_f32_16x16x32_bf16 a[236:239], a[108:111], v[180:183], a[236:239]
  v_cvt_pk_bf16_f32 v186, v196, v197
  v_cvt_pk_bf16_f32 v187, v198, v199
  v_mfma_f32_16x16x32_bf16 a[204:207], a[108:111], v[176:179], a[204:207]
  v_exp_f32 v192, v120
  v_mfma_f32_16x16x32_bf16 a[172:175], a[108:111], v[164:167], a[172:175]
  buffer_load_dwordx4 v19, s[56:59], 0 offen offset:1024 sc1 lds
  ds_read_b128 a[104:107], v18 offset:26624
  v_mfma_f32_16x16x32_bf16 v[220:223], v[232:235], v[184:187], v[216:219]
  v_exp_f32 v193, v121
  v_mfma_f32_16x16x32_bf16 a[140:143], a[108:111], v[160:163], a[140:143]
  v_exp_f32 v194, v122
  v_mfma_f32_16x16x32_bf16 a[144:147], a[112:115], v[160:163], a[144:147]
  ds_read_b128 a[108:111], v18 offset:27648
  v_cvt_pk_bf16_f32 v188, v192, v193
  v_mfma_f32_16x16x32_bf16 a[176:179], a[112:115], v[164:167], a[176:179]
  v_exp_f32 v195, v123
  v_mfma_f32_16x16x32_bf16 a[208:211], a[112:115], v[176:179], a[208:211]
  v_exp_f32 v196, v124
  v_mfma_f32_16x16x32_bf16 a[240:243], a[112:115], v[180:183], a[240:243]
  ds_read_b128 a[112:115], v18 offset:28672
  v_cvt_pk_bf16_f32 v189, v194, v195
  v_mfma_f32_16x16x32_bf16 a[244:247], a[116:119], v[180:183], a[244:247]
  v_exp_f32 v197, v125
  v_mfma_f32_16x16x32_bf16 a[212:215], a[116:119], v[176:179], a[212:215]
  buffer_load_dwordx4 v19, s[56:59], 0 offen offset:2048 sc1 lds
  v_max_f32_e64 v251, -s68, v14
  v_mfma_f32_16x16x32_bf16 a[180:183], a[116:119], v[164:167], a[180:183]
  v_exp_f32 v198, v126
  v_mfma_f32_16x16x32_bf16 a[148:151], a[116:119], v[160:163], a[148:151]
  v_exp_f32 v199, v127
  v_mfma_f32_16x16x32_bf16 a[152:155], a[120:123], v[160:163], a[152:155]
  v_cvt_pk_bf16_f32 v190, v196, v197
  v_cvt_pk_bf16_f32 v191, v198, v199
  v_mfma_f32_16x16x32_bf16 a[184:187], a[120:123], v[164:167], a[184:187]
  ds_read_b128 a[116:119], v18 offset:29696
  v_min3_f32 v136, v136, v248, -s99
  v_mfma_f32_16x16x32_bf16 v[228:231], v[232:235], v[188:191], v[224:227]
  v_min3_f32 v137, v137, v249, -s99
  v_min3_f32 v138, v138, v250, -s99
  v_mfma_f32_16x16x32_bf16 a[216:219], a[120:123], v[176:179], a[216:219]
  v_min3_f32 v139, v139, v251, -s99
  v_min3_f32 v140, v140, v29, -s68
  v_mfma_f32_16x16x32_bf16 a[248:251], a[120:123], v[180:183], a[248:251]
  ds_read_b128 a[120:123], v18 offset:30720
  v_min3_f32 v141, v141, v30, -s68
  v_mfma_f32_16x16x32_bf16 a[252:255], a[124:127], v[180:183], a[252:255]
  buffer_load_dwordx4 v19, s[56:59], 0 offen offset:3072 sc1 lds
  v_max3_f32 v252, v204, v212, v220
  v_mfma_f32_16x16x32_bf16 a[220:223], a[124:127], v[176:179], a[220:223]
  s_waitcnt lgkmcnt(2)
  v_add_f32 v252, v252, v228
  v_cmp_nge_f32 vcc, s85, v252
  v_mfma_f32_16x16x32_bf16 a[188:191], a[124:127], v[164:167], a[188:191]
  v_min3_f32 v142, v142, v31, -s68
  v_min3_f32 v143, v143, v14, -s68
  v_mfma_f32_16x16x32_bf16 a[156:159], a[124:127], v[160:163], a[156:159]
  s_cbranch_vccnz L_T1A_rare
L_T1A_rarer:
  v_mfma_f32_16x16x32_bf16 v[88:91], a[64:67], a[4:7], v[136:139]
  ds_read_b128 a[124:127], v18 offset:31744
  v_xor_b32 v18, s81, v18
  v_mfma_f32_16x16x32_bf16 v[88:91], a[72:75], a[12:15], v[88:91]
  s_xor_b32 s81, s81, 0x18000
  v_exp_f32 v192, v72
  v_mfma_f32_16x16x32_bf16 v[88:91], a[80:83], a[20:23], v[88:91]
  s_xor_b32 m0, m0, s81
  v_exp_f32 v193, v73
  v_mfma_f32_16x16x32_bf16 v[88:91], a[88:91], a[28:31], v[88:91]
  s_xor_b32 m0, m0, 0x4000
  v_exp_f32 v194, v74
  v_mfma_f32_16x16x32_bf16 v[112:115], a[88:91], a[56:59], v[144:147]
  v_cvt_pk_bf16_f32 v164, v192, v193
  v_lshrrev_b32 v58, 4, v25
  v_mfma_f32_16x16x32_bf16 v[112:115], a[80:83], a[48:51], v[112:115]
  v_exp_f32 v195, v75
  v_mfma_f32_16x16x32_bf16 v[112:115], a[72:75], a[40:43], v[112:115]
  s_waitcnt vmcnt(16) lgkmcnt(0)
  s_barrier
  v_mfma_f32_16x16x32_bf16 v[112:115], a[64:67], a[32:35], v[112:115]
  v_exp_f32 v196, v76
  v_mfma_f32_16x16x32_bf16 v[120:123], a[64:67], a[36:39], v[152:155]
  ds_read_b128 a[64:67], v18 offset:0
  v_and_b32 v59, 15, v25
  v_mfma_f32_16x16x32_bf16 v[120:123], a[72:75], a[44:47], v[120:123]
  ds_read_b128 a[72:75], v18 offset:2048
  v_lshlrev_b32 v48, 10, v58
  v_mfma_f32_16x16x32_bf16 v[120:123], a[80:83], a[52:55], v[120:123]
  ds_read_b128 a[80:83], v18 offset:4096
  v_lshlrev_b32 v49, 1, v58
  v_mfma_f32_16x16x32_bf16 v[120:123], a[88:91], a[60:63], v[120:123]
  ds_read_b128 a[88:91], v18 offset:6144
  v_cvt_pk_bf16_f32 v165, v194, v195
  v_mfma_f32_16x16x32_bf16 v[124:127], a[92:95], a[60:63], v[156:159]
  v_exp_f32 v197, v77
  v_mfma_f32_16x16x32_bf16 v[124:127], a[84:87], a[52:55], v[124:127]
  v_exp_f32 v198, v78
  v_mfma_f32_16x16x32_bf16 v[124:127], a[76:79], a[44:47], v[124:127]
  v_exp_f32 v199, v79
  v_mfma_f32_16x16x32_bf16 v[124:127], a[68:71], a[36:39], v[124:127]
  v_cvt_pk_bf16_f32 v166, v196, v197
  v_cvt_pk_bf16_f32 v167, v198, v199
  v_mfma_f32_16x16x32_bf16 v[116:119], a[68:71], a[32:35], v[148:151]
  v_exp_f32 v192, v96
  v_mfma_f32_16x16x32_bf16 v[116:119], a[76:79], a[40:43], v[116:119]
  v_exp_f32 v193, v97
  v_mfma_f32_16x16x32_bf16 v[208:211], v[232:235], v[164:167], v[212:215]
  v_exp_f32 v194, v98
  v_mfma_f32_16x16x32_bf16 v[116:119], a[84:87], a[48:51], v[116:119]
  v_cvt_pk_bf16_f32 v176, v192, v193
  v_xor_b32 v49, v49, v59
  v_mfma_f32_16x16x32_bf16 v[116:119], a[92:95], a[56:59], v[116:119]
  v_exp_f32 v195, v99
  v_mfma_f32_16x16x32_bf16 v[92:95], a[92:95], a[28:31], v[140:143]
  ds_read_b128 a[92:95], v18 offset:7168
  v_xor_b32 v50, 8, v49
  v_mfma_f32_16x16x32_bf16 v[92:95], a[84:87], a[20:23], v[92:95]
  ds_read_b128 a[84:87], v18 offset:5120
  v_lshl_add_u32 v2, v49, 4, v48
  v_mfma_f32_16x16x32_bf16 v[92:95], a[76:79], a[12:15], v[92:95]
  ds_read_b128 a[76:79], v18 offset:3072
  v_lshl_add_u32 v50, v50, 4, v48
  v_mfma_f32_16x16x32_bf16 v[92:95], a[68:71], a[4:7], v[92:95]
  ds_read_b128 a[68:71], v18 offset:1024
  v_add_u32 v3, 3072, v50
  v_mfma_f32_16x16x32_bf16 a[128:131], a[96:99], v[168:171], a[128:131]
  v_exp_f32 v196, v100
  v_mfma_f32_16x16x32_bf16 a[160:163], a[96:99], v[172:175], a[160:163]
  v_cvt_pk_bf16_f32 v177, v194, v195
  v_add_u32 v4, 6144, v2
  v_mfma_f32_16x16x32_bf16 a[192:195], a[96:99], v[184:187], a[192:195]
  v_exp_f32 v197, v101
  v_mfma_f32_16x16x32_bf16 a[224:227], a[96:99], v[188:191], a[224:227]
  ds_read_b128 a[96:99], v18 offset:16384
  v_add_u32 v5, 9216, v50
  v_mfma_f32_16x16x32_bf16 a[228:231], a[100:103], v[188:191], a[228:231]
  s_and_b32 s73, s9, 1
  v_exp_f32 v198, v102
  v_mfma_f32_16x16x32_bf16 a[196:199], a[100:103], v[184:187], a[196:199]
  s_lshl_b32 s72, s73, 10
  v_exp_f32 v199, v103
  v_mfma_f32_16x16x32_bf16 a[164:167], a[100:103], v[172:175], a[164:167]
  buffer_load_dwordx4 v19, s[60:63], 0 offen offset:0 sc1 lds
  v_cvt_pk_bf16_f32 v178, v196, v197
  v_mfma_f32_16x16x32_bf16 a[132:135], a[100:103], v[168:171], a[132:135]
  ds_read_b128 a[100:103], v18 offset:17408
  v_lshl_add_u32 v6, v25, 4, s72
  v_mfma_f32_16x16x32_bf16 a[136:139], a[104:107], v[168:171], a[136:139]
  v_cvt_pk_bf16_f32 v179, v198, v199
  v_xor_b32 v7, 0x400, v6
  v_mfma_f32_16x16x32_bf16 a[168:171], a[104:107], v[172:175], a[168:171]
  s_lshl_b32 s72, s73, 6
  v_lshl_add_u32 v12, v59, 2, s72
  v_xor_b32 v13, 64, v12
  v_mfma_f32_16x16x32_bf16 v[216:219], v[232:235], v[176:179], v[220:223]
  s_waitcnt lgkmcnt(1)
  v_exp_f32 v192, v104
  v_lshrrev_b32 v50, 2, v59
  v_mfma_f32_16x16x32_bf16 a[200:203], a[104:107], v[184:187], a[200:203]
  v_exp_f32 v193, v105
  v_mfma_f32_16x16x32_bf16 a[232:235], a[104:107], v[188:191], a[232:235]
  ds_read_b128 a[104:107], v18 offset:18432
  v_and_b32 v51, 3, v59
  v_mfma_f32_16x16x32_bf16 a[236:239], a[108:111], v[188:191], a[236:239]
  v_exp_f32 v194, v106
  v_mfma_f32_16x16x32_bf16 a[204:207], a[108:111], v[184:187], a[204:207]
  buffer_load_dwordx4 v19, s[60:63], 0 offen offset:1024 sc1 lds
  v_cvt_pk_bf16_f32 v180, v192, v193
  v_mfma_f32_16x16x32_bf16 a[172:175], a[108:111], v[172:175], a[172:175]
  v_exp_f32 v195, v107
  v_mfma_f32_16x16x32_bf16 a[140:143], a[108:111], v[168:171], a[140:143]
  ds_read_b128 a[108:111], v18 offset:19456
  v_and_b32 v52, 1, v58
  v_mfma_f32_16x16x32_bf16 a[144:147], a[112:115], v[168:171], a[144:147]
  v_exp_f32 v196, v108
  v_mfma_f32_16x16x32_bf16 a[176:179], a[112:115], v[172:175], a[176:179]
  v_cvt_pk_bf16_f32 v181, v194, v195
  v_lshl_add_u32 v53, v52, 2, v50
  v_mfma_f32_16x16x32_bf16 a[208:211], a[112:115], v[184:187], a[208:211]
  v_exp_f32 v197, v109
  v_mfma_f32_16x16x32_bf16 a[240:243], a[112:115], v[188:191], a[240:243]
  ds_read_b128 a[112:115], v18 offset:20480
  v_lshl_add_u32 v54, v58, 2, v50
  v_mfma_f32_16x16x32_bf16 a[244:247], a[116:119], v[188:191], a[244:247]
  v_exp_f32 v198, v110
  v_mfma_f32_16x16x32_bf16 a[212:215], a[116:119], v[184:187], a[212:215]
  buffer_load_dwordx4 v19, s[60:63], 0 offen offset:2048 sc1 lds
  v_lshlrev_b32 v51, 3, v51
  v_mfma_f32_16x16x32_bf16 a[180:183], a[116:119], v[172:175], a[180:183]
  v_exp_f32 v199, v111
  v_mfma_f32_16x16x32_bf16 a[148:151], a[116:119], v[168:171], a[148:151]
  ds_read_b128 a[116:119], v18 offset:21504
  v_lshl_add_u32 v54, v54, 8, v51
  v_mfma_f32_16x16x32_bf16 a[152:155], a[120:123], v[168:171], a[152:155]
  v_cvt_pk_bf16_f32 v182, v196, v197
  v_cvt_pk_bf16_f32 v183, v198, v199
  v_mfma_f32_16x16x32_bf16 a[184:187], a[120:123], v[172:175], a[184:187]
  v_add_u32 v54, 0x8000, v54
  s_lshr_b32 s73, s9, 1
  v_mfma_f32_16x16x32_bf16 v[224:227], v[232:235], v[180:183], v[228:231]
  s_lshl_b32 s73, s73, 2
  v_xor_b32 v53, s73, v53
  v_xor_b32 v56, 0, v53
  v_mfma_f32_16x16x32_bf16 a[216:219], a[120:123], v[184:187], a[216:219]
  v_lshl_add_u32 v32, v56, 5, v54
  v_add_u32 v40, 0x10000, v32
  v_mfma_f32_16x16x32_bf16 a[248:251], a[120:123], v[188:191], a[248:251]
  ds_read_b128 a[120:123], v18 offset:22528
  v_xor_b32 v56, 1, v53
  v_mfma_f32_16x16x32_bf16 a[252:255], a[124:127], v[188:191], a[252:255]
  buffer_load_dwordx4 v19, s[60:63], 0 offen offset:3072 sc1 lds
  v_lshl_add_u32 v33, v56, 5, v54
  v_mfma_f32_16x16x32_bf16 a[220:223], a[124:127], v[184:187], a[220:223]
  s_waitcnt lgkmcnt(1)
  v_max3_f32 v252, v208, v216, v224
  v_cmp_nge_f32 vcc, s85, v252
  v_mfma_f32_16x16x32_bf16 a[188:191], a[124:127], v[172:175], a[188:191]
  v_add_u32 v41, 0x10000, v33
  v_xor_b32 v56, 2, v53
  v_mfma_f32_16x16x32_bf16 a[156:159], a[124:127], v[168:171], a[156:159]
  s_cbranch_vccnz L_T1B_rare
L_T1B_rarer:
  v_mfma_f32_16x16x32_bf16 v[96:99], a[64:67], a[32:35], v[144:147]
  s_xor_b32 m0, m0, 0x4000
  ds_read_b128 a[124:127], v18 offset:23552
  v_add_u32 v19, 0x4000, v19
  v_mfma_f32_16x16x32_bf16 v[96:99], a[72:75], a[40:43], v[96:99]
  s_add_u32 s82, s82, 16384
  v_exp_f32 v192, v88
  v_mfma_f32_16x16x32_bf16 v[96:99], a[80:83], a[48:51], v[96:99]
  v_exp_f32 v193, v89
  v_mfma_f32_16x16x32_bf16 v[96:99], a[88:91], a[56:59], v[96:99]
  s_mul_i32 s83, s16, 1472
  v_exp_f32 v194, v90
  v_mfma_f32_16x16x32_bf16 v[104:107], a[88:91], a[60:63], v[152:155]
  ds_read_b128 a[88:91], v18 offset:14336
  v_cvt_pk_bf16_f32 v172, v192, v193
  v_mfma_f32_16x16x32_bf16 v[104:107], a[80:83], a[52:55], v[104:107]
  v_exp_f32 v195, v91
  v_mfma_f32_16x16x32_bf16 v[104:107], a[72:75], a[44:47], v[104:107]
  s_waitcnt lgkmcnt(2)
  v_exp_f32 v196, v92
  v_mfma_f32_16x16x32_bf16 v[104:107], a[64:67], a[36:39], v[104:107]
  s_lshl_b32 s84, s32, 3
  ds_read_b128 a[80:83], v18 offset:12288
  v_cvt_pk_bf16_f32 v173, v194, v195
  v_mfma_f32_16x16x32_bf16 v[108:111], a[68:71], a[36:39], v[156:159]
  v_exp_f32 v197, v93
  v_mfma_f32_16x16x32_bf16 v[108:111], a[76:79], a[44:47], v[108:111]
  v_exp_f32 v198, v94
  v_mfma_f32_16x16x32_bf16 v[108:111], a[84:87], a[52:55], v[108:111]
  v_exp_f32 v199, v95
  v_mfma_f32_16x16x32_bf16 v[108:111], a[92:95], a[60:63], v[108:111]
  s_add_u32 s83, s83, s84
  v_cvt_pk_bf16_f32 v174, v196, v197
  v_cvt_pk_bf16_f32 v175, v198, v199
  v_mfma_f32_16x16x32_bf16 v[100:103], a[92:95], a[56:59], v[148:151]
  v_exp_f32 v192, v112
  v_mfma_f32_16x16x32_bf16 v[212:215], v[232:235], v[172:175], v[208:211]
  v_exp_f32 v193, v113
  v_mfma_f32_16x16x32_bf16 v[100:103], a[84:87], a[48:51], v[100:103]
  s_mul_i32 s35, s77, 368
  v_exp_f32 v194, v114
  v_mfma_f32_16x16x32_bf16 v[100:103], a[76:79], a[40:43], v[100:103]
  buffer_load_dwordx4 v19, s[56:59], 0 offen offset:0 sc1 lds
  v_cvt_pk_bf16_f32 v184, v192, v193
  v_mfma_f32_16x16x32_bf16 v[100:103], a[68:71], a[32:35], v[100:103]
  v_exp_f32 v195, v115
  v_mfma_f32_16x16x32_bf16 a[160:163], a[96:99], v[164:167], a[160:163]
  v_exp_f32 v196, v116
  v_mfma_f32_16x16x32_bf16 a[192:195], a[96:99], v[176:179], a[192:195]
  s_add_u32 s35, s35, s76
  ds_read_b128 a[72:75], v18 offset:10240
  v_cvt_pk_bf16_f32 v185, v194, v195
  v_mfma_f32_16x16x32_bf16 a[224:227], a[96:99], v[180:183], a[224:227]
  v_exp_f32 v197, v117
  v_mfma_f32_16x16x32_bf16 a[228:231], a[100:103], v[180:183], a[228:231]
  v_exp_f32 v198, v118
  v_mfma_f32_16x16x32_bf16 a[196:199], a[100:103], v[176:179], a[196:199]
  s_sub_u32 s84, s83, s35
  v_exp_f32 v199, v119
  v_mfma_f32_16x16x32_bf16 a[164:167], a[100:103], v[164:167], a[164:167]
  ds_read_b128 a[64:67], v18 offset:8192
  v_cvt_pk_bf16_f32 v186, v196, v197
  v_mfma_f32_16x16x32_bf16 a[168:171], a[104:107], v[164:167], a[168:171]
  buffer_load_dwordx4 v19, s[56:59], 0 offen offset:1024 sc1 lds
  v_cvt_pk_bf16_f32 v187, v198, v199
  v_mfma_f32_16x16x32_bf16 a[200:203], a[104:107], v[176:179], a[200:203]
  v_exp_f32 v192, v120
  v_mfma_f32_16x16x32_bf16 a[232:235], a[104:107], v[180:183], a[232:235]
  s_add_u32 s83, s83, s35
  v_exp_f32 v193, v121
  v_mfma_f32_16x16x32_bf16 v[220:223], v[232:235], v[184:187], v[216:219]
  v_exp_f32 v194, v122
  v_mfma_f32_16x16x32_bf16 a[236:239], a[108:111], v[180:183], a[236:239]
  s_waitcnt lgkmcnt(1)
  ds_read_b128 a[92:95], v18 offset:15360
  v_cvt_pk_bf16_f32 v188, v192, v193
  v_mfma_f32_16x16x32_bf16 a[204:207], a[108:111], v[176:179], a[204:207]
  v_exp_f32 v195, v123
  v_mfma_f32_16x16x32_bf16 a[172:175], a[108:111], v[164:167], a[172:175]
  s_lshl_b32 s83, s83, 10
  v_exp_f32 v196, v124
  v_mfma_f32_16x16x32_bf16 a[176:179], a[112:115], v[164:167], a[176:179]
  ds_read_b128 a[84:87], v18 offset:13312
  v_cvt_pk_bf16_f32 v189, v194, v195
  v_mfma_f32_16x16x32_bf16 a[208:211], a[112:115], v[176:179], a[208:211]
  buffer_load_dwordx4 v19, s[56:59], 0 offen offset:2048 sc1 lds
  v_exp_f32 v197, v125
  v_mfma_f32_16x16x32_bf16 a[240:243], a[112:115], v[180:183], a[240:243]
  s_lshl_b32 s84, s84, 10
  v_exp_f32 v198, v126
  v_mfma_f32_16x16x32_bf16 a[244:247], a[116:119], v[180:183], a[244:247]
  v_exp_f32 v199, v127
  v_mfma_f32_16x16x32_bf16 a[212:215], a[116:119], v[176:179], a[212:215]
  v_cvt_pk_bf16_f32 v190, v196, v197
  v_cvt_pk_bf16_f32 v191, v198, v199
  v_mfma_f32_16x16x32_bf16 a[180:183], a[116:119], v[164:167], a[180:183]
  ds_read_b128 a[76:79], v18 offset:11264
  ds_read_b128 a[68:71], v18 offset:9216
  v_mfma_f32_16x16x32_bf16 v[228:231], v[232:235], v[188:191], v[224:227]
  s_add_u32 s83, s83, 33669120
  ds_read_b128 a[96:99], v18 offset:24576
  ds_read_b128 a[100:103], v18 offset:25600
  v_mfma_f32_16x16x32_bf16 a[184:187], a[120:123], v[164:167], a[184:187]
  ds_read_b128 a[104:107], v18 offset:26624
  ds_read_b128 a[108:111], v18 offset:27648
  v_mfma_f32_16x16x32_bf16 a[216:219], a[120:123], v[176:179], a[216:219]
  ds_read_b128 a[112:115], v18 offset:28672
  v_mfma_f32_16x16x32_bf16 a[248:251], a[120:123], v[180:183], a[248:251]
  buffer_load_dwordx4 v19, s[56:59], 0 offen offset:3072 sc1 lds
  ds_read_b128 a[116:119], v18 offset:29696
  v_mfma_f32_16x16x32_bf16 a[252:255], a[124:127], v[180:183], a[252:255]
  s_waitcnt lgkmcnt(8)
  v_max3_f32 v252, v212, v220, v228
  v_cmp_nge_f32 vcc, s85, v252
  v_mfma_f32_16x16x32_bf16 a[220:223], a[124:127], v[176:179], a[220:223]
  s_add_u32 s84, s84, 34800640
  ds_read_b128 a[120:123], v18 offset:30720
  v_mfma_f32_16x16x32_bf16 a[188:191], a[124:127], v[164:167], a[188:191]
  s_cbranch_vccnz L_T2A_rare
L_T2A_rarer:
  v_mfma_f32_16x16x32_bf16 v[112:115], a[64:67], a[32:35], v[144:147]
  ds_read_b128 a[124:127], v18 offset:31744
  v_xor_b32 v18, s81, v18
  v_mfma_f32_16x16x32_bf16 v[112:115], a[72:75], a[40:43], v[112:115]
  s_xor_b32 s81, s81, 0x18000
  v_exp_f32 v192, v96
  v_mfma_f32_16x16x32_bf16 v[112:115], a[80:83], a[48:51], v[112:115]
  s_xor_b32 m0, m0, s81
  v_exp_f32 v193, v97
  v_lshl_add_u32 v34, v56, 5, v54
  v_mfma_f32_16x16x32_bf16 v[112:115], a[88:91], a[56:59], v[112:115]
  s_xor_b32 m0, m0, 0x4000
  v_exp_f32 v194, v98
  v_mfma_f32_16x16x32_bf16 v[120:123], a[88:91], a[60:63], v[152:155]
  v_cvt_pk_bf16_f32 v176, v192, v193
  v_add_u32 v42, 0x10000, v34
  v_mfma_f32_16x16x32_bf16 v[120:123], a[80:83], a[52:55], v[120:123]
  v_exp_f32 v195, v99
  v_mfma_f32_16x16x32_bf16 v[120:123], a[72:75], a[44:47], v[120:123]
  s_waitcnt vmcnt(16) lgkmcnt(0)
  s_barrier
  v_mfma_f32_16x16x32_bf16 v[120:123], a[64:67], a[36:39], v[120:123]
  ds_read_b128 a[64:67], v18 offset:0
  v_xor_b32 v56, 3, v53
  v_mfma_f32_16x16x32_bf16 v[124:127], a[68:71], a[36:39], v[156:159]
  ds_read_b128 a[72:75], v18 offset:2048
  v_lshl_add_u32 v35, v56, 5, v54
  v_mfma_f32_16x16x32_bf16 v[124:127], a[76:79], a[44:47], v[124:127]
  ds_read_b128 a[80:83], v18 offset:4096
  v_add_u32 v43, 0x10000, v35
  v_mfma_f32_16x16x32_bf16 v[124:127], a[84:87], a[52:55], v[124:127]
  ds_read_b128 a[88:91], v18 offset:6144
  v_xor_b32 v56, 4, v53
  v_mfma_f32_16x16x32_bf16 v[124:127], a[92:95], a[60:63], v[124:127]
  v_exp_f32 v196, v100
  v_mfma_f32_16x16x32_bf16 v[116:119], a[92:95], a[56:59], v[148:151]
  ds_read_b128 a[92:95], v18 offset:7168
  v_cvt_pk_bf16_f32 v177, v194, v195
  v_lshl_add_u32 v36, v56, 5, v54
  v_mfma_f32_16x16x32_bf16 v[116:119], a[84:87], a[48:51], v[116:119]
  v_exp_f32 v197, v101
  v_add_u32 v44, 0x10000, v36
  v_mfma_f32_16x16x32_bf16 v[116:119], a[76:79], a[40:43], v[116:119]
  buffer_load_dwordx4 v19, s[60:63], 0 offen offset:0 sc1 lds
  ds_read_b128 a[84:87], v18 offset:5120
  v_mfma_f32_16x16x32_bf16 v[116:119], a[68:71], a[32:35], v[116:119]
  v_exp_f32 v198, v102
  v_xor_b32 v56, 5, v53
  v_mfma_f32_16x16x32_bf16 a[160:163], a[96:99], v[172:175], a[160:163]
  v_exp_f32 v199, v103
  v_lshl_add_u32 v37, v56, 5, v54
  v_mfma_f32_16x16x32_bf16 a[192:195], a[96:99], v[184:187], a[192:195]
  v_cvt_pk_bf16_f32 v178, v196, v197
  v_cvt_pk_bf16_f32 v179, v198, v199
  v_mfma_f32_16x16x32_bf16 a[224:227], a[96:99], v[188:191], a[224:227]
  ds_read_b128 a[76:79], v18 offset:3072
  v_add_u32 v45, 0x10000, v37
  v_mfma_f32_16x16x32_bf16 v[216:219], v[232:235], v[176:179], v[220:223]
  ds_read_b128 a[68:71], v18 offset:1024
  v_xor_b32 v56, 6, v53
  v_mfma_f32_16x16x32_bf16 a[228:231], a[100:103], v[188:191], a[228:231]
  ds_read_b128 a[96:99], v18 offset:16384
  v_lshl_add_u32 v38, v56, 5, v54
  v_mfma_f32_16x16x32_bf16 a[196:199], a[100:103], v[184:187], a[196:199]
  v_exp_f32 v192, v104
  v_mfma_f32_16x16x32_bf16 a[164:167], a[100:103], v[172:175], a[164:167]
  buffer_load_dwordx4 v19, s[60:63], 0 offen offset:1024 sc1 lds
  ds_read_b128 a[100:103], v18 offset:17408
  v_mfma_f32_16x16x32_bf16 a[168:171], a[104:107], v[172:175], a[168:171]
  v_exp_f32 v193, v105
  v_add_u32 v46, 0x10000, v38
  v_mfma_f32_16x16x32_bf16 a[200:203], a[104:107], v[184:187], a[200:203]
  v_exp_f32 v194, v106
  v_xor_b32 v56, 7, v53
  v_mfma_f32_16x16x32_bf16 a[232:235], a[104:107], v[188:191], a[232:235]
  ds_read_b128 a[104:107], v18 offset:18432
  v_cvt_pk_bf16_f32 v180, v192, v193
  v_mfma_f32_16x16x32_bf16 a[236:239], a[108:111], v[188:191], a[236:239]
  v_exp_f32 v195, v107
  v_mfma_f32_16x16x32_bf16 a[204:207], a[108:111], v[184:187], a[204:207]
  s_waitcnt lgkmcnt(2)
  v_exp_f32 v196, v108
  v_mfma_f32_16x16x32_bf16 a[172:175], a[108:111], v[172:175], a[172:175]
  ds_read_b128 a[108:111], v18 offset:19456
  v_cvt_pk_bf16_f32 v181, v194, v195
  v_mfma_f32_16x16x32_bf16 a[176:179], a[112:115], v[172:175], a[176:179]
  v_exp_f32 v197, v109
  v_mfma_f32_16x16x32_bf16 a[208:211], a[112:115], v[184:187], a[208:211]
  buffer_load_dwordx4 v19, s[60:63], 0 offen offset:2048 sc1 lds
  v_lshl_add_u32 v39, v56, 5, v54
  v_mfma_f32_16x16x32_bf16 a[240:243], a[112:115], v[188:191], a[240:243]
  v_exp_f32 v198, v110
  v_mfma_f32_16x16x32_bf16 a[244:247], a[116:119], v[188:191], a[244:247]
  v_exp_f32 v199, v111
  v_mfma_f32_16x16x32_bf16 a[212:215], a[116:119], v[184:187], a[212:215]
  v_cvt_pk_bf16_f32 v182, v196, v197
  v_cvt_pk_bf16_f32 v183, v198, v199
  v_mfma_f32_16x16x32_bf16 a[180:183], a[116:119], v[172:175], a[180:183]
  ds_read_b128 a[112:115], v18 offset:20480
  v_add_u32 v47, 0x10000, v39
  v_mfma_f32_16x16x32_bf16 v[224:227], v[232:235], v[180:183], v[228:231]
  ds_read_b128 a[116:119], v18 offset:21504
  v_and_b32 v15, 7, v25
  v_mfma_f32_16x16x32_bf16 a[184:187], a[120:123], v[172:175], a[184:187]
L_pg11:
  s_cbranch_execz L_walk1
  v_lshlrev_b32 v15, 2, v15
  v_lshlrev_b32 v16, 10, v59
  v_mfma_f32_16x16x32_bf16 a[216:219], a[120:123], v[184:187], a[216:219]
  v_lshl_add_u32 v16, v58, 3, v16
  s_lshl_b32 s72, s33, 7
  v_mfma_f32_16x16x32_bf16 a[248:251], a[120:123], v[188:191], a[248:251]
  buffer_load_dwordx4 v19, s[60:63], 0 offen offset:3072 sc1 lds
  ds_read_b128 a[120:123], v18 offset:22528
  v_mfma_f32_16x16x32_bf16 a[252:255], a[124:127], v[188:191], a[252:255]
  s_waitcnt lgkmcnt(3)
  v_add_f32 v252, v216, v224
  v_cmp_nge_f32 vcc, s85, v252
  v_mfma_f32_16x16x32_bf16 a[220:223], a[124:127], v[184:187], a[220:223]
  s_add_u32 s72, s72, 67121152
  v_and_b32 v26, 31, v25
  v_lshl_add_u32 v26, v26, 2, s72
  v_mfma_f32_16x16x32_bf16 a[188:191], a[124:127], v[172:175], a[188:191]
  s_cbranch_vccnz L_T2B_rare
L_T2B_rarer:
  s_cmp_lg_u32 s16, 0
  s_cbranch_scc1 L_sig_h0
  s_cmp_lg_u32 s34, 0
  s_cbranch_scc1 L_sig_h0
  s_mov_b64 exec, 1
  v_mov_b32 v236, s101
  buffer_store_dword v236, off, s[48:51], s92 sc1
  s_mov_b64 exec, -1
L_sig_h0:
  v_rcp_f32 v64, v204
  v_rcp_f32 v65, v204
  v_accvgpr_read_b32 v72, a128
  v_accvgpr_read_b32 v73, a129
  v_accvgpr_read_b32 v74, a130
  v_accvgpr_read_b32 v75, a131
  v_accvgpr_read_b32 v76, a132
  v_accvgpr_read_b32 v77, a133
  v_accvgpr_read_b32 v78, a134
  v_accvgpr_read_b32 v79, a135
  v_pk_mul_f32 v[72:73], v[72:73], v[64:65]
  v_pk_mul_f32 v[74:75], v[74:75], v[64:65]
  v_pk_mul_f32 v[76:77], v[76:77], v[64:65]
  v_pk_mul_f32 v[78:79], v[78:79], v[64:65]
  v_cvt_pk_bf16_f32 v68, v72, v73
  v_cvt_pk_bf16_f32 v69, v74, v75
  v_cvt_pk_bf16_f32 v70, v76, v77
  v_cvt_pk_bf16_f32 v71, v78, v79
  v_accvgpr_read_b32 v84, a136
  v_accvgpr_read_b32 v85, a137
  v_accvgpr_read_b32 v86, a138
  v_accvgpr_read_b32 v87, a139
  buffer_store_dwordx4 v[68:71], v22, s[48:51], s83 offen offset:0 sc1
  v_accvgpr_read_b32 v88, a140
  v_accvgpr_read_b32 v89, a141
  v_accvgpr_read_b32 v90, a142
  v_accvgpr_read_b32 v91, a143
  v_pk_mul_f32 v[84:85], v[84:85], v[64:65]
  v_pk_mul_f32 v[86:87], v[86:87], v[64:65]
  v_pk_mul_f32 v[88:89], v[88:89], v[64:65]
  v_pk_mul_f32 v[90:91], v[90:91], v[64:65]
  v_cvt_pk_bf16_f32 v80, v84, v85
  v_cvt_pk_bf16_f32 v81, v86, v87
  v_cvt_pk_bf16_f32 v82, v88, v89
  v_cvt_pk_bf16_f32 v83, v90, v91
  v_accvgpr_read_b32 v72, a144
  v_accvgpr_read_b32 v73, a145
  v_accvgpr_read_b32 v74, a146
  v_accvgpr_read_b32 v75, a147
  buffer_store_dwordx4 v[80:83], v22, s[48:51], s83 offen offset:2048 sc1
  s_add_u32 s83, s83, 4096
  v_accvgpr_read_b32 v76, a148
  v_accvgpr_read_b32 v77, a149
  v_accvgpr_read_b32 v78, a150
  v_accvgpr_read_b32 v79, a151
  v_pk_mul_f32 v[72:73], v[72:73], v[64:65]
  v_pk_mul_f32 v[74:75], v[74:75], v[64:65]
  v_pk_mul_f32 v[76:77], v[76:77], v[64:65]
  v_pk_mul_f32 v[78:79], v[78:79], v[64:65]
  v_cvt_pk_bf16_f32 v68, v72, v73
  v_cvt_pk_bf16_f32 v69, v74, v75
  v_cvt_pk_bf16_f32 v70, v76, v77
  v_cvt_pk_bf16_f32 v71, v78, v79
  v_accvgpr_read_b32 v84, a152
  v_accvgpr_read_b32 v85, a153
  v_accvgpr_read_b32 v86, a154
  v_accvgpr_read_b32 v87, a155
  buffer_store_dwordx4 v[68:71], v22, s[48:51], s83 offen offset:0 sc1
  v_accvgpr_read_b32 v88, a156
  v_accvgpr_read_b32 v89, a157
  v_accvgpr_read_b32 v90, a158
  v_accvgpr_read_b32 v91, a159
  v_pk_mul_f32 v[84:85], v[84:85], v[64:65]
  v_pk_mul_f32 v[86:87], v[86:87], v[64:65]
  v_pk_mul_f32 v[88:89], v[88:89], v[64:65]
  v_pk_mul_f32 v[90:91], v[90:91], v[64:65]
  v_cvt_pk_bf16_f32 v80, v84, v85
  v_cvt_pk_bf16_f32 v81, v86, v87
  v_cvt_pk_bf16_f32 v82, v88, v89
  v_cvt_pk_bf16_f32 v83, v90, v91
  buffer_store_dwordx4 v[80:83], v22, s[48:51], s83 offen offset:2048 sc1
  v_rcp_f32 v64, v212
  v_rcp_f32 v65, v212
  v_accvgpr_read_b32 v72, a160
  v_accvgpr_read_b32 v73, a161
  v_accvgpr_read_b32 v74, a162
  v_accvgpr_read_b32 v75, a163
  v_accvgpr_read_b32 v76, a164
  v_accvgpr_read_b32 v77, a165
  v_accvgpr_read_b32 v78, a166
  v_accvgpr_read_b32 v79, a167
  v_pk_mul_f32 v[72:73], v[72:73], v[64:65]
  v_pk_mul_f32 v[74:75], v[74:75], v[64:65]
  v_pk_mul_f32 v[76:77], v[76:77], v[64:65]
  v_pk_mul_f32 v[78:79], v[78:79], v[64:65]
  v_cvt_pk_bf16_f32 v68, v72, v73
  v_cvt_pk_bf16_f32 v69, v74, v75
  v_cvt_pk_bf16_f32 v70, v76, v77
  v_cvt_pk_bf16_f32 v71, v78, v79
  v_accvgpr_read_b32 v84, a168
  v_accvgpr_read_b32 v85, a169
  v_accvgpr_read_b32 v86, a170
  v_accvgpr_read_b32 v87, a171
  buffer_store_dwordx4 v[68:71], v22, s[48:51], s84 offen offset:0 sc1
  v_accvgpr_read_b32 v88, a172
  v_accvgpr_read_b32 v89, a173
  v_accvgpr_read_b32 v90, a174
  v_accvgpr_read_b32 v91, a175
  v_pk_mul_f32 v[84:85], v[84:85], v[64:65]
  v_pk_mul_f32 v[86:87], v[86:87], v[64:65]
  v_pk_mul_f32 v[88:89], v[88:89], v[64:65]
  v_pk_mul_f32 v[90:91], v[90:91], v[64:65]
  v_cvt_pk_bf16_f32 v80, v84, v85
  v_cvt_pk_bf16_f32 v81, v86, v87
  v_cvt_pk_bf16_f32 v82, v88, v89
  v_cvt_pk_bf16_f32 v83, v90, v91
  v_accvgpr_read_b32 v72, a176
  v_accvgpr_read_b32 v73, a177
  v_accvgpr_read_b32 v74, a178
  v_accvgpr_read_b32 v75, a179
  buffer_store_dwordx4 v[80:83], v22, s[48:51], s84 offen offset:2048 sc1
  s_add_u32 s84, s84, 4096
  v_accvgpr_read_b32 v76, a180
  v_accvgpr_read_b32 v77, a181
  v_accvgpr_read_b32 v78, a182
  v_accvgpr_read_b32 v79, a183
  v_pk_mul_f32 v[72:73], v[72:73], v[64:65]
  v_pk_mul_f32 v[74:75], v[74:75], v[64:65]
  v_pk_mul_f32 v[76:77], v[76:77], v[64:65]
  v_pk_mul_f32 v[78:79], v[78:79], v[64:65]
  v_cvt_pk_bf16_f32 v68, v72, v73
  v_cvt_pk_bf16_f32 v69, v74, v75
  v_cvt_pk_bf16_f32 v70, v76, v77
  v_cvt_pk_bf16_f32 v71, v78, v79
  v_accvgpr_read_b32 v84, a184
  v_accvgpr_read_b32 v85, a185
  v_accvgpr_read_b32 v86, a186
  v_accvgpr_read_b32 v87, a187
  buffer_store_dwordx4 v[68:71], v22, s[48:51], s84 offen offset:0 sc1
  v_accvgpr_read_b32 v88, a188
  v_accvgpr_read_b32 v89, a189
  v_accvgpr_read_b32 v90, a190
  v_accvgpr_read_b32 v91, a191
  v_pk_mul_f32 v[84:85], v[84:85], v[64:65]
  v_pk_mul_f32 v[86:87], v[86:87], v[64:65]
  v_pk_mul_f32 v[88:89], v[88:89], v[64:65]
  v_pk_mul_f32 v[90:91], v[90:91], v[64:65]
  v_cvt_pk_bf16_f32 v80, v84, v85
  v_cvt_pk_bf16_f32 v81, v86, v87
  v_cvt_pk_bf16_f32 v82, v88, v89
  v_cvt_pk_bf16_f32 v83, v90, v91
  buffer_store_dwordx4 v[80:83], v22, s[48:51], s84 offen offset:2048 sc1
  s_add_u32 s78, s80, 1
  s_lshl_b32 s78, s78, 14
  s_mov_b32 s88, s78
  s_cmp_lg_u32 s82, s78
  s_cbranch_scc1 L_S
L_Sx:
  buffer_load_dword v28, v26, s[48:51], 0 offen sc1
  s_mov_b64 exec, 0
  s_cmp_eq_u32 s34, 0
  s_cbranch_scc1 L_pg13
  s_cmp_eq_u32 s34, 1
  s_cbranch_scc1 L_pg14
  s_cmp_eq_u32 s34, 2
  s_cbranch_scc1 L_pg15
  s_branch L_pg16
L_walk2:
  s_mov_b64 exec, -1
  s_add_u32 s88, s88, 16384
L_S:
  v_mfma_f32_16x16x32_bf16 v[96:99], a[64:67], a[32:35], v[144:147]
  s_xor_b32 m0, m0, 0x4000
  ds_read_b128 a[124:127], v18 offset:23552
  v_add_u32 v19, 0x4000, v19
  v_mfma_f32_16x16x32_bf16 v[96:99], a[72:75], a[40:43], v[96:99]
  s_add_u32 s82, s82, 16384
  v_exp_f32 v192, v112
  v_mfma_f32_16x16x32_bf16 v[96:99], a[80:83], a[48:51], v[96:99]
  v_exp_f32 v193, v113
  v_mfma_f32_16x16x32_bf16 v[96:99], a[88:91], a[56:59], v[96:99]
  v_exp_f32 v194, v114
  v_mfma_f32_16x16x32_bf16 v[104:107], a[88:91], a[60:63], v[152:155]
  ds_read_b128 a[88:91], v18 offset:14336
  v_cvt_pk_bf16_f32 v184, v192, v193
  v_mfma_f32_16x16x32_bf16 v[104:107], a[80:83], a[52:55], v[104:107]
  v_exp_f32 v195, v115
  v_mfma_f32_16x16x32_bf16 v[104:107], a[72:75], a[44:47], v[104:107]
  s_waitcnt lgkmcnt(2)
  v_exp_f32 v196, v116
  v_mfma_f32_16x16x32_bf16 v[104:107], a[64:67], a[36:39], v[104:107]
  ds_read_b128 a[80:83], v18 offset:12288
  v_cvt_pk_bf16_f32 v185, v194, v195
  v_mfma_f32_16x16x32_bf16 v[108:111], a[68:71], a[36:39], v[156:159]
  s_cmp_eq_u32 s82, s88
  v_exp_f32 v197, v117
  v_mfma_f32_16x16x32_bf16 v[108:111], a[76:79], a[44:47], v[108:111]
  s_cselect_b32 s89, -1.0, s85
  v_exp_f32 v198, v118
  v_mfma_f32_16x16x32_bf16 v[108:111], a[84:87], a[52:55], v[108:111]
  v_exp_f32 v199, v119
  v_mfma_f32_16x16x32_bf16 v[108:111], a[92:95], a[60:63], v[108:111]
  ds_read_b128 a[72:75], v18 offset:10240
  v_cvt_pk_bf16_f32 v186, v196, v197
  v_mfma_f32_16x16x32_bf16 v[100:103], a[92:95], a[56:59], v[148:151]
  ds_read_b128 a[64:67], v18 offset:8192
  v_cvt_pk_bf16_f32 v187, v198, v199
  v_mfma_f32_16x16x32_bf16 v[100:103], a[84:87], a[48:51], v[100:103]
  v_exp_f32 v192, v120
  v_mfma_f32_16x16x32_bf16 v[220:223], v[232:235], v[184:187], v[216:219]
  buffer_load_dwordx4 v19, s[56:59], 0 offen offset:0 sc1 lds
  ds_read_b128 a[92:95], v18 offset:15360
  v_mfma_f32_16x16x32_bf16 v[100:103], a[76:79], a[40:43], v[100:103]
  v_exp_f32 v193, v121
  v_mfma_f32_16x16x32_bf16 v[100:103], a[68:71], a[32:35], v[100:103]
  v_exp_f32 v194, v122
  v_mfma_f32_16x16x32_bf16 a[192:195], a[96:99], v[176:179], a[192:195]
  ds_read_b128 a[84:87], v18 offset:13312
  v_cvt_pk_bf16_f32 v188, v192, v193
  v_mfma_f32_16x16x32_bf16 a[224:227], a[96:99], v[180:183], a[224:227]
  v_exp_f32 v195, v123
  v_mfma_f32_16x16x32_bf16 a[228:231], a[100:103], v[180:183], a[228:231]
  v_exp_f32 v196, v124
  v_mfma_f32_16x16x32_bf16 a[196:199], a[100:103], v[176:179], a[196:199]
  buffer_load_dwordx4 v19, s[56:59], 0 offen offset:1024 sc1 lds
  ds_read_b128 a[76:79], v18 offset:11264
  v_mfma_f32_16x16x32_bf16 a[200:203], a[104:107], v[176:179], a[200:203]
  ds_read_b128 a[68:71], v18 offset:9216
  v_cvt_pk_bf16_f32 v189, v194, v195
  v_mfma_f32_16x16x32_bf16 a[232:235], a[104:107], v[180:183], a[232:235]
  v_exp_f32 v197, v125
  v_mfma_f32_16x16x32_bf16 a[236:239], a[108:111], v[180:183], a[236:239]
  v_exp_f32 v198, v126
  v_mfma_f32_16x16x32_bf16 a[204:207], a[108:111], v[176:179], a[204:207]
  v_exp_f32 v199, v127
  v_mfma_f32_16x16x32_bf16 a[208:211], a[112:115], v[176:179], a[208:211]
  v_cvt_pk_bf16_f32 v190, v196, v197
  v_cvt_pk_bf16_f32 v191, v198, v199
  v_mfma_f32_16x16x32_bf16 a[240:243], a[112:115], v[180:183], a[240:243]
  buffer_load_dwordx4 v19, s[56:59], 0 offen offset:2048 sc1 lds
  ds_read_b128 a[96:99], v18 offset:24576
  v_mfma_f32_16x16x32_bf16 v[228:231], v[232:235], v[188:191], v[224:227]
  ds_read_b128 a[100:103], v18 offset:25600
  ds_read_b128 a[104:107], v18 offset:26624
  v_mfma_f32_16x16x32_bf16 a[244:247], a[116:119], v[180:183], a[244:247]
  ds_read_b128 a[108:111], v18 offset:27648
  v_mfma_f32_16x16x32_bf16 a[212:215], a[116:119], v[176:179], a[212:215]
  ds_read_b128 a[112:115], v18 offset:28672
  v_mfma_f32_16x16x32_bf16 a[216:219], a[120:123], v[176:179], a[216:219]
  ds_read_b128 a[116:119], v18 offset:29696
  v_mfma_f32_16x16x32_bf16 a[248:251], a[120:123], v[180:183], a[248:251]
  s_waitcnt lgkmcnt(6)
  v_add_f32 v252, v220, v228
  v_cmp_nge_f32 vcc, s85, v252
  v_mfma_f32_16x16x32_bf16 a[252:255], a[124:127], v[180:183], a[252:255]
  buffer_load_dwordx4 v19, s[56:59], 0 offen offset:3072 sc1 lds
  ds_read_b128 a[120:123], v18 offset:30720
  v_mfma_f32_16x16x32_bf16 a[220:223], a[124:127], v[176:179], a[220:223]
  s_cbranch_vccnz L_SA_rare
L_SA_rarer:
  v_mfma_f32_16x16x32_bf16 v[112:115], a[64:67], a[32:35], v[144:147]
  ds_read_b128 a[124:127], v18 offset:31744
  v_xor_b32 v18, s81, v18
  v_mfma_f32_16x16x32_bf16 v[112:115], a[72:75], a[40:43], v[112:115]
  s_xor_b32 s81, s81, 0x18000
  v_exp_f32 v192, v96
  v_mfma_f32_16x16x32_bf16 v[112:115], a[80:83], a[48:51], v[112:115]
  s_xor_b32 m0, m0, s81
  v_exp_f32 v193, v97
  v_mfma_f32_16x16x32_bf16 v[112:115], a[88:91], a[56:59], v[112:115]
  s_xor_b32 m0, m0, 0x4000
  v_exp_f32 v194, v98
  v_mfma_f32_16x16x32_bf16 v[120:123], a[88:91], a[60:63], v[152:155]
  v_cvt_pk_bf16_f32 v176, v192, v193
  v_exp_f32 v195, v99
  v_mfma_f32_16x16x32_bf16 v[120:123], a[80:83], a[52:55], v[120:123]
  v_exp_f32 v196, v100
  v_mfma_f32_16x16x32_bf16 v[120:123], a[72:75], a[44:47], v[120:123]
  s_waitcnt vmcnt(16) lgkmcnt(0)
  s_barrier
  v_mfma_f32_16x16x32_bf16 v[120:123], a[64:67], a[36:39], v[120:123]
  ds_read_b128 a[64:67], v18 offset:0
  v_cvt_pk_bf16_f32 v177, v194, v195
  v_mfma_f32_16x16x32_bf16 v[124:127], a[68:71], a[36:39], v[156:159]
  v_exp_f32 v197, v101
  v_mfma_f32_16x16x32_bf16 v[124:127], a[76:79], a[44:47], v[124:127]
  v_exp_f32 v198, v102
  v_mfma_f32_16x16x32_bf16 v[124:127], a[84:87], a[52:55], v[124:127]
  v_exp_f32 v199, v103
  v_mfma_f32_16x16x32_bf16 v[124:127], a[92:95], a[60:63], v[124:127]
  ds_read_b128 a[72:75], v18 offset:2048
  v_cvt_pk_bf16_f32 v178, v196, v197
  v_mfma_f32_16x16x32_bf16 v[116:119], a[92:95], a[56:59], v[148:151]
  ds_read_b128 a[80:83], v18 offset:4096
  v_cvt_pk_bf16_f32 v179, v198, v199
  v_mfma_f32_16x16x32_bf16 v[116:119], a[84:87], a[48:51], v[116:119]
  v_exp_f32 v192, v104
  v_mfma_f32_16x16x32_bf16 v[216:219], v[232:235], v[176:179], v[220:223]
  buffer_load_dwordx4 v19, s[60:63], 0 offen offset:0 sc1 lds
  ds_read_b128 a[88:91], v18 offset:6144
  v_mfma_f32_16x16x32_bf16 v[116:119], a[76:79], a[40:43], v[116:119]
  v_exp_f32 v193, v105
  v_mfma_f32_16x16x32_bf16 v[116:119], a[68:71], a[32:35], v[116:119]
  v_exp_f32 v194, v106
  v_mfma_f32_16x16x32_bf16 a[192:195], a[96:99], v[184:187], a[192:195]
  ds_read_b128 a[92:95], v18 offset:7168
  v_cvt_pk_bf16_f32 v180, v192, v193
  v_mfma_f32_16x16x32_bf16 a[224:227], a[96:99], v[188:191], a[224:227]
  v_exp_f32 v195, v107
  v_mfma_f32_16x16x32_bf16 a[228:231], a[100:103], v[188:191], a[228:231]
  v_exp_f32 v196, v108
  v_mfma_f32_16x16x32_bf16 a[196:199], a[100:103], v[184:187], a[196:199]
  buffer_load_dwordx4 v19, s[60:63], 0 offen offset:1024 sc1 lds
  ds_read_b128 a[84:87], v18 offset:5120
  v_mfma_f32_16x16x32_bf16 a[200:203], a[104:107], v[184:187], a[200:203]
  ds_read_b128 a[76:79], v18 offset:3072
  v_cvt_pk_bf16_f32 v181, v194, v195
  v_mfma_f32_16x16x32_bf16 a[232:235], a[104:107], v[188:191], a[232:235]
  v_exp_f32 v197, v109
  v_mfma_f32_16x16x32_bf16 a[236:239], a[108:111], v[188:191], a[236:239]
  v_exp_f32 v198, v110
  v_mfma_f32_16x16x32_bf16 a[204:207], a[108:111], v[184:187], a[204:207]
  v_exp_f32 v199, v111
  v_mfma_f32_16x16x32_bf16 a[208:211], a[112:115], v[184:187], a[208:211]
  v_cvt_pk_bf16_f32 v182, v196, v197
  v_cvt_pk_bf16_f32 v183, v198, v199
  v_mfma_f32_16x16x32_bf16 a[240:243], a[112:115], v[188:191], a[240:243]
  buffer_load_dwordx4 v19, s[60:63], 0 offen offset:2048 sc1 lds
  ds_read_b128 a[68:71], v18 offset:1024
  v_mfma_f32_16x16x32_bf16 v[224:227], v[232:235], v[180:183], v[228:231]
  ds_read_b128 a[96:99], v18 offset:16384
  ds_read_b128 a[100:103], v18 offset:17408
  v_mfma_f32_16x16x32_bf16 a[244:247], a[116:119], v[188:191], a[244:247]
  ds_read_b128 a[104:107], v18 offset:18432
  ds_read_b128 a[108:111], v18 offset:19456
  v_mfma_f32_16x16x32_bf16 a[212:215], a[116:119], v[184:187], a[212:215]
  ds_read_b128 a[112:115], v18 offset:20480
  v_mfma_f32_16x16x32_bf16 a[216:219], a[120:123], v[184:187], a[216:219]
  ds_read_b128 a[116:119], v18 offset:21504
  v_mfma_f32_16x16x32_bf16 a[248:251], a[120:123], v[188:191], a[248:251]
  s_waitcnt lgkmcnt(7)
  v_add_f32 v252, v216, v224
  v_cmp_nge_f32 vcc, s89, v252
  v_mfma_f32_16x16x32_bf16 a[252:255], a[124:127], v[188:191], a[252:255]
  buffer_load_dwordx4 v19, s[60:63], 0 offen offset:3072 sc1 lds
  ds_read_b128 a[120:123], v18 offset:22528
  v_mfma_f32_16x16x32_bf16 a[220:223], a[124:127], v[184:187], a[220:223]
  s_cbranch_vccz L_S
  v_cmp_nge_f32 vcc, s85, v252
  s_cbranch_vccnz L_SB_rare
L_SB_rarer:
  s_cmp_eq_u32 s82, s78
  s_cbranch_scc1 L_Sx
  s_waitcnt vmcnt(8)
  v_cmp_ne_u32 vcc, s101, v28
  v_max_f32_e64 v248, s68, v29
  v_max_f32_e64 v249, s68, v30
  v_max_f32_e64 v250, s68, v31
  v_max_f32_e64 v251, s68, v14
  v_min_f32 v144, v144, v248
  v_min_f32 v145, v145, v249
  v_min_f32 v146, v146, v250
  v_min_f32 v147, v147, v251
  v_max_f32_e64 v248, s99, v29
  v_max_f32_e64 v249, s99, v30
  v_max_f32_e64 v250, s99, v31
  v_max_f32_e64 v251, s99, v14
  v_min3_f32 v148, v148, v248, s68
  v_min3_f32 v149, v149, v249, s68
  v_min3_f32 v150, v150, v250, s68
  v_min3_f32 v151, v151, v251, s68
  s_cbranch_vccnz L_spin_h
L_spin_h_r:
  s_nop 0
  v_mfma_f32_16x16x32_bf16 v[96:99], a[64:67], a[32:35], v[144:147]
  ds_read_b128 a[124:127], v18 offset:23552
  v_mfma_f32_16x16x32_bf16 v[96:99], a[72:75], a[40:43], v[96:99]
  v_exp_f32 v192, v112
  v_mfma_f32_16x16x32_bf16 v[96:99], a[80:83], a[48:51], v[96:99]
  v_exp_f32 v193, v113
  v_mfma_f32_16x16x32_bf16 v[96:99], a[88:91], a[56:59], v[96:99]
  s_add_u32 m0, s69, 131072
  v_exp_f32 v194, v114
  v_mfma_f32_16x16x32_bf16 v[104:107], a[88:91], a[60:63], v[152:155]
  ds_read_b128 a[88:91], v18 offset:14336
  buffer_load_dwordx4 v2, s[40:43], s66 offen offset:0 sc1 lds
  v_mfma_f32_16x16x32_bf16 v[104:107], a[80:83], a[52:55], v[104:107]
  ds_read_b128 a[80:83], v18 offset:12288
  v_cvt_pk_bf16_f32 v184, v192, v193
  v_mfma_f32_16x16x32_bf16 v[104:107], a[72:75], a[44:47], v[104:107]
  s_waitcnt lgkmcnt(3)
  v_exp_f32 v195, v115
  v_mfma_f32_16x16x32_bf16 v[104:107], a[64:67], a[36:39], v[104:107]
  v_exp_f32 v196, v116
  v_mfma_f32_16x16x32_bf16 v[108:111], a[68:71], a[36:39], v[156:159]
  ds_read_b128 a[72:75], v18 offset:10240
  v_cvt_pk_bf16_f32 v185, v194, v195
  v_mfma_f32_16x16x32_bf16 v[108:111], a[76:79], a[44:47], v[108:111]
  buffer_load_dwordx4 v3, s[40:43], s66 offen offset:1024 sc1 lds
  v_exp_f32 v197, v117
  v_mfma_f32_16x16x32_bf16 v[108:111], a[84:87], a[52:55], v[108:111]
  v_exp_f32 v198, v118
  v_mfma_f32_16x16x32_bf16 v[108:111], a[92:95], a[60:63], v[108:111]
  buffer_load_dwordx4 v4, s[40:43], s66 offen offset:2048 sc1 lds
  v_exp_f32 v199, v119
  v_mfma_f32_16x16x32_bf16 v[100:103], a[92:95], a[56:59], v[148:151]
  ds_read_b128 a[64:67], v18 offset:8192
  v_cvt_pk_bf16_f32 v186, v196, v197
  v_mfma_f32_16x16x32_bf16 v[100:103], a[84:87], a[48:51], v[100:103]
  ds_read_b128 a[92:95], v18 offset:15360
  v_cvt_pk_bf16_f32 v187, v198, v199
  v_mfma_f32_16x16x32_bf16 v[100:103], a[76:79], a[40:43], v[100:103]
  buffer_load_dwordx4 v5, s[40:43], s66 offen offset:3072 sc1 lds
  v_exp_f32 v192, v120
  v_mfma_f32_16x16x32_bf16 v[220:223], v[232:235], v[184:187], v[216:219]
  v_exp_f32 v193, v121
  v_mfma_f32_16x16x32_bf16 v[100:103], a[68:71], a[32:35], v[100:103]
  v_exp_f32 v194, v122
  v_mfma_f32_16x16x32_bf16 a[192:195], a[96:99], v[176:179], a[192:195]
  s_add_u32 s66, s66, 65536
  ds_read_b128 a[84:87], v18 offset:13312
  v_cvt_pk_bf16_f32 v188, v192, v193
  v_mfma_f32_16x16x32_bf16 a[224:227], a[96:99], v[180:183], a[224:227]
  v_exp_f32 v195, v123
  v_max_f32_e64 v248, s20, v29
  v_mfma_f32_16x16x32_bf16 a[228:231], a[100:103], v[180:183], a[228:231]
  v_exp_f32 v196, v124
  v_max_f32_e64 v249, s20, v30
  v_mfma_f32_16x16x32_bf16 a[196:199], a[100:103], v[176:179], a[196:199]
  ds_read_b128 a[76:79], v18 offset:11264
  buffer_load_dwordx4 a[0:3], v6, s[48:51], s64 offen offset:0 sc1
  v_cvt_pk_bf16_f32 v189, v194, v195
  v_mfma_f32_16x16x32_bf16 a[200:203], a[104:107], v[176:179], a[200:203]
  v_exp_f32 v197, v125
  v_max_f32_e64 v250, s20, v31
  v_mfma_f32_16x16x32_bf16 a[232:235], a[104:107], v[180:183], a[232:235]
  v_exp_f32 v198, v126
  v_max_f32_e64 v251, s20, v14
  v_mfma_f32_16x16x32_bf16 a[236:239], a[108:111], v[180:183], a[236:239]
  buffer_load_dwordx4 a[8:11], v7, s[48:51], s64 offen offset:0 sc1
  v_exp_f32 v199, v127
  v_min3_f32 v144, v144, v248, s99
  v_mfma_f32_16x16x32_bf16 a[204:207], a[108:111], v[176:179], a[204:207]
  ds_read_b128 a[68:71], v18 offset:9216
  v_cvt_pk_bf16_f32 v190, v196, v197
  v_min3_f32 v145, v145, v249, s99
  v_mfma_f32_16x16x32_bf16 a[208:211], a[112:115], v[176:179], a[208:211]
  ds_read_b128 a[96:99], v18 offset:24576
  buffer_load_dwordx4 a[4:7], v6, s[48:51], s64 offen offset:2048 sc1
  v_cvt_pk_bf16_f32 v191, v198, v199
  v_mfma_f32_16x16x32_bf16 a[240:243], a[112:115], v[180:183], a[240:243]
  ds_read_b128 a[100:103], v18 offset:25600
  v_min3_f32 v146, v146, v250, s99
  v_mfma_f32_16x16x32_bf16 v[228:231], v[232:235], v[188:191], v[224:227]
  ds_read_b128 a[104:107], v18 offset:26624
  v_min3_f32 v147, v147, v251, s99
  v_mfma_f32_16x16x32_bf16 a[244:247], a[116:119], v[180:183], a[244:247]
  ds_read_b128 a[108:111], v18 offset:27648
  buffer_load_dwordx4 a[12:15], v7, s[48:51], s64 offen offset:2048 sc1
  v_min3_f32 v148, v148, v29, s20
  v_mfma_f32_16x16x32_bf16 a[212:215], a[116:119], v[176:179], a[212:215]
  ds_read_b128 a[112:115], v18 offset:28672
  v_min3_f32 v149, v149, v30, s20
  v_mfma_f32_16x16x32_bf16 a[216:219], a[120:123], v[176:179], a[216:219]
  ds_read_b128 a[116:119], v18 offset:29696
  v_min3_f32 v150, v150, v31, s20
  v_mfma_f32_16x16x32_bf16 a[248:251], a[120:123], v[180:183], a[248:251]
  s_waitcnt lgkmcnt(6)
  v_add_f32 v252, v220, v228
  v_cmp_nge_f32 vcc, s85, v252
  v_mfma_f32_16x16x32_bf16 a[252:255], a[124:127], v[180:183], a[252:255]
  s_add_u32 s64, s64, 4096
  ds_read_b128 a[120:123], v18 offset:30720
  v_min3_f32 v151, v151, v14, s20
  v_mfma_f32_16x16x32_bf16 a[220:223], a[124:127], v[176:179], a[220:223]
  s_cbranch_vccnz L_SpA_rare
L_SpA_rarer:
  v_mfma_f32_16x16x32_bf16 v[112:115], a[64:67], a[32:35], v[144:147]
  ds_read_b128 a[124:127], v18 offset:31744
  v_xor_b32 v18, s81, v18
  v_mfma_f32_16x16x32_bf16 v[112:115], a[72:75], a[40:43], v[112:115]
  s_xor_b32 s81, s81, 0x18000
  v_exp_f32 v192, v96
  v_mfma_f32_16x16x32_bf16 v[112:115], a[80:83], a[48:51], v[112:115]
  v_exp_f32 v193, v97
  v_mfma_f32_16x16x32_bf16 v[112:115], a[88:91], a[56:59], v[112:115]
  v_exp_f32 v194, v98
  v_mfma_f32_16x16x32_bf16 v[120:123], a[88:91], a[60:63], v[152:155]
  v_cvt_pk_bf16_f32 v176, v192, v193
  v_mfma_f32_16x16x32_bf16 v[120:123], a[80:83], a[52:55], v[120:123]
  v_exp_f32 v195, v99
  v_mfma_f32_16x16x32_bf16 v[120:123], a[72:75], a[44:47], v[120:123]
  s_waitcnt vmcnt(8) lgkmcnt(0)
  s_barrier
  v_mfma_f32_16x16x32_bf16 v[120:123], a[64:67], a[36:39], v[120:123]
  v_exp_f32 v196, v100
  v_mfma_f32_16x16x32_bf16 v[124:127], a[68:71], a[36:39], v[156:159]
  s_add_u32 m0, s69, 147456
  ds_read_b128 a[64:67], v18 offset:0
  v_cvt_pk_bf16_f32 v177, v194, v195
  v_mfma_f32_16x16x32_bf16 v[124:127], a[76:79], a[44:47], v[124:127]
  v_exp_f32 v197, v101
  v_mfma_f32_16x16x32_bf16 v[124:127], a[84:87], a[52:55], v[124:127]
  buffer_load_dwordx4 v2, s[40:43], s66 offen offset:0 sc1 lds
  v_exp_f32 v198, v102
  v_mfma_f32_16x16x32_bf16 v[124:127], a[92:95], a[60:63], v[124:127]
  v_exp_f32 v199, v103
  v_mfma_f32_16x16x32_bf16 v[116:119], a[92:95], a[56:59], v[148:151]
  ds_read_b128 a[72:75], v18 offset:2048
  buffer_load_dwordx4 v3, s[40:43], s66 offen offset:1024 sc1 lds
  v_cvt_pk_bf16_f32 v178, v196, v197
  v_mfma_f32_16x16x32_bf16 v[116:119], a[84:87], a[48:51], v[116:119]
  ds_read_b128 a[80:83], v18 offset:4096
  v_cvt_pk_bf16_f32 v179, v198, v199
  v_mfma_f32_16x16x32_bf16 v[116:119], a[76:79], a[40:43], v[116:119]
  buffer_load_dwordx4 v4, s[40:43], s66 offen offset:2048 sc1 lds
  v_exp_f32 v192, v104
  v_mfma_f32_16x16x32_bf16 v[216:219], v[232:235], v[176:179], v[220:223]
  buffer_load_dwordx4 v5, s[40:43], s66 offen offset:3072 sc1 lds
  v_exp_f32 v193, v105
  v_mfma_f32_16x16x32_bf16 v[116:119], a[68:71], a[32:35], v[116:119]
  v_exp_f32 v194, v106
  v_mfma_f32_16x16x32_bf16 a[192:195], a[96:99], v[184:187], a[192:195]
  ds_read_b128 a[88:91], v18 offset:6144
  v_cvt_pk_bf16_f32 v180, v192, v193
  v_mfma_f32_16x16x32_bf16 a[224:227], a[96:99], v[188:191], a[224:227]
  s_add_u32 s66, s66, 65536
  v_exp_f32 v195, v107
  v_max_f32_e64 v248, -s20, v29
  v_mfma_f32_16x16x32_bf16 a[228:231], a[100:103], v[188:191], a[228:231]
  v_exp_f32 v196, v108
  v_max_f32_e64 v249, -s20, v30
  v_mfma_f32_16x16x32_bf16 a[196:199], a[100:103], v[184:187], a[196:199]
  ds_read_b128 a[92:95], v18 offset:7168
  buffer_load_dword v8, v12, s[48:51], s11 offen sc1
  v_cvt_pk_bf16_f32 v181, v194, v195
  v_max_f32_e64 v250, -s20, v31
  v_mfma_f32_16x16x32_bf16 a[200:203], a[104:107], v[184:187], a[200:203]
  v_exp_f32 v197, v109
  v_max_f32_e64 v251, -s20, v14
  v_mfma_f32_16x16x32_bf16 a[232:235], a[104:107], v[188:191], a[232:235]
  buffer_load_dword v9, v13, s[48:51], s11 offen sc1
  v_exp_f32 v198, v110
  v_min_f32 v152, v152, v248
  v_mfma_f32_16x16x32_bf16 a[236:239], a[108:111], v[188:191], a[236:239]
  v_exp_f32 v199, v111
  v_min_f32 v153, v153, v249
  v_mfma_f32_16x16x32_bf16 a[204:207], a[108:111], v[184:187], a[204:207]
  ds_read_b128 a[84:87], v18 offset:5120
  buffer_load_dwordx4 a[16:19], v6, s[48:51], s64 offen offset:0 sc1
  v_cvt_pk_bf16_f32 v182, v196, v197
  v_min_f32 v154, v154, v250
  v_mfma_f32_16x16x32_bf16 a[208:211], a[112:115], v[184:187], a[208:211]
  ds_read_b128 a[76:79], v18 offset:3072
  v_cvt_pk_bf16_f32 v183, v198, v199
  v_min_f32 v155, v155, v251
  v_max_f32_e64 v248, -s99, v29
  v_mfma_f32_16x16x32_bf16 a[240:243], a[112:115], v[188:191], a[240:243]
  ds_read_b128 a[68:71], v18 offset:1024
  ds_read_b128 a[96:99], v18 offset:16384
  buffer_load_dwordx4 a[24:27], v7, s[48:51], s64 offen offset:0 sc1
  v_max_f32_e64 v249, -s99, v30
  v_mfma_f32_16x16x32_bf16 v[224:227], v[232:235], v[180:183], v[228:231]
  ds_read_b128 a[100:103], v18 offset:17408
  ds_read_b128 a[104:107], v18 offset:18432
  v_max_f32_e64 v250, -s99, v31
  v_mfma_f32_16x16x32_bf16 a[244:247], a[116:119], v[188:191], a[244:247]
  ds_read_b128 a[108:111], v18 offset:19456
  buffer_load_dwordx4 a[20:23], v6, s[48:51], s64 offen offset:2048 sc1
  v_max_f32_e64 v251, -s99, v14
  v_mfma_f32_16x16x32_bf16 a[212:215], a[116:119], v[184:187], a[212:215]
L_pg12:
  s_cbranch_execz L_walk1
  ds_read_b128 a[112:115], v18 offset:20480
  v_min3_f32 v156, v156, v248, -s20
  v_mfma_f32_16x16x32_bf16 a[216:219], a[120:123], v[184:187], a[216:219]
  ds_read_b128 a[116:119], v18 offset:21504
  buffer_load_dwordx4 a[28:31], v7, s[48:51], s64 offen offset:2048 sc1
  v_min3_f32 v157, v157, v249, -s20
  v_mfma_f32_16x16x32_bf16 a[248:251], a[120:123], v[188:191], a[248:251]
  s_waitcnt lgkmcnt(8)
  v_add_f32 v252, v216, v224
  v_cmp_nge_f32 vcc, s85, v252
  v_min3_f32 v158, v158, v250, -s20
  v_mfma_f32_16x16x32_bf16 a[252:255], a[124:127], v[188:191], a[252:255]
  s_add_u32 s64, s64, 4096
  ds_read_b128 a[120:123], v18 offset:22528
  v_min3_f32 v159, v159, v251, -s20
  v_mfma_f32_16x16x32_bf16 a[220:223], a[124:127], v[184:187], a[220:223]
  s_cbranch_vccnz L_SpB_rare
L_SpB_rarer:
  v_mfma_f32_16x16x32_bf16 v[104:107], a[64:67], a[36:39], v[152:155]
  ds_read_b128 a[124:127], v18 offset:23552
  v_exp_f32 v192, v112
  v_mfma_f32_16x16x32_bf16 v[104:107], a[72:75], a[44:47], v[104:107]
  ds_read_b128 a[64:67], v18 offset:8192
  v_exp_f32 v193, v113
  v_mfma_f32_16x16x32_bf16 v[104:107], a[80:83], a[52:55], v[104:107]
  ds_read_b128 a[72:75], v18 offset:10240
  v_exp_f32 v194, v114
  v_mfma_f32_16x16x32_bf16 v[104:107], a[88:91], a[60:63], v[104:107]
  ds_read_b128 a[80:83], v18 offset:12288
  buffer_load_dwordx4 a[128:131], v6, s[48:51], s64 offen offset:0 sc1
  v_cvt_pk_bf16_f32 v184, v192, v193
  v_mfma_f32_16x16x32_bf16 v[108:111], a[92:95], a[60:63], v[156:159]
  ds_read_b128 a[88:91], v18 offset:14336
  v_exp_f32 v195, v115
  v_mfma_f32_16x16x32_bf16 v[108:111], a[84:87], a[52:55], v[108:111]
  buffer_load_dwordx4 a[136:139], v7, s[48:51], s64 offen offset:0 sc1
  v_exp_f32 v196, v116
  s_waitcnt lgkmcnt(13)
  v_mfma_f32_16x16x32_bf16 v[108:111], a[76:79], a[44:47], v[108:111]
  s_waitcnt lgkmcnt(5)
  v_cvt_pk_bf16_f32 v185, v194, v195
  v_exp_f32 v197, v117
  v_mfma_f32_16x16x32_bf16 v[108:111], a[68:71], a[36:39], v[108:111]
  buffer_load_dwordx4 a[132:135], v6, s[48:51], s64 offen offset:2048 sc1
  v_exp_f32 v198, v118
  v_mfma_f32_16x16x32_bf16 a[192:195], a[96:99], v[176:179], a[192:195]
  v_exp_f32 v199, v119
  v_cvt_pk_bf16_f32 v186, v196, v197
  v_mfma_f32_16x16x32_bf16 a[224:227], a[96:99], v[180:183], a[224:227]
  v_cvt_pk_bf16_f32 v187, v198, v199
  v_exp_f32 v192, v120
  v_max_f32_e64 v248, -s68, v29
  v_mfma_f32_16x16x32_bf16 a[228:231], a[100:103], v[180:183], a[228:231]
  buffer_load_dwordx4 a[140:143], v7, s[48:51], s64 offen offset:2048 sc1
  v_exp_f32 v193, v121
  v_mfma_f32_16x16x32_bf16 v[220:223], v[232:235], v[184:187], v[216:219]
  v_exp_f32 v194, v122
  v_max_f32_e64 v249, -s68, v30
  v_mfma_f32_16x16x32_bf16 a[196:199], a[100:103], v[176:179], a[196:199]
  s_add_u32 s64, s64, 4096
  v_cvt_pk_bf16_f32 v188, v192, v193
  v_exp_f32 v195, v123
  v_max_f32_e64 v250, -s68, v31
  v_mfma_f32_16x16x32_bf16 a[200:203], a[104:107], v[176:179], a[200:203]
  v_exp_f32 v196, v124
  v_max_f32_e64 v251, -s68, v14
  v_mfma_f32_16x16x32_bf16 a[232:235], a[104:107], v[180:183], a[232:235]
  buffer_load_dwordx4 a[144:147], v6, s[48:51], s64 offen offset:0 sc1
  v_cvt_pk_bf16_f32 v189, v194, v195
  v_exp_f32 v197, v125
  v_min3_f32 v152, v152, v248, -s99
  v_mfma_f32_16x16x32_bf16 a[236:239], a[108:111], v[180:183], a[236:239]
  v_exp_f32 v198, v126
  v_mfma_f32_16x16x32_bf16 a[204:207], a[108:111], v[176:179], a[204:207]
  buffer_load_dwordx4 a[152:155], v7, s[48:51], s64 offen offset:0 sc1
  v_exp_f32 v199, v127
  v_min3_f32 v153, v153, v249, -s99
  v_mfma_f32_16x16x32_bf16 a[208:211], a[112:115], v[176:179], a[208:211]
  v_cvt_pk_bf16_f32 v190, v196, v197
  v_cvt_pk_bf16_f32 v191, v198, v199
  v_min3_f32 v154, v154, v250, -s99
  v_mfma_f32_16x16x32_bf16 a[240:243], a[112:115], v[180:183], a[240:243]
  ds_read_b128 a[92:95], v18 offset:15360
  ds_read_b128 a[84:87], v18 offset:13312
  v_mfma_f32_16x16x32_bf16 v[228:231], v[232:235], v[188:191], v[224:227]
  ds_read_b128 a[76:79], v18 offset:11264
  ds_read_b128 a[68:71], v18 offset:9216
  buffer_load_dwordx4 a[148:151], v6, s[48:51], s64 offen offset:2048 sc1
  v_min3_f32 v155, v155, v251, -s99
  v_mfma_f32_16x16x32_bf16 a[244:247], a[116:119], v[180:183], a[244:247]
  ds_read_b128 a[96:99], v18 offset:24576
  ds_read_b128 a[100:103], v18 offset:25600
  v_min3_f32 v156, v156, v29, -s68
  v_mfma_f32_16x16x32_bf16 a[212:215], a[116:119], v[176:179], a[212:215]
  ds_read_b128 a[104:107], v18 offset:26624
  ds_read_b128 a[108:111], v18 offset:27648
  buffer_load_dwordx4 a[156:159], v7, s[48:51], s64 offen offset:2048 sc1
  v_min3_f32 v157, v157, v30, -s68
  v_mfma_f32_16x16x32_bf16 a[216:219], a[120:123], v[176:179], a[216:219]
  ds_read_b128 a[112:115], v18 offset:28672
  ds_read_b128 a[116:119], v18 offset:29696
  v_mfma_f32_16x16x32_bf16 a[248:251], a[120:123], v[180:183], a[248:251]
  s_waitcnt lgkmcnt(10)
  v_add_f32 v252, v220, v228
  v_cmp_nge_f32 vcc, s85, v252
  v_min3_f32 v158, v158, v31, -s68
  v_mfma_f32_16x16x32_bf16 a[252:255], a[124:127], v[180:183], a[252:255]
  s_add_u32 s64, s64, 4096
  ds_read_b128 a[120:123], v18 offset:30720
  v_min3_f32 v159, v159, v14, -s68
  v_mfma_f32_16x16x32_bf16 a[220:223], a[124:127], v[176:179], a[220:223]
  s_cbranch_vccnz L_E1A_rare
L_E1A_rarer:
  v_mfma_f32_16x16x32_bf16 v[120:123], a[64:67], a[36:39], v[152:155]
  ds_read_b128 a[124:127], v18 offset:31744
  v_xor_b32 v18, s81, v18
  v_mfma_f32_16x16x32_bf16 v[120:123], a[72:75], a[44:47], v[120:123]
  s_xor_b32 s81, s81, 0x18000
  v_exp_f32 v192, v104
  v_mfma_f32_16x16x32_bf16 v[120:123], a[80:83], a[52:55], v[120:123]
  v_exp_f32 v193, v105
  v_mfma_f32_16x16x32_bf16 v[120:123], a[88:91], a[60:63], v[120:123]
  s_mul_i32 s83, s17, 1472
  v_exp_f32 v194, v106
  s_waitcnt lgkmcnt(11)
  v_mfma_f32_16x16x32_bf16 v[124:127], a[92:95], a[60:63], v[156:159]
  v_cvt_pk_bf16_f32 v180, v192, v193
  s_waitcnt lgkmcnt(10)
  v_mfma_f32_16x16x32_bf16 v[124:127], a[84:87], a[52:55], v[124:127]
  s_lshl_b32 s84, s32, 3
  v_exp_f32 v195, v107
  s_waitcnt lgkmcnt(9)
  v_mfma_f32_16x16x32_bf16 v[124:127], a[76:79], a[44:47], v[124:127]
  s_waitcnt vmcnt(14) lgkmcnt(0)
  s_barrier
  v_mfma_f32_16x16x32_bf16 v[124:127], a[68:71], a[36:39], v[124:127]
  s_add_u32 s83, s83, s84
  v_exp_f32 v196, v108
  s_add_u32 m0, s69, 32768
  v_mfma_f32_16x16x32_bf16 a[192:195], a[96:99], v[184:187], a[192:195]
  buffer_load_dwordx4 v2, s[40:43], s66 offen offset:0 sc1 lds
  v_cvt_pk_bf16_f32 v181, v194, v195
  v_mfma_f32_16x16x32_bf16 a[224:227], a[96:99], v[188:191], a[224:227]
  s_mul_i32 s35, s77, 368
  ds_read_b128 a[96:99], v18 offset:16384
  v_mfma_f32_16x16x32_bf16 a[228:231], a[100:103], v[188:191], a[228:231]
  s_add_u32 s35, s35, s76
  v_exp_f32 v197, v109
  v_mfma_f32_16x16x32_bf16 a[196:199], a[100:103], v[184:187], a[196:199]
  ds_read_b128 a[100:103], v18 offset:17408
  buffer_load_dwordx4 v3, s[40:43], s66 offen offset:1024 sc1 lds
  v_mfma_f32_16x16x32_bf16 a[200:203], a[104:107], v[184:187], a[200:203]
  s_sub_u32 s84, s83, s35
  v_exp_f32 v198, v110
  v_mfma_f32_16x16x32_bf16 a[232:235], a[104:107], v[188:191], a[232:235]
  ds_read_b128 a[104:107], v18 offset:18432
  buffer_load_dwordx4 v4, s[40:43], s66 offen offset:2048 sc1 lds
  v_mfma_f32_16x16x32_bf16 a[236:239], a[108:111], v[188:191], a[236:239]
  s_add_u32 s83, s83, s35
  v_exp_f32 v199, v111
  v_mfma_f32_16x16x32_bf16 a[204:207], a[108:111], v[184:187], a[204:207]
  ds_read_b128 a[108:111], v18 offset:19456
  buffer_load_dwordx4 v5, s[40:43], s66 offen offset:3072 sc1 lds
  v_mfma_f32_16x16x32_bf16 a[208:211], a[112:115], v[184:187], a[208:211]
  s_add_u32 s66, s66, 65536
  v_cvt_pk_bf16_f32 v182, v196, v197
  v_cvt_pk_bf16_f32 v183, v198, v199
  v_mfma_f32_16x16x32_bf16 a[240:243], a[112:115], v[188:191], a[240:243]
  s_lshl_b32 s83, s83, 10
  ds_read_b128 a[112:115], v18 offset:20480
  s_add_u32 m0, s69, 65536
  v_mfma_f32_16x16x32_bf16 v[224:227], v[232:235], v[180:183], v[228:231]
  buffer_load_dwordx4 v2, s[40:43], s66 offen offset:0 sc1 lds
  v_mfma_f32_16x16x32_bf16 a[244:247], a[116:119], v[188:191], a[244:247]
  s_lshl_b32 s84, s84, 10
  buffer_load_dwordx4 v3, s[40:43], s66 offen offset:1024 sc1 lds
  v_mfma_f32_16x16x32_bf16 a[212:215], a[116:119], v[184:187], a[212:215]
  ds_read_b128 a[116:119], v18 offset:21504
  buffer_load_dwordx4 v4, s[40:43], s66 offen offset:2048 sc1 lds
  v_mfma_f32_16x16x32_bf16 a[216:219], a[120:123], v[184:187], a[216:219]
  s_add_u32 s83, s83, 33669120
  buffer_load_dwordx4 v5, s[40:43], s66 offen offset:3072 sc1 lds
  v_mfma_f32_16x16x32_bf16 a[248:251], a[120:123], v[188:191], a[248:251]
  s_waitcnt lgkmcnt(2)
  ds_read_b128 a[120:123], v18 offset:22528
  v_cmp_nge_f32 vcc, s85, v224
  v_mfma_f32_16x16x32_bf16 a[252:255], a[124:127], v[188:191], a[252:255]
  s_add_u32 s84, s84, 34800640
  s_add_u32 s66, s66, 65536
  v_mfma_f32_16x16x32_bf16 a[220:223], a[124:127], v[184:187], a[220:223]
  s_cbranch_vccnz L_E1B_rare
L_E1B_rarer:
  ds_read_b128 a[124:127], v18 offset:23552
  v_exp_f32 v192, v120
  v_exp_f32 v193, v121
  v_mfma_f32_16x16x32_bf16 a[224:227], a[96:99], v[180:183], a[224:227]
  ds_read_b128 a[96:99], v18 offset:24576
  v_exp_f32 v194, v122
  v_mfma_f32_16x16x32_bf16 a[228:231], a[100:103], v[180:183], a[228:231]
  ds_read_b128 a[100:103], v18 offset:25600
  v_cvt_pk_bf16_f32 v188, v192, v193
  v_mfma_f32_16x16x32_bf16 a[232:235], a[104:107], v[180:183], a[232:235]
  ds_read_b128 a[104:107], v18 offset:26624
  v_exp_f32 v195, v123
  v_mfma_f32_16x16x32_bf16 a[236:239], a[108:111], v[180:183], a[236:239]
  ds_read_b128 a[108:111], v18 offset:27648
  v_exp_f32 v196, v124
  v_cvt_pk_bf16_f32 v189, v194, v195
  s_waitcnt lgkmcnt(7)
  v_mfma_f32_16x16x32_bf16 a[240:243], a[112:115], v[180:183], a[240:243]
  ds_read_b128 a[112:115], v18 offset:28672
  v_exp_f32 v197, v125
  s_waitcnt lgkmcnt(7)
  v_mfma_f32_16x16x32_bf16 a[244:247], a[116:119], v[180:183], a[244:247]
  ds_read_b128 a[116:119], v18 offset:29696
  v_exp_f32 v198, v126
  s_waitcnt lgkmcnt(7)
  v_mfma_f32_16x16x32_bf16 a[248:251], a[120:123], v[180:183], a[248:251]
  ds_read_b128 a[120:123], v18 offset:30720
  v_exp_f32 v199, v127
  s_waitcnt lgkmcnt(7)
  v_mfma_f32_16x16x32_bf16 a[252:255], a[124:127], v[180:183], a[252:255]
  ds_read_b128 a[124:127], v18 offset:31744
  v_cvt_pk_bf16_f32 v190, v196, v197
  v_cvt_pk_bf16_f32 v191, v198, v199
  s_nop 1
  v_mfma_f32_16x16x32_bf16 v[228:231], v[232:235], v[188:191], v[224:227]
  v_rcp_f32 v64, v220
  v_rcp_f32 v65, v220
  v_accvgpr_read_b32 v72, a192
  v_accvgpr_read_b32 v73, a193
  v_accvgpr_read_b32 v74, a194
  v_accvgpr_read_b32 v75, a195
  v_accvgpr_read_b32 v76, a196
  v_accvgpr_read_b32 v77, a197
  v_accvgpr_read_b32 v78, a198
  v_accvgpr_read_b32 v79, a199
  v_pk_mul_f32 v[72:73], v[72:73], v[64:65]
  v_pk_mul_f32 v[74:75], v[74:75], v[64:65]
  v_pk_mul_f32 v[76:77], v[76:77], v[64:65]
  v_pk_mul_f32 v[78:79], v[78:79], v[64:65]
  v_cvt_pk_bf16_f32 v68, v72, v73
  v_cvt_pk_bf16_f32 v69, v74, v75
  v_cvt_pk_bf16_f32 v70, v76, v77
  v_cvt_pk_bf16_f32 v71, v78, v79
  v_accvgpr_read_b32 v84, a200
  v_accvgpr_read_b32 v85, a201
  v_accvgpr_read_b32 v86, a202
  v_accvgpr_read_b32 v87, a203
  buffer_store_dwordx4 v[68:71], v22, s[48:51], s83 offen offset:0 sc1
  buffer_load_dwordx4 a[160:163], v6, s[48:51], s64 offen offset:0 sc1
  buffer_load_dwordx4 a[168:171], v7, s[48:51], s64 offen offset:0 sc1
  v_accvgpr_read_b32 v88, a204
  v_accvgpr_read_b32 v89, a205
  v_accvgpr_read_b32 v90, a206
  v_accvgpr_read_b32 v91, a207
  v_pk_mul_f32 v[84:85], v[84:85], v[64:65]
  v_pk_mul_f32 v[86:87], v[86:87], v[64:65]
  v_pk_mul_f32 v[88:89], v[88:89], v[64:65]
  v_pk_mul_f32 v[90:91], v[90:91], v[64:65]
  v_cvt_pk_bf16_f32 v80, v84, v85
  v_cvt_pk_bf16_f32 v81, v86, v87
  v_cvt_pk_bf16_f32 v82, v88, v89
  v_cvt_pk_bf16_f32 v83, v90, v91
  v_accvgpr_read_b32 v72, a208
  v_accvgpr_read_b32 v73, a209
  v_accvgpr_read_b32 v74, a210
  v_accvgpr_read_b32 v75, a211
  buffer_store_dwordx4 v[80:83], v22, s[48:51], s83 offen offset:2048 sc1
  buffer_load_dwordx4 a[164:167], v6, s[48:51], s64 offen offset:2048 sc1
  buffer_load_dwordx4 a[172:175], v7, s[48:51], s64 offen offset:2048 sc1
  s_add_u32 s64, s64, 4096
  s_add_u32 s83, s83, 4096
  v_accvgpr_read_b32 v76, a212
  v_accvgpr_read_b32 v77, a213
  v_accvgpr_read_b32 v78, a214
  v_accvgpr_read_b32 v79, a215
  v_pk_mul_f32 v[72:73], v[72:73], v[64:65]
  v_pk_mul_f32 v[74:75], v[74:75], v[64:65]
  v_pk_mul_f32 v[76:77], v[76:77], v[64:65]
  v_pk_mul_f32 v[78:79], v[78:79], v[64:65]
  v_cvt_pk_bf16_f32 v68, v72, v73
  v_cvt_pk_bf16_f32 v69, v74, v75
  v_cvt_pk_bf16_f32 v70, v76, v77
  v_cvt_pk_bf16_f32 v71, v78, v79
  v_accvgpr_read_b32 v84, a216
  v_accvgpr_read_b32 v85, a217
  v_accvgpr_read_b32 v86, a218
  v_accvgpr_read_b32 v87, a219
  buffer_store_dwordx4 v[68:71], v22, s[48:51], s83 offen offset:0 sc1
  buffer_load_dwordx4 a[176:179], v6, s[48:51], s64 offen offset:0 sc1
  buffer_load_dwordx4 a[184:187], v7, s[48:51], s64 offen offset:0 sc1
  v_accvgpr_read_b32 v88, a220
  v_accvgpr_read_b32 v89, a221
  v_accvgpr_read_b32 v90, a222
  v_accvgpr_read_b32 v91, a223
  v_pk_mul_f32 v[84:85], v[84:85], v[64:65]
  v_pk_mul_f32 v[86:87], v[86:87], v[64:65]
  v_pk_mul_f32 v[88:89], v[88:89], v[64:65]
  v_cmp_nge_f32 vcc, s85, v228
  v_pk_mul_f32 v[90:91], v[90:91], v[64:65]
  v_cvt_pk_bf16_f32 v80, v84, v85
  v_cvt_pk_bf16_f32 v81, v86, v87
  v_cvt_pk_bf16_f32 v82, v88, v89
  v_cvt_pk_bf16_f32 v83, v90, v91
  buffer_store_dwordx4 v[80:83], v22, s[48:51], s83 offen offset:2048 sc1
  buffer_load_dwordx4 a[180:183], v6, s[48:51], s64 offen offset:2048 sc1
  buffer_load_dwordx4 a[188:191], v7, s[48:51], s64 offen offset:2048 sc1
  s_add_u32 s64, s64, 4096
  s_waitcnt lgkmcnt(0)
  s_cbranch_vccnz L_E2_rare
L_E2_rarer:
  v_rcp_f32 v64, v228
  v_rcp_f32 v65, v228
  v_mfma_f32_16x16x32_bf16 a[224:227], a[96:99], v[188:191], a[224:227]
  s_mov_b32 s60, s26
  ds_read_b64_tr_b16 v[192:193], v40 offset:32768
  ds_read_b64_tr_b16 v[194:195], v40 offset:36864
  v_mfma_f32_16x16x32_bf16 a[228:231], a[100:103], v[188:191], a[228:231]
  s_mov_b32 s61, s27
  ds_read_b64_tr_b16 v[196:197], v40 offset:40960
  ds_read_b64_tr_b16 v[198:199], v40 offset:45056
  v_mfma_f32_16x16x32_bf16 a[232:235], a[104:107], v[188:191], a[232:235]
  s_mov_b32 s62, 2097152
  ds_read_b64_tr_b16 v[200:201], v41 offset:32768
  ds_read_b64_tr_b16 v[202:203], v41 offset:36864
  v_mfma_f32_16x16x32_bf16 a[236:239], a[108:111], v[188:191], a[236:239]
  s_mov_b32 s63, 0x20000
  ds_read_b64_tr_b16 v[204:205], v41 offset:40960
  ds_read_b64_tr_b16 v[206:207], v41 offset:45056
  v_mfma_f32_16x16x32_bf16 a[240:243], a[112:115], v[188:191], a[240:243]
  ds_read_b64_tr_b16 v[208:209], v42 offset:32768
  ds_read_b64_tr_b16 v[210:211], v42 offset:36864
  v_mfma_f32_16x16x32_bf16 a[244:247], a[116:119], v[188:191], a[244:247]
  ds_read_b64_tr_b16 v[212:213], v42 offset:40960
  ds_read_b64_tr_b16 v[214:215], v42 offset:45056
  v_mfma_f32_16x16x32_bf16 a[248:251], a[120:123], v[188:191], a[248:251]
  ds_read_b64_tr_b16 v[216:217], v43 offset:32768
  ds_read_b64_tr_b16 v[218:219], v43 offset:36864
  v_mfma_f32_16x16x32_bf16 a[252:255], a[124:127], v[188:191], a[252:255]
  ds_read_b64_tr_b16 v[220:221], v43 offset:40960
  ds_read_b64_tr_b16 v[222:223], v43 offset:45056
  ds_read_b64_tr_b16 v[224:225], v44 offset:32768
  ds_read_b64_tr_b16 v[226:227], v44 offset:36864
  ds_read_b64_tr_b16 v[228:229], v44 offset:40960
  ds_read_b64_tr_b16 v[230:231], v44 offset:45056
  ds_read_b64_tr_b16 v[232:233], v45 offset:32768
  ds_read_b64_tr_b16 v[234:235], v45 offset:36864
  v_accvgpr_read_b32 v72, a224
  v_accvgpr_read_b32 v73, a225
  v_accvgpr_read_b32 v74, a226
  v_accvgpr_read_b32 v75, a227
  v_accvgpr_read_b32 v76, a228
  v_accvgpr_read_b32 v77, a229
  v_accvgpr_read_b32 v78, a230
  v_accvgpr_read_b32 v79, a231
  v_pk_mul_f32 v[72:73], v[72:73], v[64:65]
  v_pk_mul_f32 v[74:75], v[74:75], v[64:65]
  v_pk_mul_f32 v[76:77], v[76:77], v[64:65]
  v_pk_mul_f32 v[78:79], v[78:79], v[64:65]
  v_cvt_pk_bf16_f32 v128, v72, v73
  v_cvt_pk_bf16_f32 v129, v74, v75
  v_cvt_pk_bf16_f32 v130, v76, v77
  v_cvt_pk_bf16_f32 v131, v78, v79
  v_accvgpr_read_b32 v84, a232
  v_accvgpr_read_b32 v85, a233
  v_accvgpr_read_b32 v86, a234
  v_accvgpr_read_b32 v87, a235
  v_accvgpr_read_b32 v88, a236
  v_accvgpr_read_b32 v89, a237
  v_accvgpr_read_b32 v90, a238
  v_accvgpr_read_b32 v91, a239
  ds_read_b64_tr_b16 v[236:237], v45 offset:40960
  ds_read_b64_tr_b16 v[238:239], v45 offset:45056
  ds_read_b64_tr_b16 v[240:241], v46 offset:32768
  ds_read_b64_tr_b16 v[242:243], v46 offset:36864
  ds_read_b64_tr_b16 v[244:245], v46 offset:40960
  ds_read_b64_tr_b16 v[246:247], v46 offset:45056
  v_pk_mul_f32 v[84:85], v[84:85], v[64:65]
  v_pk_mul_f32 v[86:87], v[86:87], v[64:65]
  v_pk_mul_f32 v[88:89], v[88:89], v[64:65]
  v_pk_mul_f32 v[90:91], v[90:91], v[64:65]
  v_cvt_pk_bf16_f32 v132, v84, v85
  v_cvt_pk_bf16_f32 v133, v86, v87
  v_cvt_pk_bf16_f32 v134, v88, v89
  v_cvt_pk_bf16_f32 v135, v90, v91
  v_accvgpr_read_b32 v72, a240
  v_accvgpr_read_b32 v73, a241
  v_accvgpr_read_b32 v74, a242
  v_accvgpr_read_b32 v75, a243
  v_accvgpr_read_b32 v76, a244
  v_accvgpr_read_b32 v77, a245
  v_accvgpr_read_b32 v78, a246
  v_accvgpr_read_b32 v79, a247
  v_pk_mul_f32 v[72:73], v[72:73], v[64:65]
  v_pk_mul_f32 v[74:75], v[74:75], v[64:65]
  v_pk_mul_f32 v[76:77], v[76:77], v[64:65]
  v_pk_mul_f32 v[78:79], v[78:79], v[64:65]
  v_cvt_pk_bf16_f32 v136, v72, v73
  v_cvt_pk_bf16_f32 v137, v74, v75
  v_cvt_pk_bf16_f32 v138, v76, v77
  v_cvt_pk_bf16_f32 v139, v78, v79
  v_accvgpr_read_b32 v84, a248
  v_accvgpr_read_b32 v85, a249
  v_accvgpr_read_b32 v86, a250
  v_accvgpr_read_b32 v87, a251
  v_accvgpr_read_b32 v88, a252
  v_accvgpr_read_b32 v89, a253
  v_accvgpr_read_b32 v90, a254
  v_accvgpr_read_b32 v91, a255
  v_pk_mul_f32 v[84:85], v[84:85], v[64:65]
  v_pk_mul_f32 v[86:87], v[86:87], v[64:65]
  v_pk_mul_f32 v[88:89], v[88:89], v[64:65]
  v_pk_mul_f32 v[90:91], v[90:91], v[64:65]
  v_cvt_pk_bf16_f32 v140, v84, v85
  v_cvt_pk_bf16_f32 v141, v86, v87
  v_cvt_pk_bf16_f32 v142, v88, v89
  v_cvt_pk_bf16_f32 v143, v90, v91
L_p4loop:
  s_waitcnt vmcnt(34) lgkmcnt(8)
  v_mfma_f32_16x16x32_bf16 v[64:67], v[192:195], a[0:3], 0
  ds_read_b64_tr_b16 v[248:249], v47 offset:32768
  ds_read_b64_tr_b16 v[250:251], v47 offset:36864
  v_mfma_f32_16x16x32_bf16 v[64:67], v[196:199], a[4:7], v[64:67]
  ds_read_b64_tr_b16 v[252:253], v47 offset:40960
  ds_read_b64_tr_b16 v[254:255], v47 offset:45056
  v_mfma_f32_16x16x32_bf16 v[68:71], v[192:195], a[8:11], 0
  buffer_store_dwordx4 v[128:131], v22, s[48:51], s84 offen offset:0 sc1
  v_mfma_f32_16x16x32_bf16 v[68:71], v[196:199], a[12:15], v[68:71]
  buffer_store_dwordx4 v[132:135], v22, s[48:51], s84 offen offset:2048 sc1
  v_mfma_f32_16x16x32_bf16 v[76:79], v[200:203], a[8:11], 0
  ds_read_b64_tr_b16 v[192:193], v40 offset:49152
  ds_read_b64_tr_b16 v[194:195], v40 offset:53248
  v_mfma_f32_16x16x32_bf16 v[76:79], v[204:207], a[12:15], v[76:79]
  ds_read_b64_tr_b16 v[196:197], v40 offset:57344
  ds_read_b64_tr_b16 v[198:199], v40 offset:61440
  v_mfma_f32_16x16x32_bf16 v[72:75], v[200:203], a[0:3], 0
  v_mfma_f32_16x16x32_bf16 v[72:75], v[204:207], a[4:7], v[72:75]
  s_add_u32 s84, s84, 4096
  v_mfma_f32_16x16x32_bf16 v[80:83], v[208:211], a[0:3], 0
  ds_read_b64_tr_b16 v[200:201], v41 offset:49152
  ds_read_b64_tr_b16 v[202:203], v41 offset:53248
  v_mfma_f32_16x16x32_bf16 v[80:83], v[212:215], a[4:7], v[80:83]
  ds_read_b64_tr_b16 v[204:205], v41 offset:57344
  ds_read_b64_tr_b16 v[206:207], v41 offset:61440
  v_mfma_f32_16x16x32_bf16 v[84:87], v[208:211], a[8:11], 0
  buffer_store_dwordx4 v[136:139], v22, s[48:51], s84 offen offset:0 sc1
  v_mfma_f32_16x16x32_bf16 v[84:87], v[212:215], a[12:15], v[84:87]
  buffer_store_dwordx4 v[140:143], v22, s[48:51], s84 offen offset:2048 sc1
  v_mfma_f32_16x16x32_bf16 v[92:95], v[216:219], a[8:11], 0
  ds_read_b64_tr_b16 v[208:209], v42 offset:49152
  ds_read_b64_tr_b16 v[210:211], v42 offset:53248
  v_mfma_f32_16x16x32_bf16 v[92:95], v[220:223], a[12:15], v[92:95]
  ds_read_b64_tr_b16 v[212:213], v42 offset:57344
  ds_read_b64_tr_b16 v[214:215], v42 offset:61440
  v_mfma_f32_16x16x32_bf16 v[88:91], v[216:219], a[0:3], 0
  v_mfma_f32_16x16x32_bf16 v[88:91], v[220:223], a[4:7], v[88:91]
  s_waitcnt lgkmcnt(8)
  s_add_u32 m0, s69, 98304
  v_mfma_f32_16x16x32_bf16 v[96:99], v[224:227], a[0:3], 0
  ds_read_b64_tr_b16 v[216:217], v43 offset:49152
  ds_read_b64_tr_b16 v[218:219], v43 offset:53248
  v_mfma_f32_16x16x32_bf16 v[96:99], v[228:231], a[4:7], v[96:99]
  ds_read_b64_tr_b16 v[220:221], v43 offset:57344
  ds_read_b64_tr_b16 v[222:223], v43 offset:61440
  v_mfma_f32_16x16x32_bf16 v[100:103], v[224:227], a[8:11], 0
  buffer_load_dwordx4 v2, s[40:43], s66 offen offset:0 sc1 lds
  v_mfma_f32_16x16x32_bf16 v[100:103], v[228:231], a[12:15], v[100:103]
  v_mfma_f32_16x16x32_bf16 v[108:111], v[232:235], a[8:11], 0
  ds_read_b64_tr_b16 v[224:225], v44 offset:49152
  ds_read_b64_tr_b16 v[226:227], v44 offset:53248
  v_mfma_f32_16x16x32_bf16 v[108:111], v[236:239], a[12:15], v[108:111]
  ds_read_b64_tr_b16 v[228:229], v44 offset:57344
  ds_read_b64_tr_b16 v[230:231], v44 offset:61440
  v_mfma_f32_16x16x32_bf16 v[104:107], v[232:235], a[0:3], 0
  buffer_load_dwordx4 v3, s[40:43], s66 offen offset:1024 sc1 lds
  v_mfma_f32_16x16x32_bf16 v[104:107], v[236:239], a[4:7], v[104:107]
  buffer_load_dwordx4 v4, s[40:43], s66 offen offset:2048 sc1 lds
  v_mfma_f32_16x16x32_bf16 v[112:115], v[240:243], a[0:3], 0
  ds_read_b64_tr_b16 v[232:233], v45 offset:49152
  ds_read_b64_tr_b16 v[234:235], v45 offset:53248
  v_mfma_f32_16x16x32_bf16 v[112:115], v[244:247], a[4:7], v[112:115]
  ds_read_b64_tr_b16 v[236:237], v45 offset:57344
  ds_read_b64_tr_b16 v[238:239], v45 offset:61440
  v_mfma_f32_16x16x32_bf16 v[116:119], v[240:243], a[8:11], 0
  buffer_load_dwordx4 v5, s[40:43], s66 offen offset:3072 sc1 lds
  v_mfma_f32_16x16x32_bf16 v[116:119], v[244:247], a[12:15], v[116:119]
  v_mfma_f32_16x16x32_bf16 v[124:127], v[248:251], a[8:11], 0
  ds_read_b64_tr_b16 v[240:241], v46 offset:49152
  ds_read_b64_tr_b16 v[242:243], v46 offset:53248
  v_mfma_f32_16x16x32_bf16 v[124:127], v[252:255], a[12:15], v[124:127]
  s_add_u32 s66, s66, 65536
  ds_read_b64_tr_b16 v[244:245], v46 offset:57344
  ds_read_b64_tr_b16 v[246:247], v46 offset:61440
  v_mfma_f32_16x16x32_bf16 v[120:123], v[248:251], a[0:3], 0
  v_mfma_f32_16x16x32_bf16 v[120:123], v[252:255], a[4:7], v[120:123]
  s_waitcnt vmcnt(24) lgkmcnt(8)
  s_barrier
  v_mfma_f32_16x16x32_bf16 v[64:67], v[192:195], a[16:19], v[64:67]
  s_lshr_b32 s92, s32, 3
  ds_read_b64_tr_b16 v[248:249], v47 offset:49152
  ds_read_b64_tr_b16 v[250:251], v47 offset:53248
  v_mfma_f32_16x16x32_bf16 v[64:67], v[196:199], a[20:23], v[64:67]
  ds_read_b64_tr_b16 v[252:253], v47 offset:57344
  ds_read_b64_tr_b16 v[254:255], v47 offset:61440
  v_mfma_f32_16x16x32_bf16 v[68:71], v[192:195], a[24:27], v[68:71]
  s_mul_i32 s92, s92, 24
  v_mfma_f32_16x16x32_bf16 v[68:71], v[196:199], a[28:31], v[68:71]
  v_mfma_f32_16x16x32_bf16 v[76:79], v[200:203], a[24:27], v[76:79]
  s_add_u32 s92, s92, s32
  ds_read_b64_tr_b16 v[192:193], v32 offset:0
  ds_read_b64_tr_b16 v[194:195], v32 offset:4096
  v_mfma_f32_16x16x32_bf16 v[76:79], v[204:207], a[28:31], v[76:79]
  ds_read_b64_tr_b16 v[196:197], v32 offset:8192
  ds_read_b64_tr_b16 v[198:199], v32 offset:12288
  v_mfma_f32_16x16x32_bf16 v[72:75], v[200:203], a[16:19], v[72:75]
  s_lshl_b32 s72, s33, 7
  v_mfma_f32_16x16x32_bf16 v[72:75], v[204:207], a[20:23], v[72:75]
  v_mfma_f32_16x16x32_bf16 v[80:83], v[208:211], a[16:19], v[80:83]
  s_add_u32 s92, s92, s72
  ds_read_b64_tr_b16 v[200:201], v33 offset:0
  ds_read_b64_tr_b16 v[202:203], v33 offset:4096
  v_mfma_f32_16x16x32_bf16 v[80:83], v[212:215], a[20:23], v[80:83]
  s_lshl_b32 s92, s92, 2
  ds_read_b64_tr_b16 v[204:205], v33 offset:8192
  ds_read_b64_tr_b16 v[206:207], v33 offset:12288
  v_mfma_f32_16x16x32_bf16 v[84:87], v[208:211], a[24:27], v[84:87]
  s_add_u32 s92, s92, 67108864
  s_add_u32 m0, s69, 49152
  v_mfma_f32_16x16x32_bf16 v[84:87], v[212:215], a[28:31], v[84:87]
  buffer_load_dwordx4 v2, s[40:43], s66 offen offset:0 sc1 lds
  v_mfma_f32_16x16x32_bf16 v[92:95], v[216:219], a[24:27], v[92:95]
  ds_read_b64_tr_b16 v[208:209], v34 offset:0
  ds_read_b64_tr_b16 v[210:211], v34 offset:4096
  v_mfma_f32_16x16x32_bf16 v[92:95], v[220:223], a[28:31], v[92:95]
  ds_read_b64_tr_b16 v[212:213], v34 offset:8192
  ds_read_b64_tr_b16 v[214:215], v34 offset:12288
  v_mfma_f32_16x16x32_bf16 v[88:91], v[216:219], a[16:19], v[88:91]
  buffer_load_dwordx4 v3, s[40:43], s66 offen offset:1024 sc1 lds
  v_mfma_f32_16x16x32_bf16 v[88:91], v[220:223], a[20:23], v[88:91]
  s_waitcnt lgkmcnt(8)
  v_mfma_f32_16x16x32_bf16 v[96:99], v[224:227], a[16:19], v[96:99]
  ds_read_b64_tr_b16 v[216:217], v35 offset:0
  ds_read_b64_tr_b16 v[218:219], v35 offset:4096
  v_mfma_f32_16x16x32_bf16 v[96:99], v[228:231], a[20:23], v[96:99]
  ds_read_b64_tr_b16 v[220:221], v35 offset:8192
  ds_read_b64_tr_b16 v[222:223], v35 offset:12288
  v_mfma_f32_16x16x32_bf16 v[100:103], v[224:227], a[24:27], v[100:103]
  buffer_load_dwordx4 v4, s[40:43], s66 offen offset:2048 sc1 lds
  v_mfma_f32_16x16x32_bf16 v[100:103], v[228:231], a[28:31], v[100:103]
  buffer_load_dwordx4 v5, s[40:43], s66 offen offset:3072 sc1 lds
  v_mfma_f32_16x16x32_bf16 v[108:111], v[232:235], a[24:27], v[108:111]
  ds_read_b64_tr_b16 v[224:225], v36 offset:0
  ds_read_b64_tr_b16 v[226:227], v36 offset:4096
  v_mfma_f32_16x16x32_bf16 v[108:111], v[236:239], a[28:31], v[108:111]
  ds_read_b64_tr_b16 v[228:229], v36 offset:8192
  ds_read_b64_tr_b16 v[230:231], v36 offset:12288
  v_mfma_f32_16x16x32_bf16 v[104:107], v[232:235], a[16:19], v[104:107]
  s_add_u32 s66, s66, 65536
  v_mfma_f32_16x16x32_bf16 v[104:107], v[236:239], a[20:23], v[104:107]
L_pg13:
  s_cbranch_execz L_walk2
  buffer_load_dwordx4 a[96:99], v6, s[48:51], s64 offen offset:0 sc1
  v_mfma_f32_16x16x32_bf16 v[112:115], v[240:243], a[16:19], v[112:115]
  ds_read_b64_tr_b16 v[232:233], v37 offset:0
  ds_read_b64_tr_b16 v[234:235], v37 offset:4096
  v_mfma_f32_16x16x32_bf16 v[112:115], v[244:247], a[20:23], v[112:115]
  ds_read_b64_tr_b16 v[236:237], v37 offset:8192
  ds_read_b64_tr_b16 v[238:239], v37 offset:12288
  v_mfma_f32_16x16x32_bf16 v[116:119], v[240:243], a[24:27], v[116:119]
  buffer_load_dwordx4 a[104:107], v7, s[48:51], s64 offen offset:0 sc1
  v_mfma_f32_16x16x32_bf16 v[116:119], v[244:247], a[28:31], v[116:119]
  buffer_load_dwordx4 a[100:103], v6, s[48:51], s64 offen offset:2048 sc1
  v_mfma_f32_16x16x32_bf16 v[124:127], v[248:251], a[24:27], v[124:127]
  ds_read_b64_tr_b16 v[240:241], v38 offset:0
  ds_read_b64_tr_b16 v[242:243], v38 offset:4096
  v_mfma_f32_16x16x32_bf16 v[124:127], v[252:255], a[28:31], v[124:127]
  ds_read_b64_tr_b16 v[244:245], v38 offset:8192
  ds_read_b64_tr_b16 v[246:247], v38 offset:12288
  v_mfma_f32_16x16x32_bf16 v[120:123], v[248:251], a[16:19], v[120:123]
  buffer_load_dwordx4 a[108:111], v7, s[48:51], s64 offen offset:2048 sc1
  v_mfma_f32_16x16x32_bf16 v[120:123], v[252:255], a[20:23], v[120:123]
  s_waitcnt vmcnt(28) lgkmcnt(8)
  s_barrier
  v_mfma_f32_16x16x32_bf16 v[64:67], v[192:195], a[128:131], v[64:67]
  ds_read_b64_tr_b16 v[248:249], v39 offset:0
  ds_read_b64_tr_b16 v[250:251], v39 offset:4096
  v_mfma_f32_16x16x32_bf16 v[64:67], v[196:199], a[132:135], v[64:67]
  s_add_u32 m0, s69, 81920
  ds_read_b64_tr_b16 v[252:253], v39 offset:8192
  ds_read_b64_tr_b16 v[254:255], v39 offset:12288
  v_mfma_f32_16x16x32_bf16 v[68:71], v[192:195], a[136:139], v[68:71]
  v_mfma_f32_16x16x32_bf16 v[68:71], v[196:199], a[140:143], v[68:71]
  buffer_load_dwordx4 v2, s[40:43], s66 offen offset:0 sc1 lds
  v_mfma_f32_16x16x32_bf16 v[76:79], v[200:203], a[136:139], v[76:79]
  ds_read_b64_tr_b16 v[192:193], v32 offset:32768
  ds_read_b64_tr_b16 v[194:195], v32 offset:36864
  v_mfma_f32_16x16x32_bf16 v[76:79], v[204:207], a[140:143], v[76:79]
  ds_read_b64_tr_b16 v[196:197], v32 offset:40960
  ds_read_b64_tr_b16 v[198:199], v32 offset:45056
  v_mfma_f32_16x16x32_bf16 v[72:75], v[200:203], a[128:131], v[72:75]
  v_mfma_f32_16x16x32_bf16 v[72:75], v[204:207], a[132:135], v[72:75]
  buffer_load_dwordx4 v3, s[40:43], s66 offen offset:1024 sc1 lds
  v_mfma_f32_16x16x32_bf16 v[80:83], v[208:211], a[128:131], v[80:83]
  ds_read_b64_tr_b16 v[200:201], v33 offset:32768
  ds_read_b64_tr_b16 v[202:203], v33 offset:36864
  v_mfma_f32_16x16x32_bf16 v[80:83], v[212:215], a[132:135], v[80:83]
  ds_read_b64_tr_b16 v[204:205], v33 offset:40960
  ds_read_b64_tr_b16 v[206:207], v33 offset:45056
  v_mfma_f32_16x16x32_bf16 v[84:87], v[208:211], a[136:139], v[84:87]
  buffer_load_dwordx4 v4, s[40:43], s66 offen offset:2048 sc1 lds
  v_mfma_f32_16x16x32_bf16 v[84:87], v[212:215], a[140:143], v[84:87]
  buffer_load_dwordx4 v5, s[40:43], s66 offen offset:3072 sc1 lds
  v_mfma_f32_16x16x32_bf16 v[92:95], v[216:219], a[136:139], v[92:95]
  ds_read_b64_tr_b16 v[208:209], v34 offset:32768
  ds_read_b64_tr_b16 v[210:211], v34 offset:36864
  v_mfma_f32_16x16x32_bf16 v[92:95], v[220:223], a[140:143], v[92:95]
  ds_read_b64_tr_b16 v[212:213], v34 offset:40960
  ds_read_b64_tr_b16 v[214:215], v34 offset:45056
  v_mfma_f32_16x16x32_bf16 v[88:91], v[216:219], a[128:131], v[88:91]
  v_mfma_f32_16x16x32_bf16 v[88:91], v[220:223], a[132:135], v[88:91]
  s_waitcnt lgkmcnt(8)
  s_add_u32 m0, s69, 114688
  v_mfma_f32_16x16x32_bf16 v[96:99], v[224:227], a[128:131], v[96:99]
  ds_read_b64_tr_b16 v[216:217], v35 offset:32768
  ds_read_b64_tr_b16 v[218:219], v35 offset:36864
  v_mfma_f32_16x16x32_bf16 v[96:99], v[228:231], a[132:135], v[96:99]
  ds_read_b64_tr_b16 v[220:221], v35 offset:40960
  ds_read_b64_tr_b16 v[222:223], v35 offset:45056
  v_mfma_f32_16x16x32_bf16 v[100:103], v[224:227], a[136:139], v[100:103]
  buffer_load_dwordx4 v2, s[44:47], s67 offen offset:0 sc1 lds
  v_mfma_f32_16x16x32_bf16 v[100:103], v[228:231], a[140:143], v[100:103]
  v_mfma_f32_16x16x32_bf16 v[108:111], v[232:235], a[136:139], v[108:111]
  ds_read_b64_tr_b16 v[224:225], v36 offset:32768
  ds_read_b64_tr_b16 v[226:227], v36 offset:36864
  v_mfma_f32_16x16x32_bf16 v[108:111], v[236:239], a[140:143], v[108:111]
  ds_read_b64_tr_b16 v[228:229], v36 offset:40960
  ds_read_b64_tr_b16 v[230:231], v36 offset:45056
  v_mfma_f32_16x16x32_bf16 v[104:107], v[232:235], a[128:131], v[104:107]
  buffer_load_dwordx4 v3, s[44:47], s67 offen offset:1024 sc1 lds
  v_mfma_f32_16x16x32_bf16 v[104:107], v[236:239], a[132:135], v[104:107]
  buffer_load_dwordx4 v4, s[44:47], s67 offen offset:2048 sc1 lds
  v_mfma_f32_16x16x32_bf16 v[112:115], v[240:243], a[128:131], v[112:115]
  ds_read_b64_tr_b16 v[232:233], v37 offset:32768
  ds_read_b64_tr_b16 v[234:235], v37 offset:36864
  v_mfma_f32_16x16x32_bf16 v[112:115], v[244:247], a[132:135], v[112:115]
  ds_read_b64_tr_b16 v[236:237], v37 offset:40960
  ds_read_b64_tr_b16 v[238:239], v37 offset:45056
  v_mfma_f32_16x16x32_bf16 v[116:119], v[240:243], a[136:139], v[116:119]
  buffer_load_dwordx4 v5, s[44:47], s67 offen offset:3072 sc1 lds
  v_mfma_f32_16x16x32_bf16 v[116:119], v[244:247], a[140:143], v[116:119]
  v_mfma_f32_16x16x32_bf16 v[124:127], v[248:251], a[136:139], v[124:127]
  ds_read_b64_tr_b16 v[240:241], v38 offset:32768
  ds_read_b64_tr_b16 v[242:243], v38 offset:36864
  v_mfma_f32_16x16x32_bf16 v[124:127], v[252:255], a[140:143], v[124:127]
  s_add_u32 s67, s67, 65536
  ds_read_b64_tr_b16 v[244:245], v38 offset:40960
  ds_read_b64_tr_b16 v[246:247], v38 offset:45056
  v_mfma_f32_16x16x32_bf16 v[120:123], v[248:251], a[128:131], v[120:123]
  v_mfma_f32_16x16x32_bf16 v[120:123], v[252:255], a[132:135], v[120:123]
  s_waitcnt vmcnt(16) lgkmcnt(8)
  s_barrier
  s_cmp_lg_u32 s34, 0
  s_cbranch_scc1 L_sig_c
  s_mov_b64 exec, 1
  v_mov_b32 v0, s101
  buffer_store_dword v0, off, s[48:51], s92 sc1
  s_mov_b64 exec, -1
L_sig_c:
  v_mfma_f32_16x16x32_bf16 v[64:67], v[192:195], a[144:147], v[64:67]
  ds_read_b64_tr_b16 v[248:249], v39 offset:32768
  ds_read_b64_tr_b16 v[250:251], v39 offset:36864
  v_mfma_f32_16x16x32_bf16 v[64:67], v[196:199], a[148:151], v[64:67]
  ds_read_b64_tr_b16 v[252:253], v39 offset:40960
  ds_read_b64_tr_b16 v[254:255], v39 offset:45056
  v_mfma_f32_16x16x32_bf16 v[68:71], v[192:195], a[152:155], v[68:71]
  buffer_load_dwordx4 a[112:115], v6, s[48:51], s65 offen offset:0 sc1
  v_mfma_f32_16x16x32_bf16 v[68:71], v[196:199], a[156:159], v[68:71]
  buffer_load_dwordx4 a[120:123], v7, s[48:51], s65 offen offset:0 sc1
  v_mfma_f32_16x16x32_bf16 v[76:79], v[200:203], a[152:155], v[76:79]
  ds_read_b64_tr_b16 v[192:193], v40 offset:0
  ds_read_b64_tr_b16 v[194:195], v40 offset:4096
  v_mfma_f32_16x16x32_bf16 v[76:79], v[204:207], a[156:159], v[76:79]
  ds_read_b64_tr_b16 v[196:197], v40 offset:8192
  ds_read_b64_tr_b16 v[198:199], v40 offset:12288
  v_mfma_f32_16x16x32_bf16 v[72:75], v[200:203], a[144:147], v[72:75]
  buffer_load_dwordx4 a[116:119], v6, s[48:51], s65 offen offset:2048 sc1
  v_mfma_f32_16x16x32_bf16 v[72:75], v[204:207], a[148:151], v[72:75]
  v_mfma_f32_16x16x32_bf16 v[80:83], v[208:211], a[144:147], v[80:83]
  ds_read_b64_tr_b16 v[200:201], v41 offset:0
  ds_read_b64_tr_b16 v[202:203], v41 offset:4096
  v_mfma_f32_16x16x32_bf16 v[80:83], v[212:215], a[148:151], v[80:83]
  ds_read_b64_tr_b16 v[204:205], v41 offset:8192
  ds_read_b64_tr_b16 v[206:207], v41 offset:12288
  v_mfma_f32_16x16x32_bf16 v[84:87], v[208:211], a[152:155], v[84:87]
  buffer_load_dwordx4 a[124:127], v7, s[48:51], s65 offen offset:2048 sc1
  v_mfma_f32_16x16x32_bf16 v[84:87], v[212:215], a[156:159], v[84:87]
  s_add_u32 s65, s65, 4096
  v_mfma_f32_16x16x32_bf16 v[92:95], v[216:219], a[152:155], v[92:95]
  ds_read_b64_tr_b16 v[208:209], v42 offset:0
  ds_read_b64_tr_b16 v[210:211], v42 offset:4096
  v_mfma_f32_16x16x32_bf16 v[92:95], v[220:223], a[156:159], v[92:95]
  ds_read_b64_tr_b16 v[212:213], v42 offset:8192
  ds_read_b64_tr_b16 v[214:215], v42 offset:12288
  v_mfma_f32_16x16x32_bf16 v[88:91], v[216:219], a[144:147], v[88:91]
  s_add_u32 m0, s69, 131072
  v_mfma_f32_16x16x32_bf16 v[88:91], v[220:223], a[148:151], v[88:91]
  s_waitcnt lgkmcnt(8)
  v_mfma_f32_16x16x32_bf16 v[96:99], v[224:227], a[144:147], v[96:99]
  ds_read_b64_tr_b16 v[216:217], v43 offset:0
  ds_read_b64_tr_b16 v[218:219], v43 offset:4096
  v_mfma_f32_16x16x32_bf16 v[96:99], v[228:231], a[148:151], v[96:99]
  ds_read_b64_tr_b16 v[220:221], v43 offset:8192
  ds_read_b64_tr_b16 v[222:223], v43 offset:12288
  v_mfma_f32_16x16x32_bf16 v[100:103], v[224:227], a[152:155], v[100:103]
  buffer_load_dwordx4 v2, s[44:47], s67 offen offset:0 sc1 lds
  v_mfma_f32_16x16x32_bf16 v[100:103], v[228:231], a[156:159], v[100:103]
  buffer_load_dwordx4 v3, s[44:47], s67 offen offset:1024 sc1 lds
  v_mfma_f32_16x16x32_bf16 v[108:111], v[232:235], a[152:155], v[108:111]
  ds_read_b64_tr_b16 v[224:225], v44 offset:0
  ds_read_b64_tr_b16 v[226:227], v44 offset:4096
  v_mfma_f32_16x16x32_bf16 v[108:111], v[236:239], a[156:159], v[108:111]
  ds_read_b64_tr_b16 v[228:229], v44 offset:8192
  ds_read_b64_tr_b16 v[230:231], v44 offset:12288
  v_mfma_f32_16x16x32_bf16 v[104:107], v[232:235], a[144:147], v[104:107]
  buffer_load_dwordx4 v4, s[44:47], s67 offen offset:2048 sc1 lds
  v_mfma_f32_16x16x32_bf16 v[104:107], v[236:239], a[148:151], v[104:107]
  buffer_load_dwordx4 v5, s[44:47], s67 offen offset:3072 sc1 lds
  v_mfma_f32_16x16x32_bf16 v[112:115], v[240:243], a[144:147], v[112:115]
  ds_read_b64_tr_b16 v[232:233], v45 offset:0
  ds_read_b64_tr_b16 v[234:235], v45 offset:4096
  v_mfma_f32_16x16x32_bf16 v[112:115], v[244:247], a[148:151], v[112:115]
  ds_read_b64_tr_b16 v[236:237], v45 offset:8192
  ds_read_b64_tr_b16 v[238:239], v45 offset:12288
  v_mfma_f32_16x16x32_bf16 v[116:119], v[240:243], a[152:155], v[116:119]
  v_mfma_f32_16x16x32_bf16 v[116:119], v[244:247], a[156:159], v[116:119]
  s_xor_b32 s67, s10, s8
  v_mfma_f32_16x16x32_bf16 v[124:127], v[248:251], a[152:155], v[124:127]
  ds_read_b64_tr_b16 v[240:241], v46 offset:0
  ds_read_b64_tr_b16 v[242:243], v46 offset:4096
  v_mfma_f32_16x16x32_bf16 v[124:127], v[252:255], a[156:159], v[124:127]
  s_add_u32 s8, s8, 131072
  ds_read_b64_tr_b16 v[244:245], v46 offset:8192
  ds_read_b64_tr_b16 v[246:247], v46 offset:12288
  v_mfma_f32_16x16x32_bf16 v[120:123], v[248:251], a[144:147], v[120:123]
  v_mfma_f32_16x16x32_bf16 v[120:123], v[252:255], a[148:151], v[120:123]
  s_waitcnt vmcnt(20) lgkmcnt(8)
  s_barrier
  v_mfma_f32_16x16x32_bf16 v[64:67], v[192:195], a[160:163], v[64:67]
  s_lshl_b32 s74, s33, 2
  ds_read_b64_tr_b16 v[248:249], v47 offset:0
  ds_read_b64_tr_b16 v[250:251], v47 offset:4096
  v_mfma_f32_16x16x32_bf16 v[64:67], v[196:199], a[164:167], v[64:67]
  ds_read_b64_tr_b16 v[252:253], v47 offset:8192
  ds_read_b64_tr_b16 v[254:255], v47 offset:12288
  v_mfma_f32_16x16x32_bf16 v[68:71], v[192:195], a[168:171], v[68:71]
  s_add_u32 s74, s74, s9
  v_mfma_f32_16x16x32_bf16 v[68:71], v[196:199], a[172:175], v[68:71]
  v_mfma_f32_16x16x32_bf16 v[76:79], v[200:203], a[168:171], v[76:79]
  s_lshl_b32 s74, s74, 7
  ds_read_b64_tr_b16 v[192:193], v32 offset:16384
  ds_read_b64_tr_b16 v[194:195], v32 offset:20480
  v_mfma_f32_16x16x32_bf16 v[76:79], v[204:207], a[172:175], v[76:79]
  ds_read_b64_tr_b16 v[196:197], v32 offset:24576
  ds_read_b64_tr_b16 v[198:199], v32 offset:28672
  v_mfma_f32_16x16x32_bf16 v[72:75], v[200:203], a[160:163], v[72:75]
  s_add_u32 s74, s74, 67108864
  v_mfma_f32_16x16x32_bf16 v[72:75], v[204:207], a[164:167], v[72:75]
  buffer_load_dwordx4 a[0:3], v6, s[48:51], s65 offen offset:0 sc1
  v_mfma_f32_16x16x32_bf16 v[80:83], v[208:211], a[160:163], v[80:83]
  ds_read_b64_tr_b16 v[200:201], v33 offset:16384
  ds_read_b64_tr_b16 v[202:203], v33 offset:20480
  v_mfma_f32_16x16x32_bf16 v[80:83], v[212:215], a[164:167], v[80:83]
  ds_read_b64_tr_b16 v[204:205], v33 offset:24576
  ds_read_b64_tr_b16 v[206:207], v33 offset:28672
  v_mfma_f32_16x16x32_bf16 v[84:87], v[208:211], a[168:171], v[84:87]
  buffer_load_dwordx4 a[8:11], v7, s[48:51], s65 offen offset:0 sc1
  v_mfma_f32_16x16x32_bf16 v[84:87], v[212:215], a[172:175], v[84:87]
  buffer_load_dwordx4 a[4:7], v6, s[48:51], s65 offen offset:2048 sc1
  v_mfma_f32_16x16x32_bf16 v[92:95], v[216:219], a[168:171], v[92:95]
  ds_read_b64_tr_b16 v[208:209], v34 offset:16384
  ds_read_b64_tr_b16 v[210:211], v34 offset:20480
  v_mfma_f32_16x16x32_bf16 v[92:95], v[220:223], a[172:175], v[92:95]
  ds_read_b64_tr_b16 v[212:213], v34 offset:24576
  ds_read_b64_tr_b16 v[214:215], v34 offset:28672
  v_mfma_f32_16x16x32_bf16 v[88:91], v[216:219], a[160:163], v[88:91]
  buffer_load_dwordx4 a[12:15], v7, s[48:51], s65 offen offset:2048 sc1
  v_mfma_f32_16x16x32_bf16 v[88:91], v[220:223], a[164:167], v[88:91]
  s_waitcnt lgkmcnt(8)
  s_xor_b32 s65, s4, s70
  v_mfma_f32_16x16x32_bf16 v[96:99], v[224:227], a[160:163], v[96:99]
  ds_read_b64_tr_b16 v[216:217], v35 offset:16384
  ds_read_b64_tr_b16 v[218:219], v35 offset:20480
  v_mfma_f32_16x16x32_bf16 v[96:99], v[228:231], a[164:167], v[96:99]
  s_add_u32 s65, s65, s1
  ds_read_b64_tr_b16 v[220:221], v35 offset:24576
  ds_read_b64_tr_b16 v[222:223], v35 offset:28672
  v_mfma_f32_16x16x32_bf16 v[100:103], v[224:227], a[168:171], v[100:103]
  v_mfma_f32_16x16x32_bf16 v[100:103], v[228:231], a[172:175], v[100:103]
  s_add_u32 s70, s70, 8192
  v_mfma_f32_16x16x32_bf16 v[108:111], v[232:235], a[168:171], v[108:111]
  s_add_u32 m0, s69, 147456
  ds_read_b64_tr_b16 v[224:225], v36 offset:16384
  ds_read_b64_tr_b16 v[226:227], v36 offset:20480
  v_mfma_f32_16x16x32_bf16 v[108:111], v[236:239], a[172:175], v[108:111]
  ds_read_b64_tr_b16 v[228:229], v36 offset:24576
  ds_read_b64_tr_b16 v[230:231], v36 offset:28672
  v_mfma_f32_16x16x32_bf16 v[104:107], v[232:235], a[160:163], v[104:107]
  buffer_load_dwordx4 v2, s[44:47], s67 offen offset:0 sc1 lds
  v_mfma_f32_16x16x32_bf16 v[104:107], v[236:239], a[164:167], v[104:107]
  buffer_load_dwordx4 v3, s[44:47], s67 offen offset:1024 sc1 lds
  v_mfma_f32_16x16x32_bf16 v[112:115], v[240:243], a[160:163], v[112:115]
  ds_read_b64_tr_b16 v[232:233], v37 offset:16384
  ds_read_b64_tr_b16 v[234:235], v37 offset:20480
  v_mfma_f32_16x16x32_bf16 v[112:115], v[244:247], a[164:167], v[112:115]
  ds_read_b64_tr_b16 v[236:237], v37 offset:24576
  ds_read_b64_tr_b16 v[238:239], v37 offset:28672
  v_mfma_f32_16x16x32_bf16 v[116:119], v[240:243], a[168:171], v[116:119]
  buffer_load_dwordx4 v4, s[44:47], s67 offen offset:2048 sc1 lds
  v_mfma_f32_16x16x32_bf16 v[116:119], v[244:247], a[172:175], v[116:119]
  buffer_load_dwordx4 v5, s[44:47], s67 offen offset:3072 sc1 lds
  v_mfma_f32_16x16x32_bf16 v[124:127], v[248:251], a[168:171], v[124:127]
  ds_read_b64_tr_b16 v[240:241], v38 offset:16384
  ds_read_b64_tr_b16 v[242:243], v38 offset:20480
  v_mfma_f32_16x16x32_bf16 v[124:127], v[252:255], a[172:175], v[124:127]
  ds_read_b64_tr_b16 v[244:245], v38 offset:24576
  ds_read_b64_tr_b16 v[246:247], v38 offset:28672
  v_mfma_f32_16x16x32_bf16 v[120:123], v[248:251], a[160:163], v[120:123]
  s_add_u32 s67, s67, 65536
  v_mfma_f32_16x16x32_bf16 v[120:123], v[252:255], a[164:167], v[120:123]
  s_waitcnt vmcnt(20) lgkmcnt(8)
  s_barrier
  buffer_load_dword v28, v15, s[48:51], s74 offen sc1
  v_mfma_f32_16x16x32_bf16 v[64:67], v[192:195], a[176:179], v[64:67]
  ds_read_b64_tr_b16 v[248:249], v39 offset:16384
  ds_read_b64_tr_b16 v[250:251], v39 offset:20480
  v_mfma_f32_16x16x32_bf16 v[64:67], v[196:199], a[180:183], v[64:67]
  s_add_u32 m0, s69, 32768
  ds_read_b64_tr_b16 v[252:253], v39 offset:24576
  ds_read_b64_tr_b16 v[254:255], v39 offset:28672
  v_mfma_f32_16x16x32_bf16 v[68:71], v[192:195], a[184:187], v[68:71]
  v_mfma_f32_16x16x32_bf16 v[68:71], v[196:199], a[188:191], v[68:71]
  buffer_load_dwordx4 v2, s[44:47], s67 offen offset:0 sc1 lds
  v_mfma_f32_16x16x32_bf16 v[76:79], v[200:203], a[184:187], v[76:79]
  ds_read_b64_tr_b16 v[192:193], v32 offset:49152
  ds_read_b64_tr_b16 v[194:195], v32 offset:53248
  v_mfma_f32_16x16x32_bf16 v[76:79], v[204:207], a[188:191], v[76:79]
  ds_read_b64_tr_b16 v[196:197], v32 offset:57344
  ds_read_b64_tr_b16 v[198:199], v32 offset:61440
  v_mfma_f32_16x16x32_bf16 v[72:75], v[200:203], a[176:179], v[72:75]
  buffer_load_dwordx4 v3, s[44:47], s67 offen offset:1024 sc1 lds
  v_mfma_f32_16x16x32_bf16 v[72:75], v[204:207], a[180:183], v[72:75]
  buffer_load_dwordx4 v4, s[44:47], s67 offen offset:2048 sc1 lds
  v_mfma_f32_16x16x32_bf16 v[80:83], v[208:211], a[176:179], v[80:83]
  ds_read_b64_tr_b16 v[200:201], v33 offset:49152
  ds_read_b64_tr_b16 v[202:203], v33 offset:53248
  v_mfma_f32_16x16x32_bf16 v[80:83], v[212:215], a[180:183], v[80:83]
  ds_read_b64_tr_b16 v[204:205], v33 offset:57344
  ds_read_b64_tr_b16 v[206:207], v33 offset:61440
  v_mfma_f32_16x16x32_bf16 v[84:87], v[208:211], a[184:187], v[84:87]
  buffer_load_dwordx4 v5, s[44:47], s67 offen offset:3072 sc1 lds
  v_mfma_f32_16x16x32_bf16 v[84:87], v[212:215], a[188:191], v[84:87]
  v_mfma_f32_16x16x32_bf16 v[92:95], v[216:219], a[184:187], v[92:95]
  ds_read_b64_tr_b16 v[208:209], v34 offset:49152
  ds_read_b64_tr_b16 v[210:211], v34 offset:53248
  v_mfma_f32_16x16x32_bf16 v[92:95], v[220:223], a[188:191], v[92:95]
  s_xor_b32 s67, s10, s8
  ds_read_b64_tr_b16 v[212:213], v34 offset:57344
  ds_read_b64_tr_b16 v[214:215], v34 offset:61440
  v_mfma_f32_16x16x32_bf16 v[88:91], v[216:219], a[176:179], v[88:91]
  v_mfma_f32_16x16x32_bf16 v[88:91], v[220:223], a[180:183], v[88:91]
  s_waitcnt lgkmcnt(8)
  s_add_u32 s8, s8, 131072
  v_mfma_f32_16x16x32_bf16 v[96:99], v[224:227], a[176:179], v[96:99]
  ds_read_b64_tr_b16 v[216:217], v35 offset:49152
  ds_read_b64_tr_b16 v[218:219], v35 offset:53248
  v_mfma_f32_16x16x32_bf16 v[96:99], v[228:231], a[180:183], v[96:99]
  s_add_u32 m0, s69, 65536
  ds_read_b64_tr_b16 v[220:221], v35 offset:57344
  ds_read_b64_tr_b16 v[222:223], v35 offset:61440
  v_mfma_f32_16x16x32_bf16 v[100:103], v[224:227], a[184:187], v[100:103]
  v_mfma_f32_16x16x32_bf16 v[100:103], v[228:231], a[188:191], v[100:103]
  buffer_load_dwordx4 v2, s[44:47], s67 offen offset:0 sc1 lds
  v_mfma_f32_16x16x32_bf16 v[108:111], v[232:235], a[184:187], v[108:111]
  ds_read_b64_tr_b16 v[224:225], v36 offset:49152
  ds_read_b64_tr_b16 v[226:227], v36 offset:53248
  v_mfma_f32_16x16x32_bf16 v[108:111], v[236:239], a[188:191], v[108:111]
  ds_read_b64_tr_b16 v[228:229], v36 offset:57344
  ds_read_b64_tr_b16 v[230:231], v36 offset:61440
  v_mfma_f32_16x16x32_bf16 v[104:107], v[232:235], a[176:179], v[104:107]
  buffer_load_dwordx4 v3, s[44:47], s67 offen offset:1024 sc1 lds
  v_mfma_f32_16x16x32_bf16 v[104:107], v[236:239], a[180:183], v[104:107]
  v_mfma_f32_16x16x32_bf16 v[112:115], v[240:243], a[176:179], v[112:115]
  ds_read_b64_tr_b16 v[232:233], v37 offset:49152
  ds_read_b64_tr_b16 v[234:235], v37 offset:53248
  v_mfma_f32_16x16x32_bf16 v[112:115], v[244:247], a[180:183], v[112:115]
  ds_read_b64_tr_b16 v[236:237], v37 offset:57344
  ds_read_b64_tr_b16 v[238:239], v37 offset:61440
  v_mfma_f32_16x16x32_bf16 v[116:119], v[240:243], a[184:187], v[116:119]
  buffer_load_dwordx4 v4, s[44:47], s67 offen offset:2048 sc1 lds
  v_mfma_f32_16x16x32_bf16 v[116:119], v[244:247], a[188:191], v[116:119]
  buffer_load_dwordx4 v5, s[44:47], s67 offen offset:3072 sc1 lds
  v_mfma_f32_16x16x32_bf16 v[124:127], v[248:251], a[184:187], v[124:127]
  ds_read_b64_tr_b16 v[240:241], v38 offset:49152
  ds_read_b64_tr_b16 v[242:243], v38 offset:53248
  v_mfma_f32_16x16x32_bf16 v[124:127], v[252:255], a[188:191], v[124:127]
  s_add_u32 s67, s67, 65536
  ds_read_b64_tr_b16 v[244:245], v38 offset:57344
  ds_read_b64_tr_b16 v[246:247], v38 offset:61440
  v_mfma_f32_16x16x32_bf16 v[120:123], v[248:251], a[176:179], v[120:123]
  v_mfma_f32_16x16x32_bf16 v[120:123], v[252:255], a[180:183], v[120:123]
  s_waitcnt vmcnt(25) lgkmcnt(8)
  s_barrier
  buffer_load_dword v27, v15, s[48:51], s74 offen sc1
  v_mfma_f32_16x16x32_bf16 v[64:67], v[192:195], a[96:99], v[64:67]
  ds_read_b64_tr_b16 v[248:249], v39 offset:49152
  ds_read_b64_tr_b16 v[250:251], v39 offset:53248
  v_mfma_f32_16x16x32_bf16 v[64:67], v[196:199], a[100:103], v[64:67]
  ds_read_b64_tr_b16 v[252:253], v39 offset:57344
  ds_read_b64_tr_b16 v[254:255], v39 offset:61440
  v_mfma_f32_16x16x32_bf16 v[68:71], v[192:195], a[104:107], v[68:71]
  s_add_u32 m0, s69, 98304
  v_mfma_f32_16x16x32_bf16 v[68:71], v[196:199], a[108:111], v[68:71]
  v_mfma_f32_16x16x32_bf16 v[76:79], v[200:203], a[104:107], v[76:79]
  ds_read_b64_tr_b16 v[192:193], v40 offset:16384
  ds_read_b64_tr_b16 v[194:195], v40 offset:20480
  v_mfma_f32_16x16x32_bf16 v[76:79], v[204:207], a[108:111], v[76:79]
  ds_read_b64_tr_b16 v[196:197], v40 offset:24576
  ds_read_b64_tr_b16 v[198:199], v40 offset:28672
  v_mfma_f32_16x16x32_bf16 v[72:75], v[200:203], a[96:99], v[72:75]
  buffer_load_dwordx4 v2, s[44:47], s67 offen offset:0 sc1 lds
  v_mfma_f32_16x16x32_bf16 v[72:75], v[204:207], a[100:103], v[72:75]
  v_mfma_f32_16x16x32_bf16 v[80:83], v[208:211], a[96:99], v[80:83]
  ds_read_b64_tr_b16 v[200:201], v41 offset:16384
  ds_read_b64_tr_b16 v[202:203], v41 offset:20480
  v_mfma_f32_16x16x32_bf16 v[80:83], v[212:215], a[100:103], v[80:83]
  ds_read_b64_tr_b16 v[204:205], v41 offset:24576
  ds_read_b64_tr_b16 v[206:207], v41 offset:28672
  v_mfma_f32_16x16x32_bf16 v[84:87], v[208:211], a[104:107], v[84:87]
  v_mfma_f32_16x16x32_bf16 v[84:87], v[212:215], a[108:111], v[84:87]
  buffer_load_dwordx4 v3, s[44:47], s67 offen offset:1024 sc1 lds
  v_mfma_f32_16x16x32_bf16 v[92:95], v[216:219], a[104:107], v[92:95]
  ds_read_b64_tr_b16 v[208:209], v42 offset:16384
  ds_read_b64_tr_b16 v[210:211], v42 offset:20480
  v_mfma_f32_16x16x32_bf16 v[92:95], v[220:223], a[108:111], v[92:95]
  ds_read_b64_tr_b16 v[212:213], v42 offset:24576
  ds_read_b64_tr_b16 v[214:215], v42 offset:28672
  v_mfma_f32_16x16x32_bf16 v[88:91], v[216:219], a[96:99], v[88:91]
  buffer_load_dwordx4 v4, s[44:47], s67 offen offset:2048 sc1 lds
  v_mfma_f32_16x16x32_bf16 v[88:91], v[220:223], a[100:103], v[88:91]
  s_waitcnt lgkmcnt(8)
  v_mfma_f32_16x16x32_bf16 v[96:99], v[224:227], a[96:99], v[96:99]
  ds_read_b64_tr_b16 v[216:217], v43 offset:16384
  ds_read_b64_tr_b16 v[218:219], v43 offset:20480
  v_mfma_f32_16x16x32_bf16 v[96:99], v[228:231], a[100:103], v[96:99]
  ds_read_b64_tr_b16 v[220:221], v43 offset:24576
  ds_read_b64_tr_b16 v[222:223], v43 offset:28672
  v_mfma_f32_16x16x32_bf16 v[100:103], v[224:227], a[104:107], v[100:103]
  v_mfma_f32_16x16x32_bf16 v[100:103], v[228:231], a[108:111], v[100:103]
  buffer_load_dwordx4 v5, s[44:47], s67 offen offset:3072 sc1 lds
  v_mfma_f32_16x16x32_bf16 v[108:111], v[232:235], a[104:107], v[108:111]
  ds_read_b64_tr_b16 v[224:225], v44 offset:16384
  ds_read_b64_tr_b16 v[226:227], v44 offset:20480
  v_mfma_f32_16x16x32_bf16 v[108:111], v[236:239], a[108:111], v[108:111]
  ds_read_b64_tr_b16 v[228:229], v44 offset:24576
  ds_read_b64_tr_b16 v[230:231], v44 offset:28672
  v_mfma_f32_16x16x32_bf16 v[104:107], v[232:235], a[96:99], v[104:107]
  v_mfma_f32_16x16x32_bf16 v[104:107], v[236:239], a[100:103], v[104:107]
  v_mfma_f32_16x16x32_bf16 v[112:115], v[240:243], a[96:99], v[112:115]
  s_xor_b32 s67, s10, s8
  ds_read_b64_tr_b16 v[232:233], v45 offset:16384
  ds_read_b64_tr_b16 v[234:235], v45 offset:20480
  v_mfma_f32_16x16x32_bf16 v[112:115], v[244:247], a[100:103], v[112:115]
  ds_read_b64_tr_b16 v[236:237], v45 offset:24576
  ds_read_b64_tr_b16 v[238:239], v45 offset:28672
  v_mfma_f32_16x16x32_bf16 v[116:119], v[240:243], a[104:107], v[116:119]
  v_mfma_f32_16x16x32_bf16 v[116:119], v[244:247], a[108:111], v[116:119]
  v_mfma_f32_16x16x32_bf16 v[124:127], v[248:251], a[104:107], v[124:127]
  s_add_u32 s8, s8, 131072
  ds_read_b64_tr_b16 v[240:241], v46 offset:16384
  ds_read_b64_tr_b16 v[242:243], v46 offset:20480
  v_mfma_f32_16x16x32_bf16 v[124:127], v[252:255], a[108:111], v[124:127]
  ds_read_b64_tr_b16 v[244:245], v46 offset:24576
  ds_read_b64_tr_b16 v[246:247], v46 offset:28672
  v_mfma_f32_16x16x32_bf16 v[120:123], v[248:251], a[96:99], v[120:123]
  v_mfma_f32_16x16x32_bf16 v[120:123], v[252:255], a[100:103], v[120:123]
  s_waitcnt vmcnt(13) lgkmcnt(8)
  s_barrier
  v_cmp_ne_u32 vcc, s101, v28
  s_cbranch_vccnz L_f2
L_spin_c_r:
  v_mfma_f32_16x16x32_bf16 v[128:131], v[192:195], a[112:115], 0
  ds_read_b64_tr_b16 v[248:249], v47 offset:16384
  ds_read_b64_tr_b16 v[250:251], v47 offset:20480
  v_mfma_f32_16x16x32_bf16 v[128:131], v[196:199], a[116:119], v[128:131]
  ds_read_b64_tr_b16 v[252:253], v47 offset:24576
  ds_read_b64_tr_b16 v[254:255], v47 offset:28672
  v_mfma_f32_16x16x32_bf16 v[132:135], v[192:195], a[120:123], 0
  buffer_load_dwordx4 a[16:19], v6, s[48:51], s65 offen offset:0 sc1
  v_mfma_f32_16x16x32_bf16 v[132:135], v[196:199], a[124:127], v[132:135]
  buffer_load_dwordx4 a[24:27], v7, s[48:51], s65 offen offset:0 sc1
  v_mfma_f32_16x16x32_bf16 v[140:143], v[200:203], a[120:123], 0
  ds_read_b64_tr_b16 v[192:193], v40 offset:32768
  ds_read_b64_tr_b16 v[194:195], v40 offset:36864
  v_mfma_f32_16x16x32_bf16 v[140:143], v[204:207], a[124:127], v[140:143]
  ds_read_b64_tr_b16 v[196:197], v40 offset:40960
  ds_read_b64_tr_b16 v[198:199], v40 offset:45056
  v_mfma_f32_16x16x32_bf16 v[136:139], v[200:203], a[112:115], 0
  buffer_load_dwordx4 a[20:23], v6, s[48:51], s65 offen offset:2048 sc1
  v_mfma_f32_16x16x32_bf16 v[136:139], v[204:207], a[116:119], v[136:139]
  v_mfma_f32_16x16x32_bf16 v[144:147], v[208:211], a[112:115], 0
  ds_read_b64_tr_b16 v[200:201], v41 offset:32768
  ds_read_b64_tr_b16 v[202:203], v41 offset:36864
  v_mfma_f32_16x16x32_bf16 v[144:147], v[212:215], a[116:119], v[144:147]
  ds_read_b64_tr_b16 v[204:205], v41 offset:40960
  ds_read_b64_tr_b16 v[206:207], v41 offset:45056
  v_mfma_f32_16x16x32_bf16 v[148:151], v[208:211], a[120:123], 0
  buffer_load_dwordx4 a[28:31], v7, s[48:51], s65 offen offset:2048 sc1
  v_mfma_f32_16x16x32_bf16 v[148:151], v[212:215], a[124:127], v[148:151]
  s_add_u32 s65, s65, 4096
  v_mfma_f32_16x16x32_bf16 v[156:159], v[216:219], a[120:123], 0
  ds_read_b64_tr_b16 v[208:209], v42 offset:32768
  ds_read_b64_tr_b16 v[210:211], v42 offset:36864
  v_mfma_f32_16x16x32_bf16 v[156:159], v[220:223], a[124:127], v[156:159]
  ds_read_b64_tr_b16 v[212:213], v42 offset:40960
  ds_read_b64_tr_b16 v[214:215], v42 offset:45056
  v_mfma_f32_16x16x32_bf16 v[152:155], v[216:219], a[112:115], 0
  buffer_load_dwordx4 a[32:35], v6, s[48:51], s65 offen offset:0 sc1
  v_mfma_f32_16x16x32_bf16 v[152:155], v[220:223], a[116:119], v[152:155]
  s_waitcnt lgkmcnt(8)
  v_mfma_f32_16x16x32_bf16 v[160:163], v[224:227], a[112:115], 0
  ds_read_b64_tr_b16 v[216:217], v43 offset:32768
  ds_read_b64_tr_b16 v[218:219], v43 offset:36864
  v_mfma_f32_16x16x32_bf16 v[160:163], v[228:231], a[116:119], v[160:163]
  ds_read_b64_tr_b16 v[220:221], v43 offset:40960
  ds_read_b64_tr_b16 v[222:223], v43 offset:45056
  v_mfma_f32_16x16x32_bf16 v[164:167], v[224:227], a[120:123], 0
  buffer_load_dwordx4 a[40:43], v7, s[48:51], s65 offen offset:0 sc1
  v_mfma_f32_16x16x32_bf16 v[164:167], v[228:231], a[124:127], v[164:167]
  buffer_load_dwordx4 a[36:39], v6, s[48:51], s65 offen offset:2048 sc1
  v_mfma_f32_16x16x32_bf16 v[172:175], v[232:235], a[120:123], 0
  ds_read_b64_tr_b16 v[224:225], v44 offset:32768
  ds_read_b64_tr_b16 v[226:227], v44 offset:36864
  v_mfma_f32_16x16x32_bf16 v[172:175], v[236:239], a[124:127], v[172:175]
  ds_read_b64_tr_b16 v[228:229], v44 offset:40960
  ds_read_b64_tr_b16 v[230:231], v44 offset:45056
  v_mfma_f32_16x16x32_bf16 v[168:171], v[232:235], a[112:115], 0
  buffer_load_dwordx4 a[44:47], v7, s[48:51], s65 offen offset:2048 sc1
  v_mfma_f32_16x16x32_bf16 v[168:171], v[236:239], a[116:119], v[168:171]
  v_mfma_f32_16x16x32_bf16 v[176:179], v[240:243], a[112:115], 0
  s_xor_b32 s65, s4, s70
  ds_read_b64_tr_b16 v[232:233], v45 offset:32768
  ds_read_b64_tr_b16 v[234:235], v45 offset:36864
  v_mfma_f32_16x16x32_bf16 v[176:179], v[244:247], a[116:119], v[176:179]
  ds_read_b64_tr_b16 v[236:237], v45 offset:40960
  ds_read_b64_tr_b16 v[238:239], v45 offset:45056
  v_mfma_f32_16x16x32_bf16 v[180:183], v[240:243], a[120:123], 0
  v_mfma_f32_16x16x32_bf16 v[180:183], v[244:247], a[124:127], v[180:183]
  s_add_u32 s65, s65, s1
  v_mfma_f32_16x16x32_bf16 v[188:191], v[248:251], a[120:123], 0
  ds_read_b64_tr_b16 v[240:241], v46 offset:32768
  ds_read_b64_tr_b16 v[242:243], v46 offset:36864
  v_mfma_f32_16x16x32_bf16 v[188:191], v[252:255], a[124:127], v[188:191]
  s_add_u32 s70, s70, 8192
  ds_read_b64_tr_b16 v[244:245], v46 offset:40960
  ds_read_b64_tr_b16 v[246:247], v46 offset:45056
  v_mfma_f32_16x16x32_bf16 v[184:187], v[248:251], a[112:115], 0
  v_mfma_f32_16x16x32_bf16 v[184:187], v[252:255], a[116:119], v[184:187]
  s_waitcnt vmcnt(21) lgkmcnt(8)
  s_barrier
  v_mfma_f32_16x16x32_bf16 v[128:131], v[192:195], a[0:3], v[128:131]
  ds_read_b64_tr_b16 v[248:249], v47 offset:32768
  ds_read_b64_tr_b16 v[250:251], v47 offset:36864
  v_mfma_f32_16x16x32_bf16 v[128:131], v[196:199], a[4:7], v[128:131]
  ds_read_b64_tr_b16 v[252:253], v47 offset:40960
  ds_read_b64_tr_b16 v[254:255], v47 offset:45056
  v_mfma_f32_16x16x32_bf16 v[132:135], v[192:195], a[8:11], v[132:135]
  buffer_load_dwordx4 a[48:51], v6, s[48:51], s65 offen offset:0 sc1
  v_mfma_f32_16x16x32_bf16 v[132:135], v[196:199], a[12:15], v[132:135]
  buffer_load_dwordx4 a[56:59], v7, s[48:51], s65 offen offset:0 sc1
  v_mfma_f32_16x16x32_bf16 v[140:143], v[200:203], a[8:11], v[140:143]
  ds_read_b64_tr_b16 v[192:193], v40 offset:49152
  ds_read_b64_tr_b16 v[194:195], v40 offset:53248
  v_mfma_f32_16x16x32_bf16 v[140:143], v[204:207], a[12:15], v[140:143]
  ds_read_b64_tr_b16 v[196:197], v40 offset:57344
  ds_read_b64_tr_b16 v[198:199], v40 offset:61440
  v_mfma_f32_16x16x32_bf16 v[136:139], v[200:203], a[0:3], v[136:139]
  buffer_load_dwordx4 a[52:55], v6, s[48:51], s65 offen offset:2048 sc1
  v_mfma_f32_16x16x32_bf16 v[136:139], v[204:207], a[4:7], v[136:139]
  buffer_load_dwordx4 a[60:63], v7, s[48:51], s65 offen offset:2048 sc1
  v_mfma_f32_16x16x32_bf16 v[144:147], v[208:211], a[0:3], v[144:147]
  ds_read_b64_tr_b16 v[200:201], v41 offset:49152
  ds_read_b64_tr_b16 v[202:203], v41 offset:53248
  v_mfma_f32_16x16x32_bf16 v[144:147], v[212:215], a[4:7], v[144:147]
L_pg14:
  s_cbranch_execz L_walk2
  ds_read_b64_tr_b16 v[204:205], v41 offset:57344
  ds_read_b64_tr_b16 v[206:207], v41 offset:61440
  v_mfma_f32_16x16x32_bf16 v[148:151], v[208:211], a[8:11], v[148:151]
  s_add_u32 s65, s65, 4096
  v_mfma_f32_16x16x32_bf16 v[148:151], v[212:215], a[12:15], v[148:151]
  v_mfma_f32_16x16x32_bf16 v[156:159], v[216:219], a[8:11], v[156:159]
  ds_read_b64_tr_b16 v[208:209], v42 offset:49152
  ds_read_b64_tr_b16 v[210:211], v42 offset:53248
  v_mfma_f32_16x16x32_bf16 v[156:159], v[220:223], a[12:15], v[156:159]
  s_add_u32 m0, s69, 49152
  ds_read_b64_tr_b16 v[212:213], v42 offset:57344
  ds_read_b64_tr_b16 v[214:215], v42 offset:61440
  v_mfma_f32_16x16x32_bf16 v[152:155], v[216:219], a[0:3], v[152:155]
  v_mfma_f32_16x16x32_bf16 v[152:155], v[220:223], a[4:7], v[152:155]
  s_waitcnt lgkmcnt(8)
  v_sub_f32 v10, 1.0, v8
  v_mfma_f32_16x16x32_bf16 v[160:163], v[224:227], a[0:3], v[160:163]
  ds_read_b64_tr_b16 v[216:217], v43 offset:49152
  ds_read_b64_tr_b16 v[218:219], v43 offset:53248
  v_mfma_f32_16x16x32_bf16 v[160:163], v[228:231], a[4:7], v[160:163]
  ds_read_b64_tr_b16 v[220:221], v43 offset:57344
  ds_read_b64_tr_b16 v[222:223], v43 offset:61440
  v_mfma_f32_16x16x32_bf16 v[164:167], v[224:227], a[8:11], v[164:167]
  buffer_load_dwordx4 v2, s[44:47], s67 offen offset:0 sc1 lds
  v_mfma_f32_16x16x32_bf16 v[164:167], v[228:231], a[12:15], v[164:167]
  buffer_load_dwordx4 v3, s[44:47], s67 offen offset:1024 sc1 lds
  v_mfma_f32_16x16x32_bf16 v[172:175], v[232:235], a[8:11], v[172:175]
  ds_read_b64_tr_b16 v[224:225], v44 offset:49152
  ds_read_b64_tr_b16 v[226:227], v44 offset:53248
  v_mfma_f32_16x16x32_bf16 v[172:175], v[236:239], a[12:15], v[172:175]
  ds_read_b64_tr_b16 v[228:229], v44 offset:57344
  ds_read_b64_tr_b16 v[230:231], v44 offset:61440
  v_mfma_f32_16x16x32_bf16 v[168:171], v[232:235], a[0:3], v[168:171]
  buffer_load_dwordx4 v4, s[44:47], s67 offen offset:2048 sc1 lds
  v_mfma_f32_16x16x32_bf16 v[168:171], v[236:239], a[4:7], v[168:171]
  v_mfma_f32_16x16x32_bf16 v[176:179], v[240:243], a[0:3], v[176:179]
  ds_read_b64_tr_b16 v[232:233], v45 offset:49152
  ds_read_b64_tr_b16 v[234:235], v45 offset:53248
  v_mfma_f32_16x16x32_bf16 v[176:179], v[244:247], a[4:7], v[176:179]
  ds_read_b64_tr_b16 v[236:237], v45 offset:57344
  ds_read_b64_tr_b16 v[238:239], v45 offset:61440
  v_mfma_f32_16x16x32_bf16 v[180:183], v[240:243], a[8:11], v[180:183]
  buffer_load_dwordx4 v5, s[44:47], s67 offen offset:3072 sc1 lds
  v_mfma_f32_16x16x32_bf16 v[180:183], v[244:247], a[12:15], v[180:183]
  s_add_u32 s67, s67, 65536
  v_mfma_f32_16x16x32_bf16 v[188:191], v[248:251], a[8:11], v[188:191]
  ds_read_b64_tr_b16 v[240:241], v46 offset:49152
  ds_read_b64_tr_b16 v[242:243], v46 offset:53248
  v_mfma_f32_16x16x32_bf16 v[188:191], v[252:255], a[12:15], v[188:191]
  ds_read_b64_tr_b16 v[244:245], v46 offset:57344
  ds_read_b64_tr_b16 v[246:247], v46 offset:61440
  v_mfma_f32_16x16x32_bf16 v[184:187], v[248:251], a[0:3], v[184:187]
  v_sub_f32 v11, 1.0, v9
  v_mfma_f32_16x16x32_bf16 v[184:187], v[252:255], a[4:7], v[184:187]
  s_waitcnt vmcnt(12) lgkmcnt(8)
  s_barrier
  v_mfma_f32_16x16x32_bf16 v[128:131], v[192:195], a[16:19], v[128:131]
  ds_read_b64_tr_b16 v[248:249], v47 offset:49152
  ds_read_b64_tr_b16 v[250:251], v47 offset:53248
  v_mfma_f32_16x16x32_bf16 v[128:131], v[196:199], a[20:23], v[128:131]
  ds_read_b64_tr_b16 v[252:253], v47 offset:57344
  ds_read_b64_tr_b16 v[254:255], v47 offset:61440
  v_mfma_f32_16x16x32_bf16 v[132:135], v[192:195], a[24:27], v[132:135]
  buffer_load_dwordx4 a[64:67], v6, s[48:51], s65 offen offset:0 sc1
  v_mfma_f32_16x16x32_bf16 v[132:135], v[196:199], a[28:31], v[132:135]
  buffer_load_dwordx4 a[72:75], v7, s[48:51], s65 offen offset:0 sc1
  v_mfma_f32_16x16x32_bf16 v[140:143], v[200:203], a[24:27], v[140:143]
  ds_read_b64_tr_b16 v[192:193], v32 offset:0
  ds_read_b64_tr_b16 v[194:195], v32 offset:4096
  v_mfma_f32_16x16x32_bf16 v[140:143], v[204:207], a[28:31], v[140:143]
  ds_read_b64_tr_b16 v[196:197], v32 offset:8192
  ds_read_b64_tr_b16 v[198:199], v32 offset:12288
  v_mfma_f32_16x16x32_bf16 v[136:139], v[200:203], a[16:19], v[136:139]
  buffer_load_dwordx4 a[68:71], v6, s[48:51], s65 offen offset:2048 sc1
  v_mfma_f32_16x16x32_bf16 v[136:139], v[204:207], a[20:23], v[136:139]
  v_mul_f32 v64, v64, v10
  v_mfma_f32_16x16x32_bf16 v[144:147], v[208:211], a[16:19], v[144:147]
  ds_read_b64_tr_b16 v[200:201], v33 offset:0
  ds_read_b64_tr_b16 v[202:203], v33 offset:4096
  v_mfma_f32_16x16x32_bf16 v[144:147], v[212:215], a[20:23], v[144:147]
  ds_read_b64_tr_b16 v[204:205], v33 offset:8192
  ds_read_b64_tr_b16 v[206:207], v33 offset:12288
  v_mfma_f32_16x16x32_bf16 v[148:151], v[208:211], a[24:27], v[148:151]
  buffer_load_dwordx4 a[76:79], v7, s[48:51], s65 offen offset:2048 sc1
  v_mfma_f32_16x16x32_bf16 v[148:151], v[212:215], a[28:31], v[148:151]
  s_xor_b32 s65, s4, s70
  v_mul_f32 v65, v65, v10
  v_mfma_f32_16x16x32_bf16 v[156:159], v[216:219], a[24:27], v[156:159]
  s_add_u32 s65, s65, s1
  ds_read_b64_tr_b16 v[208:209], v34 offset:0
  ds_read_b64_tr_b16 v[210:211], v34 offset:4096
  v_mfma_f32_16x16x32_bf16 v[156:159], v[220:223], a[28:31], v[156:159]
  s_add_u32 s70, s70, 8192
  ds_read_b64_tr_b16 v[212:213], v34 offset:8192
  ds_read_b64_tr_b16 v[214:215], v34 offset:12288
  v_mfma_f32_16x16x32_bf16 v[152:155], v[216:219], a[16:19], v[152:155]
  v_mul_f32 v66, v66, v10
  v_mfma_f32_16x16x32_bf16 v[152:155], v[220:223], a[20:23], v[152:155]
  s_waitcnt lgkmcnt(8)
  v_mfma_f32_16x16x32_bf16 v[160:163], v[224:227], a[16:19], v[160:163]
  s_add_u32 m0, s69, 81920
  ds_read_b64_tr_b16 v[216:217], v35 offset:0
  ds_read_b64_tr_b16 v[218:219], v35 offset:4096
  v_mfma_f32_16x16x32_bf16 v[160:163], v[228:231], a[20:23], v[160:163]
  ds_read_b64_tr_b16 v[220:221], v35 offset:8192
  ds_read_b64_tr_b16 v[222:223], v35 offset:12288
  v_mfma_f32_16x16x32_bf16 v[164:167], v[224:227], a[24:27], v[164:167]
  buffer_load_dwordx4 v2, s[44:47], s67 offen offset:0 sc1 lds
  v_mfma_f32_16x16x32_bf16 v[164:167], v[228:231], a[28:31], v[164:167]
  buffer_load_dwordx4 v3, s[44:47], s67 offen offset:1024 sc1 lds
  v_mfma_f32_16x16x32_bf16 v[172:175], v[232:235], a[24:27], v[172:175]
  ds_read_b64_tr_b16 v[224:225], v36 offset:0
  ds_read_b64_tr_b16 v[226:227], v36 offset:4096
  v_mfma_f32_16x16x32_bf16 v[172:175], v[236:239], a[28:31], v[172:175]
  ds_read_b64_tr_b16 v[228:229], v36 offset:8192
  ds_read_b64_tr_b16 v[230:231], v36 offset:12288
  v_mfma_f32_16x16x32_bf16 v[168:171], v[232:235], a[16:19], v[168:171]
  v_mul_f32 v67, v67, v10
  v_mfma_f32_16x16x32_bf16 v[168:171], v[236:239], a[20:23], v[168:171]
  buffer_load_dwordx4 v4, s[44:47], s67 offen offset:2048 sc1 lds
  v_mfma_f32_16x16x32_bf16 v[176:179], v[240:243], a[16:19], v[176:179]
  ds_read_b64_tr_b16 v[232:233], v37 offset:0
  ds_read_b64_tr_b16 v[234:235], v37 offset:4096
  v_mfma_f32_16x16x32_bf16 v[176:179], v[244:247], a[20:23], v[176:179]
  ds_read_b64_tr_b16 v[236:237], v37 offset:8192
  ds_read_b64_tr_b16 v[238:239], v37 offset:12288
  v_mfma_f32_16x16x32_bf16 v[180:183], v[240:243], a[24:27], v[180:183]
  buffer_load_dwordx4 v5, s[44:47], s67 offen offset:3072 sc1 lds
  v_mfma_f32_16x16x32_bf16 v[180:183], v[244:247], a[28:31], v[180:183]
  v_mul_f32 v68, v68, v11
  s_xor_b32 s67, s10, s8
  v_mfma_f32_16x16x32_bf16 v[188:191], v[248:251], a[24:27], v[188:191]
  s_add_u32 s8, s8, 131072
  ds_read_b64_tr_b16 v[240:241], v38 offset:0
  ds_read_b64_tr_b16 v[242:243], v38 offset:4096
  v_mfma_f32_16x16x32_bf16 v[188:191], v[252:255], a[28:31], v[188:191]
  ds_read_b64_tr_b16 v[244:245], v38 offset:8192
  ds_read_b64_tr_b16 v[246:247], v38 offset:12288
  v_mfma_f32_16x16x32_bf16 v[184:187], v[248:251], a[16:19], v[184:187]
  v_mul_f32 v69, v69, v11
  v_mfma_f32_16x16x32_bf16 v[184:187], v[252:255], a[20:23], v[184:187]
  s_waitcnt vmcnt(16) lgkmcnt(8)
  s_barrier
  v_mfma_f32_16x16x32_bf16 v[128:131], v[192:195], a[32:35], v[128:131]
  ds_read_b64_tr_b16 v[248:249], v39 offset:0
  ds_read_b64_tr_b16 v[250:251], v39 offset:4096
  v_mfma_f32_16x16x32_bf16 v[128:131], v[196:199], a[36:39], v[128:131]
  ds_read_b64_tr_b16 v[252:253], v39 offset:8192
  ds_read_b64_tr_b16 v[254:255], v39 offset:12288
  v_mfma_f32_16x16x32_bf16 v[132:135], v[192:195], a[40:43], v[132:135]
  buffer_load_dwordx4 a[80:83], v6, s[48:51], s65 offen offset:0 sc1
  v_mfma_f32_16x16x32_bf16 v[132:135], v[196:199], a[44:47], v[132:135]
  buffer_load_dwordx4 a[88:91], v7, s[48:51], s65 offen offset:0 sc1
  v_mfma_f32_16x16x32_bf16 v[140:143], v[200:203], a[40:43], v[140:143]
  ds_read_b64_tr_b16 v[192:193], v32 offset:32768
  ds_read_b64_tr_b16 v[194:195], v32 offset:36864
  v_mfma_f32_16x16x32_bf16 v[140:143], v[204:207], a[44:47], v[140:143]
  ds_read_b64_tr_b16 v[196:197], v32 offset:40960
  ds_read_b64_tr_b16 v[198:199], v32 offset:45056
  v_mfma_f32_16x16x32_bf16 v[136:139], v[200:203], a[32:35], v[136:139]
  v_mul_f32 v70, v70, v11
  v_mfma_f32_16x16x32_bf16 v[136:139], v[204:207], a[36:39], v[136:139]
  buffer_load_dwordx4 a[84:87], v6, s[48:51], s65 offen offset:2048 sc1
  v_mfma_f32_16x16x32_bf16 v[144:147], v[208:211], a[32:35], v[144:147]
  ds_read_b64_tr_b16 v[200:201], v33 offset:32768
  ds_read_b64_tr_b16 v[202:203], v33 offset:36864
  v_mfma_f32_16x16x32_bf16 v[144:147], v[212:215], a[36:39], v[144:147]
  ds_read_b64_tr_b16 v[204:205], v33 offset:40960
  ds_read_b64_tr_b16 v[206:207], v33 offset:45056
  v_mfma_f32_16x16x32_bf16 v[148:151], v[208:211], a[40:43], v[148:151]
  buffer_load_dwordx4 a[92:95], v7, s[48:51], s65 offen offset:2048 sc1
  v_mfma_f32_16x16x32_bf16 v[148:151], v[212:215], a[44:47], v[148:151]
  v_mul_f32 v71, v71, v11
  v_mfma_f32_16x16x32_bf16 v[156:159], v[216:219], a[40:43], v[156:159]
  s_add_u32 s65, s65, 4096
  ds_read_b64_tr_b16 v[208:209], v34 offset:32768
  ds_read_b64_tr_b16 v[210:211], v34 offset:36864
  v_mfma_f32_16x16x32_bf16 v[156:159], v[220:223], a[44:47], v[156:159]
  s_add_u32 m0, s69, 114688
  ds_read_b64_tr_b16 v[212:213], v34 offset:40960
  ds_read_b64_tr_b16 v[214:215], v34 offset:45056
  v_mfma_f32_16x16x32_bf16 v[152:155], v[216:219], a[32:35], v[152:155]
  v_mfma_f32_16x16x32_bf16 v[152:155], v[220:223], a[36:39], v[152:155]
  s_waitcnt lgkmcnt(8)
  v_mul_f32 v72, v72, v10
  v_mfma_f32_16x16x32_bf16 v[160:163], v[224:227], a[32:35], v[160:163]
  ds_read_b64_tr_b16 v[216:217], v35 offset:32768
  ds_read_b64_tr_b16 v[218:219], v35 offset:36864
  v_mfma_f32_16x16x32_bf16 v[160:163], v[228:231], a[36:39], v[160:163]
  ds_read_b64_tr_b16 v[220:221], v35 offset:40960
  ds_read_b64_tr_b16 v[222:223], v35 offset:45056
  v_mfma_f32_16x16x32_bf16 v[164:167], v[224:227], a[40:43], v[164:167]
  buffer_load_dwordx4 v2, s[44:47], s67 offen offset:0 sc1 lds
  v_mfma_f32_16x16x32_bf16 v[164:167], v[228:231], a[44:47], v[164:167]
  buffer_load_dwordx4 v3, s[44:47], s67 offen offset:1024 sc1 lds
  v_mfma_f32_16x16x32_bf16 v[172:175], v[232:235], a[40:43], v[172:175]
  ds_read_b64_tr_b16 v[224:225], v36 offset:32768
  ds_read_b64_tr_b16 v[226:227], v36 offset:36864
  v_mfma_f32_16x16x32_bf16 v[172:175], v[236:239], a[44:47], v[172:175]
  ds_read_b64_tr_b16 v[228:229], v36 offset:40960
  ds_read_b64_tr_b16 v[230:231], v36 offset:45056
  v_mfma_f32_16x16x32_bf16 v[168:171], v[232:235], a[32:35], v[168:171]
  v_mul_f32 v73, v73, v10
  v_mfma_f32_16x16x32_bf16 v[168:171], v[236:239], a[36:39], v[168:171]
  buffer_load_dwordx4 v4, s[44:47], s67 offen offset:2048 sc1 lds
  v_mfma_f32_16x16x32_bf16 v[176:179], v[240:243], a[32:35], v[176:179]
  ds_read_b64_tr_b16 v[232:233], v37 offset:32768
  ds_read_b64_tr_b16 v[234:235], v37 offset:36864
  v_mfma_f32_16x16x32_bf16 v[176:179], v[244:247], a[36:39], v[176:179]
  ds_read_b64_tr_b16 v[236:237], v37 offset:40960
  ds_read_b64_tr_b16 v[238:239], v37 offset:45056
  v_mfma_f32_16x16x32_bf16 v[180:183], v[240:243], a[40:43], v[180:183]
  buffer_load_dwordx4 v5, s[44:47], s67 offen offset:3072 sc1 lds
  v_mfma_f32_16x16x32_bf16 v[180:183], v[244:247], a[44:47], v[180:183]
  v_mul_f32 v74, v74, v10
  v_mfma_f32_16x16x32_bf16 v[188:191], v[248:251], a[40:43], v[188:191]
  s_add_u32 s67, s67, 65536
  ds_read_b64_tr_b16 v[240:241], v38 offset:32768
  ds_read_b64_tr_b16 v[242:243], v38 offset:36864
  v_mfma_f32_16x16x32_bf16 v[188:191], v[252:255], a[44:47], v[188:191]
  ds_read_b64_tr_b16 v[244:245], v38 offset:40960
  ds_read_b64_tr_b16 v[246:247], v38 offset:45056
  v_mfma_f32_16x16x32_bf16 v[184:187], v[248:251], a[32:35], v[184:187]
  v_mul_f32 v75, v75, v10
  v_mfma_f32_16x16x32_bf16 v[184:187], v[252:255], a[36:39], v[184:187]
  s_waitcnt vmcnt(20) lgkmcnt(8)
  s_barrier
  v_mfma_f32_16x16x32_bf16 v[128:131], v[192:195], a[48:51], v[128:131]
  ds_read_b64_tr_b16 v[248:249], v39 offset:32768
  ds_read_b64_tr_b16 v[250:251], v39 offset:36864
  v_mfma_f32_16x16x32_bf16 v[128:131], v[196:199], a[52:55], v[128:131]
  ds_read_b64_tr_b16 v[252:253], v39 offset:40960
  ds_read_b64_tr_b16 v[254:255], v39 offset:45056
  v_mfma_f32_16x16x32_bf16 v[132:135], v[192:195], a[56:59], v[132:135]
  buffer_load_dwordx4 a[96:99], v6, s[48:51], s65 offen offset:0 sc1
  v_mfma_f32_16x16x32_bf16 v[132:135], v[196:199], a[60:63], v[132:135]
  buffer_load_dwordx4 a[104:107], v7, s[48:51], s65 offen offset:0 sc1
  v_mfma_f32_16x16x32_bf16 v[140:143], v[200:203], a[56:59], v[140:143]
  ds_read_b64_tr_b16 v[192:193], v40 offset:0
  ds_read_b64_tr_b16 v[194:195], v40 offset:4096
  v_mfma_f32_16x16x32_bf16 v[140:143], v[204:207], a[60:63], v[140:143]
  ds_read_b64_tr_b16 v[196:197], v40 offset:8192
  ds_read_b64_tr_b16 v[198:199], v40 offset:12288
  v_mfma_f32_16x16x32_bf16 v[136:139], v[200:203], a[48:51], v[136:139]
  buffer_load_dwordx4 a[100:103], v6, s[48:51], s65 offen offset:2048 sc1
  v_mfma_f32_16x16x32_bf16 v[136:139], v[204:207], a[52:55], v[136:139]
  v_mul_f32 v76, v76, v11
  v_mfma_f32_16x16x32_bf16 v[144:147], v[208:211], a[48:51], v[144:147]
  ds_read_b64_tr_b16 v[200:201], v41 offset:0
  ds_read_b64_tr_b16 v[202:203], v41 offset:4096
  v_mfma_f32_16x16x32_bf16 v[144:147], v[212:215], a[52:55], v[144:147]
  ds_read_b64_tr_b16 v[204:205], v41 offset:8192
  ds_read_b64_tr_b16 v[206:207], v41 offset:12288
  v_mfma_f32_16x16x32_bf16 v[148:151], v[208:211], a[56:59], v[148:151]
  buffer_load_dwordx4 a[108:111], v7, s[48:51], s65 offen offset:2048 sc1
  v_mfma_f32_16x16x32_bf16 v[148:151], v[212:215], a[60:63], v[148:151]
  s_xor_b32 s65, s4, s70
  v_mul_f32 v77, v77, v11
  v_mfma_f32_16x16x32_bf16 v[156:159], v[216:219], a[56:59], v[156:159]
  s_add_u32 s65, s65, s1
  ds_read_b64_tr_b16 v[208:209], v42 offset:0
  ds_read_b64_tr_b16 v[210:211], v42 offset:4096
  v_mfma_f32_16x16x32_bf16 v[156:159], v[220:223], a[60:63], v[156:159]
  s_add_u32 s70, s70, 8192
  ds_read_b64_tr_b16 v[212:213], v42 offset:8192
  ds_read_b64_tr_b16 v[214:215], v42 offset:12288
  v_mfma_f32_16x16x32_bf16 v[152:155], v[216:219], a[48:51], v[152:155]
  v_mul_f32 v78, v78, v11
  v_mfma_f32_16x16x32_bf16 v[152:155], v[220:223], a[52:55], v[152:155]
  s_waitcnt lgkmcnt(8)
  v_mfma_f32_16x16x32_bf16 v[160:163], v[224:227], a[48:51], v[160:163]
  s_add_u32 m0, s69, 131072
  ds_read_b64_tr_b16 v[216:217], v43 offset:0
  ds_read_b64_tr_b16 v[218:219], v43 offset:4096
  v_mfma_f32_16x16x32_bf16 v[160:163], v[228:231], a[52:55], v[160:163]
  ds_read_b64_tr_b16 v[220:221], v43 offset:8192
  ds_read_b64_tr_b16 v[222:223], v43 offset:12288
  v_mfma_f32_16x16x32_bf16 v[164:167], v[224:227], a[56:59], v[164:167]
  buffer_load_dwordx4 v2, s[44:47], s67 offen offset:0 sc1 lds
  v_mfma_f32_16x16x32_bf16 v[164:167], v[228:231], a[60:63], v[164:167]
  buffer_load_dwordx4 v3, s[44:47], s67 offen offset:1024 sc1 lds
  v_mfma_f32_16x16x32_bf16 v[172:175], v[232:235], a[56:59], v[172:175]
  ds_read_b64_tr_b16 v[224:225], v44 offset:0
  ds_read_b64_tr_b16 v[226:227], v44 offset:4096
  v_mfma_f32_16x16x32_bf16 v[172:175], v[236:239], a[60:63], v[172:175]
  ds_read_b64_tr_b16 v[228:229], v44 offset:8192
  ds_read_b64_tr_b16 v[230:231], v44 offset:12288
  v_mfma_f32_16x16x32_bf16 v[168:171], v[232:235], a[48:51], v[168:171]
  v_mul_f32 v79, v79, v11
  v_mfma_f32_16x16x32_bf16 v[168:171], v[236:239], a[52:55], v[168:171]
  buffer_load_dwordx4 v4, s[44:47], s67 offen offset:2048 sc1 lds
  v_mfma_f32_16x16x32_bf16 v[176:179], v[240:243], a[48:51], v[176:179]
  ds_read_b64_tr_b16 v[232:233], v45 offset:0
  ds_read_b64_tr_b16 v[234:235], v45 offset:4096
  v_mfma_f32_16x16x32_bf16 v[176:179], v[244:247], a[52:55], v[176:179]
  ds_read_b64_tr_b16 v[236:237], v45 offset:8192
  ds_read_b64_tr_b16 v[238:239], v45 offset:12288
  v_mfma_f32_16x16x32_bf16 v[180:183], v[240:243], a[56:59], v[180:183]
  buffer_load_dwordx4 v5, s[44:47], s67 offen offset:3072 sc1 lds
  v_mfma_f32_16x16x32_bf16 v[180:183], v[244:247], a[60:63], v[180:183]
  v_mul_f32 v80, v80, v10
  s_xor_b32 s67, s10, s8
  v_mfma_f32_16x16x32_bf16 v[188:191], v[248:251], a[56:59], v[188:191]
  s_add_u32 s8, s8, 131072
  ds_read_b64_tr_b16 v[240:241], v46 offset:0
  ds_read_b64_tr_b16 v[242:243], v46 offset:4096
  v_mfma_f32_16x16x32_bf16 v[188:191], v[252:255], a[60:63], v[188:191]
  ds_read_b64_tr_b16 v[244:245], v46 offset:8192
  ds_read_b64_tr_b16 v[246:247], v46 offset:12288
  v_mfma_f32_16x16x32_bf16 v[184:187], v[248:251], a[48:51], v[184:187]
  v_mul_f32 v81, v81, v10
  v_mfma_f32_16x16x32_bf16 v[184:187], v[252:255], a[52:55], v[184:187]
  s_waitcnt vmcnt(20) lgkmcnt(8)
  s_barrier
  v_mfma_f32_16x16x32_bf16 v[128:131], v[192:195], a[64:67], v[128:131]
  ds_read_b64_tr_b16 v[248:249], v47 offset:0
  ds_read_b64_tr_b16 v[250:251], v47 offset:4096
  v_mfma_f32_16x16x32_bf16 v[128:131], v[196:199], a[68:71], v[128:131]
  ds_read_b64_tr_b16 v[252:253], v47 offset:8192
  ds_read_b64_tr_b16 v[254:255], v47 offset:12288
  v_mfma_f32_16x16x32_bf16 v[132:135], v[192:195], a[72:75], v[132:135]
  buffer_load_dwordx4 a[112:115], v6, s[48:51], s65 offen offset:0 sc1
  v_mfma_f32_16x16x32_bf16 v[132:135], v[196:199], a[76:79], v[132:135]
  buffer_load_dwordx4 a[120:123], v7, s[48:51], s65 offen offset:0 sc1
  v_mfma_f32_16x16x32_bf16 v[140:143], v[200:203], a[72:75], v[140:143]
  ds_read_b64_tr_b16 v[192:193], v32 offset:16384
  ds_read_b64_tr_b16 v[194:195], v32 offset:20480
  v_mfma_f32_16x16x32_bf16 v[140:143], v[204:207], a[76:79], v[140:143]
  ds_read_b64_tr_b16 v[196:197], v32 offset:24576
  ds_read_b64_tr_b16 v[198:199], v32 offset:28672
  v_mfma_f32_16x16x32_bf16 v[136:139], v[200:203], a[64:67], v[136:139]
  v_mul_f32 v82, v82, v10
  v_mfma_f32_16x16x32_bf16 v[136:139], v[204:207], a[68:71], v[136:139]
  buffer_load_dwordx4 a[116:119], v6, s[48:51], s65 offen offset:2048 sc1
  v_mfma_f32_16x16x32_bf16 v[144:147], v[208:211], a[64:67], v[144:147]
  ds_read_b64_tr_b16 v[200:201], v33 offset:16384
  ds_read_b64_tr_b16 v[202:203], v33 offset:20480
  v_mfma_f32_16x16x32_bf16 v[144:147], v[212:215], a[68:71], v[144:147]
  ds_read_b64_tr_b16 v[204:205], v33 offset:24576
  ds_read_b64_tr_b16 v[206:207], v33 offset:28672
  v_mfma_f32_16x16x32_bf16 v[148:151], v[208:211], a[72:75], v[148:151]
  buffer_load_dwordx4 a[124:127], v7, s[48:51], s65 offen offset:2048 sc1
  v_mfma_f32_16x16x32_bf16 v[148:151], v[212:215], a[76:79], v[148:151]
  v_mul_f32 v83, v83, v10
  v_mfma_f32_16x16x32_bf16 v[156:159], v[216:219], a[72:75], v[156:159]
  s_add_u32 s65, s65, 4096
  ds_read_b64_tr_b16 v[208:209], v34 offset:16384
  ds_read_b64_tr_b16 v[210:211], v34 offset:20480
  v_mfma_f32_16x16x32_bf16 v[156:159], v[220:223], a[76:79], v[156:159]
  s_add_u32 m0, s69, 147456
  ds_read_b64_tr_b16 v[212:213], v34 offset:24576
  ds_read_b64_tr_b16 v[214:215], v34 offset:28672
  v_mfma_f32_16x16x32_bf16 v[152:155], v[216:219], a[64:67], v[152:155]
  v_mfma_f32_16x16x32_bf16 v[152:155], v[220:223], a[68:71], v[152:155]
  s_waitcnt lgkmcnt(8)
  v_mul_f32 v84, v84, v11
  v_mfma_f32_16x16x32_bf16 v[160:163], v[224:227], a[64:67], v[160:163]
  ds_read_b64_tr_b16 v[216:217], v35 offset:16384
  ds_read_b64_tr_b16 v[218:219], v35 offset:20480
  v_mfma_f32_16x16x32_bf16 v[160:163], v[228:231], a[68:71], v[160:163]
  ds_read_b64_tr_b16 v[220:221], v35 offset:24576
  ds_read_b64_tr_b16 v[222:223], v35 offset:28672
  v_mfma_f32_16x16x32_bf16 v[164:167], v[224:227], a[72:75], v[164:167]
  buffer_load_dwordx4 v2, s[44:47], s67 offen offset:0 sc1 lds
  v_mfma_f32_16x16x32_bf16 v[164:167], v[228:231], a[76:79], v[164:167]
  buffer_load_dwordx4 v3, s[44:47], s67 offen offset:1024 sc1 lds
  v_mfma_f32_16x16x32_bf16 v[172:175], v[232:235], a[72:75], v[172:175]
  ds_read_b64_tr_b16 v[224:225], v36 offset:16384
  ds_read_b64_tr_b16 v[226:227], v36 offset:20480
  v_mfma_f32_16x16x32_bf16 v[172:175], v[236:239], a[76:79], v[172:175]
  ds_read_b64_tr_b16 v[228:229], v36 offset:24576
  ds_read_b64_tr_b16 v[230:231], v36 offset:28672
  v_mfma_f32_16x16x32_bf16 v[168:171], v[232:235], a[64:67], v[168:171]
  v_mul_f32 v85, v85, v11
  v_mfma_f32_16x16x32_bf16 v[168:171], v[236:239], a[68:71], v[168:171]
  buffer_load_dwordx4 v4, s[44:47], s67 offen offset:2048 sc1 lds
  v_mfma_f32_16x16x32_bf16 v[176:179], v[240:243], a[64:67], v[176:179]
  ds_read_b64_tr_b16 v[232:233], v37 offset:16384
  ds_read_b64_tr_b16 v[234:235], v37 offset:20480
  v_mfma_f32_16x16x32_bf16 v[176:179], v[244:247], a[68:71], v[176:179]
  ds_read_b64_tr_b16 v[236:237], v37 offset:24576
  ds_read_b64_tr_b16 v[238:239], v37 offset:28672
  v_mfma_f32_16x16x32_bf16 v[180:183], v[240:243], a[72:75], v[180:183]
  buffer_load_dwordx4 v5, s[44:47], s67 offen offset:3072 sc1 lds
  v_mfma_f32_16x16x32_bf16 v[180:183], v[244:247], a[76:79], v[180:183]
  v_mul_f32 v86, v86, v11
  v_mfma_f32_16x16x32_bf16 v[188:191], v[248:251], a[72:75], v[188:191]
  s_add_u32 s67, s67, 65536
  ds_read_b64_tr_b16 v[240:241], v38 offset:16384
  ds_read_b64_tr_b16 v[242:243], v38 offset:20480
  v_mfma_f32_16x16x32_bf16 v[188:191], v[252:255], a[76:79], v[188:191]
  ds_read_b64_tr_b16 v[244:245], v38 offset:24576
  ds_read_b64_tr_b16 v[246:247], v38 offset:28672
  v_mfma_f32_16x16x32_bf16 v[184:187], v[248:251], a[64:67], v[184:187]
  v_mul_f32 v87, v87, v11
  v_mfma_f32_16x16x32_bf16 v[184:187], v[252:255], a[68:71], v[184:187]
  s_waitcnt vmcnt(20) lgkmcnt(8)
  s_barrier
  v_mfma_f32_16x16x32_bf16 v[128:131], v[192:195], a[80:83], v[128:131]
  ds_read_b64_tr_b16 v[248:249], v39 offset:16384
  ds_read_b64_tr_b16 v[250:251], v39 offset:20480
  v_mfma_f32_16x16x32_bf16 v[128:131], v[196:199], a[84:87], v[128:131]
  ds_read_b64_tr_b16 v[252:253], v39 offset:24576
  ds_read_b64_tr_b16 v[254:255], v39 offset:28672
  v_mfma_f32_16x16x32_bf16 v[132:135], v[192:195], a[88:91], v[132:135]
  buffer_load_dwordx4 a[0:3], v6, s[48:51], s65 offen offset:0 sc1
  v_mfma_f32_16x16x32_bf16 v[132:135], v[196:199], a[92:95], v[132:135]
  buffer_load_dwordx4 a[8:11], v7, s[48:51], s65 offen offset:0 sc1
  v_mfma_f32_16x16x32_bf16 v[140:143], v[200:203], a[88:91], v[140:143]
  ds_read_b64_tr_b16 v[192:193], v32 offset:49152
  ds_read_b64_tr_b16 v[194:195], v32 offset:53248
  v_mfma_f32_16x16x32_bf16 v[140:143], v[204:207], a[92:95], v[140:143]
  ds_read_b64_tr_b16 v[196:197], v32 offset:57344
  ds_read_b64_tr_b16 v[198:199], v32 offset:61440
  v_mfma_f32_16x16x32_bf16 v[136:139], v[200:203], a[80:83], v[136:139]
  buffer_load_dwordx4 a[4:7], v6, s[48:51], s65 offen offset:2048 sc1
  v_mfma_f32_16x16x32_bf16 v[136:139], v[204:207], a[84:87], v[136:139]
  v_mul_f32 v88, v88, v10
  v_mfma_f32_16x16x32_bf16 v[144:147], v[208:211], a[80:83], v[144:147]
  ds_read_b64_tr_b16 v[200:201], v33 offset:49152
  ds_read_b64_tr_b16 v[202:203], v33 offset:53248
  v_mfma_f32_16x16x32_bf16 v[144:147], v[212:215], a[84:87], v[144:147]
  ds_read_b64_tr_b16 v[204:205], v33 offset:57344
  ds_read_b64_tr_b16 v[206:207], v33 offset:61440
  v_mfma_f32_16x16x32_bf16 v[148:151], v[208:211], a[88:91], v[148:151]
  buffer_load_dwordx4 a[12:15], v7, s[48:51], s65 offen offset:2048 sc1
  v_mfma_f32_16x16x32_bf16 v[148:151], v[212:215], a[92:95], v[148:151]
  s_xor_b32 s65, s4, s70
  v_mul_f32 v89, v89, v10
  v_mfma_f32_16x16x32_bf16 v[156:159], v[216:219], a[88:91], v[156:159]
  s_add_u32 s65, s65, s1
  ds_read_b64_tr_b16 v[208:209], v34 offset:49152
  ds_read_b64_tr_b16 v[210:211], v34 offset:53248
  v_mfma_f32_16x16x32_bf16 v[156:159], v[220:223], a[92:95], v[156:159]
  s_add_u32 s70, s70, 8192
  ds_read_b64_tr_b16 v[212:213], v34 offset:57344
  ds_read_b64_tr_b16 v[214:215], v34 offset:61440
  v_mfma_f32_16x16x32_bf16 v[152:155], v[216:219], a[80:83], v[152:155]
  v_mul_f32 v90, v90, v10
  v_mfma_f32_16x16x32_bf16 v[152:155], v[220:223], a[84:87], v[152:155]
  s_waitcnt lgkmcnt(8)
  v_mfma_f32_16x16x32_bf16 v[160:163], v[224:227], a[80:83], v[160:163]
  s_add_u32 m0, s69, 32768
  ds_read_b64_tr_b16 v[216:217], v35 offset:49152
  ds_read_b64_tr_b16 v[218:219], v35 offset:53248
  v_mfma_f32_16x16x32_bf16 v[160:163], v[228:231], a[84:87], v[160:163]
  ds_read_b64_tr_b16 v[220:221], v35 offset:57344
  ds_read_b64_tr_b16 v[222:223], v35 offset:61440
  v_mfma_f32_16x16x32_bf16 v[164:167], v[224:227], a[88:91], v[164:167]
  buffer_load_dwordx4 v2, s[44:47], s67 offen offset:0 sc1 lds
  v_mfma_f32_16x16x32_bf16 v[164:167], v[228:231], a[92:95], v[164:167]
  buffer_load_dwordx4 v3, s[44:47], s67 offen offset:1024 sc1 lds
  v_mfma_f32_16x16x32_bf16 v[172:175], v[232:235], a[88:91], v[172:175]
  ds_read_b64_tr_b16 v[224:225], v36 offset:49152
  ds_read_b64_tr_b16 v[226:227], v36 offset:53248
  v_mfma_f32_16x16x32_bf16 v[172:175], v[236:239], a[92:95], v[172:175]
  ds_read_b64_tr_b16 v[228:229], v36 offset:57344
  ds_read_b64_tr_b16 v[230:231], v36 offset:61440
  v_mfma_f32_16x16x32_bf16 v[168:171], v[232:235], a[80:83], v[168:171]
  v_mul_f32 v91, v91, v10
  v_mfma_f32_16x16x32_bf16 v[168:171], v[236:239], a[84:87], v[168:171]
  buffer_load_dwordx4 v4, s[44:47], s67 offen offset:2048 sc1 lds
  v_mfma_f32_16x16x32_bf16 v[176:179], v[240:243], a[80:83], v[176:179]
  ds_read_b64_tr_b16 v[232:233], v37 offset:49152
  ds_read_b64_tr_b16 v[234:235], v37 offset:53248
  v_mfma_f32_16x16x32_bf16 v[176:179], v[244:247], a[84:87], v[176:179]
  ds_read_b64_tr_b16 v[236:237], v37 offset:57344
  ds_read_b64_tr_b16 v[238:239], v37 offset:61440
  v_mfma_f32_16x16x32_bf16 v[180:183], v[240:243], a[88:91], v[180:183]
  buffer_load_dwordx4 v5, s[44:47], s67 offen offset:3072 sc1 lds
  v_mfma_f32_16x16x32_bf16 v[180:183], v[244:247], a[92:95], v[180:183]
  v_mul_f32 v92, v92, v11
  s_xor_b32 s67, s10, s8
  v_mfma_f32_16x16x32_bf16 v[188:191], v[248:251], a[88:91], v[188:191]
  s_add_u32 s8, s8, 131072
  ds_read_b64_tr_b16 v[240:241], v38 offset:49152
  ds_read_b64_tr_b16 v[242:243], v38 offset:53248
  v_mfma_f32_16x16x32_bf16 v[188:191], v[252:255], a[92:95], v[188:191]
  ds_read_b64_tr_b16 v[244:245], v38 offset:57344
  ds_read_b64_tr_b16 v[246:247], v38 offset:61440
  v_mfma_f32_16x16x32_bf16 v[184:187], v[248:251], a[80:83], v[184:187]
  v_mul_f32 v93, v93, v11
  v_mfma_f32_16x16x32_bf16 v[184:187], v[252:255], a[84:87], v[184:187]
  s_waitcnt vmcnt(20) lgkmcnt(8)
  s_barrier
  v_mfma_f32_16x16x32_bf16 v[128:131], v[192:195], a[96:99], v[128:131]
  ds_read_b64_tr_b16 v[248:249], v39 offset:49152
  ds_read_b64_tr_b16 v[250:251], v39 offset:53248
  v_mfma_f32_16x16x32_bf16 v[128:131], v[196:199], a[100:103], v[128:131]
  ds_read_b64_tr_b16 v[252:253], v39 offset:57344
  ds_read_b64_tr_b16 v[254:255], v39 offset:61440
  v_mfma_f32_16x16x32_bf16 v[132:135], v[192:195], a[104:107], v[132:135]
  buffer_load_dwordx4 a[16:19], v6, s[48:51], s65 offen offset:0 sc1
  v_mfma_f32_16x16x32_bf16 v[132:135], v[196:199], a[108:111], v[132:135]
  buffer_load_dwordx4 a[24:27], v7, s[48:51], s65 offen offset:0 sc1
  v_mfma_f32_16x16x32_bf16 v[140:143], v[200:203], a[104:107], v[140:143]
  ds_read_b64_tr_b16 v[192:193], v40 offset:16384
  ds_read_b64_tr_b16 v[194:195], v40 offset:20480
  v_mfma_f32_16x16x32_bf16 v[140:143], v[204:207], a[108:111], v[140:143]
  ds_read_b64_tr_b16 v[196:197], v40 offset:24576
  ds_read_b64_tr_b16 v[198:199], v40 offset:28672
  v_mfma_f32_16x16x32_bf16 v[136:139], v[200:203], a[96:99], v[136:139]
  v_mul_f32 v94, v94, v11
  v_mfma_f32_16x16x32_bf16 v[136:139], v[204:207], a[100:103], v[136:139]
  buffer_load_dwordx4 a[20:23], v6, s[48:51], s65 offen offset:2048 sc1
  v_mfma_f32_16x16x32_bf16 v[144:147], v[208:211], a[96:99], v[144:147]
  ds_read_b64_tr_b16 v[200:201], v41 offset:16384
  ds_read_b64_tr_b16 v[202:203], v41 offset:20480
  v_mfma_f32_16x16x32_bf16 v[144:147], v[212:215], a[100:103], v[144:147]
  ds_read_b64_tr_b16 v[204:205], v41 offset:24576
  ds_read_b64_tr_b16 v[206:207], v41 offset:28672
  v_mfma_f32_16x16x32_bf16 v[148:151], v[208:211], a[104:107], v[148:151]
  buffer_load_dwordx4 a[28:31], v7, s[48:51], s65 offen offset:2048 sc1
  v_mfma_f32_16x16x32_bf16 v[148:151], v[212:215], a[108:111], v[148:151]
  v_mul_f32 v95, v95, v11
  v_mfma_f32_16x16x32_bf16 v[156:159], v[216:219], a[104:107], v[156:159]
  s_add_u32 s65, s65, 4096
  ds_read_b64_tr_b16 v[208:209], v42 offset:16384
  ds_read_b64_tr_b16 v[210:211], v42 offset:20480
  v_mfma_f32_16x16x32_bf16 v[156:159], v[220:223], a[108:111], v[156:159]
  s_add_u32 m0, s69, 65536
  ds_read_b64_tr_b16 v[212:213], v42 offset:24576
  ds_read_b64_tr_b16 v[214:215], v42 offset:28672
  v_mfma_f32_16x16x32_bf16 v[152:155], v[216:219], a[96:99], v[152:155]
  v_mfma_f32_16x16x32_bf16 v[152:155], v[220:223], a[100:103], v[152:155]
  s_waitcnt lgkmcnt(8)
  v_mul_f32 v96, v96, v10
  v_mfma_f32_16x16x32_bf16 v[160:163], v[224:227], a[96:99], v[160:163]
  ds_read_b64_tr_b16 v[216:217], v43 offset:16384
  ds_read_b64_tr_b16 v[218:219], v43 offset:20480
  v_mfma_f32_16x16x32_bf16 v[160:163], v[228:231], a[100:103], v[160:163]
  ds_read_b64_tr_b16 v[220:221], v43 offset:24576
  ds_read_b64_tr_b16 v[222:223], v43 offset:28672
  v_mfma_f32_16x16x32_bf16 v[164:167], v[224:227], a[104:107], v[164:167]
  buffer_load_dwordx4 v2, s[44:47], s67 offen offset:0 sc1 lds
  v_mfma_f32_16x16x32_bf16 v[164:167], v[228:231], a[108:111], v[164:167]
  buffer_load_dwordx4 v3, s[44:47], s67 offen offset:1024 sc1 lds
  v_mfma_f32_16x16x32_bf16 v[172:175], v[232:235], a[104:107], v[172:175]
  ds_read_b64_tr_b16 v[224:225], v44 offset:16384
  ds_read_b64_tr_b16 v[226:227], v44 offset:20480
  v_mfma_f32_16x16x32_bf16 v[172:175], v[236:239], a[108:111], v[172:175]
L_pg15:
  s_cbranch_execz L_walk2
  ds_read_b64_tr_b16 v[228:229], v44 offset:24576
  ds_read_b64_tr_b16 v[230:231], v44 offset:28672
  v_mfma_f32_16x16x32_bf16 v[168:171], v[232:235], a[96:99], v[168:171]
  v_mul_f32 v97, v97, v10
  v_mfma_f32_16x16x32_bf16 v[168:171], v[236:239], a[100:103], v[168:171]
  buffer_load_dwordx4 v4, s[44:47], s67 offen offset:2048 sc1 lds
  v_mfma_f32_16x16x32_bf16 v[176:179], v[240:243], a[96:99], v[176:179]
  ds_read_b64_tr_b16 v[232:233], v45 offset:16384
  ds_read_b64_tr_b16 v[234:235], v45 offset:20480
  v_mfma_f32_16x16x32_bf16 v[176:179], v[244:247], a[100:103], v[176:179]
  ds_read_b64_tr_b16 v[236:237], v45 offset:24576
  ds_read_b64_tr_b16 v[238:239], v45 offset:28672
  v_mfma_f32_16x16x32_bf16 v[180:183], v[240:243], a[104:107], v[180:183]
  buffer_load_dwordx4 v5, s[44:47], s67 offen offset:3072 sc1 lds
  v_mfma_f32_16x16x32_bf16 v[180:183], v[244:247], a[108:111], v[180:183]
  v_mul_f32 v98, v98, v10
  v_mfma_f32_16x16x32_bf16 v[188:191], v[248:251], a[104:107], v[188:191]
  s_add_u32 s67, s67, 65536
  ds_read_b64_tr_b16 v[240:241], v46 offset:16384
  ds_read_b64_tr_b16 v[242:243], v46 offset:20480
  v_mfma_f32_16x16x32_bf16 v[188:191], v[252:255], a[108:111], v[188:191]
  ds_read_b64_tr_b16 v[244:245], v46 offset:24576
  ds_read_b64_tr_b16 v[246:247], v46 offset:28672
  v_mfma_f32_16x16x32_bf16 v[184:187], v[248:251], a[96:99], v[184:187]
  v_mul_f32 v99, v99, v10
  v_mfma_f32_16x16x32_bf16 v[184:187], v[252:255], a[100:103], v[184:187]
  s_waitcnt vmcnt(20) lgkmcnt(8)
  s_barrier
  v_mfma_f32_16x16x32_bf16 v[128:131], v[192:195], a[112:115], v[128:131]
  ds_read_b64_tr_b16 v[248:249], v47 offset:16384
  ds_read_b64_tr_b16 v[250:251], v47 offset:20480
  v_mfma_f32_16x16x32_bf16 v[128:131], v[196:199], a[116:119], v[128:131]
  ds_read_b64_tr_b16 v[252:253], v47 offset:24576
  ds_read_b64_tr_b16 v[254:255], v47 offset:28672
  v_mfma_f32_16x16x32_bf16 v[132:135], v[192:195], a[120:123], v[132:135]
  buffer_load_dwordx4 a[32:35], v6, s[48:51], s65 offen offset:0 sc1
  v_mfma_f32_16x16x32_bf16 v[132:135], v[196:199], a[124:127], v[132:135]
  buffer_load_dwordx4 a[40:43], v7, s[48:51], s65 offen offset:0 sc1
  v_mfma_f32_16x16x32_bf16 v[140:143], v[200:203], a[120:123], v[140:143]
  ds_read_b64_tr_b16 v[192:193], v40 offset:32768
  ds_read_b64_tr_b16 v[194:195], v40 offset:36864
  v_mfma_f32_16x16x32_bf16 v[140:143], v[204:207], a[124:127], v[140:143]
  ds_read_b64_tr_b16 v[196:197], v40 offset:40960
  ds_read_b64_tr_b16 v[198:199], v40 offset:45056
  v_mfma_f32_16x16x32_bf16 v[136:139], v[200:203], a[112:115], v[136:139]
  buffer_load_dwordx4 a[36:39], v6, s[48:51], s65 offen offset:2048 sc1
  v_mfma_f32_16x16x32_bf16 v[136:139], v[204:207], a[116:119], v[136:139]
  v_mul_f32 v100, v100, v11
  v_mfma_f32_16x16x32_bf16 v[144:147], v[208:211], a[112:115], v[144:147]
  ds_read_b64_tr_b16 v[200:201], v41 offset:32768
  ds_read_b64_tr_b16 v[202:203], v41 offset:36864
  v_mfma_f32_16x16x32_bf16 v[144:147], v[212:215], a[116:119], v[144:147]
  ds_read_b64_tr_b16 v[204:205], v41 offset:40960
  ds_read_b64_tr_b16 v[206:207], v41 offset:45056
  v_mfma_f32_16x16x32_bf16 v[148:151], v[208:211], a[120:123], v[148:151]
  buffer_load_dwordx4 a[44:47], v7, s[48:51], s65 offen offset:2048 sc1
  v_mfma_f32_16x16x32_bf16 v[148:151], v[212:215], a[124:127], v[148:151]
  s_xor_b32 s65, s4, s70
  v_mul_f32 v101, v101, v11
  v_mfma_f32_16x16x32_bf16 v[156:159], v[216:219], a[120:123], v[156:159]
  s_add_u32 s65, s65, s1
  ds_read_b64_tr_b16 v[208:209], v42 offset:32768
  ds_read_b64_tr_b16 v[210:211], v42 offset:36864
  v_mfma_f32_16x16x32_bf16 v[156:159], v[220:223], a[124:127], v[156:159]
  s_add_u32 s70, s70, 8192
  ds_read_b64_tr_b16 v[212:213], v42 offset:40960
  ds_read_b64_tr_b16 v[214:215], v42 offset:45056
  v_mfma_f32_16x16x32_bf16 v[152:155], v[216:219], a[112:115], v[152:155]
  v_mul_f32 v102, v102, v11
  v_mfma_f32_16x16x32_bf16 v[152:155], v[220:223], a[116:119], v[152:155]
  s_waitcnt lgkmcnt(8)
  v_mfma_f32_16x16x32_bf16 v[160:163], v[224:227], a[112:115], v[160:163]
  s_add_u32 m0, s69, 98304
  ds_read_b64_tr_b16 v[216:217], v43 offset:32768
  ds_read_b64_tr_b16 v[218:219], v43 offset:36864
  v_mfma_f32_16x16x32_bf16 v[160:163], v[228:231], a[116:119], v[160:163]
  ds_read_b64_tr_b16 v[220:221], v43 offset:40960
  ds_read_b64_tr_b16 v[222:223], v43 offset:45056
  v_mfma_f32_16x16x32_bf16 v[164:167], v[224:227], a[120:123], v[164:167]
  buffer_load_dwordx4 v2, s[44:47], s67 offen offset:0 sc1 lds
  v_mfma_f32_16x16x32_bf16 v[164:167], v[228:231], a[124:127], v[164:167]
  buffer_load_dwordx4 v3, s[44:47], s67 offen offset:1024 sc1 lds
  v_mfma_f32_16x16x32_bf16 v[172:175], v[232:235], a[120:123], v[172:175]
  ds_read_b64_tr_b16 v[224:225], v44 offset:32768
  ds_read_b64_tr_b16 v[226:227], v44 offset:36864
  v_mfma_f32_16x16x32_bf16 v[172:175], v[236:239], a[124:127], v[172:175]
  ds_read_b64_tr_b16 v[228:229], v44 offset:40960
  ds_read_b64_tr_b16 v[230:231], v44 offset:45056
  v_mfma_f32_16x16x32_bf16 v[168:171], v[232:235], a[112:115], v[168:171]
  v_mul_f32 v103, v103, v11
  v_mfma_f32_16x16x32_bf16 v[168:171], v[236:239], a[116:119], v[168:171]
  buffer_load_dwordx4 v4, s[44:47], s67 offen offset:2048 sc1 lds
  v_mfma_f32_16x16x32_bf16 v[176:179], v[240:243], a[112:115], v[176:179]
  ds_read_b64_tr_b16 v[232:233], v45 offset:32768
  ds_read_b64_tr_b16 v[234:235], v45 offset:36864
  v_mfma_f32_16x16x32_bf16 v[176:179], v[244:247], a[116:119], v[176:179]
  ds_read_b64_tr_b16 v[236:237], v45 offset:40960
  ds_read_b64_tr_b16 v[238:239], v45 offset:45056
  v_mfma_f32_16x16x32_bf16 v[180:183], v[240:243], a[120:123], v[180:183]
  buffer_load_dwordx4 v5, s[44:47], s67 offen offset:3072 sc1 lds
  v_mfma_f32_16x16x32_bf16 v[180:183], v[244:247], a[124:127], v[180:183]
  v_mul_f32 v104, v104, v10
  s_xor_b32 s67, s10, s8
  v_mfma_f32_16x16x32_bf16 v[188:191], v[248:251], a[120:123], v[188:191]
  s_add_u32 s8, s8, 131072
  ds_read_b64_tr_b16 v[240:241], v46 offset:32768
  ds_read_b64_tr_b16 v[242:243], v46 offset:36864
  v_mfma_f32_16x16x32_bf16 v[188:191], v[252:255], a[124:127], v[188:191]
  ds_read_b64_tr_b16 v[244:245], v46 offset:40960
  ds_read_b64_tr_b16 v[246:247], v46 offset:45056
  v_mfma_f32_16x16x32_bf16 v[184:187], v[248:251], a[112:115], v[184:187]
  v_mul_f32 v105, v105, v10
  v_mfma_f32_16x16x32_bf16 v[184:187], v[252:255], a[116:119], v[184:187]
  s_waitcnt vmcnt(20) lgkmcnt(8)
  s_barrier
  v_mfma_f32_16x16x32_bf16 v[128:131], v[192:195], a[0:3], v[128:131]
  ds_read_b64_tr_b16 v[248:249], v47 offset:32768
  ds_read_b64_tr_b16 v[250:251], v47 offset:36864
  v_mfma_f32_16x16x32_bf16 v[128:131], v[196:199], a[4:7], v[128:131]
  ds_read_b64_tr_b16 v[252:253], v47 offset:40960
  ds_read_b64_tr_b16 v[254:255], v47 offset:45056
  v_mfma_f32_16x16x32_bf16 v[132:135], v[192:195], a[8:11], v[132:135]
  buffer_load_dwordx4 a[48:51], v6, s[48:51], s65 offen offset:0 sc1
  v_mfma_f32_16x16x32_bf16 v[132:135], v[196:199], a[12:15], v[132:135]
  buffer_load_dwordx4 a[56:59], v7, s[48:51], s65 offen offset:0 sc1
  v_mfma_f32_16x16x32_bf16 v[140:143], v[200:203], a[8:11], v[140:143]
  ds_read_b64_tr_b16 v[192:193], v40 offset:49152
  ds_read_b64_tr_b16 v[194:195], v40 offset:53248
  v_mfma_f32_16x16x32_bf16 v[140:143], v[204:207], a[12:15], v[140:143]
  ds_read_b64_tr_b16 v[196:197], v40 offset:57344
  ds_read_b64_tr_b16 v[198:199], v40 offset:61440
  v_mfma_f32_16x16x32_bf16 v[136:139], v[200:203], a[0:3], v[136:139]
  v_mul_f32 v106, v106, v10
  v_mfma_f32_16x16x32_bf16 v[136:139], v[204:207], a[4:7], v[136:139]
  buffer_load_dwordx4 a[52:55], v6, s[48:51], s65 offen offset:2048 sc1
  v_mfma_f32_16x16x32_bf16 v[144:147], v[208:211], a[0:3], v[144:147]
  ds_read_b64_tr_b16 v[200:201], v41 offset:49152
  ds_read_b64_tr_b16 v[202:203], v41 offset:53248
  v_mfma_f32_16x16x32_bf16 v[144:147], v[212:215], a[4:7], v[144:147]
  ds_read_b64_tr_b16 v[204:205], v41 offset:57344
  ds_read_b64_tr_b16 v[206:207], v41 offset:61440
  v_mfma_f32_16x16x32_bf16 v[148:151], v[208:211], a[8:11], v[148:151]
  buffer_load_dwordx4 a[60:63], v7, s[48:51], s65 offen offset:2048 sc1
  v_mfma_f32_16x16x32_bf16 v[148:151], v[212:215], a[12:15], v[148:151]
  v_mul_f32 v107, v107, v10
  v_mfma_f32_16x16x32_bf16 v[156:159], v[216:219], a[8:11], v[156:159]
  s_add_u32 s65, s65, 4096
  ds_read_b64_tr_b16 v[208:209], v42 offset:49152
  ds_read_b64_tr_b16 v[210:211], v42 offset:53248
  v_mfma_f32_16x16x32_bf16 v[156:159], v[220:223], a[12:15], v[156:159]
  s_add_u32 m0, s69, 49152
  ds_read_b64_tr_b16 v[212:213], v42 offset:57344
  ds_read_b64_tr_b16 v[214:215], v42 offset:61440
  v_mfma_f32_16x16x32_bf16 v[152:155], v[216:219], a[0:3], v[152:155]
  v_mfma_f32_16x16x32_bf16 v[152:155], v[220:223], a[4:7], v[152:155]
  s_waitcnt lgkmcnt(8)
  v_mul_f32 v108, v108, v11
  v_mfma_f32_16x16x32_bf16 v[160:163], v[224:227], a[0:3], v[160:163]
  ds_read_b64_tr_b16 v[216:217], v43 offset:49152
  ds_read_b64_tr_b16 v[218:219], v43 offset:53248
  v_mfma_f32_16x16x32_bf16 v[160:163], v[228:231], a[4:7], v[160:163]
  ds_read_b64_tr_b16 v[220:221], v43 offset:57344
  ds_read_b64_tr_b16 v[222:223], v43 offset:61440
  v_mfma_f32_16x16x32_bf16 v[164:167], v[224:227], a[8:11], v[164:167]
  buffer_load_dwordx4 v2, s[44:47], s67 offen offset:0 sc1 lds
  v_mfma_f32_16x16x32_bf16 v[164:167], v[228:231], a[12:15], v[164:167]
  buffer_load_dwordx4 v3, s[44:47], s67 offen offset:1024 sc1 lds
  v_mfma_f32_16x16x32_bf16 v[172:175], v[232:235], a[8:11], v[172:175]
  ds_read_b64_tr_b16 v[224:225], v44 offset:49152
  ds_read_b64_tr_b16 v[226:227], v44 offset:53248
  v_mfma_f32_16x16x32_bf16 v[172:175], v[236:239], a[12:15], v[172:175]
  ds_read_b64_tr_b16 v[228:229], v44 offset:57344
  ds_read_b64_tr_b16 v[230:231], v44 offset:61440
  v_mfma_f32_16x16x32_bf16 v[168:171], v[232:235], a[0:3], v[168:171]
  v_mul_f32 v109, v109, v11
  v_mfma_f32_16x16x32_bf16 v[168:171], v[236:239], a[4:7], v[168:171]
  buffer_load_dwordx4 v4, s[44:47], s67 offen offset:2048 sc1 lds
  v_mfma_f32_16x16x32_bf16 v[176:179], v[240:243], a[0:3], v[176:179]
  ds_read_b64_tr_b16 v[232:233], v45 offset:49152
  ds_read_b64_tr_b16 v[234:235], v45 offset:53248
  v_mfma_f32_16x16x32_bf16 v[176:179], v[244:247], a[4:7], v[176:179]
  ds_read_b64_tr_b16 v[236:237], v45 offset:57344
  ds_read_b64_tr_b16 v[238:239], v45 offset:61440
  v_mfma_f32_16x16x32_bf16 v[180:183], v[240:243], a[8:11], v[180:183]
  buffer_load_dwordx4 v5, s[44:47], s67 offen offset:3072 sc1 lds
  v_mfma_f32_16x16x32_bf16 v[180:183], v[244:247], a[12:15], v[180:183]
  v_mul_f32 v110, v110, v11
  v_mfma_f32_16x16x32_bf16 v[188:191], v[248:251], a[8:11], v[188:191]
  s_add_u32 s67, s67, 65536
  ds_read_b64_tr_b16 v[240:241], v46 offset:49152
  ds_read_b64_tr_b16 v[242:243], v46 offset:53248
  v_mfma_f32_16x16x32_bf16 v[188:191], v[252:255], a[12:15], v[188:191]
  ds_read_b64_tr_b16 v[244:245], v46 offset:57344
  ds_read_b64_tr_b16 v[246:247], v46 offset:61440
  v_mfma_f32_16x16x32_bf16 v[184:187], v[248:251], a[0:3], v[184:187]
  v_mul_f32 v111, v111, v11
  v_mfma_f32_16x16x32_bf16 v[184:187], v[252:255], a[4:7], v[184:187]
  s_waitcnt vmcnt(20) lgkmcnt(8)
  s_barrier
  v_mfma_f32_16x16x32_bf16 v[128:131], v[192:195], a[16:19], v[128:131]
  ds_read_b64_tr_b16 v[248:249], v47 offset:49152
  ds_read_b64_tr_b16 v[250:251], v47 offset:53248
  v_mfma_f32_16x16x32_bf16 v[128:131], v[196:199], a[20:23], v[128:131]
  ds_read_b64_tr_b16 v[252:253], v47 offset:57344
  ds_read_b64_tr_b16 v[254:255], v47 offset:61440
  v_mfma_f32_16x16x32_bf16 v[132:135], v[192:195], a[24:27], v[132:135]
  buffer_load_dwordx4 a[64:67], v6, s[48:51], s65 offen offset:0 sc1
  v_mfma_f32_16x16x32_bf16 v[132:135], v[196:199], a[28:31], v[132:135]
  buffer_load_dwordx4 a[72:75], v7, s[48:51], s65 offen offset:0 sc1
  v_mfma_f32_16x16x32_bf16 v[140:143], v[200:203], a[24:27], v[140:143]
  ds_read_b64_tr_b16 v[192:193], v32 offset:0
  ds_read_b64_tr_b16 v[194:195], v32 offset:4096
  v_mfma_f32_16x16x32_bf16 v[140:143], v[204:207], a[28:31], v[140:143]
  ds_read_b64_tr_b16 v[196:197], v32 offset:8192
  ds_read_b64_tr_b16 v[198:199], v32 offset:12288
  v_mfma_f32_16x16x32_bf16 v[136:139], v[200:203], a[16:19], v[136:139]
  v_mul_f32 v112, v112, v10
  v_mfma_f32_16x16x32_bf16 v[136:139], v[204:207], a[20:23], v[136:139]
  buffer_load_dwordx4 a[68:71], v6, s[48:51], s65 offen offset:2048 sc1
  v_mfma_f32_16x16x32_bf16 v[144:147], v[208:211], a[16:19], v[144:147]
  ds_read_b64_tr_b16 v[200:201], v33 offset:0
  ds_read_b64_tr_b16 v[202:203], v33 offset:4096
  v_mfma_f32_16x16x32_bf16 v[144:147], v[212:215], a[20:23], v[144:147]
  ds_read_b64_tr_b16 v[204:205], v33 offset:8192
  ds_read_b64_tr_b16 v[206:207], v33 offset:12288
  v_mfma_f32_16x16x32_bf16 v[148:151], v[208:211], a[24:27], v[148:151]
  buffer_load_dwordx4 a[76:79], v7, s[48:51], s65 offen offset:2048 sc1
  v_mfma_f32_16x16x32_bf16 v[148:151], v[212:215], a[28:31], v[148:151]
  v_mul_f32 v113, v113, v10
  s_xor_b32 s65, s4, s70
  v_mfma_f32_16x16x32_bf16 v[156:159], v[216:219], a[24:27], v[156:159]
  s_add_u32 s65, s65, s1
  ds_read_b64_tr_b16 v[208:209], v34 offset:0
  ds_read_b64_tr_b16 v[210:211], v34 offset:4096
  v_mfma_f32_16x16x32_bf16 v[156:159], v[220:223], a[28:31], v[156:159]
  ds_read_b64_tr_b16 v[212:213], v34 offset:8192
  ds_read_b64_tr_b16 v[214:215], v34 offset:12288
  v_mfma_f32_16x16x32_bf16 v[152:155], v[216:219], a[16:19], v[152:155]
  v_mul_f32 v114, v114, v10
  v_mfma_f32_16x16x32_bf16 v[152:155], v[220:223], a[20:23], v[152:155]
  s_waitcnt lgkmcnt(8)
  v_mfma_f32_16x16x32_bf16 v[160:163], v[224:227], a[16:19], v[160:163]
  s_add_u32 s70, s70, 8192
  ds_read_b64_tr_b16 v[216:217], v35 offset:0
  ds_read_b64_tr_b16 v[218:219], v35 offset:4096
  v_mfma_f32_16x16x32_bf16 v[160:163], v[228:231], a[20:23], v[160:163]
  s_add_u32 m0, s69, 81920
  ds_read_b64_tr_b16 v[220:221], v35 offset:8192
  ds_read_b64_tr_b16 v[222:223], v35 offset:12288
  v_mfma_f32_16x16x32_bf16 v[164:167], v[224:227], a[24:27], v[164:167]
  v_mul_f32 v115, v115, v10
  v_mfma_f32_16x16x32_bf16 v[164:167], v[228:231], a[28:31], v[164:167]
  buffer_load_dwordx4 v2, s[44:47], s67 offen offset:0 sc1 lds
  v_mfma_f32_16x16x32_bf16 v[172:175], v[232:235], a[24:27], v[172:175]
  ds_read_b64_tr_b16 v[224:225], v36 offset:0
  ds_read_b64_tr_b16 v[226:227], v36 offset:4096
  v_mfma_f32_16x16x32_bf16 v[172:175], v[236:239], a[28:31], v[172:175]
  ds_read_b64_tr_b16 v[228:229], v36 offset:8192
  ds_read_b64_tr_b16 v[230:231], v36 offset:12288
  v_mfma_f32_16x16x32_bf16 v[168:171], v[232:235], a[16:19], v[168:171]
  buffer_load_dwordx4 v3, s[44:47], s67 offen offset:1024 sc1 lds
  v_mfma_f32_16x16x32_bf16 v[168:171], v[236:239], a[20:23], v[168:171]
  v_mul_f32 v116, v116, v11
  v_mfma_f32_16x16x32_bf16 v[176:179], v[240:243], a[16:19], v[176:179]
  ds_read_b64_tr_b16 v[232:233], v37 offset:0
  ds_read_b64_tr_b16 v[234:235], v37 offset:4096
  v_mfma_f32_16x16x32_bf16 v[176:179], v[244:247], a[20:23], v[176:179]
  ds_read_b64_tr_b16 v[236:237], v37 offset:8192
  ds_read_b64_tr_b16 v[238:239], v37 offset:12288
  v_mfma_f32_16x16x32_bf16 v[180:183], v[240:243], a[24:27], v[180:183]
  buffer_load_dwordx4 v4, s[44:47], s67 offen offset:2048 sc1 lds
  v_mfma_f32_16x16x32_bf16 v[180:183], v[244:247], a[28:31], v[180:183]
  buffer_load_dwordx4 v5, s[44:47], s67 offen offset:3072 sc1 lds
  v_mfma_f32_16x16x32_bf16 v[188:191], v[248:251], a[24:27], v[188:191]
  ds_read_b64_tr_b16 v[240:241], v38 offset:0
  ds_read_b64_tr_b16 v[242:243], v38 offset:4096
  v_mfma_f32_16x16x32_bf16 v[188:191], v[252:255], a[28:31], v[188:191]
  ds_read_b64_tr_b16 v[244:245], v38 offset:8192
  ds_read_b64_tr_b16 v[246:247], v38 offset:12288
  v_mfma_f32_16x16x32_bf16 v[184:187], v[248:251], a[16:19], v[184:187]
  v_mul_f32 v117, v117, v11
  v_mfma_f32_16x16x32_bf16 v[184:187], v[252:255], a[20:23], v[184:187]
  s_waitcnt vmcnt(20) lgkmcnt(8)
  s_barrier
  v_mfma_f32_16x16x32_bf16 v[128:131], v[192:195], a[32:35], v[128:131]
  ds_read_b64_tr_b16 v[248:249], v39 offset:0
  ds_read_b64_tr_b16 v[250:251], v39 offset:4096
  v_mul_f32 v118, v118, v11
  v_mfma_f32_16x16x32_bf16 v[128:131], v[196:199], a[36:39], v[128:131]
  ds_read_b64_tr_b16 v[252:253], v39 offset:8192
  ds_read_b64_tr_b16 v[254:255], v39 offset:12288
  buffer_load_dwordx4 a[80:83], v6, s[48:51], s65 offen offset:0 sc1
  v_mul_f32 v119, v119, v11
  v_mul_f32 v120, v120, v10
  v_mfma_f32_16x16x32_bf16 v[132:135], v[192:195], a[40:43], v[132:135]
  buffer_load_dwordx4 a[88:91], v7, s[48:51], s65 offen offset:0 sc1
  v_mul_f32 v121, v121, v10
  v_mul_f32 v122, v122, v10
  v_mfma_f32_16x16x32_bf16 v[132:135], v[196:199], a[44:47], v[132:135]
  buffer_load_dwordx4 a[84:87], v6, s[48:51], s65 offen offset:2048 sc1
  v_mul_f32 v123, v123, v10
  v_mfma_f32_16x16x32_bf16 v[140:143], v[200:203], a[40:43], v[140:143]
  ds_read_b64_tr_b16 v[192:193], v32 offset:32768
  ds_read_b64_tr_b16 v[194:195], v32 offset:36864
  v_mul_f32 v124, v124, v11
  v_mfma_f32_16x16x32_bf16 v[140:143], v[204:207], a[44:47], v[140:143]
  ds_read_b64_tr_b16 v[196:197], v32 offset:40960
  ds_read_b64_tr_b16 v[198:199], v32 offset:45056
  buffer_load_dwordx4 a[92:95], v7, s[48:51], s65 offen offset:2048 sc1
  v_mfma_f32_16x16x32_bf16 v[136:139], v[200:203], a[32:35], v[136:139]
  v_mul_f32 v125, v125, v11
  v_mul_f32 v126, v126, v11
  v_mfma_f32_16x16x32_bf16 v[136:139], v[204:207], a[36:39], v[136:139]
  s_add_u32 s65, s65, 4096
  v_mul_f32 v127, v127, v11
  v_lshlrev_b32 v48, 4, v25
  v_mfma_f32_16x16x32_bf16 v[144:147], v[208:211], a[32:35], v[144:147]
  s_lshl_b32 s72, s9, 15
  ds_read_b64_tr_b16 v[200:201], v33 offset:32768
  ds_read_b64_tr_b16 v[202:203], v33 offset:36864
  v_mfma_f32_16x16x32_bf16 v[144:147], v[212:215], a[36:39], v[144:147]
  s_add_u32 s72, s72, s3
  ds_read_b64_tr_b16 v[204:205], v33 offset:40960
  ds_read_b64_tr_b16 v[206:207], v33 offset:45056
  v_mfma_f32_16x16x32_bf16 v[148:151], v[208:211], a[40:43], v[148:151]
  s_xor_b32 s64, s9, 1
  s_lshl_b32 s64, s64, 15
  s_add_u32 s64, s64, s3
  v_mfma_f32_16x16x32_bf16 v[148:151], v[212:215], a[44:47], v[148:151]
  s_add_u32 s64, s64, 8192
  s_xor_b32 s66, s9, 2
  s_lshl_b32 s66, s66, 15
  v_mfma_f32_16x16x32_bf16 v[156:159], v[216:219], a[40:43], v[156:159]
  s_add_u32 s66, s66, s3
  ds_read_b64_tr_b16 v[208:209], v34 offset:32768
  ds_read_b64_tr_b16 v[210:211], v34 offset:36864
  v_mfma_f32_16x16x32_bf16 v[156:159], v[220:223], a[44:47], v[156:159]
  s_add_u32 s66, s66, 16384
  ds_read_b64_tr_b16 v[212:213], v34 offset:40960
  ds_read_b64_tr_b16 v[214:215], v34 offset:45056
  v_mfma_f32_16x16x32_bf16 v[152:155], v[216:219], a[32:35], v[152:155]
  s_xor_b32 s11, s9, 3
  s_lshl_b32 s11, s11, 15
  s_add_u32 s11, s11, s3
  v_mfma_f32_16x16x32_bf16 v[152:155], v[220:223], a[36:39], v[152:155]
  s_waitcnt lgkmcnt(8)
  s_add_u32 s11, s11, 24576
  s_lshl_b32 s35, s0, 2
  v_mfma_f32_16x16x32_bf16 v[160:163], v[224:227], a[32:35], v[160:163]
  s_add_u32 s35, s35, s34
  ds_read_b64_tr_b16 v[216:217], v35 offset:32768
  ds_read_b64_tr_b16 v[218:219], v35 offset:36864
  v_mfma_f32_16x16x32_bf16 v[160:163], v[228:231], a[36:39], v[160:163]
  s_lshl_b32 s35, s35, 1
  ds_read_b64_tr_b16 v[220:221], v35 offset:40960
  ds_read_b64_tr_b16 v[222:223], v35 offset:45056
  v_mfma_f32_16x16x32_bf16 v[164:167], v[224:227], a[40:43], v[164:167]
  s_and_b32 s73, s9, 1
  s_add_u32 s35, s35, s73
  s_lshl_b32 s35, s35, 14
  v_mfma_f32_16x16x32_bf16 v[164:167], v[228:231], a[44:47], v[164:167]
  s_and_b32 s73, s32, 3
  s_lshl_b32 s73, s73, 8
  s_add_u32 s35, s35, s73
  v_mfma_f32_16x16x32_bf16 v[172:175], v[232:235], a[40:43], v[172:175]
  s_lshr_b32 s73, s9, 1
  ds_read_b64_tr_b16 v[224:225], v36 offset:32768
  ds_read_b64_tr_b16 v[226:227], v36 offset:36864
  v_mfma_f32_16x16x32_bf16 v[172:175], v[236:239], a[44:47], v[172:175]
  s_lshl_b32 s73, s73, 7
  ds_read_b64_tr_b16 v[228:229], v36 offset:40960
  ds_read_b64_tr_b16 v[230:231], v36 offset:45056
  v_mfma_f32_16x16x32_bf16 v[168:171], v[232:235], a[32:35], v[168:171]
  s_add_u32 s35, s35, s73
  v_add_u32 v50, 8192, v48
  v_add_u32 v51, 16384, v48
  v_add_u32 v52, 24576, v48
  v_mfma_f32_16x16x32_bf16 v[168:171], v[236:239], a[36:39], v[168:171]
  s_mov_b32 s75, 0
  v_cmp_gt_u32 vcc, 4, v20
  v_mov_b32 v61, 0
  v_mov_b32 v62, 0x3f80
  v_mfma_f32_16x16x32_bf16 v[176:179], v[240:243], a[32:35], v[176:179]
  ds_read_b64_tr_b16 v[232:233], v37 offset:32768
  ds_read_b64_tr_b16 v[234:235], v37 offset:36864
  v_lshlrev_b32 v63, 4, v20
  v_cndmask_b32 v60, v61, v62, vcc
  v_lshlrev_b64 v[60:61], v63, v[60:61]
  v_mov_b32 v62, v60
  v_mfma_f32_16x16x32_bf16 v[176:179], v[244:247], a[36:39], v[176:179]
  ds_read_b64_tr_b16 v[236:237], v37 offset:40960
  ds_read_b64_tr_b16 v[238:239], v37 offset:45056
  v_mov_b32 v63, v61
  v_mov_b32 v56, v8
  v_mfma_f32_16x16x32_bf16 v[180:183], v[240:243], a[40:43], v[180:183]
  v_mov_b32 v57, v9
  v_mov_b32 v58, v16
  v_mfma_f32_16x16x32_bf16 v[180:183], v[244:247], a[44:47], v[180:183]
  v_and_b32 v58, 7, v25
  v_lshlrev_b32 v58, 10, v58
  v_bfe_u32 v59, v25, 3, 1
  v_mfma_f32_16x16x32_bf16 v[188:191], v[248:251], a[40:43], v[188:191]
  ds_read_b64_tr_b16 v[240:241], v38 offset:32768
  ds_read_b64_tr_b16 v[242:243], v38 offset:36864
  v_lshl_add_u32 v58, v59, 6, v58
  v_bfe_u32 v59, v25, 4, 1
  v_mfma_f32_16x16x32_bf16 v[188:191], v[252:255], a[44:47], v[188:191]
  ds_read_b64_tr_b16 v[244:245], v38 offset:40960
  ds_read_b64_tr_b16 v[246:247], v38 offset:45056
  v_lshl_add_u32 v58, v59, 5, v58
  v_lshrrev_b32 v59, 5, v25
  v_mfma_f32_16x16x32_bf16 v[184:187], v[248:251], a[32:35], v[184:187]
  v_lshl_add_u32 v58, v59, 4, v58
  v_add_u32 v59, 8192, v58
  v_mfma_f32_16x16x32_bf16 v[184:187], v[252:255], a[36:39], v[184:187]
  s_waitcnt vmcnt(16) lgkmcnt(8)
  s_barrier
  v_mfma_f32_16x16x32_bf16 v[128:131], v[192:195], a[48:51], v[128:131]
  ds_read_b64_tr_b16 v[248:249], v39 offset:32768
  ds_read_b64_tr_b16 v[250:251], v39 offset:36864
  v_mfma_f32_16x16x32_bf16 v[128:131], v[196:199], a[52:55], v[128:131]
  ds_read_b64_tr_b16 v[252:253], v39 offset:40960
  ds_read_b64_tr_b16 v[254:255], v39 offset:45056
  v_mfma_f32_16x16x32_bf16 v[132:135], v[192:195], a[56:59], v[132:135]
  buffer_load_dwordx4 a[96:99], v6, s[48:51], s65 offen offset:0 sc1
  v_mfma_f32_16x16x32_bf16 v[132:135], v[196:199], a[60:63], v[132:135]
  buffer_load_dwordx4 a[104:107], v7, s[48:51], s65 offen offset:0 sc1
  v_mfma_f32_16x16x32_bf16 v[140:143], v[200:203], a[56:59], v[140:143]
  ds_read_b64_tr_b16 v[192:193], v40 offset:0
  ds_read_b64_tr_b16 v[194:195], v40 offset:4096
  v_mfma_f32_16x16x32_bf16 v[140:143], v[204:207], a[60:63], v[140:143]
  ds_read_b64_tr_b16 v[196:197], v40 offset:8192
  ds_read_b64_tr_b16 v[198:199], v40 offset:12288
  v_mfma_f32_16x16x32_bf16 v[136:139], v[200:203], a[48:51], v[136:139]
  buffer_load_dwordx4 a[100:103], v6, s[48:51], s65 offen offset:2048 sc1
  v_mfma_f32_16x16x32_bf16 v[136:139], v[204:207], a[52:55], v[136:139]
  buffer_load_dwordx4 a[108:111], v7, s[48:51], s65 offen offset:2048 sc1
  v_mfma_f32_16x16x32_bf16 v[144:147], v[208:211], a[48:51], v[144:147]
  ds_read_b64_tr_b16 v[200:201], v41 offset:0
  ds_read_b64_tr_b16 v[202:203], v41 offset:4096
  v_mfma_f32_16x16x32_bf16 v[144:147], v[212:215], a[52:55], v[144:147]
  ds_read_b64_tr_b16 v[204:205], v41 offset:8192
  ds_read_b64_tr_b16 v[206:207], v41 offset:12288
  v_mfma_f32_16x16x32_bf16 v[148:151], v[208:211], a[56:59], v[148:151]
  ds_read_b64_tr_b16 a[128:129], v32 offset:16384
  ds_read_b64_tr_b16 a[130:131], v32 offset:20480
  v_mfma_f32_16x16x32_bf16 v[148:151], v[212:215], a[60:63], v[148:151]
  ds_read_b64_tr_b16 a[132:133], v32 offset:24576
  ds_read_b64_tr_b16 a[134:135], v32 offset:28672
  v_mfma_f32_16x16x32_bf16 v[156:159], v[216:219], a[56:59], v[156:159]
  ds_read_b64_tr_b16 v[208:209], v42 offset:0
  ds_read_b64_tr_b16 v[210:211], v42 offset:4096
  v_mfma_f32_16x16x32_bf16 v[156:159], v[220:223], a[60:63], v[156:159]
  ds_read_b64_tr_b16 v[212:213], v42 offset:8192
  ds_read_b64_tr_b16 v[214:215], v42 offset:12288
  v_mfma_f32_16x16x32_bf16 v[152:155], v[216:219], a[48:51], v[152:155]
  ds_read_b64_tr_b16 a[136:137], v33 offset:16384
  ds_read_b64_tr_b16 a[138:139], v33 offset:20480
  v_mfma_f32_16x16x32_bf16 v[152:155], v[220:223], a[52:55], v[152:155]
  s_waitcnt lgkmcnt(8)
  ds_read_b64_tr_b16 a[140:141], v33 offset:24576
  v_mfma_f32_16x16x32_bf16 v[160:163], v[224:227], a[48:51], v[160:163]
  ds_read_b64_tr_b16 v[216:217], v43 offset:0
  ds_read_b64_tr_b16 v[218:219], v43 offset:4096
  v_mfma_f32_16x16x32_bf16 v[160:163], v[228:231], a[52:55], v[160:163]
  ds_read_b64_tr_b16 v[220:221], v43 offset:8192
  ds_read_b64_tr_b16 v[222:223], v43 offset:12288
  v_mfma_f32_16x16x32_bf16 v[164:167], v[224:227], a[56:59], v[164:167]
  ds_read_b64_tr_b16 a[142:143], v33 offset:28672
  v_mfma_f32_16x16x32_bf16 v[164:167], v[228:231], a[60:63], v[164:167]
  ds_read_b64_tr_b16 a[144:145], v34 offset:16384
  ds_read_b64_tr_b16 a[146:147], v34 offset:20480
  v_mfma_f32_16x16x32_bf16 v[172:175], v[232:235], a[56:59], v[172:175]
  ds_read_b64_tr_b16 v[224:225], v44 offset:0
  ds_read_b64_tr_b16 v[226:227], v44 offset:4096
  v_mfma_f32_16x16x32_bf16 v[172:175], v[236:239], a[60:63], v[172:175]
  ds_read_b64_tr_b16 v[228:229], v44 offset:8192
  ds_read_b64_tr_b16 v[230:231], v44 offset:12288
  v_mfma_f32_16x16x32_bf16 v[168:171], v[232:235], a[48:51], v[168:171]
  ds_read_b64_tr_b16 a[148:149], v34 offset:24576
  v_mfma_f32_16x16x32_bf16 v[168:171], v[236:239], a[52:55], v[168:171]
  ds_read_b64_tr_b16 a[150:151], v34 offset:28672
  v_mfma_f32_16x16x32_bf16 v[176:179], v[240:243], a[48:51], v[176:179]
  ds_read_b64_tr_b16 v[232:233], v45 offset:0
  ds_read_b64_tr_b16 v[234:235], v45 offset:4096
  v_mfma_f32_16x16x32_bf16 v[176:179], v[244:247], a[52:55], v[176:179]
  ds_read_b64_tr_b16 v[236:237], v45 offset:8192
  ds_read_b64_tr_b16 v[238:239], v45 offset:12288
  v_mfma_f32_16x16x32_bf16 v[180:183], v[240:243], a[56:59], v[180:183]
  ds_read_b64_tr_b16 a[152:153], v35 offset:16384
  v_mfma_f32_16x16x32_bf16 v[180:183], v[244:247], a[60:63], v[180:183]
  ds_read_b64_tr_b16 a[154:155], v35 offset:20480
  ds_read_b64_tr_b16 a[156:157], v35 offset:24576
  v_mfma_f32_16x16x32_bf16 v[188:191], v[248:251], a[56:59], v[188:191]
  ds_read_b64_tr_b16 v[240:241], v46 offset:0
  ds_read_b64_tr_b16 v[242:243], v46 offset:4096
  v_mfma_f32_16x16x32_bf16 v[188:191], v[252:255], a[60:63], v[188:191]
  ds_read_b64_tr_b16 v[244:245], v46 offset:8192
  ds_read_b64_tr_b16 v[246:247], v46 offset:12288
  v_mfma_f32_16x16x32_bf16 v[184:187], v[248:251], a[48:51], v[184:187]
  ds_read_b64_tr_b16 a[158:159], v35 offset:28672
  v_mfma_f32_16x16x32_bf16 v[184:187], v[252:255], a[52:55], v[184:187]
  s_waitcnt vmcnt(8) lgkmcnt(8)
  s_barrier
  v_mfma_f32_16x16x32_bf16 v[132:135], v[192:195], a[72:75], v[132:135]
  ds_read_b64_tr_b16 a[192:193], v32 offset:49152
  ds_read_b64_tr_b16 a[194:195], v32 offset:53248
  v_mfma_f32_16x16x32_bf16 v[132:135], v[196:199], a[76:79], v[132:135]
  ds_read_b64_tr_b16 a[196:197], v32 offset:57344
  ds_read_b64_tr_b16 a[198:199], v32 offset:61440
  v_mfma_f32_16x16x32_bf16 v[140:143], v[200:203], a[72:75], v[140:143]
  ds_read_b64_tr_b16 a[200:201], v33 offset:49152
  ds_read_b64_tr_b16 a[202:203], v33 offset:53248
  v_mfma_f32_16x16x32_bf16 v[140:143], v[204:207], a[76:79], v[140:143]
  ds_read_b64_tr_b16 a[204:205], v33 offset:57344
  ds_read_b64_tr_b16 a[206:207], v33 offset:61440
  v_mfma_f32_16x16x32_bf16 v[148:151], v[208:211], a[72:75], v[148:151]
  ds_read_b64_tr_b16 a[208:209], v34 offset:49152
  ds_read_b64_tr_b16 a[210:211], v34 offset:53248
  v_mfma_f32_16x16x32_bf16 v[148:151], v[212:215], a[76:79], v[148:151]
  ds_read_b64_tr_b16 a[212:213], v34 offset:57344
  ds_read_b64_tr_b16 a[214:215], v34 offset:61440
  v_mfma_f32_16x16x32_bf16 v[156:159], v[216:219], a[72:75], v[156:159]
  ds_read_b64_tr_b16 a[216:217], v35 offset:49152
  ds_read_b64_tr_b16 a[218:219], v35 offset:53248
  v_mfma_f32_16x16x32_bf16 v[156:159], v[220:223], a[76:79], v[156:159]
  s_waitcnt vmcnt(4) lgkmcnt(12)
  ds_read_b64_tr_b16 a[220:221], v35 offset:57344
  ds_read_b64_tr_b16 a[222:223], v35 offset:61440
  v_mfma_f32_16x16x32_bf16 v[132:135], a[128:131], a[88:91], v[132:135]
  ds_read_b64_tr_b16 a[160:161], v36 offset:16384
  ds_read_b64_tr_b16 a[162:163], v36 offset:20480
  v_mfma_f32_16x16x32_bf16 v[132:135], a[132:135], a[92:95], v[132:135]
  ds_read_b64_tr_b16 a[164:165], v36 offset:24576
  ds_read_b64_tr_b16 a[166:167], v36 offset:28672
  v_mfma_f32_16x16x32_bf16 v[140:143], a[136:139], a[88:91], v[140:143]
  ds_read_b64_tr_b16 a[224:225], v36 offset:49152
  ds_read_b64_tr_b16 a[226:227], v36 offset:53248
  v_mfma_f32_16x16x32_bf16 v[140:143], a[140:143], a[92:95], v[140:143]
  ds_read_b64_tr_b16 a[228:229], v36 offset:57344
  ds_read_b64_tr_b16 a[230:231], v36 offset:61440
  v_mfma_f32_16x16x32_bf16 v[148:151], a[144:147], a[88:91], v[148:151]
  ds_read_b64_tr_b16 a[168:169], v37 offset:16384
  ds_read_b64_tr_b16 a[170:171], v37 offset:20480
  v_mfma_f32_16x16x32_bf16 v[148:151], a[148:151], a[92:95], v[148:151]
  ds_read_b64_tr_b16 a[172:173], v37 offset:24576
  ds_read_b64_tr_b16 a[174:175], v37 offset:28672
  v_mfma_f32_16x16x32_bf16 v[156:159], a[152:155], a[88:91], v[156:159]
  ds_read_b64_tr_b16 a[232:233], v37 offset:49152
  ds_read_b64_tr_b16 a[234:235], v37 offset:53248
  v_mfma_f32_16x16x32_bf16 v[156:159], a[156:159], a[92:95], v[156:159]
  s_waitcnt vmcnt(0) lgkmcnt(12)
  ds_read_b64_tr_b16 a[236:237], v37 offset:57344
  ds_read_b64_tr_b16 a[238:239], v37 offset:61440
  v_mfma_f32_16x16x32_bf16 v[132:135], a[192:195], a[104:107], v[132:135]
  ds_read_b64_tr_b16 a[176:177], v38 offset:16384
  ds_read_b64_tr_b16 a[178:179], v38 offset:20480
  v_mfma_f32_16x16x32_bf16 v[132:135], a[196:199], a[108:111], v[132:135]
L_pg16:
  s_cbranch_execz L_walk2
  ds_read_b64_tr_b16 a[180:181], v38 offset:24576
  ds_read_b64_tr_b16 a[182:183], v38 offset:28672
  v_mfma_f32_16x16x32_bf16 v[140:143], a[200:203], a[104:107], v[140:143]
  ds_read_b64_tr_b16 a[240:241], v38 offset:49152
  ds_read_b64_tr_b16 a[242:243], v38 offset:53248
  v_mfma_f32_16x16x32_bf16 v[140:143], a[204:207], a[108:111], v[140:143]
  ds_read_b64_tr_b16 a[244:245], v38 offset:57344
  ds_read_b64_tr_b16 a[246:247], v38 offset:61440
  v_mfma_f32_16x16x32_bf16 v[148:151], a[208:211], a[104:107], v[148:151]
  ds_read_b64_tr_b16 v[248:249], v47 offset:0
  ds_read_b64_tr_b16 v[250:251], v47 offset:4096
  v_mfma_f32_16x16x32_bf16 v[148:151], a[212:215], a[108:111], v[148:151]
  ds_read_b64_tr_b16 v[252:253], v47 offset:8192
  ds_read_b64_tr_b16 v[254:255], v47 offset:12288
  v_mfma_f32_16x16x32_bf16 v[156:159], a[216:219], a[104:107], v[156:159]
  s_waitcnt lgkmcnt(10)
  ds_read_b64_tr_b16 a[184:185], v39 offset:16384
  ds_read_b64_tr_b16 a[186:187], v39 offset:20480
  v_mfma_f32_16x16x32_bf16 v[156:159], a[220:223], a[108:111], v[156:159]
  ds_read_b64_tr_b16 a[188:189], v39 offset:24576
  ds_read_b64_tr_b16 a[190:191], v39 offset:28672
  v_mfma_f32_16x16x32_bf16 v[160:163], v[224:227], a[64:67], v[160:163]
  ds_read_b64_tr_b16 a[248:249], v39 offset:49152
  ds_read_b64_tr_b16 a[250:251], v39 offset:53248
  v_mfma_f32_16x16x32_bf16 v[160:163], v[228:231], a[68:71], v[160:163]
  ds_read_b64_tr_b16 a[252:253], v39 offset:57344
  ds_read_b64_tr_b16 a[254:255], v39 offset:61440
  v_mfma_f32_16x16x32_bf16 v[160:163], a[160:163], a[80:83], v[160:163]
  v_mov_b32 v2, 0
  v_mov_b32 v3, 0
  v_mov_b32 v16, 0
  v_mfma_f32_16x16x32_bf16 v[160:163], a[164:167], a[84:87], v[160:163]
  v_mov_b32 v17, 0
  v_mov_b32 v30, 0
  v_mov_b32 v31, 0
  v_mfma_f32_16x16x32_bf16 v[160:163], a[224:227], a[96:99], v[160:163]
  v_fmac_f32 v68, v132, v57
  v_fmac_f32 v69, v133, v57
  v_mfma_f32_16x16x32_bf16 v[160:163], a[228:231], a[100:103], v[160:163]
  v_fmac_f32 v70, v134, v57
  v_fmac_f32 v71, v135, v57
  v_mfma_f32_16x16x32_bf16 v[168:171], a[236:239], a[100:103], v[168:171]
  v_cvt_pk_bf16_f32 v40, v68, v69
  v_cvt_pk_bf16_f32 v41, v70, v71
  v_mfma_f32_16x16x32_bf16 v[168:171], a[232:235], a[96:99], v[168:171]
  v_fmac_f32 v76, v140, v57
  v_fmac_f32 v77, v141, v57
  v_mfma_f32_16x16x32_bf16 v[168:171], a[172:175], a[84:87], v[168:171]
  v_fmac_f32 v78, v142, v57
  v_fmac_f32 v79, v143, v57
  v_mfma_f32_16x16x32_bf16 v[168:171], a[168:171], a[80:83], v[168:171]
  s_waitcnt lgkmcnt(0)
  v_cvt_pk_bf16_f32 v42, v76, v77
  v_cvt_pk_bf16_f32 v43, v78, v79
  v_mfma_f32_16x16x32_bf16 v[168:171], v[236:239], a[68:71], v[168:171]
  buffer_store_dwordx4 v[40:43], v48, s[48:51], s64 offen offset:0 sc1
  v_fmac_f32 v84, v148, v57
  v_mfma_f32_16x16x32_bf16 v[168:171], v[232:235], a[64:67], v[168:171]
  v_fmac_f32 v85, v149, v57
  v_fmac_f32 v86, v150, v57
  v_mfma_f32_16x16x32_bf16 v[176:179], v[240:243], a[64:67], v[176:179]
  v_fmac_f32 v87, v151, v57
  v_cvt_pk_bf16_f32 v44, v84, v85
  v_mfma_f32_16x16x32_bf16 v[176:179], v[244:247], a[68:71], v[176:179]
  v_cvt_pk_bf16_f32 v45, v86, v87
  v_fmac_f32 v92, v156, v57
  v_mfma_f32_16x16x32_bf16 v[176:179], a[176:179], a[80:83], v[176:179]
  v_fmac_f32 v93, v157, v57
  v_fmac_f32 v94, v158, v57
  v_mfma_f32_16x16x32_bf16 v[176:179], a[180:183], a[84:87], v[176:179]
  v_fmac_f32 v95, v159, v57
  v_cvt_pk_bf16_f32 v46, v92, v93
  v_cvt_pk_bf16_f32 v47, v94, v95
  v_mfma_f32_16x16x32_bf16 v[176:179], a[240:243], a[96:99], v[176:179]
  buffer_store_dwordx4 v[44:47], v48, s[48:51], s64 offen offset:1024 sc1
  v_mfma_f32_16x16x32_bf16 v[176:179], a[244:247], a[100:103], v[176:179]
  v_fmac_f32 v96, v160, v56
  v_fmac_f32 v97, v161, v56
  v_mfma_f32_16x16x32_bf16 v[184:187], a[252:255], a[100:103], v[184:187]
  v_fmac_f32 v98, v162, v56
  v_mfma_f32_16x16x32_bf16 v[184:187], a[248:251], a[96:99], v[184:187]
  v_fmac_f32 v99, v163, v56
  v_cvt_pk_bf16_f32 v34, v96, v97
  v_mfma_f32_16x16x32_bf16 v[184:187], a[188:191], a[84:87], v[184:187]
  v_cvt_pk_bf16_f32 v35, v98, v99
  v_mfma_f32_16x16x32_bf16 v[184:187], a[184:187], a[80:83], v[184:187]
  v_fmac_f32 v104, v168, v56
  v_fmac_f32 v105, v169, v56
  v_mfma_f32_16x16x32_bf16 v[184:187], v[252:255], a[68:71], v[184:187]
  v_fmac_f32 v106, v170, v56
  v_fmac_f32 v107, v171, v56
  v_mfma_f32_16x16x32_bf16 v[184:187], v[248:251], a[64:67], v[184:187]
  v_cvt_pk_bf16_f32 v32, v104, v105
  v_cvt_pk_bf16_f32 v33, v106, v107
  v_mfma_f32_16x16x32_bf16 v[164:167], v[224:227], a[72:75], v[164:167]
  buffer_store_dwordx4 v[32:35], v48, s[48:51], s66 offen offset:0 sc1
  v_mfma_f32_16x16x32_bf16 v[164:167], v[228:231], a[76:79], v[164:167]
  v_fmac_f32 v112, v176, v56
  v_mfma_f32_16x16x32_bf16 v[164:167], a[160:163], a[88:91], v[164:167]
  v_fmac_f32 v113, v177, v56
  v_fmac_f32 v114, v178, v56
  v_mfma_f32_16x16x32_bf16 v[164:167], a[164:167], a[92:95], v[164:167]
  v_fmac_f32 v115, v179, v56
  v_cvt_pk_bf16_f32 v38, v112, v113
  v_mfma_f32_16x16x32_bf16 v[164:167], a[224:227], a[104:107], v[164:167]
  v_cvt_pk_bf16_f32 v39, v114, v115
  v_mfma_f32_16x16x32_bf16 v[164:167], a[228:231], a[108:111], v[164:167]
  v_fmac_f32 v120, v184, v56
  v_mfma_f32_16x16x32_bf16 v[172:175], a[236:239], a[108:111], v[172:175]
  v_fmac_f32 v121, v185, v56
  v_mfma_f32_16x16x32_bf16 v[172:175], a[232:235], a[104:107], v[172:175]
  v_fmac_f32 v122, v186, v56
  v_mfma_f32_16x16x32_bf16 v[172:175], a[172:175], a[92:95], v[172:175]
  v_fmac_f32 v123, v187, v56
  v_cvt_pk_bf16_f32 v36, v120, v121
  v_mfma_f32_16x16x32_bf16 v[172:175], a[168:171], a[88:91], v[172:175]
  v_cvt_pk_bf16_f32 v37, v122, v123
  v_mfma_f32_16x16x32_bf16 v[172:175], v[236:239], a[76:79], v[172:175]
  buffer_store_dwordx4 v[36:39], v48, s[48:51], s66 offen offset:1024 sc1
  v_mfma_f32_16x16x32_bf16 v[172:175], v[232:235], a[72:75], v[172:175]
  v_fmac_f32 v100, v164, v57
  v_mfma_f32_16x16x32_bf16 v[180:183], v[240:243], a[72:75], v[180:183]
  v_fmac_f32 v101, v165, v57
  v_mfma_f32_16x16x32_bf16 v[180:183], v[244:247], a[76:79], v[180:183]
  v_fmac_f32 v102, v166, v57
  v_fmac_f32 v103, v167, v57
  v_mfma_f32_16x16x32_bf16 v[180:183], a[176:179], a[88:91], v[180:183]
  v_cvt_pk_bf16_f32 v40, v100, v101
  v_mfma_f32_16x16x32_bf16 v[180:183], a[180:183], a[92:95], v[180:183]
  v_cvt_pk_bf16_f32 v41, v102, v103
  v_mfma_f32_16x16x32_bf16 v[180:183], a[240:243], a[104:107], v[180:183]
  v_mfma_f32_16x16x32_bf16 v[180:183], a[244:247], a[108:111], v[180:183]
  v_fmac_f32 v108, v172, v57
  v_mfma_f32_16x16x32_bf16 v[188:191], a[252:255], a[108:111], v[188:191]
  v_fmac_f32 v109, v173, v57
  v_fmac_f32 v110, v174, v57
  v_mfma_f32_16x16x32_bf16 v[188:191], a[248:251], a[104:107], v[188:191]
  v_fmac_f32 v111, v175, v57
  v_mfma_f32_16x16x32_bf16 v[188:191], a[188:191], a[92:95], v[188:191]
  v_cvt_pk_bf16_f32 v42, v108, v109
  v_cvt_pk_bf16_f32 v43, v110, v111
  v_mfma_f32_16x16x32_bf16 v[188:191], a[184:187], a[88:91], v[188:191]
  buffer_store_dwordx4 v[40:43], v48, s[48:51], s11 offen offset:0 sc1
  v_mfma_f32_16x16x32_bf16 v[188:191], v[252:255], a[76:79], v[188:191]
  v_mfma_f32_16x16x32_bf16 v[188:191], v[248:251], a[72:75], v[188:191]
  v_fmac_f32 v116, v180, v57
  v_mfma_f32_16x16x32_bf16 v[128:131], v[192:195], a[64:67], v[128:131]
  v_fmac_f32 v117, v181, v57
  v_mfma_f32_16x16x32_bf16 v[128:131], v[196:199], a[68:71], v[128:131]
  v_fmac_f32 v118, v182, v57
  v_fmac_f32 v119, v183, v57
  v_mfma_f32_16x16x32_bf16 v[128:131], a[128:131], a[80:83], v[128:131]
  v_cvt_pk_bf16_f32 v44, v116, v117
  v_mfma_f32_16x16x32_bf16 v[128:131], a[132:135], a[84:87], v[128:131]
  v_cvt_pk_bf16_f32 v45, v118, v119
  v_mfma_f32_16x16x32_bf16 v[128:131], a[192:195], a[96:99], v[128:131]
  v_mfma_f32_16x16x32_bf16 v[128:131], a[196:199], a[100:103], v[128:131]
  v_fmac_f32 v124, v188, v57
  v_mfma_f32_16x16x32_bf16 v[136:139], a[204:207], a[100:103], v[136:139]
  v_fmac_f32 v125, v189, v57
  v_fmac_f32 v126, v190, v57
  v_mfma_f32_16x16x32_bf16 v[136:139], a[200:203], a[96:99], v[136:139]
  v_fmac_f32 v127, v191, v57
  v_mfma_f32_16x16x32_bf16 v[136:139], a[140:143], a[84:87], v[136:139]
  v_cvt_pk_bf16_f32 v46, v124, v125
  v_cvt_pk_bf16_f32 v47, v126, v127
  v_mfma_f32_16x16x32_bf16 v[136:139], a[136:139], a[80:83], v[136:139]
  buffer_store_dwordx4 v[44:47], v48, s[48:51], s11 offen offset:1024 sc1
  v_mfma_f32_16x16x32_bf16 v[136:139], v[204:207], a[68:71], v[136:139]
  v_mfma_f32_16x16x32_bf16 v[136:139], v[200:203], a[64:67], v[136:139]
  v_fmac_f32 v64, v128, v56
  v_mfma_f32_16x16x32_bf16 v[144:147], v[208:211], a[64:67], v[144:147]
  v_fmac_f32 v65, v129, v56
  v_fmac_f32 v66, v130, v56
  v_mfma_f32_16x16x32_bf16 v[144:147], v[212:215], a[68:71], v[144:147]
  v_fmac_f32 v67, v131, v56
  v_mfma_f32_16x16x32_bf16 v[144:147], a[144:147], a[80:83], v[144:147]
  v_mfma_f32_16x16x32_bf16 v[144:147], a[148:151], a[84:87], v[144:147]
  v_mfma_f32_16x16x32_bf16 v[144:147], a[208:211], a[96:99], v[144:147]
  v_mfma_f32_16x16x32_bf16 v[144:147], a[212:215], a[100:103], v[144:147]
  v_fmac_f32 v72, v136, v56
  v_mfma_f32_16x16x32_bf16 v[152:155], a[220:223], a[100:103], v[152:155]
  v_fmac_f32 v73, v137, v56
  v_fmac_f32 v74, v138, v56
  v_mfma_f32_16x16x32_bf16 v[152:155], a[216:219], a[96:99], v[152:155]
  v_fmac_f32 v75, v139, v56
  v_mfma_f32_16x16x32_bf16 v[152:155], a[156:159], a[84:87], v[152:155]
  v_mfma_f32_16x16x32_bf16 v[152:155], a[152:155], a[80:83], v[152:155]
  v_mfma_f32_16x16x32_bf16 v[152:155], v[220:223], a[68:71], v[152:155]
  v_mfma_f32_16x16x32_bf16 v[152:155], v[216:219], a[64:67], v[152:155]
  v_fmac_f32 v80, v144, v56
  v_fmac_f32 v81, v145, v56
  v_fmac_f32 v82, v146, v56
  v_fmac_f32 v83, v147, v56
  s_waitcnt vmcnt(6)
  s_nop 3
  v_fmac_f32 v88, v152, v56
  v_fmac_f32 v89, v153, v56
  v_fmac_f32 v90, v154, v56
  v_fmac_f32 v91, v155, v56
L_x:
  buffer_load_dwordx4 v[4:7], v50, s[48:51], s72 offen offset:0 sc1
  buffer_load_dwordx4 v[18:21], v50, s[48:51], s72 offen offset:1024 sc1
  buffer_load_dwordx4 v[8:11], v51, s[48:51], s72 offen offset:0 sc1
  buffer_load_dwordx4 v[22:25], v51, s[48:51], s72 offen offset:1024 sc1
  buffer_load_dwordx4 v[12:15], v52, s[48:51], s72 offen offset:0 sc1
  buffer_load_dwordx4 v[26:29], v52, s[48:51], s72 offen offset:1024 sc1
  s_waitcnt vmcnt(0)
  v_max3_u32 v53, v4, v5, v6
  v_max3_u32 v54, v7, v8, v9
  v_max3_u32 v53, v53, v10, v11
  v_max3_u32 v54, v54, v12, v13
  v_max3_u32 v53, v53, v14, v15
  v_max3_u32 v54, v54, v18, v19
  v_max3_u32 v53, v53, v20, v21
  v_max3_u32 v54, v54, v22, v23
  v_max3_u32 v53, v53, v24, v25
  v_max3_u32 v54, v54, v26, v27
  v_max3_u32 v53, v53, v28, v29
  v_max_u32 v53, v53, v54
  v_cmp_eq_u32 vcc, -1, v53
  s_add_u32 s75, s75, 1
  s_cbranch_vccz L_x_ok
  s_cmp_lt_u32 s75, 1000000
  s_cbranch_scc1 L_x
L_x_ok:
  v_mfma_f32_16x16x32_bf16 v[64:67], v[60:63], v[2:5], v[64:67]
  v_mfma_f32_16x16x32_bf16 v[64:67], v[60:63], v[10:13], v[64:67]
  v_mfma_f32_16x16x32_bf16 v[72:75], v[60:63], v[6:9], v[72:75]
  v_mfma_f32_16x16x32_bf16 v[72:75], v[60:63], v[14:17], v[72:75]
  v_mfma_f32_16x16x32_bf16 v[80:83], v[60:63], v[16:19], v[80:83]
  v_mfma_f32_16x16x32_bf16 v[80:83], v[60:63], v[24:27], v[80:83]
  v_mfma_f32_16x16x32_bf16 v[88:91], v[60:63], v[20:23], v[88:91]
  v_mfma_f32_16x16x32_bf16 v[88:91], v[60:63], v[28:31], v[88:91]
  s_nop 1
  v_cvt_pk_bf16_f32 v32, v64, v65
  v_cvt_pk_bf16_f32 v33, v66, v67
  v_cvt_pk_bf16_f32 v34, v72, v73
  v_cvt_pk_bf16_f32 v35, v74, v75
  v_cvt_pk_bf16_f32 v36, v80, v81
  v_cvt_pk_bf16_f32 v37, v82, v83
  s_nop 0
  v_cvt_pk_bf16_f32 v38, v88, v89
  v_cvt_pk_bf16_f32 v39, v90, v91
  v_permlane16_swap_b32 v32, v34
  v_permlane16_swap_b32 v33, v35
  v_permlane16_swap_b32 v36, v38
  v_permlane16_swap_b32 v37, v39
  v_mov_b32 v40, v36
  v_mov_b32 v41, v37
  v_mov_b32 v42, v38
  v_mov_b32 v43, v39
  v_mov_b32_dpp v36, v32 row_ror:8 row_mask:0xf bank_mask:0x3
  v_mov_b32_dpp v37, v33 row_ror:8 row_mask:0xf bank_mask:0x3
  v_mov_b32_dpp v38, v34 row_ror:8 row_mask:0xf bank_mask:0x3
  v_mov_b32_dpp v39, v35 row_ror:8 row_mask:0xf bank_mask:0x3
  v_mov_b32_dpp v32, v40 row_ror:8 row_mask:0xf bank_mask:0xc
  v_mov_b32_dpp v33, v41 row_ror:8 row_mask:0xf bank_mask:0xc
  v_mov_b32_dpp v34, v42 row_ror:8 row_mask:0xf bank_mask:0xc
  v_mov_b32_dpp v35, v43 row_ror:8 row_mask:0xf bank_mask:0xc
  buffer_store_dwordx4 v[32:35], v58, s[60:63], s35 offen sc1
  buffer_store_dwordx4 v[36:39], v59, s[60:63], s35 offen sc1
L_end:
  s_endpgm
L_p2n:
  s_nop 7
  v_accvgpr_read_b32 v134, a132
  v_accvgpr_read_b32 v0, a133
  v_accvgpr_read_b32 v135, a134
  v_accvgpr_read_b32 v1, a135
  v_cvt_pk_bf16_f32 v134, v134, v0
  v_cvt_pk_bf16_f32 v135, v135, v1
  v_accvgpr_read_b32 v140, a160
  v_accvgpr_read_b32 v0, a161
  v_accvgpr_read_b32 v141, a162
  v_accvgpr_read_b32 v1, a163
  v_cvt_pk_bf16_f32 v140, v140, v0
  v_cvt_pk_bf16_f32 v141, v141, v1
  v_accvgpr_read_b32 v142, a164
  v_accvgpr_read_b32 v0, a165
  v_accvgpr_read_b32 v143, a166
  v_accvgpr_read_b32 v1, a167
  v_cvt_pk_bf16_f32 v142, v142, v0
  v_cvt_pk_bf16_f32 v143, v143, v1
  v_accvgpr_read_b32 v148, a136
  v_accvgpr_read_b32 v0, a137
  v_accvgpr_read_b32 v149, a138
  v_accvgpr_read_b32 v1, a139
  v_cvt_pk_bf16_f32 v148, v148, v0
  v_cvt_pk_bf16_f32 v149, v149, v1
  v_accvgpr_read_b32 v150, a140
  v_accvgpr_read_b32 v0, a141
  v_accvgpr_read_b32 v151, a142
  v_accvgpr_read_b32 v1, a143
  v_cvt_pk_bf16_f32 v150, v150, v0
  v_cvt_pk_bf16_f32 v151, v151, v1
  v_accvgpr_read_b32 v156, a168
  v_accvgpr_read_b32 v0, a169
  v_accvgpr_read_b32 v157, a170
  v_accvgpr_read_b32 v1, a171
  v_cvt_pk_bf16_f32 v156, v156, v0
  v_cvt_pk_bf16_f32 v157, v157, v1
  v_accvgpr_read_b32 v158, a172
  v_accvgpr_read_b32 v0, a173
  v_accvgpr_read_b32 v159, a174
  v_accvgpr_read_b32 v1, a175
  v_cvt_pk_bf16_f32 v158, v158, v0
  v_cvt_pk_bf16_f32 v159, v159, v1
  v_accvgpr_read_b32 v164, a144
  v_accvgpr_read_b32 v0, a145
  v_accvgpr_read_b32 v165, a146
  v_accvgpr_read_b32 v1, a147
  v_cvt_pk_bf16_f32 v164, v164, v0
  v_cvt_pk_bf16_f32 v165, v165, v1
  v_accvgpr_read_b32 v166, a148
  v_accvgpr_read_b32 v0, a149
  v_accvgpr_read_b32 v167, a150
  v_accvgpr_read_b32 v1, a151
  v_cvt_pk_bf16_f32 v166, v166, v0
  v_cvt_pk_bf16_f32 v167, v167, v1
  v_accvgpr_read_b32 v172, a176
  v_accvgpr_read_b32 v0, a177
  v_accvgpr_read_b32 v173, a178
  v_accvgpr_read_b32 v1, a179
  v_cvt_pk_bf16_f32 v172, v172, v0
  v_cvt_pk_bf16_f32 v173, v173, v1
  v_accvgpr_read_b32 v174, a180
  v_accvgpr_read_b32 v0, a181
  v_accvgpr_read_b32 v175, a182
  v_accvgpr_read_b32 v1, a183
  v_cvt_pk_bf16_f32 v174, v174, v0
  v_cvt_pk_bf16_f32 v175, v175, v1
  v_accvgpr_read_b32 v180, a152
  v_accvgpr_read_b32 v0, a153
  v_accvgpr_read_b32 v181, a154
  v_accvgpr_read_b32 v1, a155
  v_cvt_pk_bf16_f32 v180, v180, v0
  v_cvt_pk_bf16_f32 v181, v181, v1
  v_accvgpr_read_b32 v182, a156
  v_accvgpr_read_b32 v0, a157
  v_accvgpr_read_b32 v183, a158
  v_accvgpr_read_b32 v1, a159
  v_cvt_pk_bf16_f32 v182, v182, v0
  v_cvt_pk_bf16_f32 v183, v183, v1
  v_accvgpr_read_b32 v188, a184
  v_accvgpr_read_b32 v0, a185
  v_accvgpr_read_b32 v189, a186
  v_accvgpr_read_b32 v1, a187
  v_cvt_pk_bf16_f32 v188, v188, v0
  v_cvt_pk_bf16_f32 v189, v189, v1
  v_accvgpr_read_b32 v190, a188
  v_accvgpr_read_b32 v0, a189
  v_accvgpr_read_b32 v191, a190
  v_accvgpr_read_b32 v1, a191
  v_cvt_pk_bf16_f32 v190, v190, v0
  v_cvt_pk_bf16_f32 v191, v191, v1
  v_accvgpr_read_b32 v196, a192
  v_accvgpr_read_b32 v0, a193
  v_accvgpr_read_b32 v197, a194
  v_accvgpr_read_b32 v1, a195
  v_cvt_pk_bf16_f32 v196, v196, v0
  v_cvt_pk_bf16_f32 v197, v197, v1
  v_accvgpr_read_b32 v198, a196
  v_accvgpr_read_b32 v0, a197
  v_accvgpr_read_b32 v199, a198
  v_accvgpr_read_b32 v1, a199
  v_cvt_pk_bf16_f32 v198, v198, v0
  v_cvt_pk_bf16_f32 v199, v199, v1
  v_accvgpr_read_b32 v204, a224
  v_accvgpr_read_b32 v0, a225
  v_accvgpr_read_b32 v205, a226
  v_accvgpr_read_b32 v1, a227
  v_cvt_pk_bf16_f32 v204, v204, v0
  v_cvt_pk_bf16_f32 v205, v205, v1
  v_accvgpr_read_b32 v206, a228
  v_accvgpr_read_b32 v0, a229
  v_accvgpr_read_b32 v207, a230
  v_accvgpr_read_b32 v1, a231
  v_cvt_pk_bf16_f32 v206, v206, v0
  v_cvt_pk_bf16_f32 v207, v207, v1
  v_accvgpr_read_b32 v212, a200
  v_accvgpr_read_b32 v0, a201
  v_accvgpr_read_b32 v213, a202
  v_accvgpr_read_b32 v1, a203
  v_cvt_pk_bf16_f32 v212, v212, v0
  v_cvt_pk_bf16_f32 v213, v213, v1
  v_accvgpr_read_b32 v214, a204
  v_accvgpr_read_b32 v0, a205
  v_accvgpr_read_b32 v215, a206
  v_accvgpr_read_b32 v1, a207
  v_cvt_pk_bf16_f32 v214, v214, v0
  v_cvt_pk_bf16_f32 v215, v215, v1
  v_accvgpr_read_b32 v220, a232
  v_accvgpr_read_b32 v0, a233
  v_accvgpr_read_b32 v221, a234
  v_accvgpr_read_b32 v1, a235
  v_cvt_pk_bf16_f32 v220, v220, v0
  v_cvt_pk_bf16_f32 v221, v221, v1
  v_accvgpr_read_b32 v222, a236
  v_accvgpr_read_b32 v0, a237
  v_accvgpr_read_b32 v223, a238
  v_accvgpr_read_b32 v1, a239
  v_cvt_pk_bf16_f32 v222, v222, v0
  v_cvt_pk_bf16_f32 v223, v223, v1
  v_accvgpr_read_b32 v228, a208
  v_accvgpr_read_b32 v0, a209
  v_accvgpr_read_b32 v229, a210
  v_accvgpr_read_b32 v1, a211
  v_cvt_pk_bf16_f32 v228, v228, v0
  v_cvt_pk_bf16_f32 v229, v229, v1
  v_accvgpr_read_b32 v230, a212
  v_accvgpr_read_b32 v0, a213
  v_accvgpr_read_b32 v231, a214
  v_accvgpr_read_b32 v1, a215
  v_cvt_pk_bf16_f32 v230, v230, v0
  v_cvt_pk_bf16_f32 v231, v231, v1
  v_accvgpr_read_b32 v236, a240
  v_accvgpr_read_b32 v0, a241
  v_accvgpr_read_b32 v237, a242
  v_accvgpr_read_b32 v1, a243
  v_cvt_pk_bf16_f32 v236, v236, v0
  v_cvt_pk_bf16_f32 v237, v237, v1
  v_accvgpr_read_b32 v238, a244
  v_accvgpr_read_b32 v0, a245
  v_accvgpr_read_b32 v239, a246
  v_accvgpr_read_b32 v1, a247
  v_cvt_pk_bf16_f32 v238, v238, v0
  v_cvt_pk_bf16_f32 v239, v239, v1
  v_accvgpr_read_b32 v244, a216
  v_accvgpr_read_b32 v0, a217
  v_accvgpr_read_b32 v245, a218
  v_accvgpr_read_b32 v1, a219
  v_cvt_pk_bf16_f32 v244, v244, v0
  v_cvt_pk_bf16_f32 v245, v245, v1
  v_accvgpr_read_b32 v246, a220
  v_accvgpr_read_b32 v0, a221
  v_accvgpr_read_b32 v247, a222
  v_accvgpr_read_b32 v1, a223
  v_cvt_pk_bf16_f32 v246, v246, v0
  v_cvt_pk_bf16_f32 v247, v247, v1
  v_accvgpr_read_b32 v252, a248
  v_accvgpr_read_b32 v0, a249
  v_accvgpr_read_b32 v253, a250
  v_accvgpr_read_b32 v1, a251
  v_cvt_pk_bf16_f32 v252, v252, v0
  v_cvt_pk_bf16_f32 v253, v253, v1
  v_accvgpr_read_b32 v254, a252
  v_accvgpr_read_b32 v0, a253
  v_accvgpr_read_b32 v255, a254
  v_accvgpr_read_b32 v1, a255
  v_cvt_pk_bf16_f32 v254, v254, v0
  v_cvt_pk_bf16_f32 v255, v255, v1
  v_mbcnt_lo_u32_b32 v0, -1, 0
  v_mbcnt_hi_u32_b32 v0, -1, v0
  v_lshrrev_b32 v0, 4, v0
  v_lshlrev_b32 v0, 4, v0
  s_mov_b32 s56, s24
  s_mov_b32 s57, s25
  s_mov_b32 s58, 1024
  s_mov_b32 s59, 0x20000
  s_mov_b32 s35, 0
  buffer_load_dwordx4 a[160:163], v0, s[56:59], s35 offen offset:0
  buffer_load_dwordx4 a[164:167], v0, s[56:59], s35 offen offset:64
  buffer_load_dwordx4 a[168:171], v0, s[56:59], s35 offen offset:128
  buffer_load_dwordx4 a[172:175], v0, s[56:59], s35 offen offset:192
  s_add_u32 s35, s35, 256
  s_and_b32 s35, s35, 1023
  buffer_load_dwordx4 a[176:179], v0, s[56:59], s35 offen offset:0
  buffer_load_dwordx4 a[180:183], v0, s[56:59], s35 offen offset:64
  buffer_load_dwordx4 a[184:187], v0, s[56:59], s35 offen offset:128
  buffer_load_dwordx4 a[188:191], v0, s[56:59], s35 offen offset:192
  s_add_u32 s35, s35, 256
  s_and_b32 s35, s35, 1023
  buffer_load_dwordx4 a[192:195], v0, s[56:59], s35 offen offset:0
  buffer_load_dwordx4 a[196:199], v0, s[56:59], s35 offen offset:64
  buffer_load_dwordx4 a[200:203], v0, s[56:59], s35 offen offset:128
  buffer_load_dwordx4 a[204:207], v0, s[56:59], s35 offen offset:192
  s_add_u32 s35, s35, 256
  s_and_b32 s35, s35, 1023
  buffer_load_dwordx4 a[208:211], v0, s[56:59], s35 offen offset:0
  buffer_load_dwordx4 a[212:215], v0, s[56:59], s35 offen offset:64
  buffer_load_dwordx4 a[216:219], v0, s[56:59], s35 offen offset:128
  buffer_load_dwordx4 a[220:223], v0, s[56:59], s35 offen offset:192
  s_add_u32 s35, s35, 256
  s_and_b32 s35, s35, 1023
  v_mfma_f32_16x16x32_bf16 a[0:3], v[32:35], v[64:67], 0
  ds_read_b64_tr_b16 v[48:49], v8 offset:0
  v_mfma_f32_16x16x32_bf16 a[0:3], v[36:39], v[68:71], a[0:3]
  v_mfma_f32_16x16x32_bf16 a[32:35], v[40:43], v[64:67], 0
  s_add_u32 m0, s69, 114688
  ds_read_b64_tr_b16 v[50:51], v8 offset:1024
  v_mfma_f32_16x16x32_bf16 a[32:35], v[44:47], v[68:71], a[32:35]
  buffer_load_dwordx4 v26, s[44:47], s67 offen offset:0 sc1 lds
  v_mfma_f32_16x16x32_bf16 a[36:39], v[40:43], v[72:75], 0
  ds_read_b64_tr_b16 v[52:53], v8 offset:8192
  v_mfma_f32_16x16x32_bf16 a[36:39], v[44:47], v[76:79], a[36:39]
  v_mfma_f32_16x16x32_bf16 a[4:7], v[32:35], v[72:75], 0
  ds_read_b64_tr_b16 v[54:55], v8 offset:9216
  v_mfma_f32_16x16x32_bf16 a[4:7], v[36:39], v[76:79], a[4:7]
  buffer_store_dwordx4 v[152:155], v30, s[48:51], s68 offen offset:1024 sc1
  v_mfma_f32_16x16x32_bf16 a[8:11], v[32:35], v[80:83], 0
  ds_read_b64_tr_b16 v[56:57], v9 offset:0
  v_mfma_f32_16x16x32_bf16 a[8:11], v[36:39], v[84:87], a[8:11]
  v_mfma_f32_16x16x32_bf16 a[40:43], v[40:43], v[80:83], 0
  ds_read_b64_tr_b16 v[58:59], v9 offset:1024
  v_mfma_f32_16x16x32_bf16 a[40:43], v[44:47], v[84:87], a[40:43]
  buffer_load_dwordx4 v27, s[44:47], s67 offen offset:1024 sc1 lds
  v_mfma_f32_16x16x32_bf16 a[44:47], v[40:43], v[88:91], 0
  ds_read_b64_tr_b16 v[60:61], v9 offset:8192
  v_mfma_f32_16x16x32_bf16 a[44:47], v[44:47], v[92:95], a[44:47]
  v_mfma_f32_16x16x32_bf16 a[12:15], v[32:35], v[88:91], 0
  ds_read_b64_tr_b16 v[62:63], v9 offset:9216
  v_mfma_f32_16x16x32_bf16 a[12:15], v[36:39], v[92:95], a[12:15]
  s_waitcnt lgkmcnt(8)
  v_mfma_f32_16x16x32_bf16 a[16:19], v[32:35], v[96:99], 0
  v_mfma_f32_16x16x32_bf16 a[16:19], v[36:39], v[100:103], a[16:19]
  v_mfma_f32_16x16x32_bf16 a[48:51], v[40:43], v[96:99], 0
  v_mfma_f32_16x16x32_bf16 a[48:51], v[44:47], v[100:103], a[48:51]
  buffer_load_dwordx4 v28, s[44:47], s67 offen offset:2048 sc1 lds
  v_mfma_f32_16x16x32_bf16 a[52:55], v[40:43], v[104:107], 0
  v_mfma_f32_16x16x32_bf16 a[52:55], v[44:47], v[108:111], a[52:55]
  v_mfma_f32_16x16x32_bf16 a[20:23], v[32:35], v[104:107], 0
  v_mfma_f32_16x16x32_bf16 a[20:23], v[36:39], v[108:111], a[20:23]
  s_add_u32 s68, s68, 8192
  v_mfma_f32_16x16x32_bf16 a[24:27], v[32:35], v[112:115], 0
  v_mfma_f32_16x16x32_bf16 a[24:27], v[36:39], v[116:119], a[24:27]
  v_mfma_f32_16x16x32_bf16 a[56:59], v[40:43], v[112:115], 0
  v_mfma_f32_16x16x32_bf16 a[56:59], v[44:47], v[116:119], a[56:59]
  buffer_load_dwordx4 v29, s[44:47], s67 offen offset:3072 sc1 lds
  v_mfma_f32_16x16x32_bf16 a[60:63], v[40:43], v[120:123], 0
  s_add_u32 s67, s67, 229376
  v_mfma_f32_16x16x32_bf16 a[60:63], v[44:47], v[124:127], a[60:63]
  v_mfma_f32_16x16x32_bf16 a[28:31], v[32:35], v[120:123], 0
  v_mfma_f32_16x16x32_bf16 a[28:31], v[36:39], v[124:127], a[28:31]
  s_waitcnt vmcnt(5) lgkmcnt(0)
  s_barrier
  v_mfma_f32_16x16x32_bf16 a[64:67], v[48:51], v[64:67], 0
  v_mfma_f32_16x16x32_bf16 a[64:67], v[52:55], v[68:71], a[64:67]
  v_mfma_f32_16x16x32_bf16 a[96:99], v[56:59], v[64:67], 0
  s_add_u32 m0, s69, 16384
  v_mfma_f32_16x16x32_bf16 a[96:99], v[60:63], v[68:71], a[96:99]
  buffer_load_dwordx4 v18, s[36:39], s64 offen offset:0 sc1 lds
  v_mfma_f32_16x16x32_bf16 a[100:103], v[56:59], v[72:75], 0
  v_mfma_f32_16x16x32_bf16 a[100:103], v[60:63], v[76:79], a[100:103]
  v_mfma_f32_16x16x32_bf16 a[68:71], v[48:51], v[72:75], 0
  v_mfma_f32_16x16x32_bf16 a[68:71], v[52:55], v[76:79], a[68:71]
  v_mfma_f32_16x16x32_bf16 a[72:75], v[48:51], v[80:83], 0
  v_mfma_f32_16x16x32_bf16 a[72:75], v[52:55], v[84:87], a[72:75]
  v_mfma_f32_16x16x32_bf16 a[104:107], v[56:59], v[80:83], 0
  v_mfma_f32_16x16x32_bf16 a[104:107], v[60:63], v[84:87], a[104:107]
  buffer_load_dwordx4 v19, s[36:39], s64 offen offset:1024 sc1 lds
  v_mfma_f32_16x16x32_bf16 a[108:111], v[56:59], v[88:91], 0
  v_mfma_f32_16x16x32_bf16 a[108:111], v[60:63], v[92:95], a[108:111]
  v_mfma_f32_16x16x32_bf16 a[76:79], v[48:51], v[88:91], 0
  v_mfma_f32_16x16x32_bf16 a[76:79], v[52:55], v[92:95], a[76:79]
  v_mfma_f32_16x16x32_bf16 a[80:83], v[48:51], v[96:99], 0
  buffer_store_dwordx4 v[160:163], v30, s[48:51], s68 offen offset:0 sc1
  v_mfma_f32_16x16x32_bf16 a[80:83], v[52:55], v[100:103], a[80:83]
  v_mfma_f32_16x16x32_bf16 a[112:115], v[56:59], v[96:99], 0
  v_mfma_f32_16x16x32_bf16 a[112:115], v[60:63], v[100:103], a[112:115]
  buffer_load_dwordx4 v20, s[36:39], s64 offen offset:2048 sc1 lds
  v_mfma_f32_16x16x32_bf16 a[116:119], v[56:59], v[104:107], 0
  v_mfma_f32_16x16x32_bf16 a[116:119], v[60:63], v[108:111], a[116:119]
  v_mfma_f32_16x16x32_bf16 a[84:87], v[48:51], v[104:107], 0
  v_mfma_f32_16x16x32_bf16 a[84:87], v[52:55], v[108:111], a[84:87]
  v_mfma_f32_16x16x32_bf16 a[88:91], v[48:51], v[112:115], 0
  v_mfma_f32_16x16x32_bf16 a[88:91], v[52:55], v[116:119], a[88:91]
  v_mfma_f32_16x16x32_bf16 a[120:123], v[56:59], v[112:115], 0
  v_mfma_f32_16x16x32_bf16 a[120:123], v[60:63], v[116:119], a[120:123]
  buffer_load_dwordx4 v21, s[36:39], s64 offen offset:3072 sc1 lds
  v_mfma_f32_16x16x32_bf16 a[124:127], v[56:59], v[120:123], 0
  s_add_u32 s64, s64, 128
  v_mfma_f32_16x16x32_bf16 a[124:127], v[60:63], v[124:127], a[124:127]
  s_waitcnt lgkmcnt(0)
  v_mfma_f32_16x16x32_bf16 a[92:95], v[48:51], v[120:123], 0
  v_mfma_f32_16x16x32_bf16 a[92:95], v[52:55], v[124:127], a[92:95]
  v_mfma_f32_16x16x32_bf16 a[128:131], a[160:163], v[64:67], 0
  v_mfma_f32_16x16x32_bf16 a[128:131], a[164:167], v[68:71], a[128:131]
  v_mfma_f32_16x16x32_bf16 a[132:135], a[160:163], v[72:75], 0
  v_mfma_f32_16x16x32_bf16 a[132:135], a[164:167], v[76:79], a[132:135]
  v_mfma_f32_16x16x32_bf16 a[136:139], a[160:163], v[80:83], 0
  v_mfma_f32_16x16x32_bf16 a[136:139], a[164:167], v[84:87], a[136:139]
  v_mfma_f32_16x16x32_bf16 a[140:143], a[160:163], v[88:91], 0
  v_mfma_f32_16x16x32_bf16 a[140:143], a[164:167], v[92:95], a[140:143]
  v_mfma_f32_16x16x32_bf16 a[144:147], a[160:163], v[96:99], 0
  v_mfma_f32_16x16x32_bf16 a[144:147], a[164:167], v[100:103], a[144:147]
  v_mfma_f32_16x16x32_bf16 a[148:151], a[160:163], v[104:107], 0
  v_mfma_f32_16x16x32_bf16 a[148:151], a[164:167], v[108:111], a[148:151]
  v_mfma_f32_16x16x32_bf16 a[152:155], a[160:163], v[112:115], 0
  v_mfma_f32_16x16x32_bf16 a[152:155], a[164:167], v[116:119], a[152:155]
  v_mfma_f32_16x16x32_bf16 a[156:159], a[160:163], v[120:123], 0
  v_mfma_f32_16x16x32_bf16 a[156:159], a[164:167], v[124:127], a[156:159]
  s_add_u32 m0, s69, 32768
  s_nop 0
  buffer_load_dwordx4 v18, s[36:39], s65 offen offset:0 sc1 lds
  buffer_load_dwordx4 v19, s[36:39], s65 offen offset:1024 sc1 lds
  buffer_load_dwordx4 v20, s[36:39], s65 offen offset:2048 sc1 lds
  buffer_store_dwordx4 v[168:171], v30, s[48:51], s68 offen offset:1024 sc1
  s_add_u32 s68, s68, 8192
  buffer_load_dwordx4 v21, s[36:39], s65 offen offset:3072 sc1 lds
  s_add_u32 s65, s65, 128
  buffer_store_dwordx4 v[176:179], v30, s[48:51], s68 offen offset:0 sc1
  s_waitcnt vmcnt(16) lgkmcnt(0)
  s_barrier
  ds_read_b64_tr_b16 v[32:33], v10 offset:0
  ds_read_b64_tr_b16 v[34:35], v10 offset:1024
  ds_read_b64_tr_b16 v[36:37], v10 offset:8192
  ds_read_b64_tr_b16 v[38:39], v10 offset:9216
  ds_read_b64_tr_b16 v[40:41], v11 offset:0
  ds_read_b64_tr_b16 v[42:43], v11 offset:1024
  ds_read_b128 v[64:67], v4 offset:16384
  ds_read_b128 v[68:71], v5 offset:16384
  s_add_u32 m0, s69, 0
  s_nop 0
  ds_read_b64_tr_b16 v[44:45], v11 offset:8192
  ds_read_b64_tr_b16 v[46:47], v11 offset:9216
  buffer_load_dwordx4 v22, s[40:43], s66 offen offset:0 sc1 lds
  ds_read_b128 v[72:75], v4 offset:18432
  ds_read_b128 v[76:79], v5 offset:18432
  buffer_store_dwordx4 v[184:187], v30, s[48:51], s68 offen offset:1024 sc1
  s_sub_u32 s68, s68, 24576
  ds_read_b128 v[80:83], v4 offset:20480
  ds_read_b128 v[84:87], v5 offset:20480
  buffer_load_dwordx4 v23, s[40:43], s66 offen offset:1024 sc1 lds
  ds_read_b128 v[88:91], v4 offset:22528
  ds_read_b128 v[92:95], v5 offset:22528
  ds_read_b128 v[96:99], v4 offset:32768
  ds_read_b128 v[100:103], v5 offset:32768
  buffer_load_dwordx4 v24, s[40:43], s66 offen offset:2048 sc1 lds
  ds_read_b128 v[104:107], v4 offset:34816
  ds_read_b128 v[108:111], v5 offset:34816
  ds_read_b128 v[112:115], v4 offset:36864
  ds_read_b128 v[116:119], v5 offset:36864
  buffer_load_dwordx4 v25, s[40:43], s66 offen offset:3072 sc1 lds
  s_add_u32 s66, s66, 524288
  s_waitcnt lgkmcnt(6)
  ds_read_b128 v[120:123], v4 offset:38912
  ds_read_b128 v[124:127], v5 offset:38912
  v_mfma_f32_16x16x32_bf16 a[0:3], v[32:35], v[64:67], a[0:3]
  ds_read_b64_tr_b16 v[48:49], v12 offset:0
  v_mfma_f32_16x16x32_bf16 a[0:3], v[36:39], v[68:71], a[0:3]
  v_mfma_f32_16x16x32_bf16 a[32:35], v[40:43], v[64:67], a[32:35]
  s_add_u32 m0, s69, 49152
  ds_read_b64_tr_b16 v[50:51], v12 offset:1024
  v_mfma_f32_16x16x32_bf16 a[32:35], v[44:47], v[68:71], a[32:35]
  buffer_load_dwordx4 v26, s[44:47], s67 offen offset:0 sc1 lds
  v_mfma_f32_16x16x32_bf16 a[36:39], v[40:43], v[72:75], a[36:39]
  ds_read_b64_tr_b16 v[52:53], v12 offset:8192
  v_mfma_f32_16x16x32_bf16 a[36:39], v[44:47], v[76:79], a[36:39]
  v_mfma_f32_16x16x32_bf16 a[4:7], v[32:35], v[72:75], a[4:7]
  ds_read_b64_tr_b16 v[54:55], v12 offset:9216
  v_mfma_f32_16x16x32_bf16 a[4:7], v[36:39], v[76:79], a[4:7]
  v_mfma_f32_16x16x32_bf16 a[8:11], v[32:35], v[80:83], a[8:11]
  ds_read_b64_tr_b16 v[56:57], v13 offset:0
  v_mfma_f32_16x16x32_bf16 a[8:11], v[36:39], v[84:87], a[8:11]
  v_mfma_f32_16x16x32_bf16 a[40:43], v[40:43], v[80:83], a[40:43]
  ds_read_b64_tr_b16 v[58:59], v13 offset:1024
  v_mfma_f32_16x16x32_bf16 a[40:43], v[44:47], v[84:87], a[40:43]
  buffer_load_dwordx4 v27, s[44:47], s67 offen offset:1024 sc1 lds
  v_mfma_f32_16x16x32_bf16 a[44:47], v[40:43], v[88:91], a[44:47]
  ds_read_b64_tr_b16 v[60:61], v13 offset:8192
  v_mfma_f32_16x16x32_bf16 a[44:47], v[44:47], v[92:95], a[44:47]
  v_mfma_f32_16x16x32_bf16 a[12:15], v[32:35], v[88:91], a[12:15]
  ds_read_b64_tr_b16 v[62:63], v13 offset:9216
  v_mfma_f32_16x16x32_bf16 a[12:15], v[36:39], v[92:95], a[12:15]
  s_waitcnt lgkmcnt(8)
  v_mfma_f32_16x16x32_bf16 a[16:19], v[32:35], v[96:99], a[16:19]
  buffer_store_dwordx4 v[192:195], v30, s[48:51], s68 offen offset:2048 sc1
  v_mfma_f32_16x16x32_bf16 a[16:19], v[36:39], v[100:103], a[16:19]
  v_mfma_f32_16x16x32_bf16 a[48:51], v[40:43], v[96:99], a[48:51]
  v_mfma_f32_16x16x32_bf16 a[48:51], v[44:47], v[100:103], a[48:51]
  buffer_load_dwordx4 v28, s[44:47], s67 offen offset:2048 sc1 lds
  v_mfma_f32_16x16x32_bf16 a[52:55], v[40:43], v[104:107], a[52:55]
  v_mfma_f32_16x16x32_bf16 a[52:55], v[44:47], v[108:111], a[52:55]
  v_mfma_f32_16x16x32_bf16 a[20:23], v[32:35], v[104:107], a[20:23]
  v_mfma_f32_16x16x32_bf16 a[20:23], v[36:39], v[108:111], a[20:23]
  v_mfma_f32_16x16x32_bf16 a[24:27], v[32:35], v[112:115], a[24:27]
  v_mfma_f32_16x16x32_bf16 a[24:27], v[36:39], v[116:119], a[24:27]
  v_mfma_f32_16x16x32_bf16 a[56:59], v[40:43], v[112:115], a[56:59]
  v_mfma_f32_16x16x32_bf16 a[56:59], v[44:47], v[116:119], a[56:59]
  buffer_load_dwordx4 v29, s[44:47], s67 offen offset:3072 sc1 lds
  v_mfma_f32_16x16x32_bf16 a[60:63], v[40:43], v[120:123], a[60:63]
  s_add_u32 s67, s67, 229376
  v_mfma_f32_16x16x32_bf16 a[60:63], v[44:47], v[124:127], a[60:63]
  v_mfma_f32_16x16x32_bf16 a[28:31], v[32:35], v[120:123], a[28:31]
  v_mfma_f32_16x16x32_bf16 a[28:31], v[36:39], v[124:127], a[28:31]
  s_waitcnt vmcnt(21) lgkmcnt(0)
  s_barrier
  v_mfma_f32_16x16x32_bf16 a[64:67], v[48:51], v[64:67], a[64:67]
  v_mfma_f32_16x16x32_bf16 a[64:67], v[52:55], v[68:71], a[64:67]
  v_mfma_f32_16x16x32_bf16 a[96:99], v[56:59], v[64:67], a[96:99]
  s_add_u32 m0, s69, 81920
  v_mfma_f32_16x16x32_bf16 a[96:99], v[60:63], v[68:71], a[96:99]
  buffer_load_dwordx4 v18, s[36:39], s64 offen offset:0 sc1 lds
  v_mfma_f32_16x16x32_bf16 a[100:103], v[56:59], v[72:75], a[100:103]
  v_mfma_f32_16x16x32_bf16 a[100:103], v[60:63], v[76:79], a[100:103]
  v_mfma_f32_16x16x32_bf16 a[68:71], v[48:51], v[72:75], a[68:71]
  v_mfma_f32_16x16x32_bf16 a[68:71], v[52:55], v[76:79], a[68:71]
  v_mfma_f32_16x16x32_bf16 a[72:75], v[48:51], v[80:83], a[72:75]
  buffer_store_dwordx4 v[200:203], v30, s[48:51], s68 offen offset:3072 sc1
  v_mfma_f32_16x16x32_bf16 a[72:75], v[52:55], v[84:87], a[72:75]
  v_mfma_f32_16x16x32_bf16 a[104:107], v[56:59], v[80:83], a[104:107]
  v_mfma_f32_16x16x32_bf16 a[104:107], v[60:63], v[84:87], a[104:107]
  buffer_load_dwordx4 v19, s[36:39], s64 offen offset:1024 sc1 lds
  v_mfma_f32_16x16x32_bf16 a[108:111], v[56:59], v[88:91], a[108:111]
  v_mfma_f32_16x16x32_bf16 a[108:111], v[60:63], v[92:95], a[108:111]
  v_mfma_f32_16x16x32_bf16 a[76:79], v[48:51], v[88:91], a[76:79]
  v_mfma_f32_16x16x32_bf16 a[76:79], v[52:55], v[92:95], a[76:79]
  v_mfma_f32_16x16x32_bf16 a[80:83], v[48:51], v[96:99], a[80:83]
  v_mfma_f32_16x16x32_bf16 a[80:83], v[52:55], v[100:103], a[80:83]
  v_mfma_f32_16x16x32_bf16 a[112:115], v[56:59], v[96:99], a[112:115]
  v_mfma_f32_16x16x32_bf16 a[112:115], v[60:63], v[100:103], a[112:115]
  buffer_load_dwordx4 v20, s[36:39], s64 offen offset:2048 sc1 lds
  v_mfma_f32_16x16x32_bf16 a[116:119], v[56:59], v[104:107], a[116:119]
  v_mfma_f32_16x16x32_bf16 a[116:119], v[60:63], v[108:111], a[116:119]
  v_mfma_f32_16x16x32_bf16 a[84:87], v[48:51], v[104:107], a[84:87]
  v_mfma_f32_16x16x32_bf16 a[84:87], v[52:55], v[108:111], a[84:87]
  v_mfma_f32_16x16x32_bf16 a[88:91], v[48:51], v[112:115], a[88:91]
  s_add_u32 s68, s68, 8192
  v_mfma_f32_16x16x32_bf16 a[88:91], v[52:55], v[116:119], a[88:91]
  v_mfma_f32_16x16x32_bf16 a[120:123], v[56:59], v[112:115], a[120:123]
  v_mfma_f32_16x16x32_bf16 a[120:123], v[60:63], v[116:119], a[120:123]
  buffer_load_dwordx4 v21, s[36:39], s64 offen offset:3072 sc1 lds
  v_mfma_f32_16x16x32_bf16 a[124:127], v[56:59], v[120:123], a[124:127]
  s_add_u32 s64, s64, 128
  v_mfma_f32_16x16x32_bf16 a[124:127], v[60:63], v[124:127], a[124:127]
  s_waitcnt lgkmcnt(0)
  v_mfma_f32_16x16x32_bf16 a[92:95], v[48:51], v[120:123], a[92:95]
  v_mfma_f32_16x16x32_bf16 a[92:95], v[52:55], v[124:127], a[92:95]
  v_mfma_f32_16x16x32_bf16 a[128:131], a[168:171], v[64:67], a[128:131]
  v_mfma_f32_16x16x32_bf16 a[128:131], a[172:175], v[68:71], a[128:131]
  v_mfma_f32_16x16x32_bf16 a[132:135], a[168:171], v[72:75], a[132:135]
  v_mfma_f32_16x16x32_bf16 a[132:135], a[172:175], v[76:79], a[132:135]
  v_mfma_f32_16x16x32_bf16 a[136:139], a[168:171], v[80:83], a[136:139]
  v_mfma_f32_16x16x32_bf16 a[136:139], a[172:175], v[84:87], a[136:139]
  v_mfma_f32_16x16x32_bf16 a[140:143], a[168:171], v[88:91], a[140:143]
  v_mfma_f32_16x16x32_bf16 a[140:143], a[172:175], v[92:95], a[140:143]
  v_mfma_f32_16x16x32_bf16 a[144:147], a[168:171], v[96:99], a[144:147]
  v_mfma_f32_16x16x32_bf16 a[144:147], a[172:175], v[100:103], a[144:147]
  v_mfma_f32_16x16x32_bf16 a[148:151], a[168:171], v[104:107], a[148:151]
  v_mfma_f32_16x16x32_bf16 a[148:151], a[172:175], v[108:111], a[148:151]
  v_mfma_f32_16x16x32_bf16 a[152:155], a[168:171], v[112:115], a[152:155]
  v_mfma_f32_16x16x32_bf16 a[152:155], a[172:175], v[116:119], a[152:155]
  v_mfma_f32_16x16x32_bf16 a[156:159], a[168:171], v[120:123], a[156:159]
  v_mfma_f32_16x16x32_bf16 a[156:159], a[172:175], v[124:127], a[156:159]
  s_add_u32 m0, s69, 98304
  s_nop 0
  buffer_load_dwordx4 v18, s[36:39], s65 offen offset:0 sc1 lds
  buffer_load_dwordx4 v19, s[36:39], s65 offen offset:1024 sc1 lds
  buffer_load_dwordx4 v20, s[36:39], s65 offen offset:2048 sc1 lds
  buffer_store_dwordx4 v[208:211], v30, s[48:51], s68 offen offset:2048 sc1
  buffer_store_dwordx4 v[216:219], v30, s[48:51], s68 offen offset:3072 sc1
  buffer_load_dwordx4 v21, s[36:39], s65 offen offset:3072 sc1 lds
  s_add_u32 s65, s65, 128
  s_add_u32 s68, s68, 8192
  s_waitcnt vmcnt(16) lgkmcnt(0)
  s_barrier
  ds_read_b64_tr_b16 v[32:33], v6 offset:0
  ds_read_b64_tr_b16 v[34:35], v6 offset:1024
  ds_read_b64_tr_b16 v[36:37], v6 offset:8192
  ds_read_b64_tr_b16 v[38:39], v6 offset:9216
  ds_read_b64_tr_b16 v[40:41], v7 offset:0
  ds_read_b64_tr_b16 v[42:43], v7 offset:1024
  ds_read_b128 v[64:67], v2 offset:16384
  ds_read_b128 v[68:71], v3 offset:16384
  s_add_u32 m0, s69, 65536
  s_nop 0
  ds_read_b64_tr_b16 v[44:45], v7 offset:8192
  ds_read_b64_tr_b16 v[46:47], v7 offset:9216
  buffer_load_dwordx4 v22, s[40:43], s66 offen offset:0 sc1 lds
  ds_read_b128 v[72:75], v2 offset:18432
  ds_read_b128 v[76:79], v3 offset:18432
  buffer_store_dwordx4 v[224:227], v30, s[48:51], s68 offen offset:2048 sc1
  ds_read_b128 v[80:83], v2 offset:20480
  ds_read_b128 v[84:87], v3 offset:20480
  buffer_load_dwordx4 v23, s[40:43], s66 offen offset:1024 sc1 lds
  ds_read_b128 v[88:91], v2 offset:22528
  ds_read_b128 v[92:95], v3 offset:22528
  ds_read_b128 v[96:99], v2 offset:32768
  ds_read_b128 v[100:103], v3 offset:32768
  buffer_load_dwordx4 v24, s[40:43], s66 offen offset:2048 sc1 lds
  ds_read_b128 v[104:107], v2 offset:34816
  ds_read_b128 v[108:111], v3 offset:34816
  ds_read_b128 v[112:115], v2 offset:36864
  ds_read_b128 v[116:119], v3 offset:36864
  buffer_load_dwordx4 v25, s[40:43], s66 offen offset:3072 sc1 lds
  s_add_u32 s66, s66, 524288
  s_waitcnt lgkmcnt(6)
  ds_read_b128 v[120:123], v2 offset:38912
  ds_read_b128 v[124:127], v3 offset:38912
  v_mfma_f32_16x16x32_bf16 a[0:3], v[32:35], v[64:67], a[0:3]
  ds_read_b64_tr_b16 v[48:49], v8 offset:0
  v_mfma_f32_16x16x32_bf16 a[0:3], v[36:39], v[68:71], a[0:3]
  v_mfma_f32_16x16x32_bf16 a[32:35], v[40:43], v[64:67], a[32:35]
  s_add_u32 m0, s69, 114688
  ds_read_b64_tr_b16 v[50:51], v8 offset:1024
  v_mfma_f32_16x16x32_bf16 a[32:35], v[44:47], v[68:71], a[32:35]
  buffer_load_dwordx4 v26, s[44:47], s67 offen offset:0 sc1 lds
  v_mfma_f32_16x16x32_bf16 a[36:39], v[40:43], v[72:75], a[36:39]
  ds_read_b64_tr_b16 v[52:53], v8 offset:8192
  v_mfma_f32_16x16x32_bf16 a[36:39], v[44:47], v[76:79], a[36:39]
  v_mfma_f32_16x16x32_bf16 a[4:7], v[32:35], v[72:75], a[4:7]
  ds_read_b64_tr_b16 v[54:55], v8 offset:9216
  v_mfma_f32_16x16x32_bf16 a[4:7], v[36:39], v[76:79], a[4:7]
  buffer_store_dwordx4 v[232:235], v30, s[48:51], s68 offen offset:3072 sc1
  v_mfma_f32_16x16x32_bf16 a[8:11], v[32:35], v[80:83], a[8:11]
  ds_read_b64_tr_b16 v[56:57], v9 offset:0
  v_mfma_f32_16x16x32_bf16 a[8:11], v[36:39], v[84:87], a[8:11]
  v_mfma_f32_16x16x32_bf16 a[40:43], v[40:43], v[80:83], a[40:43]
  ds_read_b64_tr_b16 v[58:59], v9 offset:1024
  v_mfma_f32_16x16x32_bf16 a[40:43], v[44:47], v[84:87], a[40:43]
  buffer_load_dwordx4 v27, s[44:47], s67 offen offset:1024 sc1 lds
  v_mfma_f32_16x16x32_bf16 a[44:47], v[40:43], v[88:91], a[44:47]
  ds_read_b64_tr_b16 v[60:61], v9 offset:8192
  v_mfma_f32_16x16x32_bf16 a[44:47], v[44:47], v[92:95], a[44:47]
  v_mfma_f32_16x16x32_bf16 a[12:15], v[32:35], v[88:91], a[12:15]
  ds_read_b64_tr_b16 v[62:63], v9 offset:9216
  v_mfma_f32_16x16x32_bf16 a[12:15], v[36:39], v[92:95], a[12:15]
  s_waitcnt lgkmcnt(8)
  v_mfma_f32_16x16x32_bf16 a[16:19], v[32:35], v[96:99], a[16:19]
  v_mfma_f32_16x16x32_bf16 a[16:19], v[36:39], v[100:103], a[16:19]
  v_mfma_f32_16x16x32_bf16 a[48:51], v[40:43], v[96:99], a[48:51]
  v_mfma_f32_16x16x32_bf16 a[48:51], v[44:47], v[100:103], a[48:51]
  buffer_load_dwordx4 v28, s[44:47], s67 offen offset:2048 sc1 lds
  v_mfma_f32_16x16x32_bf16 a[52:55], v[40:43], v[104:107], a[52:55]
  v_mfma_f32_16x16x32_bf16 a[52:55], v[44:47], v[108:111], a[52:55]
  v_mfma_f32_16x16x32_bf16 a[20:23], v[32:35], v[104:107], a[20:23]
  v_mfma_f32_16x16x32_bf16 a[20:23], v[36:39], v[108:111], a[20:23]
  s_add_u32 s68, s68, 8192
  v_mfma_f32_16x16x32_bf16 a[24:27], v[32:35], v[112:115], a[24:27]
  v_mfma_f32_16x16x32_bf16 a[24:27], v[36:39], v[116:119], a[24:27]
  v_mfma_f32_16x16x32_bf16 a[56:59], v[40:43], v[112:115], a[56:59]
  v_mfma_f32_16x16x32_bf16 a[56:59], v[44:47], v[116:119], a[56:59]
  buffer_load_dwordx4 v29, s[44:47], s67 offen offset:3072 sc1 lds
  v_mfma_f32_16x16x32_bf16 a[60:63], v[40:43], v[120:123], a[60:63]
  s_add_u32 s67, s67, 229376
  v_mfma_f32_16x16x32_bf16 a[60:63], v[44:47], v[124:127], a[60:63]
  v_mfma_f32_16x16x32_bf16 a[28:31], v[32:35], v[120:123], a[28:31]
  v_mfma_f32_16x16x32_bf16 a[28:31], v[36:39], v[124:127], a[28:31]
  s_waitcnt vmcnt(21) lgkmcnt(0)
  s_barrier
  v_mfma_f32_16x16x32_bf16 a[64:67], v[48:51], v[64:67], a[64:67]
  v_mfma_f32_16x16x32_bf16 a[64:67], v[52:55], v[68:71], a[64:67]
  v_mfma_f32_16x16x32_bf16 a[96:99], v[56:59], v[64:67], a[96:99]
  s_add_u32 m0, s69, 16384
  v_mfma_f32_16x16x32_bf16 a[96:99], v[60:63], v[68:71], a[96:99]
  buffer_load_dwordx4 v18, s[36:39], s64 offen offset:0 sc1 lds
  v_mfma_f32_16x16x32_bf16 a[100:103], v[56:59], v[72:75], a[100:103]
  v_mfma_f32_16x16x32_bf16 a[100:103], v[60:63], v[76:79], a[100:103]
  v_mfma_f32_16x16x32_bf16 a[68:71], v[48:51], v[72:75], a[68:71]
  v_mfma_f32_16x16x32_bf16 a[68:71], v[52:55], v[76:79], a[68:71]
  v_mfma_f32_16x16x32_bf16 a[72:75], v[48:51], v[80:83], a[72:75]
  v_mfma_f32_16x16x32_bf16 a[72:75], v[52:55], v[84:87], a[72:75]
  v_mfma_f32_16x16x32_bf16 a[104:107], v[56:59], v[80:83], a[104:107]
  v_mfma_f32_16x16x32_bf16 a[104:107], v[60:63], v[84:87], a[104:107]
  buffer_load_dwordx4 v19, s[36:39], s64 offen offset:1024 sc1 lds
  v_mfma_f32_16x16x32_bf16 a[108:111], v[56:59], v[88:91], a[108:111]
  v_mfma_f32_16x16x32_bf16 a[108:111], v[60:63], v[92:95], a[108:111]
  v_mfma_f32_16x16x32_bf16 a[76:79], v[48:51], v[88:91], a[76:79]
  v_mfma_f32_16x16x32_bf16 a[76:79], v[52:55], v[92:95], a[76:79]
  v_mfma_f32_16x16x32_bf16 a[80:83], v[48:51], v[96:99], a[80:83]
  buffer_store_dwordx4 v[240:243], v30, s[48:51], s68 offen offset:2048 sc1
  v_mfma_f32_16x16x32_bf16 a[80:83], v[52:55], v[100:103], a[80:83]
  v_mfma_f32_16x16x32_bf16 a[112:115], v[56:59], v[96:99], a[112:115]
  v_mfma_f32_16x16x32_bf16 a[112:115], v[60:63], v[100:103], a[112:115]
  buffer_load_dwordx4 v20, s[36:39], s64 offen offset:2048 sc1 lds
  v_mfma_f32_16x16x32_bf16 a[116:119], v[56:59], v[104:107], a[116:119]
  v_mfma_f32_16x16x32_bf16 a[116:119], v[60:63], v[108:111], a[116:119]
  v_mfma_f32_16x16x32_bf16 a[84:87], v[48:51], v[104:107], a[84:87]
  v_mfma_f32_16x16x32_bf16 a[84:87], v[52:55], v[108:111], a[84:87]
  v_mfma_f32_16x16x32_bf16 a[88:91], v[48:51], v[112:115], a[88:91]
  v_mfma_f32_16x16x32_bf16 a[88:91], v[52:55], v[116:119], a[88:91]
  v_mfma_f32_16x16x32_bf16 a[120:123], v[56:59], v[112:115], a[120:123]
  v_mfma_f32_16x16x32_bf16 a[120:123], v[60:63], v[116:119], a[120:123]
  buffer_load_dwordx4 v21, s[36:39], s64 offen offset:3072 sc1 lds
  v_mfma_f32_16x16x32_bf16 a[124:127], v[56:59], v[120:123], a[124:127]
  s_add_u32 s64, s64, 128
  v_mfma_f32_16x16x32_bf16 a[124:127], v[60:63], v[124:127], a[124:127]
  s_waitcnt lgkmcnt(0)
  v_mfma_f32_16x16x32_bf16 a[92:95], v[48:51], v[120:123], a[92:95]
  v_mfma_f32_16x16x32_bf16 a[92:95], v[52:55], v[124:127], a[92:95]
  v_mfma_f32_16x16x32_bf16 a[128:131], a[176:179], v[64:67], a[128:131]
  v_mfma_f32_16x16x32_bf16 a[128:131], a[180:183], v[68:71], a[128:131]
  v_mfma_f32_16x16x32_bf16 a[132:135], a[176:179], v[72:75], a[132:135]
  v_mfma_f32_16x16x32_bf16 a[132:135], a[180:183], v[76:79], a[132:135]
  v_mfma_f32_16x16x32_bf16 a[136:139], a[176:179], v[80:83], a[136:139]
  v_mfma_f32_16x16x32_bf16 a[136:139], a[180:183], v[84:87], a[136:139]
  v_mfma_f32_16x16x32_bf16 a[140:143], a[176:179], v[88:91], a[140:143]
  v_mfma_f32_16x16x32_bf16 a[140:143], a[180:183], v[92:95], a[140:143]
  v_mfma_f32_16x16x32_bf16 a[144:147], a[176:179], v[96:99], a[144:147]
  v_mfma_f32_16x16x32_bf16 a[144:147], a[180:183], v[100:103], a[144:147]
  v_mfma_f32_16x16x32_bf16 a[148:151], a[176:179], v[104:107], a[148:151]
  v_mfma_f32_16x16x32_bf16 a[148:151], a[180:183], v[108:111], a[148:151]
  v_mfma_f32_16x16x32_bf16 a[152:155], a[176:179], v[112:115], a[152:155]
  v_mfma_f32_16x16x32_bf16 a[152:155], a[180:183], v[116:119], a[152:155]
  v_mfma_f32_16x16x32_bf16 a[156:159], a[176:179], v[120:123], a[156:159]
  v_mfma_f32_16x16x32_bf16 a[156:159], a[180:183], v[124:127], a[156:159]
  s_add_u32 m0, s69, 32768
  s_nop 0
  buffer_load_dwordx4 v18, s[36:39], s65 offen offset:0 sc1 lds
  buffer_load_dwordx4 v19, s[36:39], s65 offen offset:1024 sc1 lds
  buffer_load_dwordx4 v20, s[36:39], s65 offen offset:2048 sc1 lds
  buffer_store_dwordx4 v[248:251], v30, s[48:51], s68 offen offset:3072 sc1
  buffer_load_dwordx4 v21, s[36:39], s65 offen offset:3072 sc1 lds
  s_add_u32 s65, s65, 128
  s_sub_u32 s68, s68, 24576
  s_waitcnt vmcnt(15) lgkmcnt(0)
  s_barrier
  ds_read_b64_tr_b16 v[32:33], v10 offset:0
  ds_read_b64_tr_b16 v[34:35], v10 offset:1024
  ds_read_b64_tr_b16 v[36:37], v10 offset:8192
  ds_read_b64_tr_b16 v[38:39], v10 offset:9216
  ds_read_b64_tr_b16 v[40:41], v11 offset:0
  ds_read_b64_tr_b16 v[42:43], v11 offset:1024
  ds_read_b128 v[64:67], v4 offset:16384
  ds_read_b128 v[68:71], v5 offset:16384
  s_add_u32 m0, s69, 0
  s_nop 0
  ds_read_b64_tr_b16 v[44:45], v11 offset:8192
  ds_read_b64_tr_b16 v[46:47], v11 offset:9216
  buffer_load_dwordx4 v22, s[40:43], s66 offen offset:0 sc1 lds
  ds_read_b128 v[72:75], v4 offset:18432
  ds_read_b128 v[76:79], v5 offset:18432
  buffer_store_dwordx4 v[132:135], v30, s[48:51], s99 offen offset:0 sc1
  buffer_store_dwordx4 v[140:143], v30, s[48:51], s99 offen offset:1024 sc1
  ds_read_b128 v[80:83], v4 offset:20480
  ds_read_b128 v[84:87], v5 offset:20480
  buffer_load_dwordx4 v23, s[40:43], s66 offen offset:1024 sc1 lds
  s_add_u32 s99, s99, 8192
  ds_read_b128 v[88:91], v4 offset:22528
  ds_read_b128 v[92:95], v5 offset:22528
  ds_read_b128 v[96:99], v4 offset:32768
  ds_read_b128 v[100:103], v5 offset:32768
  buffer_load_dwordx4 v24, s[40:43], s66 offen offset:2048 sc1 lds
  ds_read_b128 v[104:107], v4 offset:34816
  ds_read_b128 v[108:111], v5 offset:34816
  ds_read_b128 v[112:115], v4 offset:36864
  ds_read_b128 v[116:119], v5 offset:36864
  buffer_load_dwordx4 v25, s[40:43], s66 offen offset:3072 sc1 lds
  s_add_u32 s66, s66, 524288
  s_waitcnt lgkmcnt(6)
  ds_read_b128 v[120:123], v4 offset:38912
  ds_read_b128 v[124:127], v5 offset:38912
  v_mfma_f32_16x16x32_bf16 a[0:3], v[32:35], v[64:67], a[0:3]
  ds_read_b64_tr_b16 v[48:49], v12 offset:0
  v_mfma_f32_16x16x32_bf16 a[0:3], v[36:39], v[68:71], a[0:3]
  v_mfma_f32_16x16x32_bf16 a[32:35], v[40:43], v[64:67], a[32:35]
  s_add_u32 m0, s69, 49152
  ds_read_b64_tr_b16 v[50:51], v12 offset:1024
  v_mfma_f32_16x16x32_bf16 a[32:35], v[44:47], v[68:71], a[32:35]
  buffer_load_dwordx4 v26, s[44:47], s67 offen offset:0 sc1 lds
  v_mfma_f32_16x16x32_bf16 a[36:39], v[40:43], v[72:75], a[36:39]
  ds_read_b64_tr_b16 v[52:53], v12 offset:8192
  v_mfma_f32_16x16x32_bf16 a[36:39], v[44:47], v[76:79], a[36:39]
  v_mfma_f32_16x16x32_bf16 a[4:7], v[32:35], v[72:75], a[4:7]
  ds_read_b64_tr_b16 v[54:55], v12 offset:9216
  v_mfma_f32_16x16x32_bf16 a[4:7], v[36:39], v[76:79], a[4:7]
  v_mfma_f32_16x16x32_bf16 a[8:11], v[32:35], v[80:83], a[8:11]
  ds_read_b64_tr_b16 v[56:57], v13 offset:0
  v_mfma_f32_16x16x32_bf16 a[8:11], v[36:39], v[84:87], a[8:11]
  v_mfma_f32_16x16x32_bf16 a[40:43], v[40:43], v[80:83], a[40:43]
  ds_read_b64_tr_b16 v[58:59], v13 offset:1024
  v_mfma_f32_16x16x32_bf16 a[40:43], v[44:47], v[84:87], a[40:43]
  buffer_load_dwordx4 v27, s[44:47], s67 offen offset:1024 sc1 lds
  v_mfma_f32_16x16x32_bf16 a[44:47], v[40:43], v[88:91], a[44:47]
  ds_read_b64_tr_b16 v[60:61], v13 offset:8192
  v_mfma_f32_16x16x32_bf16 a[44:47], v[44:47], v[92:95], a[44:47]
  v_mfma_f32_16x16x32_bf16 a[12:15], v[32:35], v[88:91], a[12:15]
  ds_read_b64_tr_b16 v[62:63], v13 offset:9216
  v_mfma_f32_16x16x32_bf16 a[12:15], v[36:39], v[92:95], a[12:15]
  s_waitcnt lgkmcnt(8)
  v_mfma_f32_16x16x32_bf16 a[16:19], v[32:35], v[96:99], a[16:19]
  buffer_store_dwordx4 v[148:151], v30, s[48:51], s99 offen offset:0 sc1
  v_mfma_f32_16x16x32_bf16 a[16:19], v[36:39], v[100:103], a[16:19]
  v_mfma_f32_16x16x32_bf16 a[48:51], v[40:43], v[96:99], a[48:51]
  v_mfma_f32_16x16x32_bf16 a[48:51], v[44:47], v[100:103], a[48:51]
  buffer_load_dwordx4 v28, s[44:47], s67 offen offset:2048 sc1 lds
  v_mfma_f32_16x16x32_bf16 a[52:55], v[40:43], v[104:107], a[52:55]
  v_mfma_f32_16x16x32_bf16 a[52:55], v[44:47], v[108:111], a[52:55]
  v_mfma_f32_16x16x32_bf16 a[20:23], v[32:35], v[104:107], a[20:23]
  v_mfma_f32_16x16x32_bf16 a[20:23], v[36:39], v[108:111], a[20:23]
  v_mfma_f32_16x16x32_bf16 a[24:27], v[32:35], v[112:115], a[24:27]
  v_mfma_f32_16x16x32_bf16 a[24:27], v[36:39], v[116:119], a[24:27]
  v_mfma_f32_16x16x32_bf16 a[56:59], v[40:43], v[112:115], a[56:59]
  v_mfma_f32_16x16x32_bf16 a[56:59], v[44:47], v[116:119], a[56:59]
  buffer_load_dwordx4 v29, s[44:47], s67 offen offset:3072 sc1 lds
  v_mfma_f32_16x16x32_bf16 a[60:63], v[40:43], v[120:123], a[60:63]
  s_add_u32 s67, s67, 229376
  v_mfma_f32_16x16x32_bf16 a[60:63], v[44:47], v[124:127], a[60:63]
  v_mfma_f32_16x16x32_bf16 a[28:31], v[32:35], v[120:123], a[28:31]
  v_mfma_f32_16x16x32_bf16 a[28:31], v[36:39], v[124:127], a[28:31]
  s_waitcnt vmcnt(21) lgkmcnt(0)
  s_barrier
  v_mfma_f32_16x16x32_bf16 a[64:67], v[48:51], v[64:67], a[64:67]
  v_mfma_f32_16x16x32_bf16 a[64:67], v[52:55], v[68:71], a[64:67]
  buffer_store_dwordx4 v[156:159], v30, s[48:51], s99 offen offset:1024 sc1
  v_mfma_f32_16x16x32_bf16 a[96:99], v[56:59], v[64:67], a[96:99]
  s_add_u32 m0, s69, 81920
  v_mfma_f32_16x16x32_bf16 a[96:99], v[60:63], v[68:71], a[96:99]
  buffer_load_dwordx4 v18, s[36:39], s64 offen offset:0 sc1 lds
  v_mfma_f32_16x16x32_bf16 a[100:103], v[56:59], v[72:75], a[100:103]
  v_mfma_f32_16x16x32_bf16 a[100:103], v[60:63], v[76:79], a[100:103]
  v_mfma_f32_16x16x32_bf16 a[68:71], v[48:51], v[72:75], a[68:71]
  v_mfma_f32_16x16x32_bf16 a[68:71], v[52:55], v[76:79], a[68:71]
  v_mfma_f32_16x16x32_bf16 a[72:75], v[48:51], v[80:83], a[72:75]
  s_add_u32 s99, s99, 8192
  v_mfma_f32_16x16x32_bf16 a[72:75], v[52:55], v[84:87], a[72:75]
  v_mfma_f32_16x16x32_bf16 a[104:107], v[56:59], v[80:83], a[104:107]
  v_mfma_f32_16x16x32_bf16 a[104:107], v[60:63], v[84:87], a[104:107]
  buffer_load_dwordx4 v19, s[36:39], s64 offen offset:1024 sc1 lds
  v_mfma_f32_16x16x32_bf16 a[108:111], v[56:59], v[88:91], a[108:111]
  v_mfma_f32_16x16x32_bf16 a[108:111], v[60:63], v[92:95], a[108:111]
  s_lshl_b32 s90, s32, 5
  v_mfma_f32_16x16x32_bf16 a[76:79], v[48:51], v[88:91], a[76:79]
  v_mfma_f32_16x16x32_bf16 a[76:79], v[52:55], v[92:95], a[76:79]
  v_mfma_f32_16x16x32_bf16 a[80:83], v[48:51], v[96:99], a[80:83]
  v_mfma_f32_16x16x32_bf16 a[80:83], v[52:55], v[100:103], a[80:83]
  v_mfma_f32_16x16x32_bf16 a[112:115], v[56:59], v[96:99], a[112:115]
  s_add_u32 s90, s90, s33
  v_mfma_f32_16x16x32_bf16 a[112:115], v[60:63], v[100:103], a[112:115]
  buffer_load_dwordx4 v20, s[36:39], s64 offen offset:2048 sc1 lds
  v_mfma_f32_16x16x32_bf16 a[116:119], v[56:59], v[104:107], a[116:119]
  v_mfma_f32_16x16x32_bf16 a[116:119], v[60:63], v[108:111], a[116:119]
  v_mfma_f32_16x16x32_bf16 a[84:87], v[48:51], v[104:107], a[84:87]
  v_mfma_f32_16x16x32_bf16 a[84:87], v[52:55], v[108:111], a[84:87]
  v_mfma_f32_16x16x32_bf16 a[88:91], v[48:51], v[112:115], a[88:91]
  s_lshl_b32 s90, s90, 2
  v_mfma_f32_16x16x32_bf16 a[88:91], v[52:55], v[116:119], a[88:91]
  v_mfma_f32_16x16x32_bf16 a[120:123], v[56:59], v[112:115], a[120:123]
  v_mfma_f32_16x16x32_bf16 a[120:123], v[60:63], v[116:119], a[120:123]
  buffer_load_dwordx4 v21, s[36:39], s64 offen offset:3072 sc1 lds
  v_mfma_f32_16x16x32_bf16 a[124:127], v[56:59], v[120:123], a[124:127]
  s_add_u32 s64, s64, 128
  v_mfma_f32_16x16x32_bf16 a[124:127], v[60:63], v[124:127], a[124:127]
  s_waitcnt lgkmcnt(0)
  s_add_u32 s90, s90, 67117056
  v_mfma_f32_16x16x32_bf16 a[92:95], v[48:51], v[120:123], a[92:95]
  v_mfma_f32_16x16x32_bf16 a[92:95], v[52:55], v[124:127], a[92:95]
  v_mfma_f32_16x16x32_bf16 a[128:131], a[184:187], v[64:67], a[128:131]
  v_mfma_f32_16x16x32_bf16 a[128:131], a[188:191], v[68:71], a[128:131]
  v_mfma_f32_16x16x32_bf16 a[132:135], a[184:187], v[72:75], a[132:135]
  v_mfma_f32_16x16x32_bf16 a[132:135], a[188:191], v[76:79], a[132:135]
  v_mfma_f32_16x16x32_bf16 a[136:139], a[184:187], v[80:83], a[136:139]
  v_mfma_f32_16x16x32_bf16 a[136:139], a[188:191], v[84:87], a[136:139]
  v_mfma_f32_16x16x32_bf16 a[140:143], a[184:187], v[88:91], a[140:143]
  v_mfma_f32_16x16x32_bf16 a[140:143], a[188:191], v[92:95], a[140:143]
  v_mfma_f32_16x16x32_bf16 a[144:147], a[184:187], v[96:99], a[144:147]
  v_mfma_f32_16x16x32_bf16 a[144:147], a[188:191], v[100:103], a[144:147]
  v_mfma_f32_16x16x32_bf16 a[148:151], a[184:187], v[104:107], a[148:151]
  v_mfma_f32_16x16x32_bf16 a[148:151], a[188:191], v[108:111], a[148:151]
  v_mfma_f32_16x16x32_bf16 a[152:155], a[184:187], v[112:115], a[152:155]
  v_mfma_f32_16x16x32_bf16 a[152:155], a[188:191], v[116:119], a[152:155]
  v_mfma_f32_16x16x32_bf16 a[156:159], a[184:187], v[120:123], a[156:159]
  v_mfma_f32_16x16x32_bf16 a[156:159], a[188:191], v[124:127], a[156:159]
  s_add_u32 m0, s69, 98304
  s_nop 0
  buffer_load_dwordx4 v18, s[36:39], s65 offen offset:0 sc1 lds
  buffer_load_dwordx4 v19, s[36:39], s65 offen offset:1024 sc1 lds
  buffer_load_dwordx4 v20, s[36:39], s65 offen offset:2048 sc1 lds
  buffer_load_dwordx4 v21, s[36:39], s65 offen offset:3072 sc1 lds
  s_add_u32 s65, s65, 128
  buffer_store_dwordx4 v[164:167], v30, s[48:51], s99 offen offset:0 sc1
  s_waitcnt vmcnt(15) lgkmcnt(0)
  s_barrier
  ds_read_b64_tr_b16 v[32:33], v6 offset:0
  ds_read_b64_tr_b16 v[34:35], v6 offset:1024
  ds_read_b64_tr_b16 v[36:37], v6 offset:8192
  ds_read_b64_tr_b16 v[38:39], v6 offset:9216
  ds_read_b64_tr_b16 v[40:41], v7 offset:0
  ds_read_b64_tr_b16 v[42:43], v7 offset:1024
  ds_read_b128 v[64:67], v2 offset:16384
  ds_read_b128 v[68:71], v3 offset:16384
  s_add_u32 m0, s69, 65536
  s_nop 0
  ds_read_b64_tr_b16 v[44:45], v7 offset:8192
  ds_read_b64_tr_b16 v[46:47], v7 offset:9216
  buffer_load_dwordx4 v22, s[40:43], s66 offen offset:0 sc1 lds
  ds_read_b128 v[72:75], v2 offset:18432
  ds_read_b128 v[76:79], v3 offset:18432
  buffer_store_dwordx4 v[172:175], v30, s[48:51], s99 offen offset:1024 sc1
  s_add_u32 s99, s99, 8192
  ds_read_b128 v[80:83], v2 offset:20480
  ds_read_b128 v[84:87], v3 offset:20480
  buffer_load_dwordx4 v23, s[40:43], s66 offen offset:1024 sc1 lds
  buffer_store_dwordx4 v[180:183], v30, s[48:51], s99 offen offset:0 sc1
  ds_read_b128 v[88:91], v2 offset:22528
  ds_read_b128 v[92:95], v3 offset:22528
  ds_read_b128 v[96:99], v2 offset:32768
  ds_read_b128 v[100:103], v3 offset:32768
  buffer_load_dwordx4 v24, s[40:43], s66 offen offset:2048 sc1 lds
  ds_read_b128 v[104:107], v2 offset:34816
  ds_read_b128 v[108:111], v3 offset:34816
  ds_read_b128 v[112:115], v2 offset:36864
  ds_read_b128 v[116:119], v3 offset:36864
  buffer_load_dwordx4 v25, s[40:43], s66 offen offset:3072 sc1 lds
  s_add_u32 s66, s66, 524288
  s_waitcnt lgkmcnt(6)
  ds_read_b128 v[120:123], v2 offset:38912
  ds_read_b128 v[124:127], v3 offset:38912
  v_mfma_f32_16x16x32_bf16 a[0:3], v[32:35], v[64:67], a[0:3]
  ds_read_b64_tr_b16 v[48:49], v8 offset:0
  v_mfma_f32_16x16x32_bf16 a[0:3], v[36:39], v[68:71], a[0:3]
  v_mfma_f32_16x16x32_bf16 a[32:35], v[40:43], v[64:67], a[32:35]
  s_add_u32 m0, s69, 114688
  ds_read_b64_tr_b16 v[50:51], v8 offset:1024
  v_mfma_f32_16x16x32_bf16 a[32:35], v[44:47], v[68:71], a[32:35]
  buffer_load_dwordx4 v26, s[44:47], s67 offen offset:0 sc1 lds
  v_mfma_f32_16x16x32_bf16 a[36:39], v[40:43], v[72:75], a[36:39]
  ds_read_b64_tr_b16 v[52:53], v8 offset:8192
  v_mfma_f32_16x16x32_bf16 a[36:39], v[44:47], v[76:79], a[36:39]
  v_mfma_f32_16x16x32_bf16 a[4:7], v[32:35], v[72:75], a[4:7]
  ds_read_b64_tr_b16 v[54:55], v8 offset:9216
  v_mfma_f32_16x16x32_bf16 a[4:7], v[36:39], v[76:79], a[4:7]
  buffer_store_dwordx4 v[188:191], v30, s[48:51], s99 offen offset:1024 sc1
  v_mfma_f32_16x16x32_bf16 a[8:11], v[32:35], v[80:83], a[8:11]
  ds_read_b64_tr_b16 v[56:57], v9 offset:0
  v_mfma_f32_16x16x32_bf16 a[8:11], v[36:39], v[84:87], a[8:11]
  v_mfma_f32_16x16x32_bf16 a[40:43], v[40:43], v[80:83], a[40:43]
  ds_read_b64_tr_b16 v[58:59], v9 offset:1024
  v_mfma_f32_16x16x32_bf16 a[40:43], v[44:47], v[84:87], a[40:43]
  buffer_load_dwordx4 v27, s[44:47], s67 offen offset:1024 sc1 lds
  v_mfma_f32_16x16x32_bf16 a[44:47], v[40:43], v[88:91], a[44:47]
  ds_read_b64_tr_b16 v[60:61], v9 offset:8192
  v_mfma_f32_16x16x32_bf16 a[44:47], v[44:47], v[92:95], a[44:47]
  v_mfma_f32_16x16x32_bf16 a[12:15], v[32:35], v[88:91], a[12:15]
  ds_read_b64_tr_b16 v[62:63], v9 offset:9216
  v_mfma_f32_16x16x32_bf16 a[12:15], v[36:39], v[92:95], a[12:15]
  s_waitcnt lgkmcnt(8)
  v_mfma_f32_16x16x32_bf16 a[16:19], v[32:35], v[96:99], a[16:19]
  v_mfma_f32_16x16x32_bf16 a[16:19], v[36:39], v[100:103], a[16:19]
  v_mfma_f32_16x16x32_bf16 a[48:51], v[40:43], v[96:99], a[48:51]
  v_mfma_f32_16x16x32_bf16 a[48:51], v[44:47], v[100:103], a[48:51]
  buffer_load_dwordx4 v28, s[44:47], s67 offen offset:2048 sc1 lds
  v_mfma_f32_16x16x32_bf16 a[52:55], v[40:43], v[104:107], a[52:55]
  v_mfma_f32_16x16x32_bf16 a[52:55], v[44:47], v[108:111], a[52:55]
  v_mfma_f32_16x16x32_bf16 a[20:23], v[32:35], v[104:107], a[20:23]
  v_mfma_f32_16x16x32_bf16 a[20:23], v[36:39], v[108:111], a[20:23]
  s_sub_u32 s99, s99, 24576
  v_mfma_f32_16x16x32_bf16 a[24:27], v[32:35], v[112:115], a[24:27]
  v_mfma_f32_16x16x32_bf16 a[24:27], v[36:39], v[116:119], a[24:27]
  v_mfma_f32_16x16x32_bf16 a[56:59], v[40:43], v[112:115], a[56:59]
  v_mfma_f32_16x16x32_bf16 a[56:59], v[44:47], v[116:119], a[56:59]
  buffer_load_dwordx4 v29, s[44:47], s67 offen offset:3072 sc1 lds
  v_mfma_f32_16x16x32_bf16 a[60:63], v[40:43], v[120:123], a[60:63]
  s_add_u32 s67, s67, 229376
  v_mfma_f32_16x16x32_bf16 a[60:63], v[44:47], v[124:127], a[60:63]
  v_mfma_f32_16x16x32_bf16 a[28:31], v[32:35], v[120:123], a[28:31]
  v_mfma_f32_16x16x32_bf16 a[28:31], v[36:39], v[124:127], a[28:31]
  s_waitcnt vmcnt(21) lgkmcnt(0)
  s_barrier
  v_mfma_f32_16x16x32_bf16 a[64:67], v[48:51], v[64:67], a[64:67]
  v_mfma_f32_16x16x32_bf16 a[64:67], v[52:55], v[68:71], a[64:67]
  v_mfma_f32_16x16x32_bf16 a[96:99], v[56:59], v[64:67], a[96:99]
  s_add_u32 m0, s69, 16384
  v_mfma_f32_16x16x32_bf16 a[96:99], v[60:63], v[68:71], a[96:99]
  buffer_load_dwordx4 v18, s[36:39], s64 offen offset:0 sc1 lds
  v_mfma_f32_16x16x32_bf16 a[100:103], v[56:59], v[72:75], a[100:103]
  v_mfma_f32_16x16x32_bf16 a[100:103], v[60:63], v[76:79], a[100:103]
  v_mfma_f32_16x16x32_bf16 a[68:71], v[48:51], v[72:75], a[68:71]
  v_mfma_f32_16x16x32_bf16 a[68:71], v[52:55], v[76:79], a[68:71]
  v_mfma_f32_16x16x32_bf16 a[72:75], v[48:51], v[80:83], a[72:75]
  v_mfma_f32_16x16x32_bf16 a[72:75], v[52:55], v[84:87], a[72:75]
  v_mfma_f32_16x16x32_bf16 a[104:107], v[56:59], v[80:83], a[104:107]
  v_mfma_f32_16x16x32_bf16 a[104:107], v[60:63], v[84:87], a[104:107]
  buffer_load_dwordx4 v19, s[36:39], s64 offen offset:1024 sc1 lds
  v_mfma_f32_16x16x32_bf16 a[108:111], v[56:59], v[88:91], a[108:111]
  v_mfma_f32_16x16x32_bf16 a[108:111], v[60:63], v[92:95], a[108:111]
  v_mfma_f32_16x16x32_bf16 a[76:79], v[48:51], v[88:91], a[76:79]
  v_mfma_f32_16x16x32_bf16 a[76:79], v[52:55], v[92:95], a[76:79]
  v_mfma_f32_16x16x32_bf16 a[80:83], v[48:51], v[96:99], a[80:83]
  buffer_store_dwordx4 v[196:199], v30, s[48:51], s99 offen offset:2048 sc1
  v_mfma_f32_16x16x32_bf16 a[80:83], v[52:55], v[100:103], a[80:83]
  v_mfma_f32_16x16x32_bf16 a[112:115], v[56:59], v[96:99], a[112:115]
  v_mfma_f32_16x16x32_bf16 a[112:115], v[60:63], v[100:103], a[112:115]
  buffer_load_dwordx4 v20, s[36:39], s64 offen offset:2048 sc1 lds
  v_mfma_f32_16x16x32_bf16 a[116:119], v[56:59], v[104:107], a[116:119]
  v_mfma_f32_16x16x32_bf16 a[116:119], v[60:63], v[108:111], a[116:119]
  v_mfma_f32_16x16x32_bf16 a[84:87], v[48:51], v[104:107], a[84:87]
  v_mfma_f32_16x16x32_bf16 a[84:87], v[52:55], v[108:111], a[84:87]
  v_mfma_f32_16x16x32_bf16 a[88:91], v[48:51], v[112:115], a[88:91]
  v_mfma_f32_16x16x32_bf16 a[88:91], v[52:55], v[116:119], a[88:91]
  v_mfma_f32_16x16x32_bf16 a[120:123], v[56:59], v[112:115], a[120:123]
  v_mfma_f32_16x16x32_bf16 a[120:123], v[60:63], v[116:119], a[120:123]
  buffer_load_dwordx4 v21, s[36:39], s64 offen offset:3072 sc1 lds
  v_mfma_f32_16x16x32_bf16 a[124:127], v[56:59], v[120:123], a[124:127]
  s_add_u32 s64, s64, 128
  v_mfma_f32_16x16x32_bf16 a[124:127], v[60:63], v[124:127], a[124:127]
  s_waitcnt lgkmcnt(0)
  v_mfma_f32_16x16x32_bf16 a[92:95], v[48:51], v[120:123], a[92:95]
  v_mfma_f32_16x16x32_bf16 a[92:95], v[52:55], v[124:127], a[92:95]
  v_mfma_f32_16x16x32_bf16 a[128:131], a[192:195], v[64:67], a[128:131]
  v_mfma_f32_16x16x32_bf16 a[128:131], a[196:199], v[68:71], a[128:131]
  v_mfma_f32_16x16x32_bf16 a[132:135], a[192:195], v[72:75], a[132:135]
  v_mfma_f32_16x16x32_bf16 a[132:135], a[196:199], v[76:79], a[132:135]
  v_mfma_f32_16x16x32_bf16 a[136:139], a[192:195], v[80:83], a[136:139]
  v_mfma_f32_16x16x32_bf16 a[136:139], a[196:199], v[84:87], a[136:139]
  v_mfma_f32_16x16x32_bf16 a[140:143], a[192:195], v[88:91], a[140:143]
  v_mfma_f32_16x16x32_bf16 a[140:143], a[196:199], v[92:95], a[140:143]
  v_mfma_f32_16x16x32_bf16 a[144:147], a[192:195], v[96:99], a[144:147]
  v_mfma_f32_16x16x32_bf16 a[144:147], a[196:199], v[100:103], a[144:147]
  v_mfma_f32_16x16x32_bf16 a[148:151], a[192:195], v[104:107], a[148:151]
  v_mfma_f32_16x16x32_bf16 a[148:151], a[196:199], v[108:111], a[148:151]
  v_mfma_f32_16x16x32_bf16 a[152:155], a[192:195], v[112:115], a[152:155]
  v_mfma_f32_16x16x32_bf16 a[152:155], a[196:199], v[116:119], a[152:155]
  v_mfma_f32_16x16x32_bf16 a[156:159], a[192:195], v[120:123], a[156:159]
  v_mfma_f32_16x16x32_bf16 a[156:159], a[196:199], v[124:127], a[156:159]
  s_add_u32 m0, s69, 32768
  s_nop 0
  buffer_load_dwordx4 v18, s[36:39], s65 offen offset:0 sc1 lds
  buffer_load_dwordx4 v19, s[36:39], s65 offen offset:1024 sc1 lds
  buffer_load_dwordx4 v20, s[36:39], s65 offen offset:2048 sc1 lds
  buffer_store_dwordx4 v[204:207], v30, s[48:51], s99 offen offset:3072 sc1
  buffer_load_dwordx4 v21, s[36:39], s65 offen offset:3072 sc1 lds
  s_add_u32 s65, s65, 128
  s_add_u32 s99, s99, 8192
  s_waitcnt vmcnt(15) lgkmcnt(0)
  s_barrier
  ds_read_b64_tr_b16 v[32:33], v10 offset:0
  ds_read_b64_tr_b16 v[34:35], v10 offset:1024
  ds_read_b64_tr_b16 v[36:37], v10 offset:8192
  ds_read_b64_tr_b16 v[38:39], v10 offset:9216
  ds_read_b64_tr_b16 v[40:41], v11 offset:0
  ds_read_b64_tr_b16 v[42:43], v11 offset:1024
  ds_read_b128 v[64:67], v4 offset:16384
  ds_read_b128 v[68:71], v5 offset:16384
  s_add_u32 m0, s69, 0
  s_nop 0
  ds_read_b64_tr_b16 v[44:45], v11 offset:8192
  ds_read_b64_tr_b16 v[46:47], v11 offset:9216
  buffer_load_dwordx4 v22, s[40:43], s66 offen offset:0 sc1 lds
  ds_read_b128 v[72:75], v4 offset:18432
  ds_read_b128 v[76:79], v5 offset:18432
  buffer_store_dwordx4 v[212:215], v30, s[48:51], s99 offen offset:2048 sc1
  buffer_store_dwordx4 v[220:223], v30, s[48:51], s99 offen offset:3072 sc1
  ds_read_b128 v[80:83], v4 offset:20480
  ds_read_b128 v[84:87], v5 offset:20480
  buffer_load_dwordx4 v23, s[40:43], s66 offen offset:1024 sc1 lds
  s_add_u32 s99, s99, 8192
  ds_read_b128 v[88:91], v4 offset:22528
  ds_read_b128 v[92:95], v5 offset:22528
  ds_read_b128 v[96:99], v4 offset:32768
  ds_read_b128 v[100:103], v5 offset:32768
  buffer_load_dwordx4 v24, s[40:43], s66 offen offset:2048 sc1 lds
  ds_read_b128 v[104:107], v4 offset:34816
  ds_read_b128 v[108:111], v5 offset:34816
  ds_read_b128 v[112:115], v4 offset:36864
  ds_read_b128 v[116:119], v5 offset:36864
  buffer_load_dwordx4 v25, s[40:43], s66 offen offset:3072 sc1 lds
  s_add_u32 s66, s66, 524288
  s_waitcnt lgkmcnt(6)
  ds_read_b128 v[120:123], v4 offset:38912
  ds_read_b128 v[124:127], v5 offset:38912
  v_mfma_f32_16x16x32_bf16 a[0:3], v[32:35], v[64:67], a[0:3]
  ds_read_b64_tr_b16 v[48:49], v12 offset:0
  v_mfma_f32_16x16x32_bf16 a[0:3], v[36:39], v[68:71], a[0:3]
  v_mfma_f32_16x16x32_bf16 a[32:35], v[40:43], v[64:67], a[32:35]
  s_add_u32 m0, s69, 49152
  ds_read_b64_tr_b16 v[50:51], v12 offset:1024
  v_mfma_f32_16x16x32_bf16 a[32:35], v[44:47], v[68:71], a[32:35]
  buffer_load_dwordx4 v26, s[44:47], s67 offen offset:0 sc1 lds
  v_mfma_f32_16x16x32_bf16 a[36:39], v[40:43], v[72:75], a[36:39]
  ds_read_b64_tr_b16 v[52:53], v12 offset:8192
  v_mfma_f32_16x16x32_bf16 a[36:39], v[44:47], v[76:79], a[36:39]
  v_mfma_f32_16x16x32_bf16 a[4:7], v[32:35], v[72:75], a[4:7]
  ds_read_b64_tr_b16 v[54:55], v12 offset:9216
  v_mfma_f32_16x16x32_bf16 a[4:7], v[36:39], v[76:79], a[4:7]
  v_mfma_f32_16x16x32_bf16 a[8:11], v[32:35], v[80:83], a[8:11]
  ds_read_b64_tr_b16 v[56:57], v13 offset:0
  v_mfma_f32_16x16x32_bf16 a[8:11], v[36:39], v[84:87], a[8:11]
  v_mfma_f32_16x16x32_bf16 a[40:43], v[40:43], v[80:83], a[40:43]
  ds_read_b64_tr_b16 v[58:59], v13 offset:1024
  v_mfma_f32_16x16x32_bf16 a[40:43], v[44:47], v[84:87], a[40:43]
  buffer_load_dwordx4 v27, s[44:47], s67 offen offset:1024 sc1 lds
  v_mfma_f32_16x16x32_bf16 a[44:47], v[40:43], v[88:91], a[44:47]
  ds_read_b64_tr_b16 v[60:61], v13 offset:8192
  v_mfma_f32_16x16x32_bf16 a[44:47], v[44:47], v[92:95], a[44:47]
  v_mfma_f32_16x16x32_bf16 a[12:15], v[32:35], v[88:91], a[12:15]
  ds_read_b64_tr_b16 v[62:63], v13 offset:9216
  v_mfma_f32_16x16x32_bf16 a[12:15], v[36:39], v[92:95], a[12:15]
  s_waitcnt lgkmcnt(8)
  v_mfma_f32_16x16x32_bf16 a[16:19], v[32:35], v[96:99], a[16:19]
  buffer_store_dwordx4 v[228:231], v30, s[48:51], s99 offen offset:2048 sc1
  v_mfma_f32_16x16x32_bf16 a[16:19], v[36:39], v[100:103], a[16:19]
  v_mfma_f32_16x16x32_bf16 a[48:51], v[40:43], v[96:99], a[48:51]
  v_mfma_f32_16x16x32_bf16 a[48:51], v[44:47], v[100:103], a[48:51]
  buffer_load_dwordx4 v28, s[44:47], s67 offen offset:2048 sc1 lds
  v_mfma_f32_16x16x32_bf16 a[52:55], v[40:43], v[104:107], a[52:55]
  v_mfma_f32_16x16x32_bf16 a[52:55], v[44:47], v[108:111], a[52:55]
  v_mfma_f32_16x16x32_bf16 a[20:23], v[32:35], v[104:107], a[20:23]
  v_mfma_f32_16x16x32_bf16 a[20:23], v[36:39], v[108:111], a[20:23]
  v_mfma_f32_16x16x32_bf16 a[24:27], v[32:35], v[112:115], a[24:27]
  v_mfma_f32_16x16x32_bf16 a[24:27], v[36:39], v[116:119], a[24:27]
  v_mfma_f32_16x16x32_bf16 a[56:59], v[40:43], v[112:115], a[56:59]
  v_mfma_f32_16x16x32_bf16 a[56:59], v[44:47], v[116:119], a[56:59]
  buffer_load_dwordx4 v29, s[44:47], s67 offen offset:3072 sc1 lds
  v_mfma_f32_16x16x32_bf16 a[60:63], v[40:43], v[120:123], a[60:63]
  s_add_u32 s67, s67, 229376
  v_mfma_f32_16x16x32_bf16 a[60:63], v[44:47], v[124:127], a[60:63]
  v_mfma_f32_16x16x32_bf16 a[28:31], v[32:35], v[120:123], a[28:31]
  v_mfma_f32_16x16x32_bf16 a[28:31], v[36:39], v[124:127], a[28:31]
  s_waitcnt vmcnt(21) lgkmcnt(0)
  s_barrier
  v_mfma_f32_16x16x32_bf16 a[64:67], v[48:51], v[64:67], a[64:67]
  v_mfma_f32_16x16x32_bf16 a[64:67], v[52:55], v[68:71], a[64:67]
  v_mfma_f32_16x16x32_bf16 a[96:99], v[56:59], v[64:67], a[96:99]
  s_add_u32 m0, s69, 81920
  v_mfma_f32_16x16x32_bf16 a[96:99], v[60:63], v[68:71], a[96:99]
  buffer_load_dwordx4 v18, s[36:39], s64 offen offset:0 sc1 lds
  v_mfma_f32_16x16x32_bf16 a[100:103], v[56:59], v[72:75], a[100:103]
  v_mfma_f32_16x16x32_bf16 a[100:103], v[60:63], v[76:79], a[100:103]
  v_mfma_f32_16x16x32_bf16 a[68:71], v[48:51], v[72:75], a[68:71]
  v_mfma_f32_16x16x32_bf16 a[68:71], v[52:55], v[76:79], a[68:71]
  v_mfma_f32_16x16x32_bf16 a[72:75], v[48:51], v[80:83], a[72:75]
  buffer_store_dwordx4 v[236:239], v30, s[48:51], s99 offen offset:3072 sc1
  v_mfma_f32_16x16x32_bf16 a[72:75], v[52:55], v[84:87], a[72:75]
  v_mfma_f32_16x16x32_bf16 a[104:107], v[56:59], v[80:83], a[104:107]
  v_mfma_f32_16x16x32_bf16 a[104:107], v[60:63], v[84:87], a[104:107]
  buffer_load_dwordx4 v19, s[36:39], s64 offen offset:1024 sc1 lds
  v_mfma_f32_16x16x32_bf16 a[108:111], v[56:59], v[88:91], a[108:111]
  v_mfma_f32_16x16x32_bf16 a[108:111], v[60:63], v[92:95], a[108:111]
  v_mfma_f32_16x16x32_bf16 a[76:79], v[48:51], v[88:91], a[76:79]
  v_mfma_f32_16x16x32_bf16 a[76:79], v[52:55], v[92:95], a[76:79]
  v_mfma_f32_16x16x32_bf16 a[80:83], v[48:51], v[96:99], a[80:83]
  v_mfma_f32_16x16x32_bf16 a[80:83], v[52:55], v[100:103], a[80:83]
  v_mfma_f32_16x16x32_bf16 a[112:115], v[56:59], v[96:99], a[112:115]
  v_mfma_f32_16x16x32_bf16 a[112:115], v[60:63], v[100:103], a[112:115]
  buffer_load_dwordx4 v20, s[36:39], s64 offen offset:2048 sc1 lds
  v_mfma_f32_16x16x32_bf16 a[116:119], v[56:59], v[104:107], a[116:119]
  v_mfma_f32_16x16x32_bf16 a[116:119], v[60:63], v[108:111], a[116:119]
  v_mfma_f32_16x16x32_bf16 a[84:87], v[48:51], v[104:107], a[84:87]
  v_mfma_f32_16x16x32_bf16 a[84:87], v[52:55], v[108:111], a[84:87]
  v_mfma_f32_16x16x32_bf16 a[88:91], v[48:51], v[112:115], a[88:91]
  s_add_u32 s99, s99, 8192
  v_mfma_f32_16x16x32_bf16 a[88:91], v[52:55], v[116:119], a[88:91]
  v_mfma_f32_16x16x32_bf16 a[120:123], v[56:59], v[112:115], a[120:123]
  v_mfma_f32_16x16x32_bf16 a[120:123], v[60:63], v[116:119], a[120:123]
  buffer_load_dwordx4 v21, s[36:39], s64 offen offset:3072 sc1 lds
  v_mfma_f32_16x16x32_bf16 a[124:127], v[56:59], v[120:123], a[124:127]
  s_add_u32 s64, s64, 128
  v_mfma_f32_16x16x32_bf16 a[124:127], v[60:63], v[124:127], a[124:127]
  s_waitcnt lgkmcnt(0)
  v_mfma_f32_16x16x32_bf16 a[92:95], v[48:51], v[120:123], a[92:95]
  v_mfma_f32_16x16x32_bf16 a[92:95], v[52:55], v[124:127], a[92:95]
  v_mfma_f32_16x16x32_bf16 a[128:131], a[200:203], v[64:67], a[128:131]
  v_mfma_f32_16x16x32_bf16 a[128:131], a[204:207], v[68:71], a[128:131]
  v_mfma_f32_16x16x32_bf16 a[132:135], a[200:203], v[72:75], a[132:135]
  v_mfma_f32_16x16x32_bf16 a[132:135], a[204:207], v[76:79], a[132:135]
  v_mfma_f32_16x16x32_bf16 a[136:139], a[200:203], v[80:83], a[136:139]
  v_mfma_f32_16x16x32_bf16 a[136:139], a[204:207], v[84:87], a[136:139]
  v_mfma_f32_16x16x32_bf16 a[140:143], a[200:203], v[88:91], a[140:143]
  v_mfma_f32_16x16x32_bf16 a[140:143], a[204:207], v[92:95], a[140:143]
  v_mfma_f32_16x16x32_bf16 a[144:147], a[200:203], v[96:99], a[144:147]
  v_mfma_f32_16x16x32_bf16 a[144:147], a[204:207], v[100:103], a[144:147]
  v_mfma_f32_16x16x32_bf16 a[148:151], a[200:203], v[104:107], a[148:151]
  v_mfma_f32_16x16x32_bf16 a[148:151], a[204:207], v[108:111], a[148:151]
  v_mfma_f32_16x16x32_bf16 a[152:155], a[200:203], v[112:115], a[152:155]
  v_mfma_f32_16x16x32_bf16 a[152:155], a[204:207], v[116:119], a[152:155]
  v_mfma_f32_16x16x32_bf16 a[156:159], a[200:203], v[120:123], a[156:159]
  v_mfma_f32_16x16x32_bf16 a[156:159], a[204:207], v[124:127], a[156:159]
  s_add_u32 m0, s69, 98304
  s_nop 0
  buffer_load_dwordx4 v18, s[36:39], s65 offen offset:0 sc1 lds
  buffer_load_dwordx4 v19, s[36:39], s65 offen offset:1024 sc1 lds
  buffer_load_dwordx4 v20, s[36:39], s65 offen offset:2048 sc1 lds
  buffer_load_dwordx4 v21, s[36:39], s65 offen offset:3072 sc1 lds
  s_add_u32 s65, s65, 128
  buffer_store_dwordx4 v[244:247], v30, s[48:51], s99 offen offset:2048 sc1
  s_waitcnt vmcnt(15) lgkmcnt(0)
  s_barrier
  ds_read_b64_tr_b16 v[32:33], v6 offset:0
  ds_read_b64_tr_b16 v[34:35], v6 offset:1024
  ds_read_b64_tr_b16 v[36:37], v6 offset:8192
  ds_read_b64_tr_b16 v[38:39], v6 offset:9216
  ds_read_b64_tr_b16 v[40:41], v7 offset:0
  ds_read_b64_tr_b16 v[42:43], v7 offset:1024
  ds_read_b128 v[64:67], v2 offset:16384
  ds_read_b128 v[68:71], v3 offset:16384
  s_add_u32 m0, s69, 65536
  s_nop 0
  ds_read_b64_tr_b16 v[44:45], v7 offset:8192
  ds_read_b64_tr_b16 v[46:47], v7 offset:9216
  buffer_load_dwordx4 v22, s[40:43], s66 offen offset:0 sc1 lds
  ds_read_b128 v[72:75], v2 offset:18432
  ds_read_b128 v[76:79], v3 offset:18432
  buffer_store_dwordx4 v[252:255], v30, s[48:51], s99 offen offset:3072 sc1
  s_sub_u32 s99, s99, 24576
  ds_read_b128 v[80:83], v2 offset:20480
  ds_read_b128 v[84:87], v3 offset:20480
  buffer_load_dwordx4 v23, s[40:43], s66 offen offset:1024 sc1 lds
  ds_read_b128 v[88:91], v2 offset:22528
  ds_read_b128 v[92:95], v3 offset:22528
  ds_read_b128 v[96:99], v2 offset:32768
  ds_read_b128 v[100:103], v3 offset:32768
  buffer_load_dwordx4 v24, s[40:43], s66 offen offset:2048 sc1 lds
  ds_read_b128 v[104:107], v2 offset:34816
  ds_read_b128 v[108:111], v3 offset:34816
  ds_read_b128 v[112:115], v2 offset:36864
  ds_read_b128 v[116:119], v3 offset:36864
  buffer_load_dwordx4 v25, s[40:43], s66 offen offset:3072 sc1 lds
  s_add_u32 s66, s66, 524288
  s_waitcnt lgkmcnt(6)
  ds_read_b128 v[120:123], v2 offset:38912
  ds_read_b128 v[124:127], v3 offset:38912
  v_mfma_f32_16x16x32_bf16 a[0:3], v[32:35], v[64:67], a[0:3]
  ds_read_b64_tr_b16 v[48:49], v8 offset:0
  v_mfma_f32_16x16x32_bf16 a[0:3], v[36:39], v[68:71], a[0:3]
  v_mov_b32 v18, -1
  v_mfma_f32_16x16x32_bf16 a[32:35], v[40:43], v[64:67], a[32:35]
  s_add_u32 m0, s69, 114688
  ds_read_b64_tr_b16 v[50:51], v8 offset:1024
  v_mfma_f32_16x16x32_bf16 a[32:35], v[44:47], v[68:71], a[32:35]
  buffer_load_dwordx4 v26, s[44:47], s67 offen offset:0 sc1 lds
  v_mfma_f32_16x16x32_bf16 a[36:39], v[40:43], v[72:75], a[36:39]
  ds_read_b64_tr_b16 v[52:53], v8 offset:8192
  v_mov_b32 v19, -1
  v_mfma_f32_16x16x32_bf16 a[36:39], v[44:47], v[76:79], a[36:39]
  v_mfma_f32_16x16x32_bf16 a[4:7], v[32:35], v[72:75], a[4:7]
  ds_read_b64_tr_b16 v[54:55], v8 offset:9216
  v_mfma_f32_16x16x32_bf16 a[4:7], v[36:39], v[76:79], a[4:7]
  v_mov_b32 v20, -1
  v_mfma_f32_16x16x32_bf16 a[8:11], v[32:35], v[80:83], a[8:11]
  ds_read_b64_tr_b16 v[56:57], v9 offset:0
  v_mfma_f32_16x16x32_bf16 a[8:11], v[36:39], v[84:87], a[8:11]
  v_mov_b32 v21, -1
  v_mfma_f32_16x16x32_bf16 a[40:43], v[40:43], v[80:83], a[40:43]
  ds_read_b64_tr_b16 v[58:59], v9 offset:1024
  v_mfma_f32_16x16x32_bf16 a[40:43], v[44:47], v[84:87], a[40:43]
  buffer_load_dwordx4 v27, s[44:47], s67 offen offset:1024 sc1 lds
  v_mfma_f32_16x16x32_bf16 a[44:47], v[40:43], v[88:91], a[44:47]
  s_lshr_b32 s72, s32, 3
  ds_read_b64_tr_b16 v[60:61], v9 offset:8192
  v_mfma_f32_16x16x32_bf16 a[44:47], v[44:47], v[92:95], a[44:47]
  v_mfma_f32_16x16x32_bf16 a[12:15], v[32:35], v[88:91], a[12:15]
  ds_read_b64_tr_b16 v[62:63], v9 offset:9216
  v_mfma_f32_16x16x32_bf16 a[12:15], v[36:39], v[92:95], a[12:15]
  s_waitcnt lgkmcnt(8)
  s_xor_b32 s35, s72, 1
  v_mfma_f32_16x16x32_bf16 a[16:19], v[32:35], v[96:99], a[16:19]
  v_mfma_f32_16x16x32_bf16 a[16:19], v[36:39], v[100:103], a[16:19]
  v_mfma_f32_16x16x32_bf16 a[48:51], v[40:43], v[96:99], a[48:51]
  s_lshl_b32 s35, s35, 15
  v_mfma_f32_16x16x32_bf16 a[48:51], v[44:47], v[100:103], a[48:51]
  buffer_load_dwordx4 v28, s[44:47], s67 offen offset:2048 sc1 lds
  v_mfma_f32_16x16x32_bf16 a[52:55], v[40:43], v[104:107], a[52:55]
  v_mfma_f32_16x16x32_bf16 a[52:55], v[44:47], v[108:111], a[52:55]
  s_add_u32 s35, s35, s3
  v_mfma_f32_16x16x32_bf16 a[20:23], v[32:35], v[104:107], a[20:23]
  v_mfma_f32_16x16x32_bf16 a[20:23], v[36:39], v[108:111], a[20:23]
  s_add_u32 s35, s35, 8192
  v_mfma_f32_16x16x32_bf16 a[24:27], v[32:35], v[112:115], a[24:27]
  v_mfma_f32_16x16x32_bf16 a[24:27], v[36:39], v[116:119], a[24:27]
  v_mfma_f32_16x16x32_bf16 a[56:59], v[40:43], v[112:115], a[56:59]
  buffer_store_dwordx4 v[18:21], v30, s[48:51], s35 offen offset:0 sc1
  v_mfma_f32_16x16x32_bf16 a[56:59], v[44:47], v[116:119], a[56:59]
  buffer_load_dwordx4 v29, s[44:47], s67 offen offset:3072 sc1 lds
  v_mfma_f32_16x16x32_bf16 a[60:63], v[40:43], v[120:123], a[60:63]
  s_add_u32 s67, s67, 229376
  v_mfma_f32_16x16x32_bf16 a[60:63], v[44:47], v[124:127], a[60:63]
  buffer_store_dwordx4 v[18:21], v30, s[48:51], s35 offen offset:1024 sc1
  v_mfma_f32_16x16x32_bf16 a[28:31], v[32:35], v[120:123], a[28:31]
  v_mfma_f32_16x16x32_bf16 a[28:31], v[36:39], v[124:127], a[28:31]
  s_waitcnt vmcnt(9) lgkmcnt(0)
  s_barrier
  s_cmp_lg_u32 s34, 0
  s_cbranch_scc1 L_sig_kv_n
  s_mov_b64 exec, 1
  v_mov_b32 v0, s101
  buffer_store_dword v0, off, s[48:51], s90 sc1
  s_mov_b64 exec, -1
L_sig_kv_n:
  v_mfma_f32_16x16x32_bf16 a[64:67], v[48:51], v[64:67], a[64:67]
  s_xor_b32 s35, s72, 2
  v_mfma_f32_16x16x32_bf16 a[64:67], v[52:55], v[68:71], a[64:67]
  s_lshl_b32 s35, s35, 15
  v_mfma_f32_16x16x32_bf16 a[96:99], v[56:59], v[64:67], a[96:99]
  v_mfma_f32_16x16x32_bf16 a[96:99], v[60:63], v[68:71], a[96:99]
  s_add_u32 s35, s35, s3
  v_mfma_f32_16x16x32_bf16 a[100:103], v[56:59], v[72:75], a[100:103]
  s_add_u32 s35, s35, 16384
  v_mfma_f32_16x16x32_bf16 a[100:103], v[60:63], v[76:79], a[100:103]
  buffer_store_dwordx4 v[18:21], v30, s[48:51], s35 offen offset:0 sc1
  v_mfma_f32_16x16x32_bf16 a[68:71], v[48:51], v[72:75], a[68:71]
  buffer_store_dwordx4 v[18:21], v30, s[48:51], s35 offen offset:1024 sc1
  v_mfma_f32_16x16x32_bf16 a[68:71], v[52:55], v[76:79], a[68:71]
  v_mfma_f32_16x16x32_bf16 a[72:75], v[48:51], v[80:83], a[72:75]
  s_xor_b32 s35, s72, 3
  v_mfma_f32_16x16x32_bf16 a[72:75], v[52:55], v[84:87], a[72:75]
  s_lshl_b32 s35, s35, 15
  v_mfma_f32_16x16x32_bf16 a[104:107], v[56:59], v[80:83], a[104:107]
  s_add_u32 s35, s35, s3
  v_mfma_f32_16x16x32_bf16 a[104:107], v[60:63], v[84:87], a[104:107]
  s_add_u32 s35, s35, 24576
  v_mfma_f32_16x16x32_bf16 a[108:111], v[56:59], v[88:91], a[108:111]
  buffer_store_dwordx4 v[18:21], v30, s[48:51], s35 offen offset:0 sc1
  v_mfma_f32_16x16x32_bf16 a[108:111], v[60:63], v[92:95], a[108:111]
  v_mfma_f32_16x16x32_bf16 a[76:79], v[48:51], v[88:91], a[76:79]
  buffer_store_dwordx4 v[18:21], v30, s[48:51], s35 offen offset:1024 sc1
  v_mfma_f32_16x16x32_bf16 a[76:79], v[52:55], v[92:95], a[76:79]
  s_mov_b32 s40, s22
  v_mfma_f32_16x16x32_bf16 a[80:83], v[48:51], v[96:99], a[80:83]
  s_mov_b32 s41, s23
  v_mfma_f32_16x16x32_bf16 a[80:83], v[52:55], v[100:103], a[80:83]
  s_mov_b32 s42, 1835008
  v_mfma_f32_16x16x32_bf16 a[112:115], v[56:59], v[96:99], a[112:115]
  v_mfma_f32_16x16x32_bf16 a[112:115], v[60:63], v[100:103], a[112:115]
  s_mov_b32 s43, 0x20000
  v_mfma_f32_16x16x32_bf16 a[116:119], v[56:59], v[104:107], a[116:119]
  s_mov_b32 s44, s14
  v_mfma_f32_16x16x32_bf16 a[116:119], v[60:63], v[108:111], a[116:119]
  s_mov_b32 s45, s15
  v_mfma_f32_16x16x32_bf16 a[84:87], v[48:51], v[104:107], a[84:87]
  s_mov_b32 s46, 4194304
  v_mfma_f32_16x16x32_bf16 a[84:87], v[52:55], v[108:111], a[84:87]
  v_mfma_f32_16x16x32_bf16 a[88:91], v[48:51], v[112:115], a[88:91]
  s_mov_b32 s47, 0x20000
  v_mfma_f32_16x16x32_bf16 a[88:91], v[52:55], v[116:119], a[88:91]
  s_lshr_b32 s9, s32, 3
  v_mfma_f32_16x16x32_bf16 a[120:123], v[56:59], v[112:115], a[120:123]
  s_bfe_u32 s72, s32, 0x10002
  v_mfma_f32_16x16x32_bf16 a[120:123], v[60:63], v[116:119], a[120:123]
  s_sub_u32 s73, s17, s16
  v_mfma_f32_16x16x32_bf16 a[124:127], v[56:59], v[120:123], a[124:127]
  s_mul_i32 s73, s73, s72
  v_mfma_f32_16x16x32_bf16 a[124:127], v[60:63], v[124:127], a[124:127]
  s_waitcnt lgkmcnt(0)
  v_mfma_f32_16x16x32_bf16 a[92:95], v[48:51], v[120:123], a[92:95]
  s_add_u32 s0, s16, s73
  v_mfma_f32_16x16x32_bf16 a[92:95], v[52:55], v[124:127], a[92:95]
  s_and_b32 s21, s33, 6
  v_mfma_f32_16x16x32_bf16 a[128:131], a[208:211], v[64:67], a[128:131]
  v_mfma_f32_16x16x32_bf16 a[128:131], a[212:215], v[68:71], a[128:131]
  v_mfma_f32_16x16x32_bf16 a[132:135], a[208:211], v[72:75], a[132:135]
  v_mfma_f32_16x16x32_bf16 a[132:135], a[212:215], v[76:79], a[132:135]
  v_mfma_f32_16x16x32_bf16 a[136:139], a[208:211], v[80:83], a[136:139]
  v_mfma_f32_16x16x32_bf16 a[136:139], a[212:215], v[84:87], a[136:139]
  v_mfma_f32_16x16x32_bf16 a[140:143], a[208:211], v[88:91], a[140:143]
  v_mfma_f32_16x16x32_bf16 a[140:143], a[212:215], v[92:95], a[140:143]
  v_mfma_f32_16x16x32_bf16 a[144:147], a[208:211], v[96:99], a[144:147]
  v_mfma_f32_16x16x32_bf16 a[144:147], a[212:215], v[100:103], a[144:147]
  v_mfma_f32_16x16x32_bf16 a[148:151], a[208:211], v[104:107], a[148:151]
  v_mfma_f32_16x16x32_bf16 a[148:151], a[212:215], v[108:111], a[148:151]
  v_mfma_f32_16x16x32_bf16 a[152:155], a[208:211], v[112:115], a[152:155]
  v_mfma_f32_16x16x32_bf16 a[152:155], a[212:215], v[116:119], a[152:155]
  v_mfma_f32_16x16x32_bf16 a[156:159], a[208:211], v[120:123], a[156:159]
  v_mfma_f32_16x16x32_bf16 a[156:159], a[212:215], v[124:127], a[156:159]
  s_or_b32 s21, s21, s72
  s_and_b32 s73, s32, 3
  s_lshl_b32 s73, s73, 8
  s_lshl_b32 s72, s34, 14
  s_add_u32 s73, s73, s72
  s_mul_i32 s66, s9, 458752
  s_add_u32 s66, s66, s73
  s_lshl_b32 s10, s9, 20
  s_add_u32 s10, s10, s73
  s_and_b32 s73, s32, 7
  s_lshl_b32 s72, s73, 17
  s_add_u32 s10, s10, s72
  s_mov_b32 s67, s10
  s_lshl_b32 s4, s73, 13
  s_mov_b32 s72, 1
  s_lshl_b32 s8, s72, 17
  s_lshl_b32 s70, s72, 13
  s_lshl_b32 s73, s0, 2
  s_add_u32 s73, s73, s34
  s_mul_i32 s72, s73, 376832
  s_add_u32 s72, s72, 33554432
  s_mul_i32 s64, s9, 28672
  s_add_u32 s64, s64, s72
  s_lshl_b32 s1, s9, 16
  s_add_u32 s1, s1, s72
  s_add_u32 s1, s1, 114688
  s_lshl_b32 s11, s73, 7
  s_add_u32 s11, s11, 67174400
  s_add_u32 s65, s1, s4
  s_waitcnt vmcnt(10) lgkmcnt(0)
  s_barrier
  s_lshl_b32 s35, s32, 19
  s_add_u32 s56, s30, s35
  s_addc_u32 s57, s31, 0
  s_add_u32 s60, s56, 16777216
  s_addc_u32 s61, s57, 0
  ds_read_b64_tr_b16 v[32:33], v10 offset:0
  ds_read_b64_tr_b16 v[34:35], v10 offset:1024
  ds_read_b64_tr_b16 v[36:37], v10 offset:8192
  ds_read_b64_tr_b16 v[38:39], v10 offset:9216
  ds_read_b64_tr_b16 v[40:41], v11 offset:0
  ds_read_b64_tr_b16 v[42:43], v11 offset:1024
  ds_read_b128 v[64:67], v4 offset:16384
  s_add_u32 s35, s17, 1
  ds_read_b128 v[68:71], v5 offset:16384
  s_lshl_b32 s58, s35, 15
  ds_read_b64_tr_b16 v[44:45], v11 offset:8192
  ds_read_b64_tr_b16 v[46:47], v11 offset:9216
  s_mov_b32 s62, s58
  s_mov_b32 s59, 0x20000
  ds_read_b128 v[72:75], v4 offset:18432
  s_mov_b32 s63, 0x20000
  ds_read_b128 v[76:79], v5 offset:18432
  v_mbcnt_lo_u32_b32 v25, -1, 0
  v_mbcnt_hi_u32_b32 v25, -1, v25
  v_and_b32 v26, 7, v25
  v_lshlrev_b32 v26, 2, v26
  s_lshl_b32 s74, s32, 7
  ds_read_b128 v[80:83], v4 offset:20480
  s_add_u32 s74, s74, 67117056
  ds_read_b128 v[84:87], v5 offset:20480
  v_lshl_add_u32 v19, v25, 4, s69
  s_mov_b32 s82, 0
  s_mov_b32 s81, 0x10000
  s_lshl_b32 s79, s16, 1
  s_lshl_b32 s80, s17, 1
  ds_read_b128 v[88:91], v4 offset:22528
  s_mov_b32 s85, 0x4e800000
  ds_read_b128 v[92:95], v5 offset:22528
  s_add_u32 s78, s79, 2
  s_lshl_b32 s78, s78, 14
  s_lshl_b32 s92, s33, 5
  s_add_u32 s92, s92, s32
  s_lshl_b32 s92, s92, 2
  s_add_u32 s92, s92, 67121152
  ds_read_b128 v[96:99], v4 offset:32768
  s_sub_u32 s68, s34, 1
  ds_read_b128 v[100:103], v5 offset:32768
  s_and_b32 s68, s68, 0x80000000
  s_or_b32 s68, s68, 0x7f800000
  s_sub_u32 s99, s34, 2
  s_and_b32 s99, s99, 0x80000000
  s_or_b32 s99, s99, 0x7f800000
  s_sub_u32 s20, s34, 3
  s_and_b32 s20, s20, 0x80000000
  ds_read_b128 v[104:107], v4 offset:34816
  s_or_b32 s20, s20, 0x7f800000
  ds_read_b128 v[108:111], v5 offset:34816
  v_lshlrev_b32 v18, 4, v25
  v_lshlrev_b32 v22, 4, v25
  v_and_b32 v0, 15, v25
  v_lshrrev_b32 v1, 4, v25
  v_lshlrev_b32 v1, 2, v1
  v_sub_u32 v20, v0, v1
  v_mov_b32 v21, 0xff800000
  ds_read_b128 v[112:115], v4 offset:36864
  s_lshl_b32 s35, s76, 15
  ds_read_b128 v[116:119], v5 offset:36864
  s_lshl_b32 s72, s77, 12
  s_add_u32 s35, s35, s72
  s_add_u32 s35, s35, 0x10000
  v_add_u32 v23, s35, v18
  s_lshl_b32 s35, s76, 15
  v_add_u32 v24, s35, v23
  s_waitcnt lgkmcnt(6)
  ds_read_b128 v[120:123], v4 offset:38912
  ds_read_b128 v[124:127], v5 offset:38912
  buffer_load_dword v28, v26, s[48:51], s74 offen sc1
  v_mfma_f32_16x16x32_bf16 a[0:3], v[32:35], v[64:67], a[0:3]
  s_lshl_b32 s35, s77, 13
  ds_read_b64_tr_b16 v[48:49], v12 offset:0
  v_mfma_f32_16x16x32_bf16 a[0:3], v[36:39], v[68:71], a[0:3]
  s_lshl_b32 s72, s76, 10
  v_mfma_f32_16x16x32_bf16 a[32:35], v[40:43], v[64:67], a[32:35]
  s_add_u32 s35, s35, s72
  ds_read_b64_tr_b16 v[50:51], v12 offset:1024
  v_mfma_f32_16x16x32_bf16 a[32:35], v[44:47], v[68:71], a[32:35]
  s_add_u32 s18, s35, 0x10000
  s_sub_u32 s19, 91136, s35
  v_mfma_f32_16x16x32_bf16 a[36:39], v[40:43], v[72:75], a[36:39]
  ds_read_b64_tr_b16 v[52:53], v12 offset:8192
  v_and_b32 v27, 3, v25
  v_mfma_f32_16x16x32_bf16 a[36:39], v[44:47], v[76:79], a[36:39]
  v_subrev_u32 v27, 1, v27
  v_ashrrev_i32 v27, 31, v27
  v_mfma_f32_16x16x32_bf16 a[4:7], v[32:35], v[72:75], a[4:7]
  ds_read_b64_tr_b16 v[54:55], v12 offset:9216
  v_and_b32 v27, 0x3f803f80, v27
  v_mfma_f32_16x16x32_bf16 a[4:7], v[36:39], v[76:79], a[4:7]
  s_mov_b32 s35, 0x7fffffff
  v_subrev_u32 v29, 0, v20
  v_bfi_b32 v29, s35, v21, v29
  v_mfma_f32_16x16x32_bf16 a[8:11], v[32:35], v[80:83], a[8:11]
  ds_read_b64_tr_b16 v[56:57], v13 offset:0
  v_subrev_u32 v30, 1, v20
  v_mfma_f32_16x16x32_bf16 a[8:11], v[36:39], v[84:87], a[8:11]
  v_accvgpr_read_b32 v2, a0
  v_accvgpr_read_b32 v0, a1
  v_mfma_f32_16x16x32_bf16 a[40:43], v[40:43], v[80:83], a[40:43]
  ds_read_b64_tr_b16 v[58:59], v13 offset:1024
  v_accvgpr_read_b32 v3, a2
  v_mfma_f32_16x16x32_bf16 a[40:43], v[44:47], v[84:87], a[40:43]
  v_accvgpr_read_b32 v1, a3
  v_cvt_pk_bf16_f32 v2, v2, v0
  v_mfma_f32_16x16x32_bf16 a[44:47], v[40:43], v[88:91], a[44:47]
  ds_read_b64_tr_b16 v[60:61], v13 offset:8192
  v_cvt_pk_bf16_f32 v3, v3, v1
  v_mfma_f32_16x16x32_bf16 a[44:47], v[44:47], v[92:95], a[44:47]
  v_accvgpr_read_b32 v4, a32
  v_accvgpr_read_b32 v0, a33
  v_mfma_f32_16x16x32_bf16 a[12:15], v[32:35], v[88:91], a[12:15]
  ds_read_b64_tr_b16 v[62:63], v13 offset:9216
  v_accvgpr_read_b32 v5, a34
  v_mfma_f32_16x16x32_bf16 a[12:15], v[36:39], v[92:95], a[12:15]
  s_waitcnt lgkmcnt(8)
  v_accvgpr_read_b32 v1, a35
  v_bfi_b32 v30, s35, v21, v30
  v_mfma_f32_16x16x32_bf16 a[16:19], v[32:35], v[96:99], a[16:19]
  v_cvt_pk_bf16_f32 v4, v4, v0
  v_cvt_pk_bf16_f32 v5, v5, v1
  v_mfma_f32_16x16x32_bf16 a[16:19], v[36:39], v[100:103], a[16:19]
  v_accvgpr_read_b32 v6, a4
  v_accvgpr_read_b32 v0, a5
  v_mfma_f32_16x16x32_bf16 a[48:51], v[40:43], v[96:99], a[48:51]
  v_accvgpr_read_b32 v7, a6
  v_subrev_u32 v31, 2, v20
  v_mfma_f32_16x16x32_bf16 a[48:51], v[44:47], v[100:103], a[48:51]
  v_accvgpr_read_b32 v1, a7
  v_cvt_pk_bf16_f32 v6, v6, v0
  v_mfma_f32_16x16x32_bf16 a[52:55], v[40:43], v[104:107], a[52:55]
  v_cvt_pk_bf16_f32 v7, v7, v1
  v_accvgpr_read_b32 v8, a36
  v_mfma_f32_16x16x32_bf16 a[52:55], v[44:47], v[108:111], a[52:55]
  v_accvgpr_read_b32 v0, a37
  v_accvgpr_read_b32 v9, a38
  v_mfma_f32_16x16x32_bf16 a[20:23], v[32:35], v[104:107], a[20:23]
  v_accvgpr_read_b32 v1, a39
  v_bfi_b32 v31, s35, v21, v31
  v_mfma_f32_16x16x32_bf16 a[20:23], v[36:39], v[108:111], a[20:23]
  v_cvt_pk_bf16_f32 v8, v8, v0
  v_cvt_pk_bf16_f32 v9, v9, v1
  v_mfma_f32_16x16x32_bf16 a[24:27], v[32:35], v[112:115], a[24:27]
  v_accvgpr_read_b32 v10, a8
  v_accvgpr_read_b32 v0, a9
  v_mfma_f32_16x16x32_bf16 a[24:27], v[36:39], v[116:119], a[24:27]
  v_accvgpr_read_b32 v11, a10
  v_subrev_u32 v14, 3, v20
  v_mfma_f32_16x16x32_bf16 a[56:59], v[40:43], v[112:115], a[56:59]
  v_accvgpr_read_b32 v1, a11
  v_cvt_pk_bf16_f32 v10, v10, v0
  v_mfma_f32_16x16x32_bf16 a[56:59], v[44:47], v[116:119], a[56:59]
  v_cvt_pk_bf16_f32 v11, v11, v1
  v_accvgpr_read_b32 v12, a40
  v_mfma_f32_16x16x32_bf16 a[60:63], v[40:43], v[120:123], a[60:63]
  v_accvgpr_read_b32 v0, a41
  v_accvgpr_read_b32 v13, a42
  v_mfma_f32_16x16x32_bf16 a[60:63], v[44:47], v[124:127], a[60:63]
  v_accvgpr_read_b32 v1, a43
  v_bfi_b32 v14, s35, v21, v14
  v_mfma_f32_16x16x32_bf16 a[28:31], v[32:35], v[120:123], a[28:31]
  v_cvt_pk_bf16_f32 v12, v12, v0
  v_cvt_pk_bf16_f32 v13, v13, v1
  v_mfma_f32_16x16x32_bf16 a[28:31], v[36:39], v[124:127], a[28:31]
  s_waitcnt vmcnt(6) lgkmcnt(0)
  s_barrier
  v_mfma_f32_16x16x32_bf16 a[64:67], v[48:51], v[64:67], a[64:67]
  v_mfma_f32_16x16x32_bf16 a[64:67], v[52:55], v[68:71], a[64:67]
  ds_write_b128 v23, v[2:5] offset:0
  v_mfma_f32_16x16x32_bf16 a[96:99], v[56:59], v[64:67], a[96:99]
  v_mfma_f32_16x16x32_bf16 a[96:99], v[60:63], v[68:71], a[96:99]
  v_accvgpr_read_b32 v2, a12
  v_accvgpr_read_b32 v0, a13
  v_mfma_f32_16x16x32_bf16 a[100:103], v[56:59], v[72:75], a[100:103]
  v_accvgpr_read_b32 v3, a14
  v_accvgpr_read_b32 v1, a15
  v_mfma_f32_16x16x32_bf16 a[100:103], v[60:63], v[76:79], a[100:103]
  ds_write_b128 v23, v[6:9] offset:1024
  v_cvt_pk_bf16_f32 v2, v2, v0
  v_cvt_pk_bf16_f32 v3, v3, v1
  v_mfma_f32_16x16x32_bf16 a[68:71], v[48:51], v[72:75], a[68:71]
  v_accvgpr_read_b32 v4, a44
  v_accvgpr_read_b32 v0, a45
  v_mfma_f32_16x16x32_bf16 a[68:71], v[52:55], v[76:79], a[68:71]
  v_accvgpr_read_b32 v5, a46
  v_accvgpr_read_b32 v1, a47
  v_mfma_f32_16x16x32_bf16 a[72:75], v[48:51], v[80:83], a[72:75]
  v_cvt_pk_bf16_f32 v4, v4, v0
  v_cvt_pk_bf16_f32 v5, v5, v1
  v_mfma_f32_16x16x32_bf16 a[72:75], v[52:55], v[84:87], a[72:75]
  ds_write_b128 v23, v[10:13] offset:8192
  ds_write_b128 v23, v[2:5] offset:9216
  v_mfma_f32_16x16x32_bf16 a[104:107], v[56:59], v[80:83], a[104:107]
  v_accvgpr_read_b32 v6, a16
  v_accvgpr_read_b32 v0, a17
  v_mfma_f32_16x16x32_bf16 a[104:107], v[60:63], v[84:87], a[104:107]
  v_accvgpr_read_b32 v7, a18
  v_accvgpr_read_b32 v1, a19
  v_mfma_f32_16x16x32_bf16 a[108:111], v[56:59], v[88:91], a[108:111]
  v_cvt_pk_bf16_f32 v6, v6, v0
  v_cvt_pk_bf16_f32 v7, v7, v1
  v_mfma_f32_16x16x32_bf16 a[108:111], v[60:63], v[92:95], a[108:111]
  v_accvgpr_read_b32 v8, a48
  v_accvgpr_read_b32 v0, a49
  v_mfma_f32_16x16x32_bf16 a[76:79], v[48:51], v[88:91], a[76:79]
  v_accvgpr_read_b32 v9, a50
  v_accvgpr_read_b32 v1, a51
  v_mfma_f32_16x16x32_bf16 a[76:79], v[52:55], v[92:95], a[76:79]
  v_cvt_pk_bf16_f32 v8, v8, v0
  v_cvt_pk_bf16_f32 v9, v9, v1
  v_mfma_f32_16x16x32_bf16 a[80:83], v[48:51], v[96:99], a[80:83]
  ds_write_b128 v24, v[6:9] offset:16384
  v_accvgpr_read_b32 v10, a20
  v_mfma_f32_16x16x32_bf16 a[80:83], v[52:55], v[100:103], a[80:83]
  v_accvgpr_read_b32 v0, a21
  v_accvgpr_read_b32 v11, a22
  v_mfma_f32_16x16x32_bf16 a[112:115], v[56:59], v[96:99], a[112:115]
  v_accvgpr_read_b32 v1, a23
  v_cvt_pk_bf16_f32 v10, v10, v0
  v_mfma_f32_16x16x32_bf16 a[112:115], v[60:63], v[100:103], a[112:115]
  v_cvt_pk_bf16_f32 v11, v11, v1
  v_accvgpr_read_b32 v12, a52
  v_mfma_f32_16x16x32_bf16 a[116:119], v[56:59], v[104:107], a[116:119]
  v_accvgpr_read_b32 v0, a53
  v_accvgpr_read_b32 v13, a54
  v_mfma_f32_16x16x32_bf16 a[116:119], v[60:63], v[108:111], a[116:119]
  v_accvgpr_read_b32 v1, a55
  v_cvt_pk_bf16_f32 v12, v12, v0
  v_cvt_pk_bf16_f32 v13, v13, v1
  v_mfma_f32_16x16x32_bf16 a[84:87], v[48:51], v[104:107], a[84:87]
  ds_write_b128 v24, v[10:13] offset:17408
  v_mfma_f32_16x16x32_bf16 a[84:87], v[52:55], v[108:111], a[84:87]
  v_accvgpr_read_b32 v2, a24
  v_accvgpr_read_b32 v0, a25
  v_mfma_f32_16x16x32_bf16 a[88:91], v[48:51], v[112:115], a[88:91]
  v_accvgpr_read_b32 v3, a26
  v_accvgpr_read_b32 v1, a27
  v_mfma_f32_16x16x32_bf16 a[88:91], v[52:55], v[116:119], a[88:91]
  v_cvt_pk_bf16_f32 v2, v2, v0
  v_cvt_pk_bf16_f32 v3, v3, v1
  v_mfma_f32_16x16x32_bf16 a[120:123], v[56:59], v[112:115], a[120:123]
  v_accvgpr_read_b32 v4, a56
  v_accvgpr_read_b32 v0, a57
  v_mfma_f32_16x16x32_bf16 a[120:123], v[60:63], v[116:119], a[120:123]
  v_accvgpr_read_b32 v5, a58
  v_accvgpr_read_b32 v1, a59
  v_mfma_f32_16x16x32_bf16 a[124:127], v[56:59], v[120:123], a[124:127]
  v_cvt_pk_bf16_f32 v4, v4, v0
  v_cvt_pk_bf16_f32 v5, v5, v1
  v_mfma_f32_16x16x32_bf16 a[124:127], v[60:63], v[124:127], a[124:127]
  s_waitcnt vmcnt(0)
  s_waitcnt lgkmcnt(0)
  ds_write_b128 v24, v[2:5] offset:24576
  v_accvgpr_read_b32 v6, a28
  v_cmp_ne_u32 vcc, s101, v28
  v_mfma_f32_16x16x32_bf16 a[92:95], v[48:51], v[120:123], a[92:95]
  v_accvgpr_read_b32 v0, a29
  v_accvgpr_read_b32 v7, a30
  v_mfma_f32_16x16x32_bf16 a[92:95], v[52:55], v[124:127], a[92:95]
  s_cbranch_vccnz L_spin_kvn
L_spin_kvn_r:
  v_mfma_f32_16x16x32_bf16 a[128:131], a[216:219], v[64:67], a[128:131]
  v_mfma_f32_16x16x32_bf16 a[128:131], a[220:223], v[68:71], a[128:131]
  v_mfma_f32_16x16x32_bf16 a[132:135], a[216:219], v[72:75], a[132:135]
  v_mfma_f32_16x16x32_bf16 a[132:135], a[220:223], v[76:79], a[132:135]
  v_mfma_f32_16x16x32_bf16 a[136:139], a[216:219], v[80:83], a[136:139]
  v_mfma_f32_16x16x32_bf16 a[136:139], a[220:223], v[84:87], a[136:139]
  v_mfma_f32_16x16x32_bf16 a[140:143], a[216:219], v[88:91], a[140:143]
  v_mfma_f32_16x16x32_bf16 a[140:143], a[220:223], v[92:95], a[140:143]
  v_mfma_f32_16x16x32_bf16 a[144:147], a[216:219], v[96:99], a[144:147]
  v_mfma_f32_16x16x32_bf16 a[144:147], a[220:223], v[100:103], a[144:147]
  v_mfma_f32_16x16x32_bf16 a[148:151], a[216:219], v[104:107], a[148:151]
  v_mfma_f32_16x16x32_bf16 a[148:151], a[220:223], v[108:111], a[148:151]
  v_mfma_f32_16x16x32_bf16 a[152:155], a[216:219], v[112:115], a[152:155]
  v_mfma_f32_16x16x32_bf16 a[152:155], a[220:223], v[116:119], a[152:155]
  v_mfma_f32_16x16x32_bf16 a[156:159], a[216:219], v[120:123], a[156:159]
  v_mfma_f32_16x16x32_bf16 a[156:159], a[220:223], v[124:127], a[156:159]
  s_nop 7
  v_accvgpr_read_b32 v1, a31
  v_cvt_pk_bf16_f32 v6, v6, v0
  v_cvt_pk_bf16_f32 v7, v7, v1
  v_accvgpr_read_b32 v8, a60
  s_add_u32 m0, s69, 0x20000
  s_nop 0
  v_accvgpr_read_b32 v0, a61
  v_accvgpr_read_b32 v9, a62
  v_accvgpr_read_b32 v1, a63
  v_cvt_pk_bf16_f32 v8, v8, v0
  s_nop 0
  v_cvt_pk_bf16_f32 v9, v9, v1
  ds_write_b128 v24, v[6:9] offset:25600
  v_accvgpr_read_b32 v10, a64
  v_accvgpr_read_b32 v0, a65
  buffer_load_dwordx4 v19, s[56:59], 0 offen offset:0 sc1 lds
  v_accvgpr_read_b32 v11, a66
  v_accvgpr_read_b32 v1, a67
  v_cvt_pk_bf16_f32 v10, v10, v0
  v_cvt_pk_bf16_f32 v11, v11, v1
  v_accvgpr_read_b32 v12, a96
  buffer_load_dwordx4 v19, s[56:59], 0 offen offset:1024 sc1 lds
  v_accvgpr_read_b32 v0, a97
  v_accvgpr_read_b32 v13, a98
  v_accvgpr_read_b32 v1, a99
  v_cvt_pk_bf16_f32 v12, v12, v0
  buffer_load_dwordx4 v19, s[56:59], 0 offen offset:2048 sc1 lds
  v_cvt_pk_bf16_f32 v13, v13, v1
  ds_write_b128 v23, v[10:13] offset:2048
  v_accvgpr_read_b32 v2, a68
  v_accvgpr_read_b32 v0, a69
  buffer_load_dwordx4 v19, s[56:59], 0 offen offset:3072 sc1 lds
  v_accvgpr_read_b32 v3, a70
  v_accvgpr_read_b32 v1, a71
  v_cvt_pk_bf16_f32 v2, v2, v0
  v_cvt_pk_bf16_f32 v3, v3, v1
  v_accvgpr_read_b32 v4, a100
  s_add_u32 m0, s69, 16384
  s_nop 0
  v_accvgpr_read_b32 v0, a101
  v_accvgpr_read_b32 v5, a102
  v_accvgpr_read_b32 v1, a103
  v_cvt_pk_bf16_f32 v4, v4, v0
  s_nop 0
  v_cvt_pk_bf16_f32 v5, v5, v1
  ds_write_b128 v23, v[2:5] offset:3072
  v_accvgpr_read_b32 v6, a72
  v_accvgpr_read_b32 v0, a73
  buffer_load_dwordx4 v19, s[60:63], 0 offen offset:0 sc1 lds
  v_accvgpr_read_b32 v7, a74
  v_accvgpr_read_b32 v1, a75
  v_cvt_pk_bf16_f32 v6, v6, v0
  v_cvt_pk_bf16_f32 v7, v7, v1
  v_accvgpr_read_b32 v8, a104
  buffer_load_dwordx4 v19, s[60:63], 0 offen offset:1024 sc1 lds
  v_accvgpr_read_b32 v0, a105
  v_accvgpr_read_b32 v9, a106
  v_accvgpr_read_b32 v1, a107
  v_cvt_pk_bf16_f32 v8, v8, v0
  buffer_load_dwordx4 v19, s[60:63], 0 offen offset:2048 sc1 lds
  v_cvt_pk_bf16_f32 v9, v9, v1
  ds_write_b128 v23, v[6:9] offset:10240
  v_accvgpr_read_b32 v10, a76
  v_accvgpr_read_b32 v0, a77
  buffer_load_dwordx4 v19, s[60:63], 0 offen offset:3072 sc1 lds
  v_accvgpr_read_b32 v11, a78
  s_waitcnt lgkmcnt(0)
  v_accvgpr_read_b32 v1, a79
  v_cvt_pk_bf16_f32 v10, v10, v0
  v_cvt_pk_bf16_f32 v11, v11, v1
  v_accvgpr_read_b32 v12, a108
  v_accvgpr_read_b32 v0, a109
  v_accvgpr_read_b32 v13, a110
  v_accvgpr_read_b32 v1, a111
  s_xor_b32 m0, m0, 0x4000
  v_cvt_pk_bf16_f32 v12, v12, v0
  v_cvt_pk_bf16_f32 v13, v13, v1
  ds_write_b128 v23, v[10:13] offset:11264
  v_accvgpr_read_b32 v2, a80
  v_accvgpr_read_b32 v0, a81
  v_accvgpr_read_b32 v3, a82
  v_accvgpr_read_b32 v1, a83
  v_cvt_pk_bf16_f32 v2, v2, v0
  s_add_u32 s82, s82, 16384
  v_cvt_pk_bf16_f32 v3, v3, v1
  v_accvgpr_read_b32 v4, a112
  v_accvgpr_read_b32 v0, a113
  v_accvgpr_read_b32 v5, a114
  v_accvgpr_read_b32 v1, a115
  v_cvt_pk_bf16_f32 v4, v4, v0
  v_cvt_pk_bf16_f32 v5, v5, v1
  ds_write_b128 v24, v[2:5] offset:18432
  v_add_u32 v19, 0x4000, v19
  v_accvgpr_read_b32 v6, a84
  v_accvgpr_read_b32 v0, a85
  v_accvgpr_read_b32 v7, a86
  v_accvgpr_read_b32 v1, a87
  v_cvt_pk_bf16_f32 v6, v6, v0
  v_cvt_pk_bf16_f32 v7, v7, v1
  v_accvgpr_read_b32 v8, a116
  buffer_load_dwordx4 v19, s[56:59], 0 offen offset:0 sc1 lds
  v_accvgpr_read_b32 v0, a117
  v_accvgpr_read_b32 v9, a118
  v_accvgpr_read_b32 v1, a119
  v_cvt_pk_bf16_f32 v8, v8, v0
  v_cvt_pk_bf16_f32 v9, v9, v1
  ds_write_b128 v24, v[6:9] offset:19456
  v_accvgpr_read_b32 v10, a88
  v_accvgpr_read_b32 v0, a89
  buffer_load_dwordx4 v19, s[56:59], 0 offen offset:1024 sc1 lds
  v_accvgpr_read_b32 v11, a90
  v_accvgpr_read_b32 v1, a91
  v_cvt_pk_bf16_f32 v10, v10, v0
  v_cvt_pk_bf16_f32 v11, v11, v1
  v_accvgpr_read_b32 v12, a120
  v_accvgpr_read_b32 v0, a121
  v_accvgpr_read_b32 v13, a122
  v_accvgpr_read_b32 v1, a123
  buffer_load_dwordx4 v19, s[56:59], 0 offen offset:2048 sc1 lds
  v_cvt_pk_bf16_f32 v12, v12, v0
  v_cvt_pk_bf16_f32 v13, v13, v1
  ds_write_b128 v24, v[10:13] offset:26624
  v_accvgpr_read_b32 v2, a92
  v_accvgpr_read_b32 v0, a93
  v_accvgpr_read_b32 v3, a94
  v_accvgpr_read_b32 v1, a95
  buffer_load_dwordx4 v19, s[56:59], 0 offen offset:3072 sc1 lds
  v_cvt_pk_bf16_f32 v2, v2, v0
  v_cvt_pk_bf16_f32 v3, v3, v1
  v_accvgpr_read_b32 v4, a124
  v_accvgpr_read_b32 v0, a125
  v_accvgpr_read_b32 v5, a126
  v_accvgpr_read_b32 v1, a127
  v_cvt_pk_bf16_f32 v4, v4, v0
  v_cvt_pk_bf16_f32 v5, v5, v1
  ds_write_b128 v24, v[2:5] offset:27648
  v_add_u32 v36, s18, v18
  v_add_u32 v37, s19, v18
  v_add_u32 v34, 0x20000, v18
  v_add_u32 v38, 0x10000, v37
  s_nop 1
  s_waitcnt vmcnt(8) lgkmcnt(0)
  s_barrier
  ds_read_b128 a[64:67], v34 offset:0
  ds_read_b128 a[72:75], v34 offset:2048
  ds_read_b128 a[80:83], v34 offset:4096
  ds_read_b128 a[88:91], v34 offset:6144
  ds_read_b128 a[0:3], v36 offset:0
  ds_read_b128 a[8:11], v36 offset:2048
  ds_read_b128 a[16:19], v36 offset:4096
  ds_read_b128 a[24:27], v36 offset:6144
  s_sub_u32 s35, s17, s16
  s_mul_i32 s35, s35, s76
  s_add_u32 s35, s35, s16
  s_lshl_b32 s35, s35, 9
  s_add_u32 s35, s35, 67174400
  s_mov_b32 s72, 0xbfb8aa3b
  v_and_b32 v2, 15, v25
  v_lshlrev_b32 v2, 2, v2
  v_accvgpr_read_b32 v4, a128
  ds_read_b128 a[4:7], v37 offset:0
  ds_read_b128 a[12:15], v37 offset:2048
  ds_read_b128 a[20:23], v37 offset:4096
  ds_read_b128 a[28:31], v37 offset:6144
  ds_read_b128 a[32:35], v36 offset:32768
  ds_read_b128 a[40:43], v36 offset:34816
  ds_read_b128 a[48:51], v36 offset:36864
  ds_read_b128 a[56:59], v36 offset:38912
  v_accvgpr_read_b32 v5, a132
  v_accvgpr_read_b32 v6, a136
  v_accvgpr_read_b32 v7, a140
  v_accvgpr_read_b32 v8, a144
  v_accvgpr_read_b32 v9, a148
  v_accvgpr_read_b32 v10, a152
  v_accvgpr_read_b32 v11, a156
  v_mul_f32 v4, s72, v4
  v_mul_f32 v5, s72, v5
  v_mul_f32 v6, s72, v6
  ds_read_b128 a[36:39], v38 offset:0
  ds_read_b128 a[44:47], v38 offset:2048
  ds_read_b128 a[52:55], v38 offset:4096
  ds_read_b128 a[60:63], v38 offset:6144
  ds_read_b128 a[68:71], v34 offset:1024
  ds_read_b128 a[76:79], v34 offset:3072
  ds_read_b128 a[84:87], v34 offset:5120
  ds_read_b128 a[92:95], v34 offset:7168
  v_mul_f32 v7, s72, v7
  v_mul_f32 v8, s72, v8
  v_mul_f32 v9, s72, v9
  v_mul_f32 v10, s72, v10
  v_mul_f32 v11, s72, v11
  v_exp_f32 v4, v4
  v_exp_f32 v5, v5
  v_exp_f32 v6, v6
  v_exp_f32 v7, v7
  v_exp_f32 v8, v8
  v_exp_f32 v9, v9
  v_exp_f32 v10, v10
  v_exp_f32 v11, v11
  v_add_f32 v4, 1.0, v4
  v_add_f32 v5, 1.0, v5
  v_add_f32 v6, 1.0, v6
  v_add_f32 v7, 1.0, v7
  v_add_f32 v8, 1.0, v8
  v_add_f32 v9, 1.0, v9
  v_add_f32 v10, 1.0, v10
  v_add_f32 v11, 1.0, v11
  v_rcp_f32 v4, v4
  v_rcp_f32 v5, v5
  v_rcp_f32 v6, v6
  v_rcp_f32 v7, v7
  v_rcp_f32 v8, v8
  v_rcp_f32 v9, v9
  v_rcp_f32 v10, v10
  v_rcp_f32 v11, v11
  buffer_store_dword v4, v2, s[48:51], s35 offen offset:0 sc1
  buffer_store_dword v5, v2, s[48:51], s35 offen offset:64 sc1
  buffer_store_dword v6, v2, s[48:51], s35 offen offset:128 sc1
  buffer_store_dword v7, v2, s[48:51], s35 offen offset:192 sc1
  buffer_store_dword v8, v2, s[48:51], s35 offen offset:256 sc1
  buffer_store_dword v9, v2, s[48:51], s35 offen offset:320 sc1
  buffer_store_dword v10, v2, s[48:51], s35 offen offset:384 sc1
  buffer_store_dword v11, v2, s[48:51], s35 offen offset:448 sc1
  v_mov_b64 v[128:129], 0
  v_mov_b64 v[130:131], 0
  v_mov_b64 v[132:133], 0
  v_mov_b64 v[134:135], 0
  v_mov_b64 v[44:45], 0
  v_mov_b64 v[46:47], 0
  s_cmp_eq_u32 s79, 0
  s_cbranch_scc1 L_pf0n
L_pf0n_r:
  s_waitcnt lgkmcnt(0)
  v_mfma_f32_16x16x32_bf16 v[64:67], a[64:67], a[0:3], v[128:131]
  s_waitcnt vmcnt(8)
  s_barrier
  v_mfma_f32_16x16x32_bf16 v[64:67], a[72:75], a[8:11], v[64:67]
  s_xor_b32 s81, s81, 0x18000
  v_mfma_f32_16x16x32_bf16 v[64:67], a[80:83], a[16:19], v[64:67]
  s_xor_b32 m0, m0, s81
  ds_read_b128 a[96:99], v18 offset:16384
  v_mfma_f32_16x16x32_bf16 v[64:67], a[88:91], a[24:27], v[64:67]
  s_xor_b32 m0, m0, 0x4000
  v_mfma_f32_16x16x32_bf16 v[72:75], a[88:91], a[28:31], 0
  buffer_load_dwordx4 v19, s[60:63], 0 offen offset:0 sc1 lds
  ds_read_b128 a[100:103], v18 offset:17408
  v_mfma_f32_16x16x32_bf16 v[72:75], a[80:83], a[20:23], v[72:75]
  v_mfma_f32_16x16x32_bf16 v[72:75], a[72:75], a[12:15], v[72:75]
  ds_read_b128 a[104:107], v18 offset:18432
  v_mfma_f32_16x16x32_bf16 v[72:75], a[64:67], a[4:7], v[72:75]
  buffer_load_dwordx4 v19, s[60:63], 0 offen offset:1024 sc1 lds
  v_mfma_f32_16x16x32_bf16 v[96:99], a[64:67], a[32:35], 0
  ds_read_b128 a[108:111], v18 offset:19456
  v_mfma_f32_16x16x32_bf16 v[96:99], a[72:75], a[40:43], v[96:99]
  v_mfma_f32_16x16x32_bf16 v[96:99], a[80:83], a[48:51], v[96:99]
  buffer_load_dwordx4 v19, s[60:63], 0 offen offset:2048 sc1 lds
  ds_read_b128 a[112:115], v18 offset:20480
  v_mfma_f32_16x16x32_bf16 v[96:99], a[88:91], a[56:59], v[96:99]
  v_mfma_f32_16x16x32_bf16 v[104:107], a[88:91], a[60:63], 0
  ds_read_b128 a[116:119], v18 offset:21504
  v_mfma_f32_16x16x32_bf16 v[104:107], a[80:83], a[52:55], v[104:107]
  buffer_load_dwordx4 v19, s[60:63], 0 offen offset:3072 sc1 lds
  v_mfma_f32_16x16x32_bf16 v[104:107], a[72:75], a[44:47], v[104:107]
  ds_read_b128 a[120:123], v18 offset:22528
  v_mfma_f32_16x16x32_bf16 v[104:107], a[64:67], a[36:39], v[104:107]
  s_xor_b32 m0, m0, 0x4000
  v_add_u32 v19, 0x4000, v19
  v_mfma_f32_16x16x32_bf16 v[108:111], a[68:71], a[36:39], 0
  s_add_u32 s82, s82, 16384
  v_mfma_f32_16x16x32_bf16 v[108:111], a[76:79], a[44:47], v[108:111]
  ds_read_b128 a[64:67], v34 offset:8192
  v_mfma_f32_16x16x32_bf16 v[108:111], a[84:87], a[52:55], v[108:111]
  buffer_load_dwordx4 v19, s[56:59], 0 offen offset:0 sc1 lds
  v_mfma_f32_16x16x32_bf16 v[108:111], a[92:95], a[60:63], v[108:111]
  v_mfma_f32_16x16x32_bf16 v[100:103], a[92:95], a[56:59], 0
  ds_read_b128 a[72:75], v34 offset:10240
  v_mfma_f32_16x16x32_bf16 v[100:103], a[84:87], a[48:51], v[100:103]
  buffer_load_dwordx4 v19, s[56:59], 0 offen offset:1024 sc1 lds
  v_mfma_f32_16x16x32_bf16 v[100:103], a[76:79], a[40:43], v[100:103]
  v_mfma_f32_16x16x32_bf16 v[100:103], a[68:71], a[32:35], v[100:103]
  ds_read_b128 a[80:83], v34 offset:12288
  v_mfma_f32_16x16x32_bf16 v[76:79], a[68:71], a[4:7], 0
  buffer_load_dwordx4 v19, s[56:59], 0 offen offset:2048 sc1 lds
  v_mfma_f32_16x16x32_bf16 v[76:79], a[76:79], a[12:15], v[76:79]
  v_mfma_f32_16x16x32_bf16 v[76:79], a[84:87], a[20:23], v[76:79]
  ds_read_b128 a[88:91], v34 offset:14336
  v_mfma_f32_16x16x32_bf16 v[76:79], a[92:95], a[28:31], v[76:79]
  buffer_load_dwordx4 v19, s[56:59], 0 offen offset:3072 sc1 lds
  v_mfma_f32_16x16x32_bf16 v[68:71], a[92:95], a[24:27], v[132:135]
  v_mfma_f32_16x16x32_bf16 v[68:71], a[84:87], a[16:19], v[68:71]
  v_mfma_f32_16x16x32_bf16 v[68:71], a[76:79], a[8:11], v[68:71]
  v_mfma_f32_16x16x32_bf16 v[68:71], a[68:71], a[0:3], v[68:71]
  ds_read_b128 a[68:71], v34 offset:9216
  ds_read_b128 a[76:79], v34 offset:11264
  ds_read_b128 a[84:87], v34 offset:13312
  ds_read_b128 a[92:95], v34 offset:15360
  s_nop 3
  v_mfma_f32_32x32x16_bf16 a[128:143], v[44:47], v[44:47], 0
  s_xor_b32 s81, s81, 0x18000
  v_max3_f32 v36, v64, v65, v66
  v_max3_f32 v38, v72, v73, v74
  v_max3_f32 v40, v96, v97, v98
  v_max3_f32 v42, v104, v105, v106
  v_max3_f32 v36, v36, v67, v68
  v_max3_f32 v38, v38, v75, v76
  v_mfma_f32_32x32x16_bf16 a[144:159], v[44:47], v[44:47], 0
  s_xor_b32 m0, m0, s81
  v_max3_f32 v40, v40, v99, v100
  v_max3_f32 v42, v42, v107, v108
  v_max3_f32 v36, v36, v69, v70
  v_max3_f32 v38, v38, v77, v78
  v_max3_f32 v40, v40, v101, v102
  v_max3_f32 v42, v42, v109, v110
  v_mfma_f32_32x32x16_bf16 a[160:175], v[44:47], v[44:47], 0
  s_xor_b32 m0, m0, 0x4000
  v_max_f32 v36, v36, v71
  v_max_f32 v38, v38, v79
  v_max_f32 v40, v40, v103
  v_max_f32 v42, v42, v111
  v_mov_b32 v37, v36
  v_mov_b32 v39, v38
  v_mfma_f32_32x32x16_bf16 a[176:191], v[44:47], v[44:47], 0
  v_mov_b32 v41, v40
  v_mov_b32 v43, v42
  v_permlane32_swap_b32 v36, v37
  v_permlane32_swap_b32 v38, v39
  v_permlane32_swap_b32 v40, v41
  v_permlane32_swap_b32 v42, v43
  v_mfma_f32_32x32x16_bf16 a[192:207], v[44:47], v[44:47], 0
  v_max_f32 v36, v36, v37
  v_max_f32 v38, v38, v39
  v_max_f32 v40, v40, v41
  v_max_f32 v42, v42, v43
  v_mov_b32 v37, v36
  v_mov_b32 v39, v38
  v_mov_b32 v41, v40
  v_mov_b32 v43, v42
  v_permlane16_swap_b32 v36, v37
  v_permlane16_swap_b32 v38, v39
  v_permlane16_swap_b32 v40, v41
  v_permlane16_swap_b32 v42, v43
  v_max_f32 v36, v36, v37
  v_max_f32 v38, v38, v39
  v_max_f32 v40, v40, v41
  v_max_f32 v42, v42, v43
  v_mov_b32 v37, v36
  v_mov_b32 v39, v38
  v_mov_b32 v41, v40
  v_mov_b32 v43, v42
  v_mov_b32 v232, v27
  v_mov_b32 v233, v27
  v_mov_b32 v234, v27
  v_mov_b32 v235, v27
  buffer_load_dwordx4 v19, s[60:63], 0 offen offset:0 sc1 lds
  v_pk_add_f32 v[128:129], v[128:129], v[36:37] neg_lo:[0,1] neg_hi:[0,1]
  v_pk_add_f32 v[130:131], v[130:131], v[36:37] neg_lo:[0,1] neg_hi:[0,1]
  v_pk_add_f32 v[132:133], v[132:133], v[36:37] neg_lo:[0,1] neg_hi:[0,1]
  v_pk_add_f32 v[134:135], v[134:135], v[36:37] neg_lo:[0,1] neg_hi:[0,1]
  v_pk_add_f32 v[144:145], 0, v[40:41] neg_lo:[0,1] neg_hi:[0,1]
  v_pk_add_f32 v[146:147], 0, v[40:41] neg_lo:[0,1] neg_hi:[0,1]
  v_pk_add_f32 v[148:149], 0, v[40:41] neg_lo:[0,1] neg_hi:[0,1]
  v_pk_add_f32 v[150:151], 0, v[40:41] neg_lo:[0,1] neg_hi:[0,1]
  v_pk_add_f32 v[64:65], v[64:65], v[36:37] neg_lo:[0,1] neg_hi:[0,1]
  v_pk_add_f32 v[66:67], v[66:67], v[36:37] neg_lo:[0,1] neg_hi:[0,1]
  v_pk_add_f32 v[68:69], v[68:69], v[36:37] neg_lo:[0,1] neg_hi:[0,1]
  v_pk_add_f32 v[70:71], v[70:71], v[36:37] neg_lo:[0,1] neg_hi:[0,1]
  v_pk_add_f32 v[96:97], v[96:97], v[40:41] neg_lo:[0,1] neg_hi:[0,1]
  v_pk_add_f32 v[98:99], v[98:99], v[40:41] neg_lo:[0,1] neg_hi:[0,1]
  v_pk_add_f32 v[100:101], v[100:101], v[40:41] neg_lo:[0,1] neg_hi:[0,1]
  v_pk_add_f32 v[102:103], v[102:103], v[40:41] neg_lo:[0,1] neg_hi:[0,1]
  buffer_load_dwordx4 v19, s[60:63], 0 offen offset:1024 sc1 lds
  v_pk_add_f32 v[136:137], 0, v[38:39] neg_lo:[0,1] neg_hi:[0,1]
  v_pk_add_f32 v[138:139], 0, v[38:39] neg_lo:[0,1] neg_hi:[0,1]
  v_pk_add_f32 v[140:141], 0, v[38:39] neg_lo:[0,1] neg_hi:[0,1]
  v_pk_add_f32 v[142:143], 0, v[38:39] neg_lo:[0,1] neg_hi:[0,1]
  v_pk_add_f32 v[152:153], 0, v[42:43] neg_lo:[0,1] neg_hi:[0,1]
  v_pk_add_f32 v[154:155], 0, v[42:43] neg_lo:[0,1] neg_hi:[0,1]
  v_pk_add_f32 v[156:157], 0, v[42:43] neg_lo:[0,1] neg_hi:[0,1]
  v_pk_add_f32 v[158:159], 0, v[42:43] neg_lo:[0,1] neg_hi:[0,1]
  v_pk_add_f32 v[72:73], v[72:73], v[38:39] neg_lo:[0,1] neg_hi:[0,1]
  v_pk_add_f32 v[74:75], v[74:75], v[38:39] neg_lo:[0,1] neg_hi:[0,1]
  v_pk_add_f32 v[76:77], v[76:77], v[38:39] neg_lo:[0,1] neg_hi:[0,1]
  v_pk_add_f32 v[78:79], v[78:79], v[38:39] neg_lo:[0,1] neg_hi:[0,1]
  v_pk_add_f32 v[104:105], v[104:105], v[42:43] neg_lo:[0,1] neg_hi:[0,1]
  v_pk_add_f32 v[106:107], v[106:107], v[42:43] neg_lo:[0,1] neg_hi:[0,1]
  v_pk_add_f32 v[108:109], v[108:109], v[42:43] neg_lo:[0,1] neg_hi:[0,1]
  v_pk_add_f32 v[110:111], v[110:111], v[42:43] neg_lo:[0,1] neg_hi:[0,1]
  s_cmp_eq_u32 s79, 0
  s_cbranch_scc1 L_pf1n
L_pf1n_r:
  s_waitcnt lgkmcnt(0)
  v_mfma_f32_16x16x32_bf16 v[80:83], a[64:67], a[0:3], v[128:131]
  v_exp_f32 v192, v64
  v_mfma_f32_16x16x32_bf16 v[80:83], a[72:75], a[8:11], v[80:83]
  buffer_load_dwordx4 v19, s[60:63], 0 offen offset:2048 sc1 lds
  v_exp_f32 v193, v65
  v_mfma_f32_16x16x32_bf16 v[80:83], a[80:83], a[16:19], v[80:83]
  v_exp_f32 v194, v66
  v_mfma_f32_16x16x32_bf16 v[80:83], a[88:91], a[24:27], v[80:83]
  v_cvt_pk_bf16_f32 v160, v192, v193
  v_exp_f32 v195, v67
  v_mfma_f32_16x16x32_bf16 v[88:91], a[88:91], a[28:31], v[136:139]
  buffer_load_dwordx4 v19, s[60:63], 0 offen offset:3072 sc1 lds
  v_exp_f32 v196, v68
  v_mfma_f32_16x16x32_bf16 v[88:91], a[80:83], a[20:23], v[88:91]
  s_xor_b32 m0, m0, 0x4000
  v_cvt_pk_bf16_f32 v161, v194, v195
  v_add_u32 v19, 0x4000, v19
  v_mfma_f32_16x16x32_bf16 v[88:91], a[72:75], a[12:15], v[88:91]
  s_add_u32 s82, s82, 16384
  v_exp_f32 v197, v69
  v_mfma_f32_16x16x32_bf16 v[88:91], a[64:67], a[4:7], v[88:91]
  v_exp_f32 v198, v70
  v_mfma_f32_16x16x32_bf16 v[112:115], a[64:67], a[32:35], v[144:147]
  buffer_load_dwordx4 v19, s[56:59], 0 offen offset:0 sc1 lds
  v_exp_f32 v199, v71
  v_mfma_f32_16x16x32_bf16 v[112:115], a[72:75], a[40:43], v[112:115]
  v_cvt_pk_bf16_f32 v162, v196, v197
  v_cvt_pk_bf16_f32 v163, v198, v199
  v_mfma_f32_16x16x32_bf16 v[112:115], a[80:83], a[48:51], v[112:115]
  v_exp_f32 v192, v72
  v_mfma_f32_16x16x32_bf16 v[200:203], v[232:235], v[160:163], 0
  buffer_load_dwordx4 v19, s[56:59], 0 offen offset:1024 sc1 lds
  v_exp_f32 v193, v73
  v_mfma_f32_16x16x32_bf16 v[112:115], a[88:91], a[56:59], v[112:115]
  v_exp_f32 v194, v74
  v_mfma_f32_16x16x32_bf16 v[120:123], a[88:91], a[60:63], v[152:155]
  v_cvt_pk_bf16_f32 v164, v192, v193
  v_exp_f32 v195, v75
  v_mfma_f32_16x16x32_bf16 v[120:123], a[80:83], a[52:55], v[120:123]
  v_exp_f32 v196, v76
  v_mfma_f32_16x16x32_bf16 v[120:123], a[72:75], a[44:47], v[120:123]
  buffer_load_dwordx4 v19, s[56:59], 0 offen offset:2048 sc1 lds
  v_cvt_pk_bf16_f32 v165, v194, v195
  v_mfma_f32_16x16x32_bf16 v[120:123], a[64:67], a[36:39], v[120:123]
  v_exp_f32 v197, v77
  v_mfma_f32_16x16x32_bf16 v[124:127], a[68:71], a[36:39], v[156:159]
  v_exp_f32 v198, v78
  v_mfma_f32_16x16x32_bf16 v[124:127], a[76:79], a[44:47], v[124:127]
  v_exp_f32 v199, v79
  v_mfma_f32_16x16x32_bf16 v[124:127], a[84:87], a[52:55], v[124:127]
  buffer_load_dwordx4 v19, s[56:59], 0 offen offset:3072 sc1 lds
  v_cvt_pk_bf16_f32 v166, v196, v197
  v_cvt_pk_bf16_f32 v167, v198, v199
  v_mfma_f32_16x16x32_bf16 v[124:127], a[92:95], a[60:63], v[124:127]
  s_xor_b32 s81, s81, 0x18000
  s_xor_b32 m0, m0, s81
  v_exp_f32 v192, v96
  v_mfma_f32_16x16x32_bf16 v[208:211], v[232:235], v[164:167], 0
  s_xor_b32 m0, m0, 0x4000
  v_exp_f32 v193, v97
  v_mfma_f32_16x16x32_bf16 v[116:119], a[92:95], a[56:59], v[148:151]
  buffer_load_dwordx4 v19, s[60:63], 0 offen offset:0 sc1 lds
  ds_read_b128 a[64:67], v18 offset:0
  v_mfma_f32_16x16x32_bf16 v[116:119], a[84:87], a[48:51], v[116:119]
  v_exp_f32 v194, v98
  v_mfma_f32_16x16x32_bf16 v[116:119], a[76:79], a[40:43], v[116:119]
  v_cvt_pk_bf16_f32 v176, v192, v193
  v_exp_f32 v195, v99
  v_mfma_f32_16x16x32_bf16 v[116:119], a[68:71], a[32:35], v[116:119]
  v_exp_f32 v196, v100
  v_mfma_f32_16x16x32_bf16 v[92:95], a[68:71], a[4:7], v[140:143]
  buffer_load_dwordx4 v19, s[60:63], 0 offen offset:1024 sc1 lds
  v_cvt_pk_bf16_f32 v177, v194, v195
  v_exp_f32 v197, v101
  v_mfma_f32_16x16x32_bf16 v[92:95], a[76:79], a[12:15], v[92:95]
  v_exp_f32 v198, v102
  v_mfma_f32_16x16x32_bf16 v[92:95], a[84:87], a[20:23], v[92:95]
  v_exp_f32 v199, v103
  v_mfma_f32_16x16x32_bf16 v[92:95], a[92:95], a[28:31], v[92:95]
  buffer_load_dwordx4 v19, s[60:63], 0 offen offset:2048 sc1 lds
  v_cvt_pk_bf16_f32 v178, v196, v197
  v_cvt_pk_bf16_f32 v179, v198, v199
  v_mfma_f32_16x16x32_bf16 v[84:87], a[92:95], a[24:27], v[132:135]
  ds_read_b128 a[72:75], v18 offset:2048
  ds_read_b128 a[80:83], v18 offset:4096
  v_mfma_f32_16x16x32_bf16 v[216:219], v[232:235], v[176:179], 0
  v_exp_f32 v192, v104
  v_mfma_f32_16x16x32_bf16 v[84:87], a[84:87], a[16:19], v[84:87]
  v_exp_f32 v193, v105
  v_mfma_f32_16x16x32_bf16 v[84:87], a[76:79], a[8:11], v[84:87]
  buffer_load_dwordx4 v19, s[60:63], 0 offen offset:3072 sc1 lds
  ds_read_b128 a[88:91], v18 offset:6144
  v_mfma_f32_16x16x32_bf16 v[84:87], a[68:71], a[0:3], v[84:87]
  ds_read_b128 a[68:71], v18 offset:1024
  v_mfma_f32_32x32x16_bf16 a[208:223], v[44:47], v[44:47], 0
  ds_read_b128 a[76:79], v18 offset:3072
  v_exp_f32 v194, v106
  v_cvt_pk_bf16_f32 v180, v192, v193
  v_exp_f32 v195, v107
  v_mfma_f32_32x32x16_bf16 a[224:239], v[44:47], v[44:47], 0
  ds_read_b128 a[84:87], v18 offset:5120
  v_exp_f32 v196, v108
  v_cvt_pk_bf16_f32 v181, v194, v195
  v_exp_f32 v197, v109
  v_mfma_f32_32x32x16_bf16 a[240:255], v[44:47], v[44:47], 0
  v_exp_f32 v198, v110
  v_exp_f32 v199, v111
  v_cvt_pk_bf16_f32 v182, v196, v197
  v_cvt_pk_bf16_f32 v183, v198, v199
  s_nop 1
  v_mfma_f32_16x16x32_bf16 v[224:227], v[232:235], v[180:183], 0
  ds_read_b128 a[92:95], v18 offset:7168
  s_waitcnt lgkmcnt(4)
  s_branch L_p2_done
L_tagl:
  v_mbcnt_lo_u32_b32 v0, -1, 0
  v_mbcnt_hi_u32_b32 v0, -1, v0
  v_lshlrev_b32 v1, 4, v0
  s_mov_b32 s35, 67108864
  s_mov_b32 s72, 67121152
  s_mov_b32 s73, 67117056
  buffer_load_dwordx4 a[4:7], v1, s[48:51], s72 offen sc1
  v_lshrrev_b32 v1, 1, v0
  v_lshlrev_b32 v1, 7, v1
  v_and_b32 v0, 1, v0
  v_lshl_add_u32 v1, v0, 4, v1
  buffer_load_dwordx4 a[8:11], v1, s[48:51], s35 offen sc1
  buffer_load_dwordx4 a[12:15], v1, s[48:51], s73 offen sc1
  s_branch L_tagl_r
L_tagp:
  s_mov_b32 s72, 0
L_tagp_l:
  s_add_u32 s72, s72, 1
  s_mov_b64 s[92:93], 0
  v_accvgpr_read_b32 v0, a4
  v_cmp_eq_u32 vcc, s72, v0
  s_or_b64 s[92:93], s[92:93], vcc
  v_accvgpr_read_b32 v0, a5
  v_cmp_eq_u32 vcc, s72, v0
  s_or_b64 s[92:93], s[92:93], vcc
  v_accvgpr_read_b32 v0, a6
  v_cmp_eq_u32 vcc, s72, v0
  s_or_b64 s[92:93], s[92:93], vcc
  v_accvgpr_read_b32 v0, a7
  v_cmp_eq_u32 vcc, s72, v0
  s_or_b64 s[92:93], s[92:93], vcc
  v_accvgpr_read_b32 v0, a8
  v_cmp_eq_u32 vcc, s72, v0
  s_or_b64 s[92:93], s[92:93], vcc
  v_accvgpr_read_b32 v0, a9
  v_cmp_eq_u32 vcc, s72, v0
  s_or_b64 s[92:93], s[92:93], vcc
  v_accvgpr_read_b32 v0, a10
  v_cmp_eq_u32 vcc, s72, v0
  s_or_b64 s[92:93], s[92:93], vcc
  v_accvgpr_read_b32 v0, a11
  v_cmp_eq_u32 vcc, s72, v0
  s_or_b64 s[92:93], s[92:93], vcc
  v_accvgpr_read_b32 v0, a12
  v_cmp_eq_u32 vcc, s72, v0
  s_or_b64 s[92:93], s[92:93], vcc
  v_accvgpr_read_b32 v0, a13
  v_cmp_eq_u32 vcc, s72, v0
  s_or_b64 s[92:93], s[92:93], vcc
  v_accvgpr_read_b32 v0, a14
  v_cmp_eq_u32 vcc, s72, v0
  s_or_b64 s[92:93], s[92:93], vcc
  v_accvgpr_read_b32 v0, a15
  v_cmp_eq_u32 vcc, s72, v0
  s_or_b64 s[92:93], s[92:93], vcc
  s_cbranch_scc1 L_tagp_l
  s_getreg_b32 s73, hwreg(HW_REG_XCC_ID, 0, 1)
  s_lshl_b32 s73, s73, 31
  s_or_b32 s72, s72, s73
  v_mov_b32 v0, s72
  s_mov_b64 exec, 1
  buffer_store_dword v0, off, s[52:55], 0 sc1
  s_mov_b64 exec, -1
  s_branch L_tagp_r
L_spin_tag:
  s_mov_b32 s75, 0
L_spin_tag_l:
  buffer_load_dword v1, v0, s[52:55], 0 offen sc1
  s_waitcnt vmcnt(0)
  v_cmp_eq_u32 vcc, 0, v1
  s_add_u32 s75, s75, 1
  s_cbranch_vccz L_spin_tag_r
  s_cmp_lt_u32 s75, 1000000
  s_cbranch_scc1 L_spin_tag_l
  s_branch L_spin_tag_r
L_spin_kvg:
  s_mov_b32 s75, 0
L_spin_kvg_l:
  buffer_load_dword v28, v26, s[48:51], s74 offen sc1
  s_waitcnt vmcnt(0)
  v_cmp_ne_u32 vcc, s101, v28
  s_add_u32 s75, s75, 1
  s_cbranch_vccz L_spin_kvg_r
  s_cmp_lt_u32 s75, 1000000
  s_cbranch_scc1 L_spin_kvg_l
  s_branch L_spin_kvg_r
L_pf0g:
  v_max_f32_e64 v48, s68, v29
  v_max_f32_e64 v49, s68, v30
  v_max_f32_e64 v50, s68, v31
  v_max_f32_e64 v51, s68, v14
  v_min_f32 v128, v128, v48
  v_min_f32 v129, v129, v49
  v_min_f32 v130, v130, v50
  v_min_f32 v131, v131, v51
  v_max_f32_e64 v48, s99, v29
  v_max_f32_e64 v49, s99, v30
  v_max_f32_e64 v50, s99, v31
  v_max_f32_e64 v51, s99, v14
  v_min3_f32 v132, v132, v48, s68
  v_min3_f32 v133, v133, v49, s68
  v_min3_f32 v134, v134, v50, s68
  v_min3_f32 v135, v135, v51, s68
  s_nop 1
  s_branch L_pf0g_r
L_pf1g:
  v_max_f32_e64 v48, s20, v29
  v_max_f32_e64 v49, s20, v30
  v_max_f32_e64 v50, s20, v31
  v_max_f32_e64 v51, s20, v14
  v_min3_f32 v128, v128, v48, s99
  v_min3_f32 v129, v129, v49, s99
  v_min3_f32 v130, v130, v50, s99
  v_min3_f32 v131, v131, v51, s99
  v_min3_f32 v132, v132, v29, s20
  v_min3_f32 v133, v133, v30, s20
  v_min3_f32 v134, v134, v31, s20
  v_min3_f32 v135, v135, v14, s20
  s_nop 1
  s_branch L_pf1g_r
L_spin_kvn:
  s_mov_b32 s75, 0
L_spin_kvn_l:
  buffer_load_dword v28, v26, s[48:51], s74 offen sc1
  s_waitcnt vmcnt(0)
  v_cmp_ne_u32 vcc, s101, v28
  s_add_u32 s75, s75, 1
  s_cbranch_vccz L_spin_kvn_r
  s_cmp_lt_u32 s75, 1000000
  s_cbranch_scc1 L_spin_kvn_l
  s_branch L_spin_kvn_r
L_pf0n:
  v_max_f32_e64 v48, s68, v29
  v_max_f32_e64 v49, s68, v30
  v_max_f32_e64 v50, s68, v31
  v_max_f32_e64 v51, s68, v14
  v_min_f32 v128, v128, v48
  v_min_f32 v129, v129, v49
  v_min_f32 v130, v130, v50
  v_min_f32 v131, v131, v51
  v_max_f32_e64 v48, s99, v29
  v_max_f32_e64 v49, s99, v30
  v_max_f32_e64 v50, s99, v31
  v_max_f32_e64 v51, s99, v14
  v_min3_f32 v132, v132, v48, s68
  v_min3_f32 v133, v133, v49, s68
  v_min3_f32 v134, v134, v50, s68
  v_min3_f32 v135, v135, v51, s68
  s_nop 1
  s_branch L_pf0n_r
L_pf1n:
  v_max_f32_e64 v48, s20, v29
  v_max_f32_e64 v49, s20, v30
  v_max_f32_e64 v50, s20, v31
  v_max_f32_e64 v51, s20, v14
  v_min3_f32 v128, v128, v48, s99
  v_min3_f32 v129, v129, v49, s99
  v_min3_f32 v130, v130, v50, s99
  v_min3_f32 v131, v131, v51, s99
  v_min3_f32 v132, v132, v29, s20
  v_min3_f32 v133, v133, v30, s20
  v_min3_f32 v134, v134, v31, s20
  v_min3_f32 v135, v135, v14, s20
  s_nop 1
  s_branch L_pf1n_r
L_spin_h:
  s_mov_b32 s75, 0
L_spin_h_l:
  buffer_load_dword v28, v26, s[48:51], 0 offen sc1
  s_waitcnt vmcnt(0)
  v_cmp_ne_u32 vcc, s101, v28
  s_add_u32 s75, s75, 1
  s_cbranch_vccz L_spin_h_r
  s_cmp_lt_u32 s75, 1000000
  s_cbranch_scc1 L_spin_h_l
  s_branch L_spin_h_r
L_DA_rare:
  s_call_b64 s[86:87], L_rare001
  s_call_b64 s[86:87], L_rare011
  s_call_b64 s[86:87], L_rare101
  s_call_b64 s[86:87], L_rare111
  s_branch L_DA_rarer
L_DB_rare:
  s_call_b64 s[86:87], L_rare000
  s_call_b64 s[86:87], L_rare010
  s_call_b64 s[86:87], L_rare100
  s_call_b64 s[86:87], L_rare110
  s_cmp_lg_u32 s82, s88
  s_cbranch_scc1 L_D
  s_branch L_DB_rarer
L_DpA_rare:
  s_call_b64 s[86:87], L_rare001
  s_call_b64 s[86:87], L_rare011
  s_call_b64 s[86:87], L_rare101
  s_call_b64 s[86:87], L_rare111
  s_branch L_DpA_rarer
L_DpB_rare:
  s_call_b64 s[86:87], L_rare000
  s_call_b64 s[86:87], L_rare010
  s_call_b64 s[86:87], L_rare100
  s_call_b64 s[86:87], L_rare110
  s_branch L_DpB_rarer
L_T1A_rare:
  s_call_b64 s[86:87], L_rare001
  s_call_b64 s[86:87], L_rare011
  s_call_b64 s[86:87], L_rare101
  s_call_b64 s[86:87], L_rare111
  s_branch L_T1A_rarer
L_T1B_rare:
  s_call_b64 s[86:87], L_rare010
  s_call_b64 s[86:87], L_rare100
  s_call_b64 s[86:87], L_rare110
  s_branch L_T1B_rarer
L_T2A_rare:
  s_call_b64 s[86:87], L_rare011
  s_call_b64 s[86:87], L_rare101
  s_call_b64 s[86:87], L_rare111
  s_branch L_T2A_rarer
L_T2B_rare:
  s_call_b64 s[86:87], L_rare100
  s_call_b64 s[86:87], L_rare110
  s_branch L_T2B_rarer
L_SA_rare:
  s_call_b64 s[86:87], L_rare101
  s_call_b64 s[86:87], L_rare111
  s_branch L_SA_rarer
L_SB_rare:
  s_call_b64 s[86:87], L_rare100
  s_call_b64 s[86:87], L_rare110
  s_cmp_lg_u32 s82, s88
  s_cbranch_scc1 L_S
  s_branch L_SB_rarer
L_SpA_rare:
  s_call_b64 s[86:87], L_rare101
  s_call_b64 s[86:87], L_rare111
  s_branch L_SpA_rarer
L_SpB_rare:
  s_call_b64 s[86:87], L_rare100
  s_call_b64 s[86:87], L_rare110
  s_branch L_SpB_rarer
L_E1A_rare:
  s_call_b64 s[86:87], L_rare101
  s_call_b64 s[86:87], L_rare111
  s_branch L_E1A_rarer
L_E1B_rare:
  s_call_b64 s[86:87], L_rare110
  s_branch L_E1B_rarer
L_T0:
  v_max_f32_e64 v248, -s20, v29
  v_max_f32_e64 v249, -s20, v30
  v_max_f32_e64 v250, -s20, v31
  v_max_f32_e64 v251, -s20, v14
  v_min_f32 v136, v136, v248
  v_min_f32 v137, v137, v249
  v_min_f32 v138, v138, v250
  v_min_f32 v139, v139, v251
  v_max_f32_e64 v248, -s99, v29
  v_max_f32_e64 v249, -s99, v30
  v_max_f32_e64 v250, -s99, v31
  v_max_f32_e64 v251, -s99, v14
  v_min3_f32 v140, v140, v248, -s20
  v_min3_f32 v141, v141, v249, -s20
  v_min3_f32 v142, v142, v250, -s20
  v_min3_f32 v143, v143, v251, -s20
  s_nop 1
  s_branch L_T
L_rare000:
  s_nop 15
  v_max3_f32 v236, v64, v65, v66
  v_max3_f32 v236, v236, v67, v68
  v_max3_f32 v236, v236, v69, v70
  v_max_f32 v236, v236, v71
  v_mov_b32 v237, v236
  s_nop 1
  v_permlane32_swap_b32 v236, v237
  v_max_f32 v236, v236, v237
  v_mov_b32 v237, v236
  s_nop 1
  v_permlane16_swap_b32 v236, v237
  v_max_f32 v236, v236, v237
  v_log_f32 v237, v204
  s_nop 0
  v_add_f32 v237, 0xc1300000, v237
  v_max3_f32 v236, 0, v236, v237
  v_exp_f32 v237, -v236
  v_sub_f32 v128, v128, v236
  v_sub_f32 v64, v64, v236
  v_sub_f32 v80, v80, v236
  v_sub_f32 v129, v129, v236
  v_sub_f32 v65, v65, v236
  v_sub_f32 v81, v81, v236
  v_sub_f32 v130, v130, v236
  v_sub_f32 v66, v66, v236
  v_sub_f32 v82, v82, v236
  v_sub_f32 v131, v131, v236
  v_sub_f32 v67, v67, v236
  v_sub_f32 v83, v83, v236
  v_sub_f32 v132, v132, v236
  v_sub_f32 v68, v68, v236
  v_sub_f32 v84, v84, v236
  v_sub_f32 v133, v133, v236
  v_sub_f32 v69, v69, v236
  v_sub_f32 v85, v85, v236
  v_sub_f32 v134, v134, v236
  v_sub_f32 v70, v70, v236
  v_sub_f32 v86, v86, v236
  v_sub_f32 v135, v135, v236
  v_sub_f32 v71, v71, v236
  v_sub_f32 v87, v87, v236
  v_mul_f32 v204, v204, v237
  v_mul_f32 v205, v205, v237
  v_mul_f32 v206, v206, v237
  v_mul_f32 v207, v207, v237
  v_accvgpr_read_b32 v238, a128
  v_accvgpr_read_b32 v239, a129
  v_accvgpr_read_b32 v240, a130
  v_accvgpr_read_b32 v241, a131
  v_mul_f32 v238, v238, v237
  v_mul_f32 v239, v239, v237
  v_mul_f32 v240, v240, v237
  v_mul_f32 v241, v241, v237
  v_accvgpr_write_b32 a128, v238
  v_accvgpr_write_b32 a129, v239
  v_accvgpr_write_b32 a130, v240
  v_accvgpr_write_b32 a131, v241
  v_accvgpr_read_b32 v238, a132
  v_accvgpr_read_b32 v239, a133
  v_accvgpr_read_b32 v240, a134
  v_accvgpr_read_b32 v241, a135
  v_mul_f32 v238, v238, v237
  v_mul_f32 v239, v239, v237
  v_mul_f32 v240, v240, v237
  v_mul_f32 v241, v241, v237
  v_accvgpr_write_b32 a132, v238
  v_accvgpr_write_b32 a133, v239
  v_accvgpr_write_b32 a134, v240
  v_accvgpr_write_b32 a135, v241
  v_accvgpr_read_b32 v238, a136
  v_accvgpr_read_b32 v239, a137
  v_accvgpr_read_b32 v240, a138
  v_accvgpr_read_b32 v241, a139
  v_mul_f32 v238, v238, v237
  v_mul_f32 v239, v239, v237
  v_mul_f32 v240, v240, v237
  v_mul_f32 v241, v241, v237
  v_accvgpr_write_b32 a136, v238
  v_accvgpr_write_b32 a137, v239
  v_accvgpr_write_b32 a138, v240
  v_accvgpr_write_b32 a139, v241
  v_accvgpr_read_b32 v238, a140
  v_accvgpr_read_b32 v239, a141
  v_accvgpr_read_b32 v240, a142
  v_accvgpr_read_b32 v241, a143
  v_mul_f32 v238, v238, v237
  v_mul_f32 v239, v239, v237
  v_mul_f32 v240, v240, v237
  v_mul_f32 v241, v241, v237
  v_accvgpr_write_b32 a140, v238
  v_accvgpr_write_b32 a141, v239
  v_accvgpr_write_b32 a142, v240
  v_accvgpr_write_b32 a143, v241
  v_accvgpr_read_b32 v238, a144
  v_accvgpr_read_b32 v239, a145
  v_accvgpr_read_b32 v240, a146
  v_accvgpr_read_b32 v241, a147
  v_mul_f32 v238, v238, v237
  v_mul_f32 v239, v239, v237
  v_mul_f32 v240, v240, v237
  v_mul_f32 v241, v241, v237
  v_accvgpr_write_b32 a144, v238
  v_accvgpr_write_b32 a145, v239
  v_accvgpr_write_b32 a146, v240
  v_accvgpr_write_b32 a147, v241
  v_accvgpr_read_b32 v238, a148
  v_accvgpr_read_b32 v239, a149
  v_accvgpr_read_b32 v240, a150
  v_accvgpr_read_b32 v241, a151
  v_mul_f32 v238, v238, v237
  v_mul_f32 v239, v239, v237
  v_mul_f32 v240, v240, v237
  v_mul_f32 v241, v241, v237
  v_accvgpr_write_b32 a148, v238
  v_accvgpr_write_b32 a149, v239
  v_accvgpr_write_b32 a150, v240
  v_accvgpr_write_b32 a151, v241
  v_accvgpr_read_b32 v238, a152
  v_accvgpr_read_b32 v239, a153
  v_accvgpr_read_b32 v240, a154
  v_accvgpr_read_b32 v241, a155
  v_mul_f32 v238, v238, v237
  v_mul_f32 v239, v239, v237
  v_mul_f32 v240, v240, v237
  v_mul_f32 v241, v241, v237
  v_accvgpr_write_b32 a152, v238
  v_accvgpr_write_b32 a153, v239
  v_accvgpr_write_b32 a154, v240
  v_accvgpr_write_b32 a155, v241
  v_accvgpr_read_b32 v238, a156
  v_accvgpr_read_b32 v239, a157
  v_accvgpr_read_b32 v240, a158
  v_accvgpr_read_b32 v241, a159
  v_mul_f32 v238, v238, v237
  v_mul_f32 v239, v239, v237
  v_mul_f32 v240, v240, v237
  v_mul_f32 v241, v241, v237
  v_accvgpr_write_b32 a156, v238
  v_accvgpr_write_b32 a157, v239
  v_accvgpr_write_b32 a158, v240
  v_accvgpr_write_b32 a159, v241
  v_exp_f32 v192, v64
  v_exp_f32 v193, v65
  v_exp_f32 v194, v66
  v_cvt_pk_bf16_f32 v160, v192, v193
  v_exp_f32 v195, v67
  v_exp_f32 v196, v68
  v_cvt_pk_bf16_f32 v161, v194, v195
  v_exp_f32 v197, v69
  v_exp_f32 v198, v70
  v_exp_f32 v199, v71
  v_cvt_pk_bf16_f32 v162, v196, v197
  v_cvt_pk_bf16_f32 v163, v198, v199
  s_nop 1
  v_mfma_f32_16x16x32_bf16 v[200:203], v[232:235], v[160:163], v[204:207]
  s_nop 7
  s_setpc_b64 s[86:87]
L_rare001:
  s_nop 15
  v_max3_f32 v236, v80, v81, v82
  v_max3_f32 v236, v236, v83, v84
  v_max3_f32 v236, v236, v85, v86
  v_max_f32 v236, v236, v87
  v_mov_b32 v237, v236
  s_nop 1
  v_permlane32_swap_b32 v236, v237
  v_max_f32 v236, v236, v237
  v_mov_b32 v237, v236
  s_nop 1
  v_permlane16_swap_b32 v236, v237
  v_max_f32 v236, v236, v237
  v_log_f32 v237, v200
  s_nop 0
  v_add_f32 v237, 0xc1300000, v237
  v_max3_f32 v236, 0, v236, v237
  v_exp_f32 v237, -v236
  v_sub_f32 v128, v128, v236
  v_sub_f32 v64, v64, v236
  v_sub_f32 v80, v80, v236
  v_sub_f32 v129, v129, v236
  v_sub_f32 v65, v65, v236
  v_sub_f32 v81, v81, v236
  v_sub_f32 v130, v130, v236
  v_sub_f32 v66, v66, v236
  v_sub_f32 v82, v82, v236
  v_sub_f32 v131, v131, v236
  v_sub_f32 v67, v67, v236
  v_sub_f32 v83, v83, v236
  v_sub_f32 v132, v132, v236
  v_sub_f32 v68, v68, v236
  v_sub_f32 v84, v84, v236
  v_sub_f32 v133, v133, v236
  v_sub_f32 v69, v69, v236
  v_sub_f32 v85, v85, v236
  v_sub_f32 v134, v134, v236
  v_sub_f32 v70, v70, v236
  v_sub_f32 v86, v86, v236
  v_sub_f32 v135, v135, v236
  v_sub_f32 v71, v71, v236
  v_sub_f32 v87, v87, v236
  v_mul_f32 v200, v200, v237
  v_mul_f32 v201, v201, v237
  v_mul_f32 v202, v202, v237
  v_mul_f32 v203, v203, v237
  v_accvgpr_read_b32 v238, a128
  v_accvgpr_read_b32 v239, a129
  v_accvgpr_read_b32 v240, a130
  v_accvgpr_read_b32 v241, a131
  v_mul_f32 v238, v238, v237
  v_mul_f32 v239, v239, v237
  v_mul_f32 v240, v240, v237
  v_mul_f32 v241, v241, v237
  v_accvgpr_write_b32 a128, v238
  v_accvgpr_write_b32 a129, v239
  v_accvgpr_write_b32 a130, v240
  v_accvgpr_write_b32 a131, v241
  v_accvgpr_read_b32 v238, a132
  v_accvgpr_read_b32 v239, a133
  v_accvgpr_read_b32 v240, a134
  v_accvgpr_read_b32 v241, a135
  v_mul_f32 v238, v238, v237
  v_mul_f32 v239, v239, v237
  v_mul_f32 v240, v240, v237
  v_mul_f32 v241, v241, v237
  v_accvgpr_write_b32 a132, v238
  v_accvgpr_write_b32 a133, v239
  v_accvgpr_write_b32 a134, v240
  v_accvgpr_write_b32 a135, v241
  v_accvgpr_read_b32 v238, a136
  v_accvgpr_read_b32 v239, a137
  v_accvgpr_read_b32 v240, a138
  v_accvgpr_read_b32 v241, a139
  v_mul_f32 v238, v238, v237
  v_mul_f32 v239, v239, v237
  v_mul_f32 v240, v240, v237
  v_mul_f32 v241, v241, v237
  v_accvgpr_write_b32 a136, v238
  v_accvgpr_write_b32 a137, v239
  v_accvgpr_write_b32 a138, v240
  v_accvgpr_write_b32 a139, v241
  v_accvgpr_read_b32 v238, a140
  v_accvgpr_read_b32 v239, a141
  v_accvgpr_read_b32 v240, a142
  v_accvgpr_read_b32 v241, a143
  v_mul_f32 v238, v238, v237
  v_mul_f32 v239, v239, v237
  v_mul_f32 v240, v240, v237
  v_mul_f32 v241, v241, v237
  v_accvgpr_write_b32 a140, v238
  v_accvgpr_write_b32 a141, v239
  v_accvgpr_write_b32 a142, v240
  v_accvgpr_write_b32 a143, v241
  v_accvgpr_read_b32 v238, a144
  v_accvgpr_read_b32 v239, a145
  v_accvgpr_read_b32 v240, a146
  v_accvgpr_read_b32 v241, a147
  v_mul_f32 v238, v238, v237
  v_mul_f32 v239, v239, v237
  v_mul_f32 v240, v240, v237
  v_mul_f32 v241, v241, v237
  v_accvgpr_write_b32 a144, v238
  v_accvgpr_write_b32 a145, v239
  v_accvgpr_write_b32 a146, v240
  v_accvgpr_write_b32 a147, v241
  v_accvgpr_read_b32 v238, a148
  v_accvgpr_read_b32 v239, a149
  v_accvgpr_read_b32 v240, a150
  v_accvgpr_read_b32 v241, a151
  v_mul_f32 v238, v238, v237
  v_mul_f32 v239, v239, v237
  v_mul_f32 v240, v240, v237
  v_mul_f32 v241, v241, v237
  v_accvgpr_write_b32 a148, v238
  v_accvgpr_write_b32 a149, v239
  v_accvgpr_write_b32 a150, v240
  v_accvgpr_write_b32 a151, v241
  v_accvgpr_read_b32 v238, a152
  v_accvgpr_read_b32 v239, a153
  v_accvgpr_read_b32 v240, a154
  v_accvgpr_read_b32 v241, a155
  v_mul_f32 v238, v238, v237
  v_mul_f32 v239, v239, v237
  v_mul_f32 v240, v240, v237
  v_mul_f32 v241, v241, v237
  v_accvgpr_write_b32 a152, v238
  v_accvgpr_write_b32 a153, v239
  v_accvgpr_write_b32 a154, v240
  v_accvgpr_write_b32 a155, v241
  v_accvgpr_read_b32 v238, a156
  v_accvgpr_read_b32 v239, a157
  v_accvgpr_read_b32 v240, a158
  v_accvgpr_read_b32 v241, a159
  v_mul_f32 v238, v238, v237
  v_mul_f32 v239, v239, v237
  v_mul_f32 v240, v240, v237
  v_mul_f32 v241, v241, v237
  v_accvgpr_write_b32 a156, v238
  v_accvgpr_write_b32 a157, v239
  v_accvgpr_write_b32 a158, v240
  v_accvgpr_write_b32 a159, v241
  v_exp_f32 v192, v80
  v_exp_f32 v193, v81
  v_exp_f32 v194, v82
  v_cvt_pk_bf16_f32 v168, v192, v193
  v_exp_f32 v195, v83
  v_exp_f32 v196, v84
  v_cvt_pk_bf16_f32 v169, v194, v195
  v_exp_f32 v197, v85
  v_exp_f32 v198, v86
  v_exp_f32 v199, v87
  v_cvt_pk_bf16_f32 v170, v196, v197
  v_cvt_pk_bf16_f32 v171, v198, v199
  s_nop 1
  v_mfma_f32_16x16x32_bf16 v[204:207], v[232:235], v[168:171], v[200:203]
  s_nop 7
  s_setpc_b64 s[86:87]
L_rare010:
  s_nop 15
  v_max3_f32 v236, v72, v73, v74
  v_max3_f32 v236, v236, v75, v76
  v_max3_f32 v236, v236, v77, v78
  v_max_f32 v236, v236, v79
  v_mov_b32 v237, v236
  s_nop 1
  v_permlane32_swap_b32 v236, v237
  v_max_f32 v236, v236, v237
  v_mov_b32 v237, v236
  s_nop 1
  v_permlane16_swap_b32 v236, v237
  v_max_f32 v236, v236, v237
  v_log_f32 v237, v212
  s_nop 0
  v_add_f32 v237, 0xc1300000, v237
  v_max3_f32 v236, 0, v236, v237
  v_exp_f32 v237, -v236
  v_sub_f32 v136, v136, v236
  v_sub_f32 v72, v72, v236
  v_sub_f32 v88, v88, v236
  v_sub_f32 v137, v137, v236
  v_sub_f32 v73, v73, v236
  v_sub_f32 v89, v89, v236
  v_sub_f32 v138, v138, v236
  v_sub_f32 v74, v74, v236
  v_sub_f32 v90, v90, v236
  v_sub_f32 v139, v139, v236
  v_sub_f32 v75, v75, v236
  v_sub_f32 v91, v91, v236
  v_sub_f32 v140, v140, v236
  v_sub_f32 v76, v76, v236
  v_sub_f32 v92, v92, v236
  v_sub_f32 v141, v141, v236
  v_sub_f32 v77, v77, v236
  v_sub_f32 v93, v93, v236
  v_sub_f32 v142, v142, v236
  v_sub_f32 v78, v78, v236
  v_sub_f32 v94, v94, v236
  v_sub_f32 v143, v143, v236
  v_sub_f32 v79, v79, v236
  v_sub_f32 v95, v95, v236
  v_mul_f32 v212, v212, v237
  v_mul_f32 v213, v213, v237
  v_mul_f32 v214, v214, v237
  v_mul_f32 v215, v215, v237
  v_accvgpr_read_b32 v238, a160
  v_accvgpr_read_b32 v239, a161
  v_accvgpr_read_b32 v240, a162
  v_accvgpr_read_b32 v241, a163
  v_mul_f32 v238, v238, v237
  v_mul_f32 v239, v239, v237
  v_mul_f32 v240, v240, v237
  v_mul_f32 v241, v241, v237
  v_accvgpr_write_b32 a160, v238
  v_accvgpr_write_b32 a161, v239
  v_accvgpr_write_b32 a162, v240
  v_accvgpr_write_b32 a163, v241
  v_accvgpr_read_b32 v238, a164
  v_accvgpr_read_b32 v239, a165
  v_accvgpr_read_b32 v240, a166
  v_accvgpr_read_b32 v241, a167
  v_mul_f32 v238, v238, v237
  v_mul_f32 v239, v239, v237
  v_mul_f32 v240, v240, v237
  v_mul_f32 v241, v241, v237
  v_accvgpr_write_b32 a164, v238
  v_accvgpr_write_b32 a165, v239
  v_accvgpr_write_b32 a166, v240
  v_accvgpr_write_b32 a167, v241
  v_accvgpr_read_b32 v238, a168
  v_accvgpr_read_b32 v239, a169
  v_accvgpr_read_b32 v240, a170
  v_accvgpr_read_b32 v241, a171
  v_mul_f32 v238, v238, v237
  v_mul_f32 v239, v239, v237
  v_mul_f32 v240, v240, v237
  v_mul_f32 v241, v241, v237
  v_accvgpr_write_b32 a168, v238
  v_accvgpr_write_b32 a169, v239
  v_accvgpr_write_b32 a170, v240
  v_accvgpr_write_b32 a171, v241
  v_accvgpr_read_b32 v238, a172
  v_accvgpr_read_b32 v239, a173
  v_accvgpr_read_b32 v240, a174
  v_accvgpr_read_b32 v241, a175
  v_mul_f32 v238, v238, v237
  v_mul_f32 v239, v239, v237
  v_mul_f32 v240, v240, v237
  v_mul_f32 v241, v241, v237
  v_accvgpr_write_b32 a172, v238
  v_accvgpr_write_b32 a173, v239
  v_accvgpr_write_b32 a174, v240
  v_accvgpr_write_b32 a175, v241
  v_accvgpr_read_b32 v238, a176
  v_accvgpr_read_b32 v239, a177
  v_accvgpr_read_b32 v240, a178
  v_accvgpr_read_b32 v241, a179
  v_mul_f32 v238, v238, v237
  v_mul_f32 v239, v239, v237
  v_mul_f32 v240, v240, v237
  v_mul_f32 v241, v241, v237
  v_accvgpr_write_b32 a176, v238
  v_accvgpr_write_b32 a177, v239
  v_accvgpr_write_b32 a178, v240
  v_accvgpr_write_b32 a179, v241
  v_accvgpr_read_b32 v238, a180
  v_accvgpr_read_b32 v239, a181
  v_accvgpr_read_b32 v240, a182
  v_accvgpr_read_b32 v241, a183
  v_mul_f32 v238, v238, v237
  v_mul_f32 v239, v239, v237
  v_mul_f32 v240, v240, v237
  v_mul_f32 v241, v241, v237
  v_accvgpr_write_b32 a180, v238
  v_accvgpr_write_b32 a181, v239
  v_accvgpr_write_b32 a182, v240
  v_accvgpr_write_b32 a183, v241
  v_accvgpr_read_b32 v238, a184
  v_accvgpr_read_b32 v239, a185
  v_accvgpr_read_b32 v240, a186
  v_accvgpr_read_b32 v241, a187
  v_mul_f32 v238, v238, v237
  v_mul_f32 v239, v239, v237
  v_mul_f32 v240, v240, v237
  v_mul_f32 v241, v241, v237
  v_accvgpr_write_b32 a184, v238
  v_accvgpr_write_b32 a185, v239
  v_accvgpr_write_b32 a186, v240
  v_accvgpr_write_b32 a187, v241
  v_accvgpr_read_b32 v238, a188
  v_accvgpr_read_b32 v239, a189
  v_accvgpr_read_b32 v240, a190
  v_accvgpr_read_b32 v241, a191
  v_mul_f32 v238, v238, v237
  v_mul_f32 v239, v239, v237
  v_mul_f32 v240, v240, v237
  v_mul_f32 v241, v241, v237
  v_accvgpr_write_b32 a188, v238
  v_accvgpr_write_b32 a189, v239
  v_accvgpr_write_b32 a190, v240
  v_accvgpr_write_b32 a191, v241
  v_exp_f32 v192, v72
  v_exp_f32 v193, v73
  v_exp_f32 v194, v74
  v_cvt_pk_bf16_f32 v164, v192, v193
  v_exp_f32 v195, v75
  v_exp_f32 v196, v76
  v_cvt_pk_bf16_f32 v165, v194, v195
  v_exp_f32 v197, v77
  v_exp_f32 v198, v78
  v_exp_f32 v199, v79
  v_cvt_pk_bf16_f32 v166, v196, v197
  v_cvt_pk_bf16_f32 v167, v198, v199
  s_nop 1
  v_mfma_f32_16x16x32_bf16 v[208:211], v[232:235], v[164:167], v[212:215]
  s_nop 7
  s_setpc_b64 s[86:87]
L_rare011:
  s_nop 15
  v_max3_f32 v236, v88, v89, v90
  v_max3_f32 v236, v236, v91, v92
  v_max3_f32 v236, v236, v93, v94
  v_max_f32 v236, v236, v95
  v_mov_b32 v237, v236
  s_nop 1
  v_permlane32_swap_b32 v236, v237
  v_max_f32 v236, v236, v237
  v_mov_b32 v237, v236
  s_nop 1
  v_permlane16_swap_b32 v236, v237
  v_max_f32 v236, v236, v237
  v_log_f32 v237, v208
  s_nop 0
  v_add_f32 v237, 0xc1300000, v237
  v_max3_f32 v236, 0, v236, v237
  v_exp_f32 v237, -v236
  v_sub_f32 v136, v136, v236
  v_sub_f32 v72, v72, v236
  v_sub_f32 v88, v88, v236
  v_sub_f32 v137, v137, v236
  v_sub_f32 v73, v73, v236
  v_sub_f32 v89, v89, v236
  v_sub_f32 v138, v138, v236
  v_sub_f32 v74, v74, v236
  v_sub_f32 v90, v90, v236
  v_sub_f32 v139, v139, v236
  v_sub_f32 v75, v75, v236
  v_sub_f32 v91, v91, v236
  v_sub_f32 v140, v140, v236
  v_sub_f32 v76, v76, v236
  v_sub_f32 v92, v92, v236
  v_sub_f32 v141, v141, v236
  v_sub_f32 v77, v77, v236
  v_sub_f32 v93, v93, v236
  v_sub_f32 v142, v142, v236
  v_sub_f32 v78, v78, v236
  v_sub_f32 v94, v94, v236
  v_sub_f32 v143, v143, v236
  v_sub_f32 v79, v79, v236
  v_sub_f32 v95, v95, v236
  v_mul_f32 v208, v208, v237
  v_mul_f32 v209, v209, v237
  v_mul_f32 v210, v210, v237
  v_mul_f32 v211, v211, v237
  v_accvgpr_read_b32 v238, a160
  v_accvgpr_read_b32 v239, a161
  v_accvgpr_read_b32 v240, a162
  v_accvgpr_read_b32 v241, a163
  v_mul_f32 v238, v238, v237
  v_mul_f32 v239, v239, v237
  v_mul_f32 v240, v240, v237
  v_mul_f32 v241, v241, v237
  v_accvgpr_write_b32 a160, v238
  v_accvgpr_write_b32 a161, v239
  v_accvgpr_write_b32 a162, v240
  v_accvgpr_write_b32 a163, v241
  v_accvgpr_read_b32 v238, a164
  v_accvgpr_read_b32 v239, a165
  v_accvgpr_read_b32 v240, a166
  v_accvgpr_read_b32 v241, a167
  v_mul_f32 v238, v238, v237
  v_mul_f32 v239, v239, v237
  v_mul_f32 v240, v240, v237
  v_mul_f32 v241, v241, v237
  v_accvgpr_write_b32 a164, v238
  v_accvgpr_write_b32 a165, v239
  v_accvgpr_write_b32 a166, v240
  v_accvgpr_write_b32 a167, v241
  v_accvgpr_read_b32 v238, a168
  v_accvgpr_read_b32 v239, a169
  v_accvgpr_read_b32 v240, a170
  v_accvgpr_read_b32 v241, a171
  v_mul_f32 v238, v238, v237
  v_mul_f32 v239, v239, v237
  v_mul_f32 v240, v240, v237
  v_mul_f32 v241, v241, v237
  v_accvgpr_write_b32 a168, v238
  v_accvgpr_write_b32 a169, v239
  v_accvgpr_write_b32 a170, v240
  v_accvgpr_write_b32 a171, v241
  v_accvgpr_read_b32 v238, a172
  v_accvgpr_read_b32 v239, a173
  v_accvgpr_read_b32 v240, a174
  v_accvgpr_read_b32 v241, a175
  v_mul_f32 v238, v238, v237
  v_mul_f32 v239, v239, v237
  v_mul_f32 v240, v240, v237
  v_mul_f32 v241, v241, v237
  v_accvgpr_write_b32 a172, v238
  v_accvgpr_write_b32 a173, v239
  v_accvgpr_write_b32 a174, v240
  v_accvgpr_write_b32 a175, v241
  v_accvgpr_read_b32 v238, a176
  v_accvgpr_read_b32 v239, a177
  v_accvgpr_read_b32 v240, a178
  v_accvgpr_read_b32 v241, a179
  v_mul_f32 v238, v238, v237
  v_mul_f32 v239, v239, v237
  v_mul_f32 v240, v240, v237
  v_mul_f32 v241, v241, v237
  v_accvgpr_write_b32 a176, v238
  v_accvgpr_write_b32 a177, v239
  v_accvgpr_write_b32 a178, v240
  v_accvgpr_write_b32 a179, v241
  v_accvgpr_read_b32 v238, a180
  v_accvgpr_read_b32 v239, a181
  v_accvgpr_read_b32 v240, a182
  v_accvgpr_read_b32 v241, a183
  v_mul_f32 v238, v238, v237
  v_mul_f32 v239, v239, v237
  v_mul_f32 v240, v240, v237
  v_mul_f32 v241, v241, v237
  v_accvgpr_write_b32 a180, v238
  v_accvgpr_write_b32 a181, v239
  v_accvgpr_write_b32 a182, v240
  v_accvgpr_write_b32 a183, v241
  v_accvgpr_read_b32 v238, a184
  v_accvgpr_read_b32 v239, a185
  v_accvgpr_read_b32 v240, a186
  v_accvgpr_read_b32 v241, a187
  v_mul_f32 v238, v238, v237
  v_mul_f32 v239, v239, v237
  v_mul_f32 v240, v240, v237
  v_mul_f32 v241, v241, v237
  v_accvgpr_write_b32 a184, v238
  v_accvgpr_write_b32 a185, v239
  v_accvgpr_write_b32 a186, v240
  v_accvgpr_write_b32 a187, v241
  v_accvgpr_read_b32 v238, a188
  v_accvgpr_read_b32 v239, a189
  v_accvgpr_read_b32 v240, a190
  v_accvgpr_read_b32 v241, a191
  v_mul_f32 v238, v238, v237
  v_mul_f32 v239, v239, v237
  v_mul_f32 v240, v240, v237
  v_mul_f32 v241, v241, v237
  v_accvgpr_write_b32 a188, v238
  v_accvgpr_write_b32 a189, v239
  v_accvgpr_write_b32 a190, v240
  v_accvgpr_write_b32 a191, v241
  v_exp_f32 v192, v88
  v_exp_f32 v193, v89
  v_exp_f32 v194, v90
  v_cvt_pk_bf16_f32 v172, v192, v193
  v_exp_f32 v195, v91
  v_exp_f32 v196, v92
  v_cvt_pk_bf16_f32 v173, v194, v195
  v_exp_f32 v197, v93
  v_exp_f32 v198, v94
  v_exp_f32 v199, v95
  v_cvt_pk_bf16_f32 v174, v196, v197
  v_cvt_pk_bf16_f32 v175, v198, v199
  s_nop 1
  v_mfma_f32_16x16x32_bf16 v[212:215], v[232:235], v[172:175], v[208:211]
  s_nop 7
  s_setpc_b64 s[86:87]
L_rare100:
  s_nop 15
  v_max3_f32 v236, v96, v97, v98
  v_max3_f32 v236, v236, v99, v100
  v_max3_f32 v236, v236, v101, v102
  v_max_f32 v236, v236, v103
  v_mov_b32 v237, v236
  s_nop 1
  v_permlane32_swap_b32 v236, v237
  v_max_f32 v236, v236, v237
  v_mov_b32 v237, v236
  s_nop 1
  v_permlane16_swap_b32 v236, v237
  v_max_f32 v236, v236, v237
  v_log_f32 v237, v220
  s_nop 0
  v_add_f32 v237, 0xc1300000, v237
  v_max3_f32 v236, 0, v236, v237
  v_exp_f32 v237, -v236
  v_sub_f32 v144, v144, v236
  v_sub_f32 v96, v96, v236
  v_sub_f32 v112, v112, v236
  v_sub_f32 v145, v145, v236
  v_sub_f32 v97, v97, v236
  v_sub_f32 v113, v113, v236
  v_sub_f32 v146, v146, v236
  v_sub_f32 v98, v98, v236
  v_sub_f32 v114, v114, v236
  v_sub_f32 v147, v147, v236
  v_sub_f32 v99, v99, v236
  v_sub_f32 v115, v115, v236
  v_sub_f32 v148, v148, v236
  v_sub_f32 v100, v100, v236
  v_sub_f32 v116, v116, v236
  v_sub_f32 v149, v149, v236
  v_sub_f32 v101, v101, v236
  v_sub_f32 v117, v117, v236
  v_sub_f32 v150, v150, v236
  v_sub_f32 v102, v102, v236
  v_sub_f32 v118, v118, v236
  v_sub_f32 v151, v151, v236
  v_sub_f32 v103, v103, v236
  v_sub_f32 v119, v119, v236
  v_mul_f32 v220, v220, v237
  v_mul_f32 v221, v221, v237
  v_mul_f32 v222, v222, v237
  v_mul_f32 v223, v223, v237
  v_accvgpr_read_b32 v238, a192
  v_accvgpr_read_b32 v239, a193
  v_accvgpr_read_b32 v240, a194
  v_accvgpr_read_b32 v241, a195
  v_mul_f32 v238, v238, v237
  v_mul_f32 v239, v239, v237
  v_mul_f32 v240, v240, v237
  v_mul_f32 v241, v241, v237
  v_accvgpr_write_b32 a192, v238
  v_accvgpr_write_b32 a193, v239
  v_accvgpr_write_b32 a194, v240
  v_accvgpr_write_b32 a195, v241
  v_accvgpr_read_b32 v238, a196
  v_accvgpr_read_b32 v239, a197
  v_accvgpr_read_b32 v240, a198
  v_accvgpr_read_b32 v241, a199
  v_mul_f32 v238, v238, v237
  v_mul_f32 v239, v239, v237
  v_mul_f32 v240, v240, v237
  v_mul_f32 v241, v241, v237
  v_accvgpr_write_b32 a196, v238
  v_accvgpr_write_b32 a197, v239
  v_accvgpr_write_b32 a198, v240
  v_accvgpr_write_b32 a199, v241
  v_accvgpr_read_b32 v238, a200
  v_accvgpr_read_b32 v239, a201
  v_accvgpr_read_b32 v240, a202
  v_accvgpr_read_b32 v241, a203
  v_mul_f32 v238, v238, v237
  v_mul_f32 v239, v239, v237
  v_mul_f32 v240, v240, v237
  v_mul_f32 v241, v241, v237
  v_accvgpr_write_b32 a200, v238
  v_accvgpr_write_b32 a201, v239
  v_accvgpr_write_b32 a202, v240
  v_accvgpr_write_b32 a203, v241
  v_accvgpr_read_b32 v238, a204
  v_accvgpr_read_b32 v239, a205
  v_accvgpr_read_b32 v240, a206
  v_accvgpr_read_b32 v241, a207
  v_mul_f32 v238, v238, v237
  v_mul_f32 v239, v239, v237
  v_mul_f32 v240, v240, v237
  v_mul_f32 v241, v241, v237
  v_accvgpr_write_b32 a204, v238
  v_accvgpr_write_b32 a205, v239
  v_accvgpr_write_b32 a206, v240
  v_accvgpr_write_b32 a207, v241
  v_accvgpr_read_b32 v238, a208
  v_accvgpr_read_b32 v239, a209
  v_accvgpr_read_b32 v240, a210
  v_accvgpr_read_b32 v241, a211
  v_mul_f32 v238, v238, v237
  v_mul_f32 v239, v239, v237
  v_mul_f32 v240, v240, v237
  v_mul_f32 v241, v241, v237
  v_accvgpr_write_b32 a208, v238
  v_accvgpr_write_b32 a209, v239
  v_accvgpr_write_b32 a210, v240
  v_accvgpr_write_b32 a211, v241
  v_accvgpr_read_b32 v238, a212
  v_accvgpr_read_b32 v239, a213
  v_accvgpr_read_b32 v240, a214
  v_accvgpr_read_b32 v241, a215
  v_mul_f32 v238, v238, v237
  v_mul_f32 v239, v239, v237
  v_mul_f32 v240, v240, v237
  v_mul_f32 v241, v241, v237
  v_accvgpr_write_b32 a212, v238
  v_accvgpr_write_b32 a213, v239
  v_accvgpr_write_b32 a214, v240
  v_accvgpr_write_b32 a215, v241
  v_accvgpr_read_b32 v238, a216
  v_accvgpr_read_b32 v239, a217
  v_accvgpr_read_b32 v240, a218
  v_accvgpr_read_b32 v241, a219
  v_mul_f32 v238, v238, v237
  v_mul_f32 v239, v239, v237
  v_mul_f32 v240, v240, v237
  v_mul_f32 v241, v241, v237
  v_accvgpr_write_b32 a216, v238
  v_accvgpr_write_b32 a217, v239
  v_accvgpr_write_b32 a218, v240
  v_accvgpr_write_b32 a219, v241
  v_accvgpr_read_b32 v238, a220
  v_accvgpr_read_b32 v239, a221
  v_accvgpr_read_b32 v240, a222
  v_accvgpr_read_b32 v241, a223
  v_mul_f32 v238, v238, v237
  v_mul_f32 v239, v239, v237
  v_mul_f32 v240, v240, v237
  v_mul_f32 v241, v241, v237
  v_accvgpr_write_b32 a220, v238
  v_accvgpr_write_b32 a221, v239
  v_accvgpr_write_b32 a222, v240
  v_accvgpr_write_b32 a223, v241
  v_exp_f32 v192, v96
  v_exp_f32 v193, v97
  v_exp_f32 v194, v98
  v_cvt_pk_bf16_f32 v176, v192, v193
  v_exp_f32 v195, v99
  v_exp_f32 v196, v100
  v_cvt_pk_bf16_f32 v177, v194, v195
  v_exp_f32 v197, v101
  v_exp_f32 v198, v102
  v_exp_f32 v199, v103
  v_cvt_pk_bf16_f32 v178, v196, v197
  v_cvt_pk_bf16_f32 v179, v198, v199
  s_nop 1
  v_mfma_f32_16x16x32_bf16 v[216:219], v[232:235], v[176:179], v[220:223]
  s_nop 7
  s_setpc_b64 s[86:87]
L_rare101:
  s_nop 15
  v_max3_f32 v236, v112, v113, v114
  v_max3_f32 v236, v236, v115, v116
  v_max3_f32 v236, v236, v117, v118
  v_max_f32 v236, v236, v119
  v_mov_b32 v237, v236
  s_nop 1
  v_permlane32_swap_b32 v236, v237
  v_max_f32 v236, v236, v237
  v_mov_b32 v237, v236
  s_nop 1
  v_permlane16_swap_b32 v236, v237
  v_max_f32 v236, v236, v237
  v_log_f32 v237, v216
  s_nop 0
  v_add_f32 v237, 0xc1300000, v237
  v_max3_f32 v236, 0, v236, v237
  v_exp_f32 v237, -v236
  v_sub_f32 v144, v144, v236
  v_sub_f32 v96, v96, v236
  v_sub_f32 v112, v112, v236
  v_sub_f32 v145, v145, v236
  v_sub_f32 v97, v97, v236
  v_sub_f32 v113, v113, v236
  v_sub_f32 v146, v146, v236
  v_sub_f32 v98, v98, v236
  v_sub_f32 v114, v114, v236
  v_sub_f32 v147, v147, v236
  v_sub_f32 v99, v99, v236
  v_sub_f32 v115, v115, v236
  v_sub_f32 v148, v148, v236
  v_sub_f32 v100, v100, v236
  v_sub_f32 v116, v116, v236
  v_sub_f32 v149, v149, v236
  v_sub_f32 v101, v101, v236
  v_sub_f32 v117, v117, v236
  v_sub_f32 v150, v150, v236
  v_sub_f32 v102, v102, v236
  v_sub_f32 v118, v118, v236
  v_sub_f32 v151, v151, v236
  v_sub_f32 v103, v103, v236
  v_sub_f32 v119, v119, v236
  v_mul_f32 v216, v216, v237
  v_mul_f32 v217, v217, v237
  v_mul_f32 v218, v218, v237
  v_mul_f32 v219, v219, v237
  v_accvgpr_read_b32 v238, a192
  v_accvgpr_read_b32 v239, a193
  v_accvgpr_read_b32 v240, a194
  v_accvgpr_read_b32 v241, a195
  v_mul_f32 v238, v238, v237
  v_mul_f32 v239, v239, v237
  v_mul_f32 v240, v240, v237
  v_mul_f32 v241, v241, v237
  v_accvgpr_write_b32 a192, v238
  v_accvgpr_write_b32 a193, v239
  v_accvgpr_write_b32 a194, v240
  v_accvgpr_write_b32 a195, v241
  v_accvgpr_read_b32 v238, a196
  v_accvgpr_read_b32 v239, a197
  v_accvgpr_read_b32 v240, a198
  v_accvgpr_read_b32 v241, a199
  v_mul_f32 v238, v238, v237
  v_mul_f32 v239, v239, v237
  v_mul_f32 v240, v240, v237
  v_mul_f32 v241, v241, v237
  v_accvgpr_write_b32 a196, v238
  v_accvgpr_write_b32 a197, v239
  v_accvgpr_write_b32 a198, v240
  v_accvgpr_write_b32 a199, v241
  v_accvgpr_read_b32 v238, a200
  v_accvgpr_read_b32 v239, a201
  v_accvgpr_read_b32 v240, a202
  v_accvgpr_read_b32 v241, a203
  v_mul_f32 v238, v238, v237
  v_mul_f32 v239, v239, v237
  v_mul_f32 v240, v240, v237
  v_mul_f32 v241, v241, v237
  v_accvgpr_write_b32 a200, v238
  v_accvgpr_write_b32 a201, v239
  v_accvgpr_write_b32 a202, v240
  v_accvgpr_write_b32 a203, v241
  v_accvgpr_read_b32 v238, a204
  v_accvgpr_read_b32 v239, a205
  v_accvgpr_read_b32 v240, a206
  v_accvgpr_read_b32 v241, a207
  v_mul_f32 v238, v238, v237
  v_mul_f32 v239, v239, v237
  v_mul_f32 v240, v240, v237
  v_mul_f32 v241, v241, v237
  v_accvgpr_write_b32 a204, v238
  v_accvgpr_write_b32 a205, v239
  v_accvgpr_write_b32 a206, v240
  v_accvgpr_write_b32 a207, v241
  v_accvgpr_read_b32 v238, a208
  v_accvgpr_read_b32 v239, a209
  v_accvgpr_read_b32 v240, a210
  v_accvgpr_read_b32 v241, a211
  v_mul_f32 v238, v238, v237
  v_mul_f32 v239, v239, v237
  v_mul_f32 v240, v240, v237
  v_mul_f32 v241, v241, v237
  v_accvgpr_write_b32 a208, v238
  v_accvgpr_write_b32 a209, v239
  v_accvgpr_write_b32 a210, v240
  v_accvgpr_write_b32 a211, v241
  v_accvgpr_read_b32 v238, a212
  v_accvgpr_read_b32 v239, a213
  v_accvgpr_read_b32 v240, a214
  v_accvgpr_read_b32 v241, a215
  v_mul_f32 v238, v238, v237
  v_mul_f32 v239, v239, v237
  v_mul_f32 v240, v240, v237
  v_mul_f32 v241, v241, v237
  v_accvgpr_write_b32 a212, v238
  v_accvgpr_write_b32 a213, v239
  v_accvgpr_write_b32 a214, v240
  v_accvgpr_write_b32 a215, v241
  v_accvgpr_read_b32 v238, a216
  v_accvgpr_read_b32 v239, a217
  v_accvgpr_read_b32 v240, a218
  v_accvgpr_read_b32 v241, a219
  v_mul_f32 v238, v238, v237
  v_mul_f32 v239, v239, v237
  v_mul_f32 v240, v240, v237
  v_mul_f32 v241, v241, v237
  v_accvgpr_write_b32 a216, v238
  v_accvgpr_write_b32 a217, v239
  v_accvgpr_write_b32 a218, v240
  v_accvgpr_write_b32 a219, v241
  v_accvgpr_read_b32 v238, a220
  v_accvgpr_read_b32 v239, a221
  v_accvgpr_read_b32 v240, a222
  v_accvgpr_read_b32 v241, a223
  v_mul_f32 v238, v238, v237
  v_mul_f32 v239, v239, v237
  v_mul_f32 v240, v240, v237
  v_mul_f32 v241, v241, v237
  v_accvgpr_write_b32 a220, v238
  v_accvgpr_write_b32 a221, v239
  v_accvgpr_write_b32 a222, v240
  v_accvgpr_write_b32 a223, v241
  v_exp_f32 v192, v112
  v_exp_f32 v193, v113
  v_exp_f32 v194, v114
  v_cvt_pk_bf16_f32 v184, v192, v193
  v_exp_f32 v195, v115
  v_exp_f32 v196, v116
  v_cvt_pk_bf16_f32 v185, v194, v195
  v_exp_f32 v197, v117
  v_exp_f32 v198, v118
  v_exp_f32 v199, v119
  v_cvt_pk_bf16_f32 v186, v196, v197
  v_cvt_pk_bf16_f32 v187, v198, v199
  s_nop 1
  v_mfma_f32_16x16x32_bf16 v[220:223], v[232:235], v[184:187], v[216:219]
  s_nop 7
  s_setpc_b64 s[86:87]
L_rare110:
  s_nop 15
  v_max3_f32 v236, v104, v105, v106
  v_max3_f32 v236, v236, v107, v108
  v_max3_f32 v236, v236, v109, v110
  v_max_f32 v236, v236, v111
  v_mov_b32 v237, v236
  s_nop 1
  v_permlane32_swap_b32 v236, v237
  v_max_f32 v236, v236, v237
  v_mov_b32 v237, v236
  s_nop 1
  v_permlane16_swap_b32 v236, v237
  v_max_f32 v236, v236, v237
  v_log_f32 v237, v228
  s_nop 0
  v_add_f32 v237, 0xc1300000, v237
  v_max3_f32 v236, 0, v236, v237
  v_exp_f32 v237, -v236
  v_sub_f32 v152, v152, v236
  v_sub_f32 v104, v104, v236
  v_sub_f32 v120, v120, v236
  v_sub_f32 v153, v153, v236
  v_sub_f32 v105, v105, v236
  v_sub_f32 v121, v121, v236
  v_sub_f32 v154, v154, v236
  v_sub_f32 v106, v106, v236
  v_sub_f32 v122, v122, v236
  v_sub_f32 v155, v155, v236
  v_sub_f32 v107, v107, v236
  v_sub_f32 v123, v123, v236
  v_sub_f32 v156, v156, v236
  v_sub_f32 v108, v108, v236
  v_sub_f32 v124, v124, v236
  v_sub_f32 v157, v157, v236
  v_sub_f32 v109, v109, v236
  v_sub_f32 v125, v125, v236
  v_sub_f32 v158, v158, v236
  v_sub_f32 v110, v110, v236
  v_sub_f32 v126, v126, v236
  v_sub_f32 v159, v159, v236
  v_sub_f32 v111, v111, v236
  v_sub_f32 v127, v127, v236
  v_mul_f32 v228, v228, v237
  v_mul_f32 v229, v229, v237
  v_mul_f32 v230, v230, v237
  v_mul_f32 v231, v231, v237
  v_accvgpr_read_b32 v238, a224
  v_accvgpr_read_b32 v239, a225
  v_accvgpr_read_b32 v240, a226
  v_accvgpr_read_b32 v241, a227
  v_mul_f32 v238, v238, v237
  v_mul_f32 v239, v239, v237
  v_mul_f32 v240, v240, v237
  v_mul_f32 v241, v241, v237
  v_accvgpr_write_b32 a224, v238
  v_accvgpr_write_b32 a225, v239
  v_accvgpr_write_b32 a226, v240
  v_accvgpr_write_b32 a227, v241
  v_accvgpr_read_b32 v238, a228
  v_accvgpr_read_b32 v239, a229
  v_accvgpr_read_b32 v240, a230
  v_accvgpr_read_b32 v241, a231
  v_mul_f32 v238, v238, v237
  v_mul_f32 v239, v239, v237
  v_mul_f32 v240, v240, v237
  v_mul_f32 v241, v241, v237
  v_accvgpr_write_b32 a228, v238
  v_accvgpr_write_b32 a229, v239
  v_accvgpr_write_b32 a230, v240
  v_accvgpr_write_b32 a231, v241
  v_accvgpr_read_b32 v238, a232
  v_accvgpr_read_b32 v239, a233
  v_accvgpr_read_b32 v240, a234
  v_accvgpr_read_b32 v241, a235
  v_mul_f32 v238, v238, v237
  v_mul_f32 v239, v239, v237
  v_mul_f32 v240, v240, v237
  v_mul_f32 v241, v241, v237
  v_accvgpr_write_b32 a232, v238
  v_accvgpr_write_b32 a233, v239
  v_accvgpr_write_b32 a234, v240
  v_accvgpr_write_b32 a235, v241
  v_accvgpr_read_b32 v238, a236
  v_accvgpr_read_b32 v239, a237
  v_accvgpr_read_b32 v240, a238
  v_accvgpr_read_b32 v241, a239
  v_mul_f32 v238, v238, v237
  v_mul_f32 v239, v239, v237
  v_mul_f32 v240, v240, v237
  v_mul_f32 v241, v241, v237
  v_accvgpr_write_b32 a236, v238
  v_accvgpr_write_b32 a237, v239
  v_accvgpr_write_b32 a238, v240
  v_accvgpr_write_b32 a239, v241
  v_accvgpr_read_b32 v238, a240
  v_accvgpr_read_b32 v239, a241
  v_accvgpr_read_b32 v240, a242
  v_accvgpr_read_b32 v241, a243
  v_mul_f32 v238, v238, v237
  v_mul_f32 v239, v239, v237
  v_mul_f32 v240, v240, v237
  v_mul_f32 v241, v241, v237
  v_accvgpr_write_b32 a240, v238
  v_accvgpr_write_b32 a241, v239
  v_accvgpr_write_b32 a242, v240
  v_accvgpr_write_b32 a243, v241
  v_accvgpr_read_b32 v238, a244
  v_accvgpr_read_b32 v239, a245
  v_accvgpr_read_b32 v240, a246
  v_accvgpr_read_b32 v241, a247
  v_mul_f32 v238, v238, v237
  v_mul_f32 v239, v239, v237
  v_mul_f32 v240, v240, v237
  v_mul_f32 v241, v241, v237
  v_accvgpr_write_b32 a244, v238
  v_accvgpr_write_b32 a245, v239
  v_accvgpr_write_b32 a246, v240
  v_accvgpr_write_b32 a247, v241
  v_accvgpr_read_b32 v238, a248
  v_accvgpr_read_b32 v239, a249
  v_accvgpr_read_b32 v240, a250
  v_accvgpr_read_b32 v241, a251
  v_mul_f32 v238, v238, v237
  v_mul_f32 v239, v239, v237
  v_mul_f32 v240, v240, v237
  v_mul_f32 v241, v241, v237
  v_accvgpr_write_b32 a248, v238
  v_accvgpr_write_b32 a249, v239
  v_accvgpr_write_b32 a250, v240
  v_accvgpr_write_b32 a251, v241
  v_accvgpr_read_b32 v238, a252
  v_accvgpr_read_b32 v239, a253
  v_accvgpr_read_b32 v240, a254
  v_accvgpr_read_b32 v241, a255
  v_mul_f32 v238, v238, v237
  v_mul_f32 v239, v239, v237
  v_mul_f32 v240, v240, v237
  v_mul_f32 v241, v241, v237
  v_accvgpr_write_b32 a252, v238
  v_accvgpr_write_b32 a253, v239
  v_accvgpr_write_b32 a254, v240
  v_accvgpr_write_b32 a255, v241
  v_exp_f32 v192, v104
  v_exp_f32 v193, v105
  v_exp_f32 v194, v106
  v_cvt_pk_bf16_f32 v180, v192, v193
  v_exp_f32 v195, v107
  v_exp_f32 v196, v108
  v_cvt_pk_bf16_f32 v181, v194, v195
  v_exp_f32 v197, v109
  v_exp_f32 v198, v110
  v_exp_f32 v199, v111
  v_cvt_pk_bf16_f32 v182, v196, v197
  v_cvt_pk_bf16_f32 v183, v198, v199
  s_nop 1
  v_mfma_f32_16x16x32_bf16 v[224:227], v[232:235], v[180:183], v[228:231]
  s_nop 7
  s_setpc_b64 s[86:87]
L_rare111:
  s_nop 15
  v_max3_f32 v236, v120, v121, v122
  v_max3_f32 v236, v236, v123, v124
  v_max3_f32 v236, v236, v125, v126
  v_max_f32 v236, v236, v127
  v_mov_b32 v237, v236
  s_nop 1
  v_permlane32_swap_b32 v236, v237
  v_max_f32 v236, v236, v237
  v_mov_b32 v237, v236
  s_nop 1
  v_permlane16_swap_b32 v236, v237
  v_max_f32 v236, v236, v237
  v_log_f32 v237, v224
  s_nop 0
  v_add_f32 v237, 0xc1300000, v237
  v_max3_f32 v236, 0, v236, v237
  v_exp_f32 v237, -v236
  v_sub_f32 v152, v152, v236
  v_sub_f32 v104, v104, v236
  v_sub_f32 v120, v120, v236
  v_sub_f32 v153, v153, v236
  v_sub_f32 v105, v105, v236
  v_sub_f32 v121, v121, v236
  v_sub_f32 v154, v154, v236
  v_sub_f32 v106, v106, v236
  v_sub_f32 v122, v122, v236
  v_sub_f32 v155, v155, v236
  v_sub_f32 v107, v107, v236
  v_sub_f32 v123, v123, v236
  v_sub_f32 v156, v156, v236
  v_sub_f32 v108, v108, v236
  v_sub_f32 v124, v124, v236
  v_sub_f32 v157, v157, v236
  v_sub_f32 v109, v109, v236
  v_sub_f32 v125, v125, v236
  v_sub_f32 v158, v158, v236
  v_sub_f32 v110, v110, v236
  v_sub_f32 v126, v126, v236
  v_sub_f32 v159, v159, v236
  v_sub_f32 v111, v111, v236
  v_sub_f32 v127, v127, v236
  v_mul_f32 v224, v224, v237
  v_mul_f32 v225, v225, v237
  v_mul_f32 v226, v226, v237
  v_mul_f32 v227, v227, v237
  v_accvgpr_read_b32 v238, a224
  v_accvgpr_read_b32 v239, a225
  v_accvgpr_read_b32 v240, a226
  v_accvgpr_read_b32 v241, a227
  v_mul_f32 v238, v238, v237
  v_mul_f32 v239, v239, v237
  v_mul_f32 v240, v240, v237
  v_mul_f32 v241, v241, v237
  v_accvgpr_write_b32 a224, v238
  v_accvgpr_write_b32 a225, v239
  v_accvgpr_write_b32 a226, v240
  v_accvgpr_write_b32 a227, v241
  v_accvgpr_read_b32 v238, a228
  v_accvgpr_read_b32 v239, a229
  v_accvgpr_read_b32 v240, a230
  v_accvgpr_read_b32 v241, a231
  v_mul_f32 v238, v238, v237
  v_mul_f32 v239, v239, v237
  v_mul_f32 v240, v240, v237
  v_mul_f32 v241, v241, v237
  v_accvgpr_write_b32 a228, v238
  v_accvgpr_write_b32 a229, v239
  v_accvgpr_write_b32 a230, v240
  v_accvgpr_write_b32 a231, v241
  v_accvgpr_read_b32 v238, a232
  v_accvgpr_read_b32 v239, a233
  v_accvgpr_read_b32 v240, a234
  v_accvgpr_read_b32 v241, a235
  v_mul_f32 v238, v238, v237
  v_mul_f32 v239, v239, v237
  v_mul_f32 v240, v240, v237
  v_mul_f32 v241, v241, v237
  v_accvgpr_write_b32 a232, v238
  v_accvgpr_write_b32 a233, v239
  v_accvgpr_write_b32 a234, v240
  v_accvgpr_write_b32 a235, v241
  v_accvgpr_read_b32 v238, a236
  v_accvgpr_read_b32 v239, a237
  v_accvgpr_read_b32 v240, a238
  v_accvgpr_read_b32 v241, a239
  v_mul_f32 v238, v238, v237
  v_mul_f32 v239, v239, v237
  v_mul_f32 v240, v240, v237
  v_mul_f32 v241, v241, v237
  v_accvgpr_write_b32 a236, v238
  v_accvgpr_write_b32 a237, v239
  v_accvgpr_write_b32 a238, v240
  v_accvgpr_write_b32 a239, v241
  v_accvgpr_read_b32 v238, a240
  v_accvgpr_read_b32 v239, a241
  v_accvgpr_read_b32 v240, a242
  v_accvgpr_read_b32 v241, a243
  v_mul_f32 v238, v238, v237
  v_mul_f32 v239, v239, v237
  v_mul_f32 v240, v240, v237
  v_mul_f32 v241, v241, v237
  v_accvgpr_write_b32 a240, v238
  v_accvgpr_write_b32 a241, v239
  v_accvgpr_write_b32 a242, v240
  v_accvgpr_write_b32 a243, v241
  v_accvgpr_read_b32 v238, a244
  v_accvgpr_read_b32 v239, a245
  v_accvgpr_read_b32 v240, a246
  v_accvgpr_read_b32 v241, a247
  v_mul_f32 v238, v238, v237
  v_mul_f32 v239, v239, v237
  v_mul_f32 v240, v240, v237
  v_mul_f32 v241, v241, v237
  v_accvgpr_write_b32 a244, v238
  v_accvgpr_write_b32 a245, v239
  v_accvgpr_write_b32 a246, v240
  v_accvgpr_write_b32 a247, v241
  v_accvgpr_read_b32 v238, a248
  v_accvgpr_read_b32 v239, a249
  v_accvgpr_read_b32 v240, a250
  v_accvgpr_read_b32 v241, a251
  v_mul_f32 v238, v238, v237
  v_mul_f32 v239, v239, v237
  v_mul_f32 v240, v240, v237
  v_mul_f32 v241, v241, v237
  v_accvgpr_write_b32 a248, v238
  v_accvgpr_write_b32 a249, v239
  v_accvgpr_write_b32 a250, v240
  v_accvgpr_write_b32 a251, v241
  v_accvgpr_read_b32 v238, a252
  v_accvgpr_read_b32 v239, a253
  v_accvgpr_read_b32 v240, a254
  v_accvgpr_read_b32 v241, a255
  v_mul_f32 v238, v238, v237
  v_mul_f32 v239, v239, v237
  v_mul_f32 v240, v240, v237
  v_mul_f32 v241, v241, v237
  v_accvgpr_write_b32 a252, v238
  v_accvgpr_write_b32 a253, v239
  v_accvgpr_write_b32 a254, v240
  v_accvgpr_write_b32 a255, v241
  v_exp_f32 v192, v120
  v_exp_f32 v193, v121
  v_exp_f32 v194, v122
  v_cvt_pk_bf16_f32 v188, v192, v193
  v_exp_f32 v195, v123
  v_exp_f32 v196, v124
  v_cvt_pk_bf16_f32 v189, v194, v195
  v_exp_f32 v197, v125
  v_exp_f32 v198, v126
  v_exp_f32 v199, v127
  v_cvt_pk_bf16_f32 v190, v196, v197
  v_cvt_pk_bf16_f32 v191, v198, v199
  s_nop 1
  v_mfma_f32_16x16x32_bf16 v[228:231], v[232:235], v[188:191], v[224:227]
  s_nop 7
  s_setpc_b64 s[86:87]
L_E2_rare:
  s_call_b64 s[86:87], L_rare111
  s_branch L_E2_rarer
L_f2:
  s_waitcnt vmcnt(4)
  v_cmp_ne_u32 vcc, s101, v27
  s_cbranch_vccz L_spin_c_r
L_spin_c:
  s_mov_b32 s75, 0
L_spin_c_l:
  buffer_load_dword v28, v15, s[48:51], s74 offen sc1
  s_waitcnt vmcnt(0)
  v_cmp_ne_u32 vcc, s101, v28
  s_add_u32 s75, s75, 1
  s_cbranch_vccz L_spin_c_r
  s_cmp_lt_u32 s75, 1000000
  s_cbranch_scc1 L_spin_c_l
  s_branch L_spin_c_r
  s_endpgm
.fill 2048, 4, 0xbf800000
.section .rodata,"a"
.p2align 6
.amdhsa_kernel gated_mix__compressed_kv_cla__glu_gated_glu__prompt_kernel
  .amdhsa_next_free_vgpr 512
  .amdhsa_next_free_sgpr 102
  .amdhsa_accum_offset 256
  .amdhsa_group_segment_fixed_size 0
  .amdhsa_kernarg_size 112
  .amdhsa_user_sgpr_count 2
  .amdhsa_user_sgpr_kernarg_segment_ptr 1
  .amdhsa_system_sgpr_workgroup_id_x 1
.end_amdhsa_kernel
```
